```python
import torch

def _softmax(x, axis=-1):
    return torch.softmax(x, dim=axis)
def _gelu(x):
    return torch.nn.functional.gelu(x, approximate="tanh")
def _silu(x):
    return torch.nn.functional.silu(x)
def _sigmoid(x):
    return torch.sigmoid(x)
def _layernorm(x, axis=-1, eps=1e-5):
    m = x.mean(dim=axis, keepdim=True)
    v = x.var(dim=axis, keepdim=True, unbiased=False)
    return (x - m) / torch.sqrt(v + eps)
def _scatter_add(tgt, idx, src, axis=0):
    return tgt.clone().index_add_(axis, idx, src)
def _segment_sum(src, seg, n):
    out = torch.zeros((n,) + src.shape[1:], dtype=src.dtype)
    return out.index_add_(0, seg, src)
def _pad(x, pw):
    flat = tuple(v for pair in reversed(pw) for v in pair)
    return torch.nn.functional.pad(x, flat)

kernel_name = 'standalone__mha_block_cached__near_ridge'

def setup_inputs():

    _w = (lambda a: (lambda t: t.to(torch.bfloat16) if t.is_floating_point() else t)(torch.as_tensor(a)))
    B, Sq, D = 8, 240, 640
    H, Sk, Dh = 32, 1024, 128
    return {
        "x": _w((lambda *s: torch.randn(*s, dtype=torch.bfloat16) * 0.8)(B, Sq, D)),
        "k_cache": _w((lambda *s: torch.randn(*s, dtype=torch.bfloat16) * 0.8)(B, H, Sk, Dh)),
        "v_cache": _w((lambda *s: torch.randn(*s, dtype=torch.bfloat16) * 0.05)(B, H, Sk, Dh)),
        "wq": _w((lambda *s: torch.randn(*s, dtype=torch.bfloat16) * 0.8)(D, H * Dh) * (D ** -0.5)),
        "wo": _w((lambda *s: torch.randn(*s, dtype=torch.bfloat16) * 0.05)(H * Dh, D) * ((H * Dh) ** -0.5)),
    }

def reference(x, k_cache, v_cache, wq, wo):
    B, Sq, D = x.shape
    H, Dh = 32, 128
    q = (lambda x, *d: x.permute(*d))((x @ wq).reshape(B, Sq, H, Dh), 0, 2, 1, 3)
    scores = torch.einsum("bhqd,bhkd->bhqk", q, k_cache) * (Dh ** -0.5)
    p = _softmax(scores, axis=-1)
    o = torch.einsum("bhqk,bhkd->bhqd", p, v_cache)
    return (lambda x, *d: x.permute(*d))(o, 0, 2, 1, 3).reshape(B, Sq, H * Dh) @ wo
```

```asm
; @launch grid=(256,1,1) block=(256,1,1) lds=163840
.amdgcn_target "amdgcn-amd-amdhsa--gfx950"
.text
.globl standalone__mha_block_cached__near_ridge_kernel
.p2align 8
.type standalone__mha_block_cached__near_ridge_kernel,@function
standalone__mha_block_cached__near_ridge_kernel:
    s_cmp_ge_u32 s2, 0x100
    s_cbranch_scc1 L_end
    s_load_dwordx8 s[36:43], s[0:1], 0
    s_load_dwordx8 s[44:51], s[0:1], 32
    s_getpc_b64 s[72:73]
L_pc0:
    s_lshr_b32 s67, s2, 3
    s_lshl_b32 s67, s67, 12
    v_lshrrev_b32 v3, 6, v0
    v_and_b32 v1, 7, v0
    v_lshl_add_u32 v1, v3, 3, v1
    v_lshl_add_u32 v1, v1, 7, s67
    v_min_u32 v1, L_codeend-L_pc0-4, v1
    s_mov_b64 exec, 0xff
    global_load_dword v40, v1, s[72:73]
    s_mov_b64 exec, -1
    v_and_b32 v0, 63, v0
    v_readfirstlane_b32 s52, v3
    s_and_b32 s67, s2, 7
    s_lshr_b32 s68, s2, 3
    s_and_b32 s54, s67, 1
    s_lshl_b32 s54, s54, 2
    s_and_b32 s69, s68, 3
    s_add_u32 s54, s54, s69
    s_lshr_b32 s55, s67, 1
    s_lshl_b32 s55, s55, 3
    s_lshr_b32 s69, s68, 2
    s_add_u32 s55, s55, s69
    s_lshl_b32 s53, s52, 12
    v_lshrrev_b32 v3, 4, v0
    v_lshlrev_b32 v4, 1, v3
    v_and_b32 v5, 15, v0
    v_xor_b32 v4, v4, v5
    s_lshl_b32 s69, s52, 17
    v_lshlrev_b32 v6, 13, v3
    v_add_u32 v6, s69, v6
    v_xor_b32 v7, 0, v4
    v_lshl_add_u32 v7, v7, 4, v6
    v_add_u32 v56, 0, v7
    v_xor_b32 v7, 0, v4
    v_lshl_add_u32 v7, v7, 4, v6
    v_add_u32 v57, 0x7c00, v7
    v_xor_b32 v7, 8, v4
    v_lshl_add_u32 v7, v7, 4, v6
    v_add_u32 v58, 0xf800, v7
    v_xor_b32 v7, 8, v4
    v_lshl_add_u32 v7, v7, 4, v6
    v_add_u32 v59, 0x17400, v7
    s_mul_i32 s69, s52, 0x14000
    v_lshrrev_b32 v6, 3, v0
    v_mul_u32_u24 v6, 0x500, v6
    v_add_u32 v6, s69, v6
    v_and_b32 v4, 7, v0
    v_xor_b32 v4, v4, v3
    v_xor_b32 v7, 0, v4
    v_lshl_add_u32 v7, v7, 4, v6
    v_add_u32 v60, 0, v7
    v_xor_b32 v7, 4, v4
    v_lshl_add_u32 v7, v7, 4, v6
    v_add_u32 v61, 0x2400, v7
    s_mul_i32 s67, s54, 0x4b000
    s_waitcnt lgkmcnt(0)
    s_add_u32 s4, s36, s67
    s_addc_u32 s5, s37, 0
    s_mov_b32 s6, 0x4b000
    s_mov_b32 s7, 0x20000
    s_lshl_b32 s67, s55, 8
    s_sub_u32 s68, 0x500000, s67
    s_add_u32 s8, s42, s67
    s_addc_u32 s9, s43, 0
    s_mov_b32 s10, s68
    s_mov_b32 s11, 0x20000
    s_add_u32 m0, s53, 0x24000
    s_mov_b32 s65, 0
    buffer_load_dwordx4 v56, s[8:11], s65 offen lds
    buffer_load_dwordx4 v57, s[8:11], s65 offen offset:1024 lds
    buffer_load_dwordx4 v58, s[8:11], s65 offen offset:2048 lds
    buffer_load_dwordx4 v59, s[8:11], s65 offen offset:3072 lds
    s_add_u32 m0, s53, 0x10000
    s_mov_b32 s63, 0
    buffer_load_dwordx4 v60, s[4:7], s63 offen lds
    buffer_load_dwordx4 v61, s[4:7], s63 offen offset:1024 lds
    s_add_u32 m0, s53, 0x10800
    s_mov_b32 s63, 0x5000
    buffer_load_dwordx4 v60, s[4:7], s63 offen lds
    buffer_load_dwordx4 v61, s[4:7], s63 offen offset:1024 lds
    s_add_u32 m0, s53, 0x8000
    s_mov_b32 s63, 0xa000
    buffer_load_dwordx4 v60, s[4:7], s63 offen lds
    buffer_load_dwordx4 v61, s[4:7], s63 offen offset:1024 lds
    s_add_u32 m0, s53, 0x8800
    s_mov_b32 s63, 0xf000
    buffer_load_dwordx4 v60, s[4:7], s63 offen lds
    buffer_load_dwordx4 v61, s[4:7], s63 offen offset:1024 lds
    s_mul_i32 s67, s54, 0x1e0
    s_add_u32 s67, s67, s55
    s_lshl_b32 s67, s67, 12
    s_add_u32 s20, s50, s67
    s_addc_u32 s21, s51, 0
    s_mov_b32 s22, 0x1c1000
    s_mov_b32 s23, 0x20000
    s_add_u32 s32, s48, 0
    s_addc_u32 s33, s49, 0
    s_mov_b32 s34, 0x100
    s_mov_b32 s35, 0x20000
    s_mov_b32 s56, 0
    s_mov_b32 s57, 0x20000
    s_mov_b32 s58, 0x40000
    s_mov_b32 s59, 0x60000
    s_mov_b32 s60, 0x80000
    s_mov_b32 s71, 0
    s_mov_b32 s70, 0x3e0293ee
    v_lshrrev_b32 v3, 4, v0
    v_and_b32 v4, 15, v0
    v_lshlrev_b32 v5, 1, v3
    v_xor_b32 v5, v5, v4
    v_lshlrev_b32 v6, 8, v3
    v_add_u32 v6, s53, v6
    v_xor_b32 v7, 0, v5
    v_lshl_add_u32 v24, v7, 4, v6
    v_xor_b32 v7, 8, v5
    v_lshl_add_u32 v25, v7, 4, v6
    v_xor_b32 v5, v3, v4
    v_xor_b32 v7, 0, v5
    v_lshl_add_u32 v20, v7, 4, v6
    v_xor_b32 v7, 4, v5
    v_lshl_add_u32 v21, v7, 4, v6
    v_xor_b32 v7, 8, v5
    v_lshl_add_u32 v22, v7, 4, v6
    v_xor_b32 v7, 12, v5
    v_lshl_add_u32 v23, v7, 4, v6
    v_lshlrev_b32 v6, 8, v4
    v_xor_b32 v7, 0, v5
    v_lshl_add_u32 v8, v7, 4, v6
    v_xor_b32 v7, 4, v5
    v_lshl_add_u32 v9, v7, 4, v6
    v_xor_b32 v7, 8, v5
    v_lshl_add_u32 v10, v7, 4, v6
    v_xor_b32 v7, 12, v5
    v_lshl_add_u32 v11, v7, 4, v6
    v_lshrrev_b32 v5, 1, v4
    v_xor_b32 v5, v5, v3
    v_lshlrev_b32 v6, 7, v4
    v_add_u32 v6, s53, v6
    v_add_u32 v6, 0x8000, v6
    v_xor_b32 v7, 0, v5
    v_lshl_add_u32 v62, v7, 4, v6
    v_xor_b32 v7, 4, v5
    v_lshl_add_u32 v63, v7, 4, v6
    s_lshl_b32 s67, s52, 19
    v_lshlrev_b32 v5, 4, v0
    v_add_u32 v47, s67, v5
    v_and_b32 v5, 3, v0
    v_cmp_eq_u32 vcc, 0, v5
    v_mov_b32 v6, 0x3f803f80
    s_nop 0
    v_cndmask_b32 v28, 0, v6, vcc
    v_mov_b32 v29, v28
    v_mov_b32 v30, v28
    v_mov_b32 v31, v28
    v_bfe_u32 v5, v0, 2, 2
    v_and_b32 v6, 3, v0
    v_lshlrev_b32 v6, 3, v6
    v_lshl_add_u32 v6, v5, 8, v6
    v_and_b32 v4, 1, v3
    v_lshl_or_b32 v5, v4, 2, v5
    v_lshl_add_u32 v4, v3, 10, v6
    v_add_u32 v4, 0x10000, v4
    v_lshl_add_u32 v6, v3, 11, v6
    v_add_u32 v6, 0x1c000, v6
    v_xor_b32 v7, 0, v5
    v_lshl_add_u32 v12, v7, 5, v4
    v_lshl_add_u32 v48, v7, 5, v6
    v_xor_b32 v7, 1, v5
    v_lshl_add_u32 v13, v7, 5, v4
    v_lshl_add_u32 v49, v7, 5, v6
    v_xor_b32 v7, 2, v5
    v_lshl_add_u32 v14, v7, 5, v4
    v_lshl_add_u32 v50, v7, 5, v6
    v_xor_b32 v7, 3, v5
    v_lshl_add_u32 v15, v7, 5, v4
    v_lshl_add_u32 v51, v7, 5, v6
    v_xor_b32 v7, 4, v5
    v_lshl_add_u32 v16, v7, 5, v4
    v_lshl_add_u32 v52, v7, 5, v6
    v_xor_b32 v7, 5, v5
    v_lshl_add_u32 v17, v7, 5, v4
    v_lshl_add_u32 v53, v7, 5, v6
    v_xor_b32 v7, 6, v5
    v_lshl_add_u32 v18, v7, 5, v4
    v_lshl_add_u32 v54, v7, 5, v6
    v_xor_b32 v7, 7, v5
    v_lshl_add_u32 v19, v7, 5, v4
    v_lshl_add_u32 v55, v7, 5, v6
    s_lshr_b32 s68, s2, 3
    s_mul_i32 s75, s68, 52
    s_lshr_b32 s75, s75, 8
    s_mul_i32 s62, s75, 5
    s_sub_u32 s62, s68, s62
    s_bfe_u32 s68, s2, 0x10001
    s_mul_i32 s68, s68, 5
    s_add_u32 s62, s62, s68
    s_bfe_u32 s67, s2, 0x10002
    s_mul_i32 s67, s67, 6
    s_add_u32 s67, s67, s75
    s_lshl_b32 s67, s67, 1
    s_and_b32 s68, s2, 1
    s_add_u32 s61, s67, s68
    s_mul_i32 s69, s52, 0xa0000
    v_lshrrev_b32 v4, 3, v0
    v_mul_u32_u24 v4, 0x500, v4
    v_add_u32 v4, s69, v4
    v_lshlrev_b32 v5, 1, v3
    v_and_b32 v6, 7, v0
    v_xor_b32 v5, v5, v6
    v_lshl_add_u32 v32, v5, 4, v4
    v_add_u32 v33, 0x2400, v32
    v_add_u32 v34, 0x4800, v32
    v_add_u32 v35, 0x6c00, v32
    s_mul_i32 s68, s68, 0x280000
    s_lshl_b32 s67, s62, 7
    s_add_u32 s67, s67, s68
    s_cmp_lt_u32 s2, 0xf0
    s_cselect_b32 s68, 0x27fb80, 0
    s_add_u32 s24, s44, s67
    s_addc_u32 s25, s45, 0
    s_mov_b32 s26, s68
    s_mov_b32 s27, 0x20000
    s_add_u32 m0, s53, 0x1c000
    s_mov_b32 s65, 0x80000
    buffer_load_dwordx4 v56, s[8:11], s65 offen lds
    buffer_load_dwordx4 v57, s[8:11], s65 offen offset:1024 lds
    buffer_load_dwordx4 v58, s[8:11], s65 offen offset:2048 lds
    buffer_load_dwordx4 v59, s[8:11], s65 offen offset:3072 lds
    s_add_u32 m0, s53, 0xc000
    s_mov_b32 s63, 0x80
    buffer_load_dwordx4 v60, s[4:7], s63 offen lds
    buffer_load_dwordx4 v61, s[4:7], s63 offen offset:1024 lds
    s_add_u32 m0, s53, 0xc800
    s_mov_b32 s63, 0x5080
    buffer_load_dwordx4 v60, s[4:7], s63 offen lds
    buffer_load_dwordx4 v61, s[4:7], s63 offen offset:1024 lds
    s_add_u32 m0, s53, 0x14000
    s_mov_b32 s63, 0xa080
    buffer_load_dwordx4 v60, s[4:7], s63 offen lds
    buffer_load_dwordx4 v61, s[4:7], s63 offen offset:1024 lds
    s_add_u32 m0, s53, 0x14800
    s_mov_b32 s63, 0xf080
    buffer_load_dwordx4 v60, s[4:7], s63 offen lds
    buffer_load_dwordx4 v61, s[4:7], s63 offen offset:1024 lds
    s_lshl_b32 s67, s2, 2
    s_add_u32 s67, s67, s52
    s_mul_i32 s68, s67, 0x1000
    s_add_u32 s68, s68, 0x100000
    s_mul_i32 s67, s67, 15
    s_mov_b32 s69, 0x20000001
    s_mov_b32 s12, s36
    s_mov_b32 s13, s37
    s_mov_b32 s14, 0x258000
    s_mov_b32 s15, 0x20000
    s_mov_b32 s16, s42
    s_mov_b32 s17, s43
    s_mov_b32 s18, 0x500000
    s_mov_b32 s19, 0x20000
    v_add_u32 v3, s67, v0
    v_mul_hi_u32 v4, v3, s69
    v_mul_u32_u24 v5, 8, v4
    v_sub_u32 v3, v3, v5
    v_add_u32 v3, 2, v3
    v_lshlrev_b32 v3, 7, v3
    v_mul_u32_u24 v4, 0x500, v4
    v_add_u32 v3, v3, v4
    v_cmp_gt_u32 vcc, 15, v0
    s_nop 1
    v_cndmask_b32 v3, -1, v3, vcc
    v_lshlrev_b32 v4, 7, v0
    v_cmp_gt_u32 vcc, 32, v0
    s_nop 1
    v_cndmask_b32 v4, -1, v4, vcc
    buffer_load_dword v42, v4, s[16:19], s68 offen
    buffer_load_dword v43, v3, s[12:15], 0 offen
    s_lshl_b32 s67, s54, 5
    s_add_u32 s67, s67, s55
    s_lshl_b32 s67, s67, 18
    s_add_u32 s12, s38, s67
    s_addc_u32 s13, s39, 0
    s_mov_b32 s14, 0x40000
    s_mov_b32 s15, 0x20000
    s_add_u32 s16, s40, s67
    s_addc_u32 s17, s41, 0
    s_mov_b32 s18, 0x40000
    s_mov_b32 s19, 0x20000
    v_lshlrev_b32 v46, 7, v0
    s_or_b32 s67, s2, s52
    s_cbranch_scc1 L_notag
    s_memrealtime s[72:73]
    s_waitcnt lgkmcnt(0)
    s_or_b32 s67, s72, 1
    v_mov_b32 v2, s67
    v_mov_b32 v3, 0
    s_mov_b64 exec, 1
    buffer_store_dword v2, v3, s[32:35], 0 offen sc1
    s_mov_b64 exec, -1
L_notag:
    s_waitcnt vmcnt(14)
    s_barrier
    s_cmp_eq_u32 s52, 3
    s_cbranch_scc1 L_w3
    ds_read_b64_tr_b16 a[0:1], v48 offset:32768
    ds_read_b64_tr_b16 a[2:3], v48 offset:33792
    ds_read_b64_tr_b16 a[4:5], v48 offset:40960
    ds_read_b64_tr_b16 a[6:7], v48 offset:41984
    ds_read_b128 a[64:67], v62 offset:32768
    ds_read_b128 a[68:71], v63 offset:32768
    ds_read_b128 a[72:75], v62 offset:34816
    ds_read_b128 a[76:79], v63 offset:34816
    ds_read_b128 a[80:83], v62
    ds_read_b128 a[84:87], v63
    ds_read_b128 a[88:91], v62 offset:2048
    ds_read_b128 a[92:95], v63 offset:2048
    ds_read_b64_tr_b16 a[8:9], v49 offset:32768
    ds_read_b64_tr_b16 a[10:11], v49 offset:33792
    ds_read_b64_tr_b16 a[12:13], v49 offset:40960
    ds_read_b64_tr_b16 a[14:15], v49 offset:41984
    s_waitcnt lgkmcnt(11)
    v_mfma_f32_16x16x32_bf16 v[128:131], a[0:3], a[64:67], 0
    ds_read_b64_tr_b16 a[16:17], v50 offset:32768
    s_add_u32 m0, s53, 0x20000
    s_waitcnt lgkmcnt(11)
    v_mfma_f32_16x16x32_bf16 v[128:131], a[4:7], a[68:71], v[128:131]
    ds_read_b64_tr_b16 a[18:19], v50 offset:33792
    s_mov_b32 s65, 0x100000
    s_waitcnt lgkmcnt(11)
    v_mfma_f32_16x16x32_bf16 v[160:163], a[0:3], a[72:75], 0
    ds_read_b64_tr_b16 a[20:21], v50 offset:40960
    buffer_load_dwordx4 v56, s[8:11], s65 offen lds
    s_waitcnt lgkmcnt(11)
    v_mfma_f32_16x16x32_bf16 v[160:163], a[4:7], a[76:79], v[160:163]
    ds_read_b64_tr_b16 a[22:23], v50 offset:41984
    s_waitcnt lgkmcnt(11)
    v_mfma_f32_16x16x32_bf16 v[192:195], a[0:3], a[80:83], 0
    ds_read_b64_tr_b16 a[24:25], v51 offset:32768
    s_waitcnt lgkmcnt(11)
    v_mfma_f32_16x16x32_bf16 v[192:195], a[4:7], a[84:87], v[192:195]
    ds_read_b64_tr_b16 a[26:27], v51 offset:33792
    s_waitcnt lgkmcnt(11)
    v_mfma_f32_16x16x32_bf16 v[224:227], a[0:3], a[88:91], 0
    ds_read_b64_tr_b16 a[28:29], v51 offset:40960
    s_waitcnt lgkmcnt(10)
    v_mfma_f32_16x16x32_bf16 v[224:227], a[4:7], a[92:95], v[224:227]
    ds_read_b64_tr_b16 a[30:31], v51 offset:41984
    buffer_load_dwordx4 v57, s[8:11], s65 offen offset:1024 lds
    s_waitcnt lgkmcnt(8)
    v_mfma_f32_16x16x32_bf16 v[132:135], a[8:11], a[64:67], 0
    ds_read_b64_tr_b16 a[32:33], v52 offset:32768
    v_mfma_f32_16x16x32_bf16 v[132:135], a[12:15], a[68:71], v[132:135]
    ds_read_b64_tr_b16 a[34:35], v52 offset:33792
    v_mfma_f32_16x16x32_bf16 v[164:167], a[8:11], a[72:75], 0
    ds_read_b64_tr_b16 a[36:37], v52 offset:40960
    v_mfma_f32_16x16x32_bf16 v[164:167], a[12:15], a[76:79], v[164:167]
    ds_read_b64_tr_b16 a[38:39], v52 offset:41984
    v_mfma_f32_16x16x32_bf16 v[196:199], a[8:11], a[80:83], 0
    ds_read_b64_tr_b16 a[40:41], v53 offset:32768
    buffer_load_dwordx4 v58, s[8:11], s65 offen offset:2048 lds
    v_mfma_f32_16x16x32_bf16 v[196:199], a[12:15], a[84:87], v[196:199]
    ds_read_b64_tr_b16 a[42:43], v53 offset:33792
    v_mfma_f32_16x16x32_bf16 v[228:231], a[8:11], a[88:91], 0
    ds_read_b64_tr_b16 a[44:45], v53 offset:40960
    v_mfma_f32_16x16x32_bf16 v[228:231], a[12:15], a[92:95], v[228:231]
    ds_read_b64_tr_b16 a[46:47], v53 offset:41984
    s_waitcnt lgkmcnt(8)
    v_mfma_f32_16x16x32_bf16 v[136:139], a[16:19], a[64:67], 0
    ds_read_b64_tr_b16 a[48:49], v54 offset:32768
    v_mfma_f32_16x16x32_bf16 v[136:139], a[20:23], a[68:71], v[136:139]
    ds_read_b64_tr_b16 a[50:51], v54 offset:33792
    buffer_load_dwordx4 v59, s[8:11], s65 offen offset:3072 lds
    v_mfma_f32_16x16x32_bf16 v[168:171], a[16:19], a[72:75], 0
    ds_read_b64_tr_b16 a[52:53], v54 offset:40960
    v_mfma_f32_16x16x32_bf16 v[168:171], a[20:23], a[76:79], v[168:171]
    ds_read_b64_tr_b16 a[54:55], v54 offset:41984
    s_add_u32 m0, s53, 0x10000
    v_mfma_f32_16x16x32_bf16 v[200:203], a[16:19], a[80:83], 0
    ds_read_b64_tr_b16 a[56:57], v55 offset:32768
    s_mov_b32 s63, 0x100
    v_mfma_f32_16x16x32_bf16 v[200:203], a[20:23], a[84:87], v[200:203]
    ds_read_b64_tr_b16 a[58:59], v55 offset:33792
    buffer_load_dwordx4 v60, s[4:7], s63 offen lds
    v_mfma_f32_16x16x32_bf16 v[232:235], a[16:19], a[88:91], 0
    ds_read_b64_tr_b16 a[60:61], v55 offset:40960
    v_mfma_f32_16x16x32_bf16 v[232:235], a[20:23], a[92:95], v[232:235]
    ds_read_b64_tr_b16 a[62:63], v55 offset:41984
    v_mfma_f32_16x16x32_bf16 v[140:143], a[24:27], a[64:67], 0
    v_mfma_f32_16x16x32_bf16 v[140:143], a[28:31], a[68:71], v[140:143]
    v_mfma_f32_16x16x32_bf16 v[172:175], a[24:27], a[72:75], 0
    buffer_load_dwordx4 v61, s[4:7], s63 offen offset:1024 lds
    v_mfma_f32_16x16x32_bf16 v[172:175], a[28:31], a[76:79], v[172:175]
    v_mfma_f32_16x16x32_bf16 v[204:207], a[24:27], a[80:83], 0
    s_waitcnt vmcnt(16) lgkmcnt(0)
    s_barrier
    v_mfma_f32_16x16x32_bf16 v[204:207], a[28:31], a[84:87], v[204:207]
    ds_read_b64_tr_b16 a[0:1], v48
    s_add_u32 m0, s53, 0x10800
    v_mfma_f32_16x16x32_bf16 v[236:239], a[24:27], a[88:91], 0
    s_mov_b32 s63, 0x5100
    v_mfma_f32_16x16x32_bf16 v[236:239], a[28:31], a[92:95], v[236:239]
    ds_read_b64_tr_b16 a[2:3], v48 offset:1024
    buffer_load_dwordx4 v60, s[4:7], s63 offen lds
    v_mfma_f32_16x16x32_bf16 v[144:147], a[32:35], a[64:67], 0
    v_mfma_f32_16x16x32_bf16 v[144:147], a[36:39], a[68:71], v[144:147]
    ds_read_b64_tr_b16 a[4:5], v48 offset:8192
    v_mfma_f32_16x16x32_bf16 v[176:179], a[32:35], a[72:75], 0
    v_mfma_f32_16x16x32_bf16 v[176:179], a[36:39], a[76:79], v[176:179]
    ds_read_b64_tr_b16 a[6:7], v48 offset:9216
    v_mfma_f32_16x16x32_bf16 v[208:211], a[32:35], a[80:83], 0
    buffer_load_dwordx4 v61, s[4:7], s63 offen offset:1024 lds
    v_mfma_f32_16x16x32_bf16 v[208:211], a[36:39], a[84:87], v[208:211]
    ds_read_b64_tr_b16 a[8:9], v49
    v_mfma_f32_16x16x32_bf16 v[240:243], a[32:35], a[88:91], 0
    v_mfma_f32_16x16x32_bf16 v[240:243], a[36:39], a[92:95], v[240:243]
    ds_read_b64_tr_b16 a[10:11], v49 offset:1024
    s_add_u32 m0, s53, 0x8000
    v_mfma_f32_16x16x32_bf16 v[148:151], a[40:43], a[64:67], 0
    s_mov_b32 s63, 0xa100
    v_mfma_f32_16x16x32_bf16 v[148:151], a[44:47], a[68:71], v[148:151]
    ds_read_b64_tr_b16 a[12:13], v49 offset:8192
    buffer_load_dwordx4 v60, s[4:7], s63 offen lds
    v_mfma_f32_16x16x32_bf16 v[180:183], a[40:43], a[72:75], 0
    v_mfma_f32_16x16x32_bf16 v[180:183], a[44:47], a[76:79], v[180:183]
    ds_read_b64_tr_b16 a[14:15], v49 offset:9216
    v_mfma_f32_16x16x32_bf16 v[212:215], a[40:43], a[80:83], 0
    s_waitcnt vmcnt(17)
    ds_read_b128 a[96:99], v62 offset:16384
    v_mfma_f32_16x16x32_bf16 v[212:215], a[44:47], a[84:87], v[212:215]
    ds_read_b64_tr_b16 a[16:17], v50
    v_mfma_f32_16x16x32_bf16 v[244:247], a[40:43], a[88:91], 0
    ds_read_b128 a[100:103], v63 offset:16384
    buffer_load_dwordx4 v61, s[4:7], s63 offen offset:1024 lds
    v_mfma_f32_16x16x32_bf16 v[244:247], a[44:47], a[92:95], v[244:247]
    ds_read_b64_tr_b16 a[18:19], v50 offset:1024
    v_mfma_f32_16x16x32_bf16 v[152:155], a[48:51], a[64:67], 0
    s_waitcnt vmcnt(16)
    ds_read_b128 a[104:107], v62 offset:18432
    v_mfma_f32_16x16x32_bf16 v[152:155], a[52:55], a[68:71], v[152:155]
    ds_read_b64_tr_b16 a[20:21], v50 offset:8192
    s_add_u32 m0, s53, 0x8800
    v_mfma_f32_16x16x32_bf16 v[184:187], a[48:51], a[72:75], 0
    ds_read_b128 a[108:111], v63 offset:18432
    s_mov_b32 s63, 0xf100
    v_mfma_f32_16x16x32_bf16 v[184:187], a[52:55], a[76:79], v[184:187]
    ds_read_b64_tr_b16 a[22:23], v50 offset:9216
    buffer_load_dwordx4 v60, s[4:7], s63 offen lds
    v_mfma_f32_16x16x32_bf16 v[216:219], a[48:51], a[80:83], 0
    s_waitcnt vmcnt(15)
    ds_read_b128 a[112:115], v62 offset:49152
    v_mfma_f32_16x16x32_bf16 v[216:219], a[52:55], a[84:87], v[216:219]
    ds_read_b64_tr_b16 a[24:25], v51
    v_mfma_f32_16x16x32_bf16 v[248:251], a[48:51], a[88:91], 0
    ds_read_b128 a[116:119], v63 offset:49152
    v_mfma_f32_16x16x32_bf16 v[248:251], a[52:55], a[92:95], v[248:251]
    ds_read_b64_tr_b16 a[26:27], v51 offset:1024
    v_mfma_f32_16x16x32_bf16 v[156:159], a[56:59], a[64:67], 0
    s_waitcnt vmcnt(13)
    ds_read_b128 a[120:123], v62 offset:51200
    v_mfma_f32_16x16x32_bf16 v[156:159], a[60:63], a[68:71], v[156:159]
    ds_read_b64_tr_b16 a[28:29], v51 offset:8192
    buffer_load_dwordx4 v61, s[4:7], s63 offen offset:1024 lds
    v_mfma_f32_16x16x32_bf16 v[188:191], a[56:59], a[72:75], 0
    ds_read_b128 a[124:127], v63 offset:51200
    v_mfma_f32_16x16x32_bf16 v[188:191], a[60:63], a[76:79], v[188:191]
    ds_read_b64_tr_b16 a[30:31], v51 offset:9216
    v_mfma_f32_16x16x32_bf16 v[220:223], a[56:59], a[80:83], 0
    v_mfma_f32_16x16x32_bf16 v[220:223], a[60:63], a[84:87], v[220:223]
    v_mfma_f32_16x16x32_bf16 v[252:255], a[56:59], a[88:91], 0
    v_mfma_f32_16x16x32_bf16 v[252:255], a[60:63], a[92:95], v[252:255]
    s_waitcnt lgkmcnt(4)
    v_mfma_f32_16x16x32_bf16 v[128:131], a[0:3], a[96:99], v[128:131]
    ds_read_b64_tr_b16 a[32:33], v52
    s_add_u32 m0, s53, 0x24000
    v_mfma_f32_16x16x32_bf16 v[128:131], a[4:7], a[100:103], v[128:131]
    ds_read_b64_tr_b16 a[34:35], v52 offset:1024
    s_mov_b32 s65, 0x180000
    v_mfma_f32_16x16x32_bf16 v[160:163], a[0:3], a[104:107], v[160:163]
    ds_read_b64_tr_b16 a[36:37], v52 offset:8192
    buffer_load_dwordx4 v56, s[8:11], s65 offen lds
    v_mfma_f32_16x16x32_bf16 v[160:163], a[4:7], a[108:111], v[160:163]
    v_mfma_f32_16x16x32_bf16 v[192:195], a[0:3], a[112:115], v[192:195]
    ds_read_b64_tr_b16 a[38:39], v52 offset:9216
    v_mfma_f32_16x16x32_bf16 v[192:195], a[4:7], a[116:119], v[192:195]
    ds_read_b64_tr_b16 a[40:41], v53
    s_waitcnt lgkmcnt(5)
    v_mfma_f32_16x16x32_bf16 v[224:227], a[0:3], a[120:123], v[224:227]
    ds_read_b64_tr_b16 a[42:43], v53 offset:1024
    v_mfma_f32_16x16x32_bf16 v[224:227], a[4:7], a[124:127], v[224:227]
    buffer_load_dwordx4 v57, s[8:11], s65 offen offset:1024 lds
    v_mfma_f32_16x16x32_bf16 v[132:135], a[8:11], a[96:99], v[132:135]
    ds_read_b64_tr_b16 a[44:45], v53 offset:8192
    v_mfma_f32_16x16x32_bf16 v[132:135], a[12:15], a[100:103], v[132:135]
    ds_read_b64_tr_b16 a[46:47], v53 offset:9216
    v_mfma_f32_16x16x32_bf16 v[164:167], a[8:11], a[104:107], v[164:167]
    ds_read_b64_tr_b16 a[48:49], v54
    v_mfma_f32_16x16x32_bf16 v[164:167], a[12:15], a[108:111], v[164:167]
    v_mfma_f32_16x16x32_bf16 v[196:199], a[8:11], a[112:115], v[196:199]
    ds_read_b64_tr_b16 a[50:51], v54 offset:1024
    buffer_load_dwordx4 v58, s[8:11], s65 offen offset:2048 lds
    v_mfma_f32_16x16x32_bf16 v[196:199], a[12:15], a[116:119], v[196:199]
    ds_read_b64_tr_b16 a[52:53], v54 offset:8192
    v_mfma_f32_16x16x32_bf16 v[228:231], a[8:11], a[120:123], v[228:231]
    ds_read_b64_tr_b16 a[54:55], v54 offset:9216
    v_mfma_f32_16x16x32_bf16 v[228:231], a[12:15], a[124:127], v[228:231]
    v_mfma_f32_16x16x32_bf16 v[136:139], a[16:19], a[96:99], v[136:139]
    ds_read_b64_tr_b16 a[56:57], v55
    v_mfma_f32_16x16x32_bf16 v[136:139], a[20:23], a[100:103], v[136:139]
    ds_read_b64_tr_b16 a[58:59], v55 offset:1024
    buffer_load_dwordx4 v59, s[8:11], s65 offen offset:3072 lds
    v_mfma_f32_16x16x32_bf16 v[168:171], a[16:19], a[104:107], v[168:171]
    ds_read_b64_tr_b16 a[60:61], v55 offset:8192
    v_mfma_f32_16x16x32_bf16 v[168:171], a[20:23], a[108:111], v[168:171]
    s_add_u32 m0, s53, 0xc000
    s_mov_b32 s63, 0x180
    v_mfma_f32_16x16x32_bf16 v[200:203], a[16:19], a[112:115], v[200:203]
    ds_read_b64_tr_b16 a[62:63], v55 offset:9216
    buffer_load_dwordx4 v60, s[4:7], s63 offen lds
    v_mfma_f32_16x16x32_bf16 v[200:203], a[20:23], a[116:119], v[200:203]
    v_mfma_f32_16x16x32_bf16 v[232:235], a[16:19], a[120:123], v[232:235]
    v_mfma_f32_16x16x32_bf16 v[232:235], a[20:23], a[124:127], v[232:235]
    v_mfma_f32_16x16x32_bf16 v[140:143], a[24:27], a[96:99], v[140:143]
    v_mfma_f32_16x16x32_bf16 v[140:143], a[28:31], a[100:103], v[140:143]
    v_mfma_f32_16x16x32_bf16 v[172:175], a[24:27], a[104:107], v[172:175]
    buffer_load_dwordx4 v61, s[4:7], s63 offen offset:1024 lds
    v_mfma_f32_16x16x32_bf16 v[172:175], a[28:31], a[108:111], v[172:175]
    v_mfma_f32_16x16x32_bf16 v[204:207], a[24:27], a[112:115], v[204:207]
    s_waitcnt vmcnt(14) lgkmcnt(0)
    s_barrier
    v_mfma_f32_16x16x32_bf16 v[204:207], a[28:31], a[116:119], v[204:207]
    ds_read_b64_tr_b16 a[0:1], v48 offset:16384
    s_add_u32 m0, s53, 0xc800
    v_mfma_f32_16x16x32_bf16 v[236:239], a[24:27], a[120:123], v[236:239]
    s_mov_b32 s63, 0x5180
    v_mfma_f32_16x16x32_bf16 v[236:239], a[28:31], a[124:127], v[236:239]
    ds_read_b64_tr_b16 a[2:3], v48 offset:17408
    buffer_load_dwordx4 v60, s[4:7], s63 offen lds
    v_mfma_f32_16x16x32_bf16 v[144:147], a[32:35], a[96:99], v[144:147]
    v_mfma_f32_16x16x32_bf16 v[144:147], a[36:39], a[100:103], v[144:147]
    ds_read_b64_tr_b16 a[4:5], v48 offset:24576
    v_mfma_f32_16x16x32_bf16 v[176:179], a[32:35], a[104:107], v[176:179]
    v_mfma_f32_16x16x32_bf16 v[176:179], a[36:39], a[108:111], v[176:179]
    ds_read_b64_tr_b16 a[6:7], v48 offset:25600
    v_mfma_f32_16x16x32_bf16 v[208:211], a[32:35], a[112:115], v[208:211]
    buffer_load_dwordx4 v61, s[4:7], s63 offen offset:1024 lds
    v_mfma_f32_16x16x32_bf16 v[208:211], a[36:39], a[116:119], v[208:211]
    ds_read_b64_tr_b16 a[8:9], v49 offset:16384
    v_mfma_f32_16x16x32_bf16 v[240:243], a[32:35], a[120:123], v[240:243]
    v_mfma_f32_16x16x32_bf16 v[240:243], a[36:39], a[124:127], v[240:243]
    ds_read_b64_tr_b16 a[10:11], v49 offset:17408
    s_add_u32 m0, s53, 0x14000
    v_mfma_f32_16x16x32_bf16 v[148:151], a[40:43], a[96:99], v[148:151]
    s_mov_b32 s63, 0xa180
    v_mfma_f32_16x16x32_bf16 v[148:151], a[44:47], a[100:103], v[148:151]
    ds_read_b64_tr_b16 a[12:13], v49 offset:24576
    buffer_load_dwordx4 v60, s[4:7], s63 offen lds
    v_mfma_f32_16x16x32_bf16 v[180:183], a[40:43], a[104:107], v[180:183]
    v_mfma_f32_16x16x32_bf16 v[180:183], a[44:47], a[108:111], v[180:183]
    ds_read_b64_tr_b16 a[14:15], v49 offset:25600
    v_mfma_f32_16x16x32_bf16 v[212:215], a[40:43], a[112:115], v[212:215]
    s_waitcnt vmcnt(15)
    ds_read_b128 a[64:67], v62 offset:32768
    v_mfma_f32_16x16x32_bf16 v[212:215], a[44:47], a[116:119], v[212:215]
    ds_read_b64_tr_b16 a[16:17], v50 offset:16384
    v_mfma_f32_16x16x32_bf16 v[244:247], a[40:43], a[120:123], v[244:247]
    ds_read_b128 a[68:71], v63 offset:32768
    buffer_load_dwordx4 v61, s[4:7], s63 offen offset:1024 lds
    v_mfma_f32_16x16x32_bf16 v[244:247], a[44:47], a[124:127], v[244:247]
    ds_read_b64_tr_b16 a[18:19], v50 offset:17408
    v_mfma_f32_16x16x32_bf16 v[152:155], a[48:51], a[96:99], v[152:155]
    s_waitcnt vmcnt(14)
    ds_read_b128 a[72:75], v62 offset:34816
    v_mfma_f32_16x16x32_bf16 v[152:155], a[52:55], a[100:103], v[152:155]
    ds_read_b64_tr_b16 a[20:21], v50 offset:24576
    s_add_u32 m0, s53, 0x14800
    v_mfma_f32_16x16x32_bf16 v[184:187], a[48:51], a[104:107], v[184:187]
    ds_read_b128 a[76:79], v63 offset:34816
    s_mov_b32 s63, 0xf180
    v_mfma_f32_16x16x32_bf16 v[184:187], a[52:55], a[108:111], v[184:187]
    ds_read_b64_tr_b16 a[22:23], v50 offset:25600
    buffer_load_dwordx4 v60, s[4:7], s63 offen lds
    v_mfma_f32_16x16x32_bf16 v[216:219], a[48:51], a[112:115], v[216:219]
    s_waitcnt vmcnt(13)
    ds_read_b128 a[80:83], v62
    v_mfma_f32_16x16x32_bf16 v[216:219], a[52:55], a[116:119], v[216:219]
    ds_read_b64_tr_b16 a[24:25], v51 offset:16384
    v_mfma_f32_16x16x32_bf16 v[248:251], a[48:51], a[120:123], v[248:251]
    ds_read_b128 a[84:87], v63
    v_mfma_f32_16x16x32_bf16 v[248:251], a[52:55], a[124:127], v[248:251]
    ds_read_b64_tr_b16 a[26:27], v51 offset:17408
    v_mfma_f32_16x16x32_bf16 v[156:159], a[56:59], a[96:99], v[156:159]
    s_waitcnt vmcnt(11)
    ds_read_b128 a[88:91], v62 offset:2048
    v_mfma_f32_16x16x32_bf16 v[156:159], a[60:63], a[100:103], v[156:159]
    ds_read_b64_tr_b16 a[28:29], v51 offset:24576
    buffer_load_dwordx4 v61, s[4:7], s63 offen offset:1024 lds
    v_mfma_f32_16x16x32_bf16 v[188:191], a[56:59], a[104:107], v[188:191]
    ds_read_b128 a[92:95], v63 offset:2048
    v_mfma_f32_16x16x32_bf16 v[188:191], a[60:63], a[108:111], v[188:191]
    ds_read_b64_tr_b16 a[30:31], v51 offset:25600
    v_mfma_f32_16x16x32_bf16 v[220:223], a[56:59], a[112:115], v[220:223]
    v_mfma_f32_16x16x32_bf16 v[220:223], a[60:63], a[116:119], v[220:223]
    v_mfma_f32_16x16x32_bf16 v[252:255], a[56:59], a[120:123], v[252:255]
    v_mfma_f32_16x16x32_bf16 v[252:255], a[60:63], a[124:127], v[252:255]
    s_waitcnt lgkmcnt(4)
    v_mfma_f32_16x16x32_bf16 v[128:131], a[0:3], a[64:67], v[128:131]
    ds_read_b64_tr_b16 a[32:33], v52 offset:16384
    s_add_u32 m0, s53, 0x1c000
    v_mfma_f32_16x16x32_bf16 v[128:131], a[4:7], a[68:71], v[128:131]
    ds_read_b64_tr_b16 a[34:35], v52 offset:17408
    s_mov_b32 s65, 0x200000
    v_mfma_f32_16x16x32_bf16 v[160:163], a[0:3], a[72:75], v[160:163]
    ds_read_b64_tr_b16 a[36:37], v52 offset:24576
    buffer_load_dwordx4 v56, s[8:11], s65 offen lds
    v_mfma_f32_16x16x32_bf16 v[160:163], a[4:7], a[76:79], v[160:163]
    v_mfma_f32_16x16x32_bf16 v[192:195], a[0:3], a[80:83], v[192:195]
    ds_read_b64_tr_b16 a[38:39], v52 offset:25600
    v_mfma_f32_16x16x32_bf16 v[192:195], a[4:7], a[84:87], v[192:195]
    ds_read_b64_tr_b16 a[40:41], v53 offset:16384
    s_waitcnt lgkmcnt(5)
    v_mfma_f32_16x16x32_bf16 v[224:227], a[0:3], a[88:91], v[224:227]
    ds_read_b64_tr_b16 a[42:43], v53 offset:17408
    v_mfma_f32_16x16x32_bf16 v[224:227], a[4:7], a[92:95], v[224:227]
    buffer_load_dwordx4 v57, s[8:11], s65 offen offset:1024 lds
    v_mfma_f32_16x16x32_bf16 v[132:135], a[8:11], a[64:67], v[132:135]
    ds_read_b64_tr_b16 a[44:45], v53 offset:24576
    v_mfma_f32_16x16x32_bf16 v[132:135], a[12:15], a[68:71], v[132:135]
    ds_read_b64_tr_b16 a[46:47], v53 offset:25600
    v_mfma_f32_16x16x32_bf16 v[164:167], a[8:11], a[72:75], v[164:167]
    ds_read_b64_tr_b16 a[48:49], v54 offset:16384
    v_mfma_f32_16x16x32_bf16 v[164:167], a[12:15], a[76:79], v[164:167]
    v_mfma_f32_16x16x32_bf16 v[196:199], a[8:11], a[80:83], v[196:199]
    ds_read_b64_tr_b16 a[50:51], v54 offset:17408
    buffer_load_dwordx4 v58, s[8:11], s65 offen offset:2048 lds
    v_mfma_f32_16x16x32_bf16 v[196:199], a[12:15], a[84:87], v[196:199]
    ds_read_b64_tr_b16 a[52:53], v54 offset:24576
    v_mfma_f32_16x16x32_bf16 v[228:231], a[8:11], a[88:91], v[228:231]
    ds_read_b64_tr_b16 a[54:55], v54 offset:25600
    v_mfma_f32_16x16x32_bf16 v[228:231], a[12:15], a[92:95], v[228:231]
    v_mfma_f32_16x16x32_bf16 v[136:139], a[16:19], a[64:67], v[136:139]
    ds_read_b64_tr_b16 a[56:57], v55 offset:16384
    v_mfma_f32_16x16x32_bf16 v[136:139], a[20:23], a[68:71], v[136:139]
    ds_read_b64_tr_b16 a[58:59], v55 offset:17408
    buffer_load_dwordx4 v59, s[8:11], s65 offen offset:3072 lds
    v_mfma_f32_16x16x32_bf16 v[168:171], a[16:19], a[72:75], v[168:171]
    ds_read_b64_tr_b16 a[60:61], v55 offset:24576
    v_mfma_f32_16x16x32_bf16 v[168:171], a[20:23], a[76:79], v[168:171]
    s_add_u32 m0, s53, 0x10000
    s_mov_b32 s63, 0x200
    v_mfma_f32_16x16x32_bf16 v[200:203], a[16:19], a[80:83], v[200:203]
    ds_read_b64_tr_b16 a[62:63], v55 offset:25600
    buffer_load_dwordx4 v60, s[4:7], s63 offen lds
    v_mfma_f32_16x16x32_bf16 v[200:203], a[20:23], a[84:87], v[200:203]
    v_mfma_f32_16x16x32_bf16 v[232:235], a[16:19], a[88:91], v[232:235]
    v_mfma_f32_16x16x32_bf16 v[232:235], a[20:23], a[92:95], v[232:235]
    v_mfma_f32_16x16x32_bf16 v[140:143], a[24:27], a[64:67], v[140:143]
    v_mfma_f32_16x16x32_bf16 v[140:143], a[28:31], a[68:71], v[140:143]
    v_mfma_f32_16x16x32_bf16 v[172:175], a[24:27], a[72:75], v[172:175]
    buffer_load_dwordx4 v61, s[4:7], s63 offen offset:1024 lds
    v_mfma_f32_16x16x32_bf16 v[172:175], a[28:31], a[76:79], v[172:175]
    v_mfma_f32_16x16x32_bf16 v[204:207], a[24:27], a[80:83], v[204:207]
    s_waitcnt vmcnt(14) lgkmcnt(0)
    s_barrier
    v_mfma_f32_16x16x32_bf16 v[204:207], a[28:31], a[84:87], v[204:207]
    ds_read_b64_tr_b16 a[0:1], v48 offset:32768
    s_add_u32 m0, s53, 0x10800
    v_mfma_f32_16x16x32_bf16 v[236:239], a[24:27], a[88:91], v[236:239]
    s_mov_b32 s63, 0x5200
    v_mfma_f32_16x16x32_bf16 v[236:239], a[28:31], a[92:95], v[236:239]
    ds_read_b64_tr_b16 a[2:3], v48 offset:33792
    buffer_load_dwordx4 v60, s[4:7], s63 offen lds
    v_mfma_f32_16x16x32_bf16 v[144:147], a[32:35], a[64:67], v[144:147]
    v_mfma_f32_16x16x32_bf16 v[144:147], a[36:39], a[68:71], v[144:147]
    ds_read_b64_tr_b16 a[4:5], v48 offset:40960
    v_mfma_f32_16x16x32_bf16 v[176:179], a[32:35], a[72:75], v[176:179]
    v_mfma_f32_16x16x32_bf16 v[176:179], a[36:39], a[76:79], v[176:179]
    ds_read_b64_tr_b16 a[6:7], v48 offset:41984
    v_mfma_f32_16x16x32_bf16 v[208:211], a[32:35], a[80:83], v[208:211]
    buffer_load_dwordx4 v61, s[4:7], s63 offen offset:1024 lds
    v_mfma_f32_16x16x32_bf16 v[208:211], a[36:39], a[84:87], v[208:211]
    ds_read_b64_tr_b16 a[8:9], v49 offset:32768
    v_mfma_f32_16x16x32_bf16 v[240:243], a[32:35], a[88:91], v[240:243]
    v_mfma_f32_16x16x32_bf16 v[240:243], a[36:39], a[92:95], v[240:243]
    ds_read_b64_tr_b16 a[10:11], v49 offset:33792
    s_add_u32 m0, s53, 0x8000
    v_mfma_f32_16x16x32_bf16 v[148:151], a[40:43], a[64:67], v[148:151]
    s_mov_b32 s63, 0xa200
    v_mfma_f32_16x16x32_bf16 v[148:151], a[44:47], a[68:71], v[148:151]
    ds_read_b64_tr_b16 a[12:13], v49 offset:40960
    buffer_load_dwordx4 v60, s[4:7], s63 offen lds
    v_mfma_f32_16x16x32_bf16 v[180:183], a[40:43], a[72:75], v[180:183]
    v_mfma_f32_16x16x32_bf16 v[180:183], a[44:47], a[76:79], v[180:183]
    ds_read_b64_tr_b16 a[14:15], v49 offset:41984
    v_mfma_f32_16x16x32_bf16 v[212:215], a[40:43], a[80:83], v[212:215]
    s_waitcnt vmcnt(15)
    ds_read_b128 a[96:99], v62 offset:16384
    v_mfma_f32_16x16x32_bf16 v[212:215], a[44:47], a[84:87], v[212:215]
    ds_read_b64_tr_b16 a[16:17], v50 offset:32768
    v_mfma_f32_16x16x32_bf16 v[244:247], a[40:43], a[88:91], v[244:247]
    ds_read_b128 a[100:103], v63 offset:16384
    buffer_load_dwordx4 v61, s[4:7], s63 offen offset:1024 lds
    v_mfma_f32_16x16x32_bf16 v[244:247], a[44:47], a[92:95], v[244:247]
    ds_read_b64_tr_b16 a[18:19], v50 offset:33792
    v_mfma_f32_16x16x32_bf16 v[152:155], a[48:51], a[64:67], v[152:155]
    s_waitcnt vmcnt(14)
    ds_read_b128 a[104:107], v62 offset:18432
    v_mfma_f32_16x16x32_bf16 v[152:155], a[52:55], a[68:71], v[152:155]
    ds_read_b64_tr_b16 a[20:21], v50 offset:40960
    s_add_u32 m0, s53, 0x8800
    v_mfma_f32_16x16x32_bf16 v[184:187], a[48:51], a[72:75], v[184:187]
    ds_read_b128 a[108:111], v63 offset:18432
    s_mov_b32 s63, 0xf200
    v_mfma_f32_16x16x32_bf16 v[184:187], a[52:55], a[76:79], v[184:187]
    ds_read_b64_tr_b16 a[22:23], v50 offset:41984
    buffer_load_dwordx4 v60, s[4:7], s63 offen lds
    v_mfma_f32_16x16x32_bf16 v[216:219], a[48:51], a[80:83], v[216:219]
    s_waitcnt vmcnt(13)
    ds_read_b128 a[112:115], v62 offset:49152
    v_mfma_f32_16x16x32_bf16 v[216:219], a[52:55], a[84:87], v[216:219]
    ds_read_b64_tr_b16 a[24:25], v51 offset:32768
    v_mfma_f32_16x16x32_bf16 v[248:251], a[48:51], a[88:91], v[248:251]
    ds_read_b128 a[116:119], v63 offset:49152
    v_mfma_f32_16x16x32_bf16 v[248:251], a[52:55], a[92:95], v[248:251]
    ds_read_b64_tr_b16 a[26:27], v51 offset:33792
    v_mfma_f32_16x16x32_bf16 v[156:159], a[56:59], a[64:67], v[156:159]
    s_waitcnt vmcnt(11)
    ds_read_b128 a[120:123], v62 offset:51200
    v_mfma_f32_16x16x32_bf16 v[156:159], a[60:63], a[68:71], v[156:159]
    ds_read_b64_tr_b16 a[28:29], v51 offset:40960
    buffer_load_dwordx4 v61, s[4:7], s63 offen offset:1024 lds
    v_mfma_f32_16x16x32_bf16 v[188:191], a[56:59], a[72:75], v[188:191]
    ds_read_b128 a[124:127], v63 offset:51200
    v_mfma_f32_16x16x32_bf16 v[188:191], a[60:63], a[76:79], v[188:191]
    ds_read_b64_tr_b16 a[30:31], v51 offset:41984
    v_mfma_f32_16x16x32_bf16 v[220:223], a[56:59], a[80:83], v[220:223]
    v_mfma_f32_16x16x32_bf16 v[220:223], a[60:63], a[84:87], v[220:223]
    v_mfma_f32_16x16x32_bf16 v[252:255], a[56:59], a[88:91], v[252:255]
    v_mfma_f32_16x16x32_bf16 v[252:255], a[60:63], a[92:95], v[252:255]
    s_waitcnt lgkmcnt(4)
    v_mfma_f32_16x16x32_bf16 v[128:131], a[0:3], a[96:99], v[128:131]
    ds_read_b64_tr_b16 a[32:33], v52 offset:32768
    s_add_u32 m0, s53, 0x20000
    v_mfma_f32_16x16x32_bf16 v[128:131], a[4:7], a[100:103], v[128:131]
    ds_read_b64_tr_b16 a[34:35], v52 offset:33792
    s_mov_b32 s65, 0x280000
    v_mfma_f32_16x16x32_bf16 v[160:163], a[0:3], a[104:107], v[160:163]
    ds_read_b64_tr_b16 a[36:37], v52 offset:40960
    buffer_load_dwordx4 v56, s[8:11], s65 offen lds
    v_mfma_f32_16x16x32_bf16 v[160:163], a[4:7], a[108:111], v[160:163]
    v_mfma_f32_16x16x32_bf16 v[192:195], a[0:3], a[112:115], v[192:195]
    ds_read_b64_tr_b16 a[38:39], v52 offset:41984
    v_mfma_f32_16x16x32_bf16 v[192:195], a[4:7], a[116:119], v[192:195]
    ds_read_b64_tr_b16 a[40:41], v53 offset:32768
    s_waitcnt lgkmcnt(5)
    v_mfma_f32_16x16x32_bf16 v[224:227], a[0:3], a[120:123], v[224:227]
    ds_read_b64_tr_b16 a[42:43], v53 offset:33792
    v_mfma_f32_16x16x32_bf16 v[224:227], a[4:7], a[124:127], v[224:227]
    buffer_load_dwordx4 v57, s[8:11], s65 offen offset:1024 lds
    v_mfma_f32_16x16x32_bf16 v[132:135], a[8:11], a[96:99], v[132:135]
    ds_read_b64_tr_b16 a[44:45], v53 offset:40960
    v_mfma_f32_16x16x32_bf16 v[132:135], a[12:15], a[100:103], v[132:135]
    ds_read_b64_tr_b16 a[46:47], v53 offset:41984
    v_mfma_f32_16x16x32_bf16 v[164:167], a[8:11], a[104:107], v[164:167]
    ds_read_b64_tr_b16 a[48:49], v54 offset:32768
    v_mfma_f32_16x16x32_bf16 v[164:167], a[12:15], a[108:111], v[164:167]
    v_mfma_f32_16x16x32_bf16 v[196:199], a[8:11], a[112:115], v[196:199]
    ds_read_b64_tr_b16 a[50:51], v54 offset:33792
    buffer_load_dwordx4 v58, s[8:11], s65 offen offset:2048 lds
    v_mfma_f32_16x16x32_bf16 v[196:199], a[12:15], a[116:119], v[196:199]
    ds_read_b64_tr_b16 a[52:53], v54 offset:40960
    v_mfma_f32_16x16x32_bf16 v[228:231], a[8:11], a[120:123], v[228:231]
    ds_read_b64_tr_b16 a[54:55], v54 offset:41984
    v_mfma_f32_16x16x32_bf16 v[228:231], a[12:15], a[124:127], v[228:231]
    v_mfma_f32_16x16x32_bf16 v[136:139], a[16:19], a[96:99], v[136:139]
    ds_read_b64_tr_b16 a[56:57], v55 offset:32768
    v_mfma_f32_16x16x32_bf16 v[136:139], a[20:23], a[100:103], v[136:139]
    ds_read_b64_tr_b16 a[58:59], v55 offset:33792
    buffer_load_dwordx4 v59, s[8:11], s65 offen offset:3072 lds
    v_mfma_f32_16x16x32_bf16 v[168:171], a[16:19], a[104:107], v[168:171]
    ds_read_b64_tr_b16 a[60:61], v55 offset:40960
    v_mfma_f32_16x16x32_bf16 v[168:171], a[20:23], a[108:111], v[168:171]
    s_add_u32 m0, s53, 0xc000
    s_mov_b32 s63, 0x280
    v_mfma_f32_16x16x32_bf16 v[200:203], a[16:19], a[112:115], v[200:203]
    ds_read_b64_tr_b16 a[62:63], v55 offset:41984
    buffer_load_dwordx4 v60, s[4:7], s63 offen lds
    v_mfma_f32_16x16x32_bf16 v[200:203], a[20:23], a[116:119], v[200:203]
    v_mfma_f32_16x16x32_bf16 v[232:235], a[16:19], a[120:123], v[232:235]
    v_mfma_f32_16x16x32_bf16 v[232:235], a[20:23], a[124:127], v[232:235]
    v_mfma_f32_16x16x32_bf16 v[140:143], a[24:27], a[96:99], v[140:143]
    v_mfma_f32_16x16x32_bf16 v[140:143], a[28:31], a[100:103], v[140:143]
    v_mfma_f32_16x16x32_bf16 v[172:175], a[24:27], a[104:107], v[172:175]
    buffer_load_dwordx4 v61, s[4:7], s63 offen offset:1024 lds
    v_mfma_f32_16x16x32_bf16 v[172:175], a[28:31], a[108:111], v[172:175]
    v_mfma_f32_16x16x32_bf16 v[204:207], a[24:27], a[112:115], v[204:207]
    s_waitcnt vmcnt(14) lgkmcnt(0)
    s_barrier
    v_mfma_f32_16x16x32_bf16 v[204:207], a[28:31], a[116:119], v[204:207]
    ds_read_b64_tr_b16 a[0:1], v48
    s_add_u32 m0, s53, 0xc800
    v_mfma_f32_16x16x32_bf16 v[236:239], a[24:27], a[120:123], v[236:239]
    s_mov_b32 s63, 0x5280
    v_mfma_f32_16x16x32_bf16 v[236:239], a[28:31], a[124:127], v[236:239]
    ds_read_b64_tr_b16 a[2:3], v48 offset:1024
    buffer_load_dwordx4 v60, s[4:7], s63 offen lds
    v_mfma_f32_16x16x32_bf16 v[144:147], a[32:35], a[96:99], v[144:147]
    v_mfma_f32_16x16x32_bf16 v[144:147], a[36:39], a[100:103], v[144:147]
    ds_read_b64_tr_b16 a[4:5], v48 offset:8192
    v_mfma_f32_16x16x32_bf16 v[176:179], a[32:35], a[104:107], v[176:179]
    v_mfma_f32_16x16x32_bf16 v[176:179], a[36:39], a[108:111], v[176:179]
    ds_read_b64_tr_b16 a[6:7], v48 offset:9216
    v_mfma_f32_16x16x32_bf16 v[208:211], a[32:35], a[112:115], v[208:211]
    buffer_load_dwordx4 v61, s[4:7], s63 offen offset:1024 lds
    v_mfma_f32_16x16x32_bf16 v[208:211], a[36:39], a[116:119], v[208:211]
    ds_read_b64_tr_b16 a[8:9], v49
    v_mfma_f32_16x16x32_bf16 v[240:243], a[32:35], a[120:123], v[240:243]
    v_mfma_f32_16x16x32_bf16 v[240:243], a[36:39], a[124:127], v[240:243]
    ds_read_b64_tr_b16 a[10:11], v49 offset:1024
    s_add_u32 m0, s53, 0x14000
    v_mfma_f32_16x16x32_bf16 v[148:151], a[40:43], a[96:99], v[148:151]
    s_mov_b32 s63, 0xa280
    v_mfma_f32_16x16x32_bf16 v[148:151], a[44:47], a[100:103], v[148:151]
    ds_read_b64_tr_b16 a[12:13], v49 offset:8192
    buffer_load_dwordx4 v60, s[4:7], s63 offen lds
    v_mfma_f32_16x16x32_bf16 v[180:183], a[40:43], a[104:107], v[180:183]
    v_mfma_f32_16x16x32_bf16 v[180:183], a[44:47], a[108:111], v[180:183]
    ds_read_b64_tr_b16 a[14:15], v49 offset:9216
    v_mfma_f32_16x16x32_bf16 v[212:215], a[40:43], a[112:115], v[212:215]
    s_waitcnt vmcnt(15)
    ds_read_b128 a[64:67], v62 offset:32768
    v_mfma_f32_16x16x32_bf16 v[212:215], a[44:47], a[116:119], v[212:215]
    ds_read_b64_tr_b16 a[16:17], v50
    v_mfma_f32_16x16x32_bf16 v[244:247], a[40:43], a[120:123], v[244:247]
    ds_read_b128 a[68:71], v63 offset:32768
    buffer_load_dwordx4 v61, s[4:7], s63 offen offset:1024 lds
    v_mfma_f32_16x16x32_bf16 v[244:247], a[44:47], a[124:127], v[244:247]
    ds_read_b64_tr_b16 a[18:19], v50 offset:1024
    v_mfma_f32_16x16x32_bf16 v[152:155], a[48:51], a[96:99], v[152:155]
    s_waitcnt vmcnt(14)
    ds_read_b128 a[72:75], v62 offset:34816
    v_mfma_f32_16x16x32_bf16 v[152:155], a[52:55], a[100:103], v[152:155]
    ds_read_b64_tr_b16 a[20:21], v50 offset:8192
    s_add_u32 m0, s53, 0x14800
    v_mfma_f32_16x16x32_bf16 v[184:187], a[48:51], a[104:107], v[184:187]
    ds_read_b128 a[76:79], v63 offset:34816
    s_mov_b32 s63, 0xf280
    v_mfma_f32_16x16x32_bf16 v[184:187], a[52:55], a[108:111], v[184:187]
    ds_read_b64_tr_b16 a[22:23], v50 offset:9216
    buffer_load_dwordx4 v60, s[4:7], s63 offen lds
    v_mfma_f32_16x16x32_bf16 v[216:219], a[48:51], a[112:115], v[216:219]
    s_waitcnt vmcnt(13)
    ds_read_b128 a[80:83], v62
    v_mfma_f32_16x16x32_bf16 v[216:219], a[52:55], a[116:119], v[216:219]
    ds_read_b64_tr_b16 a[24:25], v51
    v_mfma_f32_16x16x32_bf16 v[248:251], a[48:51], a[120:123], v[248:251]
    ds_read_b128 a[84:87], v63
    v_mfma_f32_16x16x32_bf16 v[248:251], a[52:55], a[124:127], v[248:251]
    ds_read_b64_tr_b16 a[26:27], v51 offset:1024
    v_mfma_f32_16x16x32_bf16 v[156:159], a[56:59], a[96:99], v[156:159]
    s_waitcnt vmcnt(11)
    ds_read_b128 a[88:91], v62 offset:2048
    v_mfma_f32_16x16x32_bf16 v[156:159], a[60:63], a[100:103], v[156:159]
    ds_read_b64_tr_b16 a[28:29], v51 offset:8192
    buffer_load_dwordx4 v61, s[4:7], s63 offen offset:1024 lds
    v_mfma_f32_16x16x32_bf16 v[188:191], a[56:59], a[104:107], v[188:191]
    ds_read_b128 a[92:95], v63 offset:2048
    v_mfma_f32_16x16x32_bf16 v[188:191], a[60:63], a[108:111], v[188:191]
    ds_read_b64_tr_b16 a[30:31], v51 offset:9216
    v_mfma_f32_16x16x32_bf16 v[220:223], a[56:59], a[112:115], v[220:223]
    v_mfma_f32_16x16x32_bf16 v[220:223], a[60:63], a[116:119], v[220:223]
    v_mfma_f32_16x16x32_bf16 v[252:255], a[56:59], a[120:123], v[252:255]
    v_mfma_f32_16x16x32_bf16 v[252:255], a[60:63], a[124:127], v[252:255]
    s_waitcnt lgkmcnt(4)
    v_mfma_f32_16x16x32_bf16 v[128:131], a[0:3], a[64:67], v[128:131]
    ds_read_b64_tr_b16 a[32:33], v52
    s_add_u32 m0, s53, 0x24000
    v_mfma_f32_16x16x32_bf16 v[128:131], a[4:7], a[68:71], v[128:131]
    ds_read_b64_tr_b16 a[34:35], v52 offset:1024
    s_mov_b32 s65, 0x300000
    v_mfma_f32_16x16x32_bf16 v[160:163], a[0:3], a[72:75], v[160:163]
    ds_read_b64_tr_b16 a[36:37], v52 offset:8192
    buffer_load_dwordx4 v56, s[8:11], s65 offen lds
    v_mfma_f32_16x16x32_bf16 v[160:163], a[4:7], a[76:79], v[160:163]
    v_mfma_f32_16x16x32_bf16 v[192:195], a[0:3], a[80:83], v[192:195]
    ds_read_b64_tr_b16 a[38:39], v52 offset:9216
    v_mfma_f32_16x16x32_bf16 v[192:195], a[4:7], a[84:87], v[192:195]
    ds_read_b64_tr_b16 a[40:41], v53
    s_waitcnt lgkmcnt(5)
    v_mfma_f32_16x16x32_bf16 v[224:227], a[0:3], a[88:91], v[224:227]
    ds_read_b64_tr_b16 a[42:43], v53 offset:1024
    v_mfma_f32_16x16x32_bf16 v[224:227], a[4:7], a[92:95], v[224:227]
    buffer_load_dwordx4 v57, s[8:11], s65 offen offset:1024 lds
    v_mfma_f32_16x16x32_bf16 v[132:135], a[8:11], a[64:67], v[132:135]
    ds_read_b64_tr_b16 a[44:45], v53 offset:8192
    v_mfma_f32_16x16x32_bf16 v[132:135], a[12:15], a[68:71], v[132:135]
    ds_read_b64_tr_b16 a[46:47], v53 offset:9216
    v_mfma_f32_16x16x32_bf16 v[164:167], a[8:11], a[72:75], v[164:167]
    ds_read_b64_tr_b16 a[48:49], v54
    v_mfma_f32_16x16x32_bf16 v[164:167], a[12:15], a[76:79], v[164:167]
    v_mfma_f32_16x16x32_bf16 v[196:199], a[8:11], a[80:83], v[196:199]
    ds_read_b64_tr_b16 a[50:51], v54 offset:1024
    buffer_load_dwordx4 v58, s[8:11], s65 offen offset:2048 lds
    v_mfma_f32_16x16x32_bf16 v[196:199], a[12:15], a[84:87], v[196:199]
    ds_read_b64_tr_b16 a[52:53], v54 offset:8192
    v_mfma_f32_16x16x32_bf16 v[228:231], a[8:11], a[88:91], v[228:231]
    ds_read_b64_tr_b16 a[54:55], v54 offset:9216
    v_mfma_f32_16x16x32_bf16 v[228:231], a[12:15], a[92:95], v[228:231]
    v_mfma_f32_16x16x32_bf16 v[136:139], a[16:19], a[64:67], v[136:139]
    ds_read_b64_tr_b16 a[56:57], v55
    v_mfma_f32_16x16x32_bf16 v[136:139], a[20:23], a[68:71], v[136:139]
    ds_read_b64_tr_b16 a[58:59], v55 offset:1024
    buffer_load_dwordx4 v59, s[8:11], s65 offen offset:3072 lds
    v_mfma_f32_16x16x32_bf16 v[168:171], a[16:19], a[72:75], v[168:171]
    ds_read_b64_tr_b16 a[60:61], v55 offset:8192
    v_mfma_f32_16x16x32_bf16 v[168:171], a[20:23], a[76:79], v[168:171]
    s_add_u32 m0, s53, 0x10000
    s_mov_b32 s63, 0x300
    v_mfma_f32_16x16x32_bf16 v[200:203], a[16:19], a[80:83], v[200:203]
    ds_read_b64_tr_b16 a[62:63], v55 offset:9216
    buffer_load_dwordx4 v60, s[4:7], s63 offen lds
    v_mfma_f32_16x16x32_bf16 v[200:203], a[20:23], a[84:87], v[200:203]
    v_mfma_f32_16x16x32_bf16 v[232:235], a[16:19], a[88:91], v[232:235]
    v_mfma_f32_16x16x32_bf16 v[232:235], a[20:23], a[92:95], v[232:235]
    v_mfma_f32_16x16x32_bf16 v[140:143], a[24:27], a[64:67], v[140:143]
    v_mfma_f32_16x16x32_bf16 v[140:143], a[28:31], a[68:71], v[140:143]
    v_mfma_f32_16x16x32_bf16 v[172:175], a[24:27], a[72:75], v[172:175]
    buffer_load_dwordx4 v61, s[4:7], s63 offen offset:1024 lds
    v_mfma_f32_16x16x32_bf16 v[172:175], a[28:31], a[76:79], v[172:175]
    v_mfma_f32_16x16x32_bf16 v[204:207], a[24:27], a[80:83], v[204:207]
    s_waitcnt vmcnt(14) lgkmcnt(0)
    s_barrier
    v_mfma_f32_16x16x32_bf16 v[204:207], a[28:31], a[84:87], v[204:207]
    ds_read_b64_tr_b16 a[0:1], v48 offset:16384
    s_add_u32 m0, s53, 0x10800
    v_mfma_f32_16x16x32_bf16 v[236:239], a[24:27], a[88:91], v[236:239]
    s_mov_b32 s63, 0x5300
    v_mfma_f32_16x16x32_bf16 v[236:239], a[28:31], a[92:95], v[236:239]
    ds_read_b64_tr_b16 a[2:3], v48 offset:17408
    buffer_load_dwordx4 v60, s[4:7], s63 offen lds
    v_mfma_f32_16x16x32_bf16 v[144:147], a[32:35], a[64:67], v[144:147]
    v_mfma_f32_16x16x32_bf16 v[144:147], a[36:39], a[68:71], v[144:147]
    ds_read_b64_tr_b16 a[4:5], v48 offset:24576
    v_mfma_f32_16x16x32_bf16 v[176:179], a[32:35], a[72:75], v[176:179]
    v_mfma_f32_16x16x32_bf16 v[176:179], a[36:39], a[76:79], v[176:179]
    ds_read_b64_tr_b16 a[6:7], v48 offset:25600
    v_mfma_f32_16x16x32_bf16 v[208:211], a[32:35], a[80:83], v[208:211]
    buffer_load_dwordx4 v61, s[4:7], s63 offen offset:1024 lds
    v_mfma_f32_16x16x32_bf16 v[208:211], a[36:39], a[84:87], v[208:211]
    ds_read_b64_tr_b16 a[8:9], v49 offset:16384
    v_mfma_f32_16x16x32_bf16 v[240:243], a[32:35], a[88:91], v[240:243]
    v_mfma_f32_16x16x32_bf16 v[240:243], a[36:39], a[92:95], v[240:243]
    ds_read_b64_tr_b16 a[10:11], v49 offset:17408
    s_add_u32 m0, s53, 0x8000
    v_mfma_f32_16x16x32_bf16 v[148:151], a[40:43], a[64:67], v[148:151]
    s_mov_b32 s63, 0xa300
    v_mfma_f32_16x16x32_bf16 v[148:151], a[44:47], a[68:71], v[148:151]
    ds_read_b64_tr_b16 a[12:13], v49 offset:24576
    buffer_load_dwordx4 v60, s[4:7], s63 offen lds
    v_mfma_f32_16x16x32_bf16 v[180:183], a[40:43], a[72:75], v[180:183]
    v_mfma_f32_16x16x32_bf16 v[180:183], a[44:47], a[76:79], v[180:183]
    ds_read_b64_tr_b16 a[14:15], v49 offset:25600
    v_mfma_f32_16x16x32_bf16 v[212:215], a[40:43], a[80:83], v[212:215]
    s_waitcnt vmcnt(15)
    ds_read_b128 a[96:99], v62 offset:16384
    v_mfma_f32_16x16x32_bf16 v[212:215], a[44:47], a[84:87], v[212:215]
    ds_read_b64_tr_b16 a[16:17], v50 offset:16384
    v_mfma_f32_16x16x32_bf16 v[244:247], a[40:43], a[88:91], v[244:247]
    ds_read_b128 a[100:103], v63 offset:16384
    buffer_load_dwordx4 v61, s[4:7], s63 offen offset:1024 lds
    v_mfma_f32_16x16x32_bf16 v[244:247], a[44:47], a[92:95], v[244:247]
    ds_read_b64_tr_b16 a[18:19], v50 offset:17408
    v_mfma_f32_16x16x32_bf16 v[152:155], a[48:51], a[64:67], v[152:155]
    s_waitcnt vmcnt(14)
    ds_read_b128 a[104:107], v62 offset:18432
    v_mfma_f32_16x16x32_bf16 v[152:155], a[52:55], a[68:71], v[152:155]
    ds_read_b64_tr_b16 a[20:21], v50 offset:24576
    s_add_u32 m0, s53, 0x8800
    v_mfma_f32_16x16x32_bf16 v[184:187], a[48:51], a[72:75], v[184:187]
    ds_read_b128 a[108:111], v63 offset:18432
    s_mov_b32 s63, 0xf300
    v_mfma_f32_16x16x32_bf16 v[184:187], a[52:55], a[76:79], v[184:187]
    ds_read_b64_tr_b16 a[22:23], v50 offset:25600
    buffer_load_dwordx4 v60, s[4:7], s63 offen lds
    v_mfma_f32_16x16x32_bf16 v[216:219], a[48:51], a[80:83], v[216:219]
    s_waitcnt vmcnt(13)
    ds_read_b128 a[112:115], v62 offset:49152
    v_mfma_f32_16x16x32_bf16 v[216:219], a[52:55], a[84:87], v[216:219]
    ds_read_b64_tr_b16 a[24:25], v51 offset:16384
    v_mfma_f32_16x16x32_bf16 v[248:251], a[48:51], a[88:91], v[248:251]
    ds_read_b128 a[116:119], v63 offset:49152
    v_mfma_f32_16x16x32_bf16 v[248:251], a[52:55], a[92:95], v[248:251]
    ds_read_b64_tr_b16 a[26:27], v51 offset:17408
    v_mfma_f32_16x16x32_bf16 v[156:159], a[56:59], a[64:67], v[156:159]
    s_waitcnt vmcnt(11)
    ds_read_b128 a[120:123], v62 offset:51200
    v_mfma_f32_16x16x32_bf16 v[156:159], a[60:63], a[68:71], v[156:159]
    ds_read_b64_tr_b16 a[28:29], v51 offset:24576
    buffer_load_dwordx4 v61, s[4:7], s63 offen offset:1024 lds
    v_mfma_f32_16x16x32_bf16 v[188:191], a[56:59], a[72:75], v[188:191]
    ds_read_b128 a[124:127], v63 offset:51200
    v_mfma_f32_16x16x32_bf16 v[188:191], a[60:63], a[76:79], v[188:191]
    ds_read_b64_tr_b16 a[30:31], v51 offset:25600
    v_mfma_f32_16x16x32_bf16 v[220:223], a[56:59], a[80:83], v[220:223]
    v_mfma_f32_16x16x32_bf16 v[220:223], a[60:63], a[84:87], v[220:223]
    v_mfma_f32_16x16x32_bf16 v[252:255], a[56:59], a[88:91], v[252:255]
    v_mfma_f32_16x16x32_bf16 v[252:255], a[60:63], a[92:95], v[252:255]
    s_waitcnt lgkmcnt(4)
    v_mfma_f32_16x16x32_bf16 v[128:131], a[0:3], a[96:99], v[128:131]
    ds_read_b64_tr_b16 a[32:33], v52 offset:16384
    s_add_u32 m0, s53, 0x1c000
    v_mfma_f32_16x16x32_bf16 v[128:131], a[4:7], a[100:103], v[128:131]
    ds_read_b64_tr_b16 a[34:35], v52 offset:17408
    s_mov_b32 s65, 0x380000
    v_mfma_f32_16x16x32_bf16 v[160:163], a[0:3], a[104:107], v[160:163]
    ds_read_b64_tr_b16 a[36:37], v52 offset:24576
    buffer_load_dwordx4 v56, s[8:11], s65 offen lds
    v_mfma_f32_16x16x32_bf16 v[160:163], a[4:7], a[108:111], v[160:163]
    v_mfma_f32_16x16x32_bf16 v[192:195], a[0:3], a[112:115], v[192:195]
    ds_read_b64_tr_b16 a[38:39], v52 offset:25600
    v_mfma_f32_16x16x32_bf16 v[192:195], a[4:7], a[116:119], v[192:195]
    ds_read_b64_tr_b16 a[40:41], v53 offset:16384
    s_waitcnt lgkmcnt(5)
    v_mfma_f32_16x16x32_bf16 v[224:227], a[0:3], a[120:123], v[224:227]
    ds_read_b64_tr_b16 a[42:43], v53 offset:17408
    v_mfma_f32_16x16x32_bf16 v[224:227], a[4:7], a[124:127], v[224:227]
    buffer_load_dwordx4 v57, s[8:11], s65 offen offset:1024 lds
    v_mfma_f32_16x16x32_bf16 v[132:135], a[8:11], a[96:99], v[132:135]
    ds_read_b64_tr_b16 a[44:45], v53 offset:24576
    v_mfma_f32_16x16x32_bf16 v[132:135], a[12:15], a[100:103], v[132:135]
    ds_read_b64_tr_b16 a[46:47], v53 offset:25600
    v_mfma_f32_16x16x32_bf16 v[164:167], a[8:11], a[104:107], v[164:167]
    ds_read_b64_tr_b16 a[48:49], v54 offset:16384
    v_mfma_f32_16x16x32_bf16 v[164:167], a[12:15], a[108:111], v[164:167]
    v_mfma_f32_16x16x32_bf16 v[196:199], a[8:11], a[112:115], v[196:199]
    ds_read_b64_tr_b16 a[50:51], v54 offset:17408
    buffer_load_dwordx4 v58, s[8:11], s65 offen offset:2048 lds
    v_mfma_f32_16x16x32_bf16 v[196:199], a[12:15], a[116:119], v[196:199]
    ds_read_b64_tr_b16 a[52:53], v54 offset:24576
    v_mfma_f32_16x16x32_bf16 v[228:231], a[8:11], a[120:123], v[228:231]
    ds_read_b64_tr_b16 a[54:55], v54 offset:25600
    v_mfma_f32_16x16x32_bf16 v[228:231], a[12:15], a[124:127], v[228:231]
    v_mfma_f32_16x16x32_bf16 v[136:139], a[16:19], a[96:99], v[136:139]
    ds_read_b64_tr_b16 a[56:57], v55 offset:16384
    v_mfma_f32_16x16x32_bf16 v[136:139], a[20:23], a[100:103], v[136:139]
    ds_read_b64_tr_b16 a[58:59], v55 offset:17408
    buffer_load_dwordx4 v59, s[8:11], s65 offen offset:3072 lds
    v_mfma_f32_16x16x32_bf16 v[168:171], a[16:19], a[104:107], v[168:171]
    ds_read_b64_tr_b16 a[60:61], v55 offset:24576
    v_mfma_f32_16x16x32_bf16 v[168:171], a[20:23], a[108:111], v[168:171]
    s_add_u32 m0, s53, 0xc000
    s_mov_b32 s63, 0x380
    v_mfma_f32_16x16x32_bf16 v[200:203], a[16:19], a[112:115], v[200:203]
    ds_read_b64_tr_b16 a[62:63], v55 offset:25600
    buffer_load_dwordx4 v60, s[4:7], s63 offen lds
    v_mfma_f32_16x16x32_bf16 v[200:203], a[20:23], a[116:119], v[200:203]
    v_mfma_f32_16x16x32_bf16 v[232:235], a[16:19], a[120:123], v[232:235]
    v_mfma_f32_16x16x32_bf16 v[232:235], a[20:23], a[124:127], v[232:235]
    v_mfma_f32_16x16x32_bf16 v[140:143], a[24:27], a[96:99], v[140:143]
    v_mfma_f32_16x16x32_bf16 v[140:143], a[28:31], a[100:103], v[140:143]
    v_mfma_f32_16x16x32_bf16 v[172:175], a[24:27], a[104:107], v[172:175]
    buffer_load_dwordx4 v61, s[4:7], s63 offen offset:1024 lds
    v_mfma_f32_16x16x32_bf16 v[172:175], a[28:31], a[108:111], v[172:175]
    v_mfma_f32_16x16x32_bf16 v[204:207], a[24:27], a[112:115], v[204:207]
    s_waitcnt vmcnt(14) lgkmcnt(0)
    s_barrier
    v_mfma_f32_16x16x32_bf16 v[204:207], a[28:31], a[116:119], v[204:207]
    ds_read_b64_tr_b16 a[0:1], v48 offset:32768
    s_add_u32 m0, s53, 0xc800
    v_mfma_f32_16x16x32_bf16 v[236:239], a[24:27], a[120:123], v[236:239]
    s_mov_b32 s63, 0x5380
    v_mfma_f32_16x16x32_bf16 v[236:239], a[28:31], a[124:127], v[236:239]
    ds_read_b64_tr_b16 a[2:3], v48 offset:33792
    buffer_load_dwordx4 v60, s[4:7], s63 offen lds
    v_mfma_f32_16x16x32_bf16 v[144:147], a[32:35], a[96:99], v[144:147]
    v_mfma_f32_16x16x32_bf16 v[144:147], a[36:39], a[100:103], v[144:147]
    ds_read_b64_tr_b16 a[4:5], v48 offset:40960
    v_mfma_f32_16x16x32_bf16 v[176:179], a[32:35], a[104:107], v[176:179]
    v_mfma_f32_16x16x32_bf16 v[176:179], a[36:39], a[108:111], v[176:179]
    ds_read_b64_tr_b16 a[6:7], v48 offset:41984
    v_mfma_f32_16x16x32_bf16 v[208:211], a[32:35], a[112:115], v[208:211]
    buffer_load_dwordx4 v61, s[4:7], s63 offen offset:1024 lds
    v_mfma_f32_16x16x32_bf16 v[208:211], a[36:39], a[116:119], v[208:211]
    ds_read_b64_tr_b16 a[8:9], v49 offset:32768
    v_mfma_f32_16x16x32_bf16 v[240:243], a[32:35], a[120:123], v[240:243]
    v_mfma_f32_16x16x32_bf16 v[240:243], a[36:39], a[124:127], v[240:243]
    ds_read_b64_tr_b16 a[10:11], v49 offset:33792
    s_add_u32 m0, s53, 0x14000
    v_mfma_f32_16x16x32_bf16 v[148:151], a[40:43], a[96:99], v[148:151]
    s_mov_b32 s63, 0xa380
    v_mfma_f32_16x16x32_bf16 v[148:151], a[44:47], a[100:103], v[148:151]
    ds_read_b64_tr_b16 a[12:13], v49 offset:40960
    buffer_load_dwordx4 v60, s[4:7], s63 offen lds
    v_mfma_f32_16x16x32_bf16 v[180:183], a[40:43], a[104:107], v[180:183]
    v_mfma_f32_16x16x32_bf16 v[180:183], a[44:47], a[108:111], v[180:183]
    ds_read_b64_tr_b16 a[14:15], v49 offset:41984
    v_mfma_f32_16x16x32_bf16 v[212:215], a[40:43], a[112:115], v[212:215]
    s_waitcnt vmcnt(15)
    ds_read_b128 a[64:67], v62 offset:32768
    v_mfma_f32_16x16x32_bf16 v[212:215], a[44:47], a[116:119], v[212:215]
    ds_read_b64_tr_b16 a[16:17], v50 offset:32768
    v_mfma_f32_16x16x32_bf16 v[244:247], a[40:43], a[120:123], v[244:247]
    ds_read_b128 a[68:71], v63 offset:32768
    buffer_load_dwordx4 v61, s[4:7], s63 offen offset:1024 lds
    v_mfma_f32_16x16x32_bf16 v[244:247], a[44:47], a[124:127], v[244:247]
    ds_read_b64_tr_b16 a[18:19], v50 offset:33792
    v_mfma_f32_16x16x32_bf16 v[152:155], a[48:51], a[96:99], v[152:155]
    s_waitcnt vmcnt(14)
    ds_read_b128 a[72:75], v62 offset:34816
    v_mfma_f32_16x16x32_bf16 v[152:155], a[52:55], a[100:103], v[152:155]
    ds_read_b64_tr_b16 a[20:21], v50 offset:40960
    s_add_u32 m0, s53, 0x14800
    v_mfma_f32_16x16x32_bf16 v[184:187], a[48:51], a[104:107], v[184:187]
    ds_read_b128 a[76:79], v63 offset:34816
    s_mov_b32 s63, 0xf380
    v_mfma_f32_16x16x32_bf16 v[184:187], a[52:55], a[108:111], v[184:187]
    ds_read_b64_tr_b16 a[22:23], v50 offset:41984
    buffer_load_dwordx4 v60, s[4:7], s63 offen lds
    v_mfma_f32_16x16x32_bf16 v[216:219], a[48:51], a[112:115], v[216:219]
    s_waitcnt vmcnt(13)
    ds_read_b128 a[80:83], v62
    v_mfma_f32_16x16x32_bf16 v[216:219], a[52:55], a[116:119], v[216:219]
    ds_read_b64_tr_b16 a[24:25], v51 offset:32768
    v_mfma_f32_16x16x32_bf16 v[248:251], a[48:51], a[120:123], v[248:251]
    ds_read_b128 a[84:87], v63
    v_mfma_f32_16x16x32_bf16 v[248:251], a[52:55], a[124:127], v[248:251]
    ds_read_b64_tr_b16 a[26:27], v51 offset:33792
    v_mfma_f32_16x16x32_bf16 v[156:159], a[56:59], a[96:99], v[156:159]
    s_waitcnt vmcnt(11)
    ds_read_b128 a[88:91], v62 offset:2048
    v_mfma_f32_16x16x32_bf16 v[156:159], a[60:63], a[100:103], v[156:159]
    ds_read_b64_tr_b16 a[28:29], v51 offset:40960
    buffer_load_dwordx4 v61, s[4:7], s63 offen offset:1024 lds
    v_mfma_f32_16x16x32_bf16 v[188:191], a[56:59], a[104:107], v[188:191]
    ds_read_b128 a[92:95], v63 offset:2048
    v_mfma_f32_16x16x32_bf16 v[188:191], a[60:63], a[108:111], v[188:191]
    ds_read_b64_tr_b16 a[30:31], v51 offset:41984
    v_mfma_f32_16x16x32_bf16 v[220:223], a[56:59], a[112:115], v[220:223]
    v_mfma_f32_16x16x32_bf16 v[220:223], a[60:63], a[116:119], v[220:223]
    v_mfma_f32_16x16x32_bf16 v[252:255], a[56:59], a[120:123], v[252:255]
    v_mfma_f32_16x16x32_bf16 v[252:255], a[60:63], a[124:127], v[252:255]
    s_waitcnt lgkmcnt(4)
    v_mfma_f32_16x16x32_bf16 v[128:131], a[0:3], a[64:67], v[128:131]
    ds_read_b64_tr_b16 a[32:33], v52 offset:32768
    s_add_u32 m0, s53, 0x20000
    v_mfma_f32_16x16x32_bf16 v[128:131], a[4:7], a[68:71], v[128:131]
    ds_read_b64_tr_b16 a[34:35], v52 offset:33792
    s_mov_b32 s65, 0x400000
    v_mfma_f32_16x16x32_bf16 v[160:163], a[0:3], a[72:75], v[160:163]
    ds_read_b64_tr_b16 a[36:37], v52 offset:40960
    buffer_load_dwordx4 v56, s[8:11], s65 offen lds
    v_mfma_f32_16x16x32_bf16 v[160:163], a[4:7], a[76:79], v[160:163]
    v_mfma_f32_16x16x32_bf16 v[192:195], a[0:3], a[80:83], v[192:195]
    ds_read_b64_tr_b16 a[38:39], v52 offset:41984
    v_mfma_f32_16x16x32_bf16 v[192:195], a[4:7], a[84:87], v[192:195]
    ds_read_b64_tr_b16 a[40:41], v53 offset:32768
    s_waitcnt lgkmcnt(5)
    v_mfma_f32_16x16x32_bf16 v[224:227], a[0:3], a[88:91], v[224:227]
    ds_read_b64_tr_b16 a[42:43], v53 offset:33792
    v_mfma_f32_16x16x32_bf16 v[224:227], a[4:7], a[92:95], v[224:227]
    buffer_load_dwordx4 v57, s[8:11], s65 offen offset:1024 lds
    v_mfma_f32_16x16x32_bf16 v[132:135], a[8:11], a[64:67], v[132:135]
    ds_read_b64_tr_b16 a[44:45], v53 offset:40960
    v_mfma_f32_16x16x32_bf16 v[132:135], a[12:15], a[68:71], v[132:135]
    ds_read_b64_tr_b16 a[46:47], v53 offset:41984
    v_mfma_f32_16x16x32_bf16 v[164:167], a[8:11], a[72:75], v[164:167]
    ds_read_b64_tr_b16 a[48:49], v54 offset:32768
    v_mfma_f32_16x16x32_bf16 v[164:167], a[12:15], a[76:79], v[164:167]
    v_mfma_f32_16x16x32_bf16 v[196:199], a[8:11], a[80:83], v[196:199]
    ds_read_b64_tr_b16 a[50:51], v54 offset:33792
    buffer_load_dwordx4 v58, s[8:11], s65 offen offset:2048 lds
    v_mfma_f32_16x16x32_bf16 v[196:199], a[12:15], a[84:87], v[196:199]
    ds_read_b64_tr_b16 a[52:53], v54 offset:40960
    v_mfma_f32_16x16x32_bf16 v[228:231], a[8:11], a[88:91], v[228:231]
    ds_read_b64_tr_b16 a[54:55], v54 offset:41984
    v_mfma_f32_16x16x32_bf16 v[228:231], a[12:15], a[92:95], v[228:231]
    v_mfma_f32_16x16x32_bf16 v[136:139], a[16:19], a[64:67], v[136:139]
    ds_read_b64_tr_b16 a[56:57], v55 offset:32768
    v_mfma_f32_16x16x32_bf16 v[136:139], a[20:23], a[68:71], v[136:139]
    ds_read_b64_tr_b16 a[58:59], v55 offset:33792
    buffer_load_dwordx4 v59, s[8:11], s65 offen offset:3072 lds
    v_mfma_f32_16x16x32_bf16 v[168:171], a[16:19], a[72:75], v[168:171]
    ds_read_b64_tr_b16 a[60:61], v55 offset:40960
    v_mfma_f32_16x16x32_bf16 v[168:171], a[20:23], a[76:79], v[168:171]
    s_add_u32 m0, s53, 0x10000
    s_mov_b32 s63, 0x400
    v_mfma_f32_16x16x32_bf16 v[200:203], a[16:19], a[80:83], v[200:203]
    ds_read_b64_tr_b16 a[62:63], v55 offset:41984
    buffer_load_dwordx4 v60, s[4:7], s63 offen lds
    v_mfma_f32_16x16x32_bf16 v[200:203], a[20:23], a[84:87], v[200:203]
    v_mfma_f32_16x16x32_bf16 v[232:235], a[16:19], a[88:91], v[232:235]
    v_mfma_f32_16x16x32_bf16 v[232:235], a[20:23], a[92:95], v[232:235]
    v_mfma_f32_16x16x32_bf16 v[140:143], a[24:27], a[64:67], v[140:143]
    v_mfma_f32_16x16x32_bf16 v[140:143], a[28:31], a[68:71], v[140:143]
    v_mfma_f32_16x16x32_bf16 v[172:175], a[24:27], a[72:75], v[172:175]
    buffer_load_dwordx4 v61, s[4:7], s63 offen offset:1024 lds
    v_mfma_f32_16x16x32_bf16 v[172:175], a[28:31], a[76:79], v[172:175]
    v_mfma_f32_16x16x32_bf16 v[204:207], a[24:27], a[80:83], v[204:207]
    s_waitcnt vmcnt(14) lgkmcnt(0)
    s_barrier
    v_mfma_f32_16x16x32_bf16 v[204:207], a[28:31], a[84:87], v[204:207]
    ds_read_b64_tr_b16 a[0:1], v48
    s_add_u32 m0, s53, 0x10800
    v_mfma_f32_16x16x32_bf16 v[236:239], a[24:27], a[88:91], v[236:239]
    s_mov_b32 s63, 0x5400
    v_mfma_f32_16x16x32_bf16 v[236:239], a[28:31], a[92:95], v[236:239]
    ds_read_b64_tr_b16 a[2:3], v48 offset:1024
    buffer_load_dwordx4 v60, s[4:7], s63 offen lds
    v_mfma_f32_16x16x32_bf16 v[144:147], a[32:35], a[64:67], v[144:147]
    v_mfma_f32_16x16x32_bf16 v[144:147], a[36:39], a[68:71], v[144:147]
    ds_read_b64_tr_b16 a[4:5], v48 offset:8192
    v_mfma_f32_16x16x32_bf16 v[176:179], a[32:35], a[72:75], v[176:179]
    v_mfma_f32_16x16x32_bf16 v[176:179], a[36:39], a[76:79], v[176:179]
    ds_read_b64_tr_b16 a[6:7], v48 offset:9216
    v_mfma_f32_16x16x32_bf16 v[208:211], a[32:35], a[80:83], v[208:211]
    buffer_load_dwordx4 v61, s[4:7], s63 offen offset:1024 lds
    v_mfma_f32_16x16x32_bf16 v[208:211], a[36:39], a[84:87], v[208:211]
    ds_read_b64_tr_b16 a[8:9], v49
    v_mfma_f32_16x16x32_bf16 v[240:243], a[32:35], a[88:91], v[240:243]
    v_mfma_f32_16x16x32_bf16 v[240:243], a[36:39], a[92:95], v[240:243]
    ds_read_b64_tr_b16 a[10:11], v49 offset:1024
    s_add_u32 m0, s53, 0x8000
    v_mfma_f32_16x16x32_bf16 v[148:151], a[40:43], a[64:67], v[148:151]
    s_mov_b32 s63, 0xa400
    v_mfma_f32_16x16x32_bf16 v[148:151], a[44:47], a[68:71], v[148:151]
    ds_read_b64_tr_b16 a[12:13], v49 offset:8192
    buffer_load_dwordx4 v60, s[4:7], s63 offen lds
    v_mfma_f32_16x16x32_bf16 v[180:183], a[40:43], a[72:75], v[180:183]
    v_mfma_f32_16x16x32_bf16 v[180:183], a[44:47], a[76:79], v[180:183]
    ds_read_b64_tr_b16 a[14:15], v49 offset:9216
    v_mfma_f32_16x16x32_bf16 v[212:215], a[40:43], a[80:83], v[212:215]
    s_waitcnt vmcnt(15)
    ds_read_b128 a[96:99], v62 offset:16384
    v_mfma_f32_16x16x32_bf16 v[212:215], a[44:47], a[84:87], v[212:215]
    ds_read_b64_tr_b16 a[16:17], v50
    v_mfma_f32_16x16x32_bf16 v[244:247], a[40:43], a[88:91], v[244:247]
    ds_read_b128 a[100:103], v63 offset:16384
    buffer_load_dwordx4 v61, s[4:7], s63 offen offset:1024 lds
    v_mfma_f32_16x16x32_bf16 v[244:247], a[44:47], a[92:95], v[244:247]
    ds_read_b64_tr_b16 a[18:19], v50 offset:1024
    v_mfma_f32_16x16x32_bf16 v[152:155], a[48:51], a[64:67], v[152:155]
    s_waitcnt vmcnt(14)
    ds_read_b128 a[104:107], v62 offset:18432
    v_mfma_f32_16x16x32_bf16 v[152:155], a[52:55], a[68:71], v[152:155]
    ds_read_b64_tr_b16 a[20:21], v50 offset:8192
    s_add_u32 m0, s53, 0x8800
    v_mfma_f32_16x16x32_bf16 v[184:187], a[48:51], a[72:75], v[184:187]
    ds_read_b128 a[108:111], v63 offset:18432
    s_mov_b32 s63, 0xf400
    v_mfma_f32_16x16x32_bf16 v[184:187], a[52:55], a[76:79], v[184:187]
    ds_read_b64_tr_b16 a[22:23], v50 offset:9216
    buffer_load_dwordx4 v60, s[4:7], s63 offen lds
    v_mfma_f32_16x16x32_bf16 v[216:219], a[48:51], a[80:83], v[216:219]
    s_waitcnt vmcnt(13)
    ds_read_b128 a[112:115], v62 offset:49152
    v_mfma_f32_16x16x32_bf16 v[216:219], a[52:55], a[84:87], v[216:219]
    ds_read_b64_tr_b16 a[24:25], v51
    v_mfma_f32_16x16x32_bf16 v[248:251], a[48:51], a[88:91], v[248:251]
    ds_read_b128 a[116:119], v63 offset:49152
    v_mfma_f32_16x16x32_bf16 v[248:251], a[52:55], a[92:95], v[248:251]
    ds_read_b64_tr_b16 a[26:27], v51 offset:1024
    v_mfma_f32_16x16x32_bf16 v[156:159], a[56:59], a[64:67], v[156:159]
    s_waitcnt vmcnt(11)
    ds_read_b128 a[120:123], v62 offset:51200
    v_mfma_f32_16x16x32_bf16 v[156:159], a[60:63], a[68:71], v[156:159]
    ds_read_b64_tr_b16 a[28:29], v51 offset:8192
    buffer_load_dwordx4 v61, s[4:7], s63 offen offset:1024 lds
    v_mfma_f32_16x16x32_bf16 v[188:191], a[56:59], a[72:75], v[188:191]
    ds_read_b128 a[124:127], v63 offset:51200
    v_mfma_f32_16x16x32_bf16 v[188:191], a[60:63], a[76:79], v[188:191]
    ds_read_b64_tr_b16 a[30:31], v51 offset:9216
    v_mfma_f32_16x16x32_bf16 v[220:223], a[56:59], a[80:83], v[220:223]
    v_mfma_f32_16x16x32_bf16 v[220:223], a[60:63], a[84:87], v[220:223]
    v_mfma_f32_16x16x32_bf16 v[252:255], a[56:59], a[88:91], v[252:255]
    v_mfma_f32_16x16x32_bf16 v[252:255], a[60:63], a[92:95], v[252:255]
    s_waitcnt lgkmcnt(4)
    v_mfma_f32_16x16x32_bf16 v[128:131], a[0:3], a[96:99], v[128:131]
    ds_read_b64_tr_b16 a[32:33], v52
    s_add_u32 m0, s53, 0x24000
    v_mfma_f32_16x16x32_bf16 v[128:131], a[4:7], a[100:103], v[128:131]
    ds_read_b64_tr_b16 a[34:35], v52 offset:1024
    s_mov_b32 s65, 0x480000
    v_mfma_f32_16x16x32_bf16 v[160:163], a[0:3], a[104:107], v[160:163]
    ds_read_b64_tr_b16 a[36:37], v52 offset:8192
    buffer_load_dwordx4 v56, s[8:11], s65 offen lds
    v_mfma_f32_16x16x32_bf16 v[160:163], a[4:7], a[108:111], v[160:163]
    v_mfma_f32_16x16x32_bf16 v[192:195], a[0:3], a[112:115], v[192:195]
    ds_read_b64_tr_b16 a[38:39], v52 offset:9216
    v_mfma_f32_16x16x32_bf16 v[192:195], a[4:7], a[116:119], v[192:195]
    ds_read_b64_tr_b16 a[40:41], v53
    s_waitcnt lgkmcnt(5)
    v_mfma_f32_16x16x32_bf16 v[224:227], a[0:3], a[120:123], v[224:227]
    ds_read_b64_tr_b16 a[42:43], v53 offset:1024
    v_mfma_f32_16x16x32_bf16 v[224:227], a[4:7], a[124:127], v[224:227]
    buffer_load_dwordx4 v57, s[8:11], s65 offen offset:1024 lds
    v_mfma_f32_16x16x32_bf16 v[132:135], a[8:11], a[96:99], v[132:135]
    ds_read_b64_tr_b16 a[44:45], v53 offset:8192
    v_mfma_f32_16x16x32_bf16 v[132:135], a[12:15], a[100:103], v[132:135]
    ds_read_b64_tr_b16 a[46:47], v53 offset:9216
    v_mfma_f32_16x16x32_bf16 v[164:167], a[8:11], a[104:107], v[164:167]
    ds_read_b64_tr_b16 a[48:49], v54
    v_mfma_f32_16x16x32_bf16 v[164:167], a[12:15], a[108:111], v[164:167]
    v_mfma_f32_16x16x32_bf16 v[196:199], a[8:11], a[112:115], v[196:199]
    ds_read_b64_tr_b16 a[50:51], v54 offset:1024
    buffer_load_dwordx4 v58, s[8:11], s65 offen offset:2048 lds
    v_mfma_f32_16x16x32_bf16 v[196:199], a[12:15], a[116:119], v[196:199]
    ds_read_b64_tr_b16 a[52:53], v54 offset:8192
    v_mfma_f32_16x16x32_bf16 v[228:231], a[8:11], a[120:123], v[228:231]
    ds_read_b64_tr_b16 a[54:55], v54 offset:9216
    v_mfma_f32_16x16x32_bf16 v[228:231], a[12:15], a[124:127], v[228:231]
    v_mfma_f32_16x16x32_bf16 v[136:139], a[16:19], a[96:99], v[136:139]
    ds_read_b64_tr_b16 a[56:57], v55
    v_mfma_f32_16x16x32_bf16 v[136:139], a[20:23], a[100:103], v[136:139]
    ds_read_b64_tr_b16 a[58:59], v55 offset:1024
    buffer_load_dwordx4 v59, s[8:11], s65 offen offset:3072 lds
    v_mfma_f32_16x16x32_bf16 v[168:171], a[16:19], a[104:107], v[168:171]
    ds_read_b64_tr_b16 a[60:61], v55 offset:8192
    v_mfma_f32_16x16x32_bf16 v[168:171], a[20:23], a[108:111], v[168:171]
    s_add_u32 m0, s53, 0xc000
    s_mov_b32 s63, 0x480
    v_mfma_f32_16x16x32_bf16 v[200:203], a[16:19], a[112:115], v[200:203]
    ds_read_b64_tr_b16 a[62:63], v55 offset:9216
    buffer_load_dwordx4 v60, s[4:7], s63 offen lds
    v_mfma_f32_16x16x32_bf16 v[200:203], a[20:23], a[116:119], v[200:203]
    v_mfma_f32_16x16x32_bf16 v[232:235], a[16:19], a[120:123], v[232:235]
    v_mfma_f32_16x16x32_bf16 v[232:235], a[20:23], a[124:127], v[232:235]
    v_mfma_f32_16x16x32_bf16 v[140:143], a[24:27], a[96:99], v[140:143]
    v_mfma_f32_16x16x32_bf16 v[140:143], a[28:31], a[100:103], v[140:143]
    v_mfma_f32_16x16x32_bf16 v[172:175], a[24:27], a[104:107], v[172:175]
    buffer_load_dwordx4 v61, s[4:7], s63 offen offset:1024 lds
    v_mfma_f32_16x16x32_bf16 v[172:175], a[28:31], a[108:111], v[172:175]
    v_mfma_f32_16x16x32_bf16 v[204:207], a[24:27], a[112:115], v[204:207]
    s_waitcnt vmcnt(14) lgkmcnt(0)
    s_barrier
    v_mfma_f32_16x16x32_bf16 v[204:207], a[28:31], a[116:119], v[204:207]
    ds_read_b64_tr_b16 a[0:1], v48 offset:16384
    s_add_u32 m0, s53, 0xc800
    v_mfma_f32_16x16x32_bf16 v[236:239], a[24:27], a[120:123], v[236:239]
    s_mov_b32 s63, 0x5480
    v_mfma_f32_16x16x32_bf16 v[236:239], a[28:31], a[124:127], v[236:239]
    ds_read_b64_tr_b16 a[2:3], v48 offset:17408
    buffer_load_dwordx4 v60, s[4:7], s63 offen lds
    v_mfma_f32_16x16x32_bf16 v[144:147], a[32:35], a[96:99], v[144:147]
    v_mfma_f32_16x16x32_bf16 v[144:147], a[36:39], a[100:103], v[144:147]
    ds_read_b64_tr_b16 a[4:5], v48 offset:24576
    v_mfma_f32_16x16x32_bf16 v[176:179], a[32:35], a[104:107], v[176:179]
    v_mfma_f32_16x16x32_bf16 v[176:179], a[36:39], a[108:111], v[176:179]
    ds_read_b64_tr_b16 a[6:7], v48 offset:25600
    v_mfma_f32_16x16x32_bf16 v[208:211], a[32:35], a[112:115], v[208:211]
    buffer_load_dwordx4 v61, s[4:7], s63 offen offset:1024 lds
    v_mfma_f32_16x16x32_bf16 v[208:211], a[36:39], a[116:119], v[208:211]
    ds_read_b64_tr_b16 a[8:9], v49 offset:16384
    v_mfma_f32_16x16x32_bf16 v[240:243], a[32:35], a[120:123], v[240:243]
    v_mfma_f32_16x16x32_bf16 v[240:243], a[36:39], a[124:127], v[240:243]
    ds_read_b64_tr_b16 a[10:11], v49 offset:17408
    s_add_u32 m0, s53, 0x14000
    v_mfma_f32_16x16x32_bf16 v[148:151], a[40:43], a[96:99], v[148:151]
    s_mov_b32 s63, 0xa480
    v_mfma_f32_16x16x32_bf16 v[148:151], a[44:47], a[100:103], v[148:151]
    ds_read_b64_tr_b16 a[12:13], v49 offset:24576
    buffer_load_dwordx4 v60, s[4:7], s63 offen lds
    v_mfma_f32_16x16x32_bf16 v[180:183], a[40:43], a[104:107], v[180:183]
    v_mfma_f32_16x16x32_bf16 v[180:183], a[44:47], a[108:111], v[180:183]
    ds_read_b64_tr_b16 a[14:15], v49 offset:25600
    v_mfma_f32_16x16x32_bf16 v[212:215], a[40:43], a[112:115], v[212:215]
    s_waitcnt vmcnt(15)
    ds_read_b128 a[64:67], v62 offset:32768
    v_mfma_f32_16x16x32_bf16 v[212:215], a[44:47], a[116:119], v[212:215]
    ds_read_b64_tr_b16 a[16:17], v50 offset:16384
    v_mfma_f32_16x16x32_bf16 v[244:247], a[40:43], a[120:123], v[244:247]
    ds_read_b128 a[68:71], v63 offset:32768
    buffer_load_dwordx4 v61, s[4:7], s63 offen offset:1024 lds
    v_mfma_f32_16x16x32_bf16 v[244:247], a[44:47], a[124:127], v[244:247]
    ds_read_b64_tr_b16 a[18:19], v50 offset:17408
    v_mfma_f32_16x16x32_bf16 v[152:155], a[48:51], a[96:99], v[152:155]
    s_waitcnt vmcnt(14)
    ds_read_b128 a[72:75], v62 offset:34816
    v_mfma_f32_16x16x32_bf16 v[152:155], a[52:55], a[100:103], v[152:155]
    ds_read_b64_tr_b16 a[20:21], v50 offset:24576
    s_add_u32 m0, s53, 0x14800
    v_mfma_f32_16x16x32_bf16 v[184:187], a[48:51], a[104:107], v[184:187]
    ds_read_b128 a[76:79], v63 offset:34816
    s_mov_b32 s63, 0xf480
    v_mfma_f32_16x16x32_bf16 v[184:187], a[52:55], a[108:111], v[184:187]
    ds_read_b64_tr_b16 a[22:23], v50 offset:25600
    buffer_load_dwordx4 v60, s[4:7], s63 offen lds
    v_mfma_f32_16x16x32_bf16 v[216:219], a[48:51], a[112:115], v[216:219]
    s_waitcnt vmcnt(13)
    ds_read_b128 a[80:83], v62
    v_mfma_f32_16x16x32_bf16 v[216:219], a[52:55], a[116:119], v[216:219]
    ds_read_b64_tr_b16 a[24:25], v51 offset:16384
    v_mfma_f32_16x16x32_bf16 v[248:251], a[48:51], a[120:123], v[248:251]
    ds_read_b128 a[84:87], v63
    v_mfma_f32_16x16x32_bf16 v[248:251], a[52:55], a[124:127], v[248:251]
    ds_read_b64_tr_b16 a[26:27], v51 offset:17408
    v_mfma_f32_16x16x32_bf16 v[156:159], a[56:59], a[96:99], v[156:159]
    s_waitcnt vmcnt(11)
    ds_read_b128 a[88:91], v62 offset:2048
    v_mfma_f32_16x16x32_bf16 v[156:159], a[60:63], a[100:103], v[156:159]
    ds_read_b64_tr_b16 a[28:29], v51 offset:24576
    buffer_load_dwordx4 v61, s[4:7], s63 offen offset:1024 lds
    v_mfma_f32_16x16x32_bf16 v[188:191], a[56:59], a[104:107], v[188:191]
    ds_read_b128 a[92:95], v63 offset:2048
    v_mfma_f32_16x16x32_bf16 v[188:191], a[60:63], a[108:111], v[188:191]
    ds_read_b64_tr_b16 a[30:31], v51 offset:25600
    v_mfma_f32_16x16x32_bf16 v[220:223], a[56:59], a[112:115], v[220:223]
    v_mfma_f32_16x16x32_bf16 v[220:223], a[60:63], a[116:119], v[220:223]
    v_mfma_f32_16x16x32_bf16 v[252:255], a[56:59], a[120:123], v[252:255]
    v_mfma_f32_16x16x32_bf16 v[252:255], a[60:63], a[124:127], v[252:255]
    s_waitcnt lgkmcnt(4)
    v_mfma_f32_16x16x32_bf16 v[128:131], a[0:3], a[64:67], v[128:131]
    ds_read_b64_tr_b16 a[32:33], v52 offset:16384
    v_mfma_f32_16x16x32_bf16 v[128:131], a[4:7], a[68:71], v[128:131]
    ds_read_b64_tr_b16 a[34:35], v52 offset:17408
    v_mfma_f32_16x16x32_bf16 v[160:163], a[0:3], a[72:75], v[160:163]
    ds_read_b64_tr_b16 a[36:37], v52 offset:24576
    v_mfma_f32_16x16x32_bf16 v[160:163], a[4:7], a[76:79], v[160:163]
    v_mfma_f32_16x16x32_bf16 v[192:195], a[0:3], a[80:83], v[192:195]
    ds_read_b64_tr_b16 a[38:39], v52 offset:25600
    s_add_u32 m0, s53, 0
    s_mov_b32 s64, 0
    buffer_load_dwordx4 v20, s[12:15], s64 offen nt lds
    v_mfma_f32_16x16x32_bf16 v[192:195], a[4:7], a[84:87], v[192:195]
    ds_read_b64_tr_b16 a[40:41], v53 offset:16384
    s_waitcnt lgkmcnt(5)
    v_mfma_f32_16x16x32_bf16 v[224:227], a[0:3], a[88:91], v[224:227]
    ds_read_b64_tr_b16 a[42:43], v53 offset:17408
    v_mfma_f32_16x16x32_bf16 v[224:227], a[4:7], a[92:95], v[224:227]
    v_mfma_f32_16x16x32_bf16 v[132:135], a[8:11], a[64:67], v[132:135]
    ds_read_b64_tr_b16 a[44:45], v53 offset:24576
    v_mfma_f32_16x16x32_bf16 v[132:135], a[12:15], a[68:71], v[132:135]
    ds_read_b64_tr_b16 a[46:47], v53 offset:25600
    v_mfma_f32_16x16x32_bf16 v[164:167], a[8:11], a[72:75], v[164:167]
    ds_read_b64_tr_b16 a[48:49], v54 offset:16384
    v_mfma_f32_16x16x32_bf16 v[164:167], a[12:15], a[76:79], v[164:167]
    buffer_load_dwordx4 v21, s[12:15], s64 offen offset:1024 nt lds
    v_mfma_f32_16x16x32_bf16 v[196:199], a[8:11], a[80:83], v[196:199]
    ds_read_b64_tr_b16 a[50:51], v54 offset:17408
    v_mfma_f32_16x16x32_bf16 v[196:199], a[12:15], a[84:87], v[196:199]
    ds_read_b64_tr_b16 a[52:53], v54 offset:24576
    v_mfma_f32_16x16x32_bf16 v[228:231], a[8:11], a[88:91], v[228:231]
    ds_read_b64_tr_b16 a[54:55], v54 offset:25600
    v_mfma_f32_16x16x32_bf16 v[228:231], a[12:15], a[92:95], v[228:231]
    v_mfma_f32_16x16x32_bf16 v[136:139], a[16:19], a[64:67], v[136:139]
    ds_read_b64_tr_b16 a[56:57], v55 offset:16384
    v_mfma_f32_16x16x32_bf16 v[136:139], a[20:23], a[68:71], v[136:139]
    ds_read_b64_tr_b16 a[58:59], v55 offset:17408
    v_mfma_f32_16x16x32_bf16 v[168:171], a[16:19], a[72:75], v[168:171]
    ds_read_b64_tr_b16 a[60:61], v55 offset:24576
    buffer_load_dwordx4 v22, s[12:15], s64 offen offset:2048 nt lds
    v_mfma_f32_16x16x32_bf16 v[168:171], a[20:23], a[76:79], v[168:171]
    v_mfma_f32_16x16x32_bf16 v[200:203], a[16:19], a[80:83], v[200:203]
    ds_read_b64_tr_b16 a[62:63], v55 offset:25600
    v_mfma_f32_16x16x32_bf16 v[200:203], a[20:23], a[84:87], v[200:203]
    v_mfma_f32_16x16x32_bf16 v[232:235], a[16:19], a[88:91], v[232:235]
    v_mfma_f32_16x16x32_bf16 v[232:235], a[20:23], a[92:95], v[232:235]
    v_mfma_f32_16x16x32_bf16 v[140:143], a[24:27], a[64:67], v[140:143]
    v_mfma_f32_16x16x32_bf16 v[140:143], a[28:31], a[68:71], v[140:143]
    buffer_load_dwordx4 v23, s[12:15], s64 offen offset:3072 nt lds
    v_mfma_f32_16x16x32_bf16 v[172:175], a[24:27], a[72:75], v[172:175]
    v_mfma_f32_16x16x32_bf16 v[172:175], a[28:31], a[76:79], v[172:175]
    v_mfma_f32_16x16x32_bf16 v[204:207], a[24:27], a[80:83], v[204:207]
    s_waitcnt vmcnt(12) lgkmcnt(0)
    s_barrier
    v_mfma_f32_16x16x32_bf16 v[204:207], a[28:31], a[84:87], v[204:207]
    ds_read_b64_tr_b16 a[0:1], v48 offset:32768
    v_mfma_f32_16x16x32_bf16 v[236:239], a[24:27], a[88:91], v[236:239]
    ds_read_b64_tr_b16 a[2:3], v48 offset:33792
    v_mfma_f32_16x16x32_bf16 v[236:239], a[28:31], a[92:95], v[236:239]
    ds_read_b64_tr_b16 a[4:5], v48 offset:40960
    v_mfma_f32_16x16x32_bf16 v[144:147], a[32:35], a[64:67], v[144:147]
    ds_read_b64_tr_b16 a[6:7], v48 offset:41984
    s_add_u32 m0, s53, 0x18000
    s_mov_b32 s64, 0
    buffer_load_dwordx4 v24, s[16:19], s64 offen nt lds
    v_mfma_f32_16x16x32_bf16 v[144:147], a[36:39], a[68:71], v[144:147]
    ds_read_b64_tr_b16 a[8:9], v49 offset:32768
    v_mfma_f32_16x16x32_bf16 v[176:179], a[32:35], a[72:75], v[176:179]
    ds_read_b64_tr_b16 a[10:11], v49 offset:33792
    v_mfma_f32_16x16x32_bf16 v[176:179], a[36:39], a[76:79], v[176:179]
    ds_read_b64_tr_b16 a[12:13], v49 offset:40960
    v_mfma_f32_16x16x32_bf16 v[208:211], a[32:35], a[80:83], v[208:211]
    ds_read_b64_tr_b16 a[14:15], v49 offset:41984
    v_mfma_f32_16x16x32_bf16 v[208:211], a[36:39], a[84:87], v[208:211]
    ds_read_b64_tr_b16 a[16:17], v50 offset:32768
    v_mfma_f32_16x16x32_bf16 v[240:243], a[32:35], a[88:91], v[240:243]
    ds_read_b64_tr_b16 a[18:19], v50 offset:33792
    v_mfma_f32_16x16x32_bf16 v[240:243], a[36:39], a[92:95], v[240:243]
    ds_read_b64_tr_b16 a[20:21], v50 offset:40960
    buffer_load_dwordx4 v25, s[16:19], s64 offen offset:1024 nt lds
    v_mfma_f32_16x16x32_bf16 v[148:151], a[40:43], a[64:67], v[148:151]
    ds_read_b64_tr_b16 a[22:23], v50 offset:41984
    v_mfma_f32_16x16x32_bf16 v[148:151], a[44:47], a[68:71], v[148:151]
    ds_read_b64_tr_b16 a[24:25], v51 offset:32768
    v_mfma_f32_16x16x32_bf16 v[180:183], a[40:43], a[72:75], v[180:183]
    ds_read_b64_tr_b16 a[26:27], v51 offset:33792
    v_mfma_f32_16x16x32_bf16 v[180:183], a[44:47], a[76:79], v[180:183]
    ds_read_b64_tr_b16 a[28:29], v51 offset:40960
    v_mfma_f32_16x16x32_bf16 v[212:215], a[40:43], a[80:83], v[212:215]
    ds_read_b64_tr_b16 a[30:31], v51 offset:41984
    s_waitcnt vmcnt(12)
    ds_read_b128 a[96:99], v62 offset:16384
    v_mfma_f32_16x16x32_bf16 v[212:215], a[44:47], a[84:87], v[212:215]
    ds_read_b64_tr_b16 a[32:33], v52 offset:32768
    v_mfma_f32_16x16x32_bf16 v[244:247], a[40:43], a[88:91], v[244:247]
    ds_read_b64_tr_b16 a[34:35], v52 offset:33792
    ds_read_b128 a[100:103], v63 offset:16384
    buffer_load_dwordx4 v24, s[16:19], s64 offen offset:2048 nt lds
    v_mfma_f32_16x16x32_bf16 v[244:247], a[44:47], a[92:95], v[244:247]
    ds_read_b64_tr_b16 a[36:37], v52 offset:40960
    v_mfma_f32_16x16x32_bf16 v[152:155], a[48:51], a[64:67], v[152:155]
    ds_read_b64_tr_b16 a[38:39], v52 offset:41984
    s_waitcnt vmcnt(11)
    ds_read_b128 a[104:107], v62 offset:18432
    v_mfma_f32_16x16x32_bf16 v[152:155], a[52:55], a[68:71], v[152:155]
    ds_read_b64_tr_b16 a[40:41], v53 offset:32768
    v_mfma_f32_16x16x32_bf16 v[184:187], a[48:51], a[72:75], v[184:187]
    ds_read_b64_tr_b16 a[42:43], v53 offset:33792
    ds_read_b128 a[108:111], v63 offset:18432
    v_mfma_f32_16x16x32_bf16 v[184:187], a[52:55], a[76:79], v[184:187]
    ds_read_b64_tr_b16 a[44:45], v53 offset:40960
    v_mfma_f32_16x16x32_bf16 v[216:219], a[48:51], a[80:83], v[216:219]
    ds_read_b64_tr_b16 a[46:47], v53 offset:41984
    s_waitcnt vmcnt(9)
    ds_read_b128 a[112:115], v62 offset:49152
    v_mfma_f32_16x16x32_bf16 v[216:219], a[52:55], a[84:87], v[216:219]
    buffer_load_dwordx4 v25, s[16:19], s64 offen offset:3072 nt lds
    v_mfma_f32_16x16x32_bf16 v[248:251], a[48:51], a[88:91], v[248:251]
    ds_read_b128 a[116:119], v63 offset:49152
    v_mfma_f32_16x16x32_bf16 v[248:251], a[52:55], a[92:95], v[248:251]
    v_mfma_f32_16x16x32_bf16 v[156:159], a[56:59], a[64:67], v[156:159]
    ds_read_b64_tr_b16 a[48:49], v54 offset:32768
    s_waitcnt vmcnt(8)
    ds_read_b128 a[120:123], v62 offset:51200
    v_mfma_f32_16x16x32_bf16 v[156:159], a[60:63], a[68:71], v[156:159]
    ds_read_b64_tr_b16 a[50:51], v54 offset:33792
    v_mfma_f32_16x16x32_bf16 v[188:191], a[56:59], a[72:75], v[188:191]
    ds_read_b64_tr_b16 a[52:53], v54 offset:40960
    ds_read_b128 a[124:127], v63 offset:51200
    v_mfma_f32_16x16x32_bf16 v[188:191], a[60:63], a[76:79], v[188:191]
    ds_read_b64_tr_b16 a[54:55], v54 offset:41984
    v_mfma_f32_16x16x32_bf16 v[220:223], a[56:59], a[80:83], v[220:223]
    v_mfma_f32_16x16x32_bf16 v[220:223], a[60:63], a[84:87], v[220:223]
    v_mfma_f32_16x16x32_bf16 v[252:255], a[56:59], a[88:91], v[252:255]
    v_mfma_f32_16x16x32_bf16 v[252:255], a[60:63], a[92:95], v[252:255]
    s_waitcnt lgkmcnt(6)
    v_mfma_f32_16x16x32_bf16 v[128:131], a[0:3], a[96:99], v[128:131]
    ds_read_b64_tr_b16 a[56:57], v55 offset:32768
    v_mfma_f32_16x16x32_bf16 v[128:131], a[4:7], a[100:103], v[128:131]
    ds_read_b64_tr_b16 a[58:59], v55 offset:33792
    v_mfma_f32_16x16x32_bf16 v[132:135], a[8:11], a[96:99], v[132:135]
    ds_read_b64_tr_b16 a[60:61], v55 offset:40960
    v_mfma_f32_16x16x32_bf16 v[132:135], a[12:15], a[100:103], v[132:135]
    ds_read_b64_tr_b16 a[62:63], v55 offset:41984
    v_mfma_f32_16x16x32_bf16 v[136:139], a[16:19], a[96:99], v[136:139]
    s_add_u32 m0, s53, 0x4000
    s_mov_b32 s64, 0x4000
    buffer_load_dwordx4 v20, s[12:15], s64 offen nt lds
    v_mfma_f32_16x16x32_bf16 v[136:139], a[20:23], a[100:103], v[136:139]
    v_mfma_f32_16x16x32_bf16 v[140:143], a[24:27], a[96:99], v[140:143]
    v_mfma_f32_16x16x32_bf16 v[140:143], a[28:31], a[100:103], v[140:143]
    v_mfma_f32_16x16x32_bf16 v[144:147], a[32:35], a[96:99], v[144:147]
    v_mfma_f32_16x16x32_bf16 v[144:147], a[36:39], a[100:103], v[144:147]
    v_mfma_f32_16x16x32_bf16 v[148:151], a[40:43], a[96:99], v[148:151]
    v_mfma_f32_16x16x32_bf16 v[148:151], a[44:47], a[100:103], v[148:151]
    buffer_load_dwordx4 v21, s[12:15], s64 offen offset:1024 nt lds
    s_waitcnt lgkmcnt(0)
    v_mfma_f32_16x16x32_bf16 v[152:155], a[48:51], a[96:99], v[152:155]
    v_mfma_f32_16x16x32_bf16 v[152:155], a[52:55], a[100:103], v[152:155]
    v_mfma_f32_16x16x32_bf16 v[156:159], a[56:59], a[96:99], v[156:159]
    v_mfma_f32_16x16x32_bf16 v[156:159], a[60:63], a[100:103], v[156:159]
    v_mfma_f32_16x16x32_bf16 v[160:163], a[0:3], a[104:107], v[160:163]
    v_mfma_f32_16x16x32_bf16 v[160:163], a[4:7], a[108:111], v[160:163]
    v_mfma_f32_16x16x32_bf16 v[164:167], a[8:11], a[104:107], v[164:167]
    buffer_load_dwordx4 v22, s[12:15], s64 offen offset:2048 nt lds
    v_mfma_f32_16x16x32_bf16 v[164:167], a[12:15], a[108:111], v[164:167]
    v_mfma_f32_16x16x32_bf16 v[168:171], a[16:19], a[104:107], v[168:171]
    v_mfma_f32_16x16x32_bf16 v[168:171], a[20:23], a[108:111], v[168:171]
    v_mul_f32 v128, s70, v128
    v_mul_f32 v129, s70, v129
    v_mul_f32 v130, s70, v130
    v_mul_f32 v131, s70, v131
    v_cvt_pk_bf16_f32 v80, v128, v129
    v_mfma_f32_16x16x32_bf16 v[172:175], a[24:27], a[104:107], v[172:175]
    v_cvt_pk_bf16_f32 v81, v130, v131
    v_mul_f32 v132, s70, v132
    v_mul_f32 v133, s70, v133
    v_mul_f32 v134, s70, v134
    v_mul_f32 v135, s70, v135
    v_mfma_f32_16x16x32_bf16 v[172:175], a[28:31], a[108:111], v[172:175]
    v_cvt_pk_bf16_f32 v82, v132, v133
    v_cvt_pk_bf16_f32 v83, v134, v135
    v_mul_f32 v136, s70, v136
    v_mul_f32 v137, s70, v137
    v_mul_f32 v138, s70, v138
    v_mfma_f32_16x16x32_bf16 v[176:179], a[32:35], a[104:107], v[176:179]
    v_mul_f32 v139, s70, v139
    v_cvt_pk_bf16_f32 v84, v136, v137
    v_cvt_pk_bf16_f32 v85, v138, v139
    v_mul_f32 v140, s70, v140
    v_mul_f32 v141, s70, v141
    v_mfma_f32_16x16x32_bf16 v[176:179], a[36:39], a[108:111], v[176:179]
    buffer_load_dwordx4 v23, s[12:15], s64 offen offset:3072 nt lds
    v_mul_f32 v142, s70, v142
    v_mul_f32 v143, s70, v143
    v_cvt_pk_bf16_f32 v86, v140, v141
    v_cvt_pk_bf16_f32 v87, v142, v143
    v_permlane32_swap_b32 v80, v82
    v_mfma_f32_16x16x32_bf16 v[180:183], a[40:43], a[104:107], v[180:183]
    v_permlane32_swap_b32 v81, v83
    v_permlane32_swap_b32 v84, v86
    v_permlane32_swap_b32 v85, v87
    v_permlane16_swap_b32 v80, v82
    v_permlane16_swap_b32 v81, v83
    v_mfma_f32_16x16x32_bf16 v[180:183], a[44:47], a[108:111], v[180:183]
    v_permlane16_swap_b32 v84, v86
    v_permlane16_swap_b32 v85, v87
    v_accvgpr_write_b32 a192, v80
    v_accvgpr_write_b32 a193, v81
    v_accvgpr_write_b32 a194, v82
    v_mfma_f32_16x16x32_bf16 v[184:187], a[48:51], a[104:107], v[184:187]
    v_accvgpr_write_b32 a195, v83
    v_accvgpr_write_b32 a196, v84
    v_accvgpr_write_b32 a197, v85
    v_accvgpr_write_b32 a198, v86
    v_accvgpr_write_b32 a199, v87
    v_mfma_f32_16x16x32_bf16 v[184:187], a[52:55], a[108:111], v[184:187]
    v_mul_f32 v144, s70, v144
    v_mul_f32 v145, s70, v145
    v_mul_f32 v146, s70, v146
    v_mul_f32 v147, s70, v147
    v_cvt_pk_bf16_f32 v80, v144, v145
    v_mfma_f32_16x16x32_bf16 v[188:191], a[56:59], a[104:107], v[188:191]
    v_cvt_pk_bf16_f32 v81, v146, v147
    v_mul_f32 v148, s70, v148
    v_mul_f32 v149, s70, v149
    v_mul_f32 v150, s70, v150
    v_mul_f32 v151, s70, v151
    v_mfma_f32_16x16x32_bf16 v[188:191], a[60:63], a[108:111], v[188:191]
    v_cvt_pk_bf16_f32 v82, v148, v149
    v_cvt_pk_bf16_f32 v83, v150, v151
    v_mul_f32 v152, s70, v152
    v_mul_f32 v153, s70, v153
    v_mul_f32 v154, s70, v154
    v_mfma_f32_16x16x32_bf16 v[192:195], a[0:3], a[112:115], v[192:195]
    s_add_u32 m0, s53, 0x10000
    s_mov_b32 s64, 0x4000
    buffer_load_dwordx4 v24, s[16:19], s64 offen nt lds
    v_mul_f32 v155, s70, v155
    v_cvt_pk_bf16_f32 v84, v152, v153
    v_cvt_pk_bf16_f32 v85, v154, v155
    v_mul_f32 v156, s70, v156
    v_mul_f32 v157, s70, v157
    v_mfma_f32_16x16x32_bf16 v[192:195], a[4:7], a[116:119], v[192:195]
    v_mul_f32 v158, s70, v158
    v_mul_f32 v159, s70, v159
    v_cvt_pk_bf16_f32 v86, v156, v157
    v_cvt_pk_bf16_f32 v87, v158, v159
    v_permlane32_swap_b32 v80, v82
    v_mfma_f32_16x16x32_bf16 v[196:199], a[8:11], a[112:115], v[196:199]
    v_permlane32_swap_b32 v81, v83
    v_permlane32_swap_b32 v84, v86
    v_permlane32_swap_b32 v85, v87
    v_permlane16_swap_b32 v80, v82
    v_permlane16_swap_b32 v81, v83
    v_mfma_f32_16x16x32_bf16 v[196:199], a[12:15], a[116:119], v[196:199]
    v_permlane16_swap_b32 v84, v86
    v_permlane16_swap_b32 v85, v87
    v_accvgpr_write_b32 a200, v80
    v_accvgpr_write_b32 a201, v81
    v_accvgpr_write_b32 a202, v82
    v_mfma_f32_16x16x32_bf16 v[200:203], a[16:19], a[112:115], v[200:203]
    v_accvgpr_write_b32 a203, v83
    v_accvgpr_write_b32 a204, v84
    v_accvgpr_write_b32 a205, v85
    v_accvgpr_write_b32 a206, v86
    v_accvgpr_write_b32 a207, v87
    v_mfma_f32_16x16x32_bf16 v[200:203], a[20:23], a[116:119], v[200:203]
    v_mul_f32 v160, s70, v160
    v_mul_f32 v161, s70, v161
    v_mul_f32 v162, s70, v162
    v_mul_f32 v163, s70, v163
    v_cvt_pk_bf16_f32 v80, v160, v161
    v_mfma_f32_16x16x32_bf16 v[204:207], a[24:27], a[112:115], v[204:207]
    v_cvt_pk_bf16_f32 v81, v162, v163
    v_mul_f32 v164, s70, v164
    v_mul_f32 v165, s70, v165
    v_mul_f32 v166, s70, v166
    v_mul_f32 v167, s70, v167
    v_mfma_f32_16x16x32_bf16 v[204:207], a[28:31], a[116:119], v[204:207]
    buffer_load_dwordx4 v25, s[16:19], s64 offen offset:1024 nt lds
    v_cvt_pk_bf16_f32 v82, v164, v165
    v_cvt_pk_bf16_f32 v83, v166, v167
    v_mul_f32 v168, s70, v168
    v_mul_f32 v169, s70, v169
    v_mul_f32 v170, s70, v170
    v_mfma_f32_16x16x32_bf16 v[208:211], a[32:35], a[112:115], v[208:211]
    v_mul_f32 v171, s70, v171
    v_cvt_pk_bf16_f32 v84, v168, v169
    v_cvt_pk_bf16_f32 v85, v170, v171
    v_mul_f32 v172, s70, v172
    v_mul_f32 v173, s70, v173
    v_mfma_f32_16x16x32_bf16 v[208:211], a[36:39], a[116:119], v[208:211]
    v_mul_f32 v174, s70, v174
    v_mul_f32 v175, s70, v175
    v_cvt_pk_bf16_f32 v86, v172, v173
    v_cvt_pk_bf16_f32 v87, v174, v175
    v_permlane32_swap_b32 v80, v82
    v_mfma_f32_16x16x32_bf16 v[212:215], a[40:43], a[112:115], v[212:215]
    v_permlane32_swap_b32 v81, v83
    v_permlane32_swap_b32 v84, v86
    v_permlane32_swap_b32 v85, v87
    v_permlane16_swap_b32 v80, v82
    v_permlane16_swap_b32 v81, v83
    v_mfma_f32_16x16x32_bf16 v[212:215], a[44:47], a[116:119], v[212:215]
    v_permlane16_swap_b32 v84, v86
    v_permlane16_swap_b32 v85, v87
    v_accvgpr_write_b32 a208, v80
    v_accvgpr_write_b32 a209, v81
    v_accvgpr_write_b32 a210, v82
    v_mfma_f32_16x16x32_bf16 v[216:219], a[48:51], a[112:115], v[216:219]
    v_accvgpr_write_b32 a211, v83
    v_accvgpr_write_b32 a212, v84
    v_accvgpr_write_b32 a213, v85
    v_accvgpr_write_b32 a214, v86
    v_accvgpr_write_b32 a215, v87
    v_mfma_f32_16x16x32_bf16 v[216:219], a[52:55], a[116:119], v[216:219]
    v_mul_f32 v176, s70, v176
    v_mul_f32 v177, s70, v177
    v_mul_f32 v178, s70, v178
    v_mul_f32 v179, s70, v179
    v_cvt_pk_bf16_f32 v80, v176, v177
    v_mfma_f32_16x16x32_bf16 v[220:223], a[56:59], a[112:115], v[220:223]
    buffer_load_dwordx4 v24, s[16:19], s64 offen offset:2048 nt lds
    v_cvt_pk_bf16_f32 v81, v178, v179
    v_mul_f32 v180, s70, v180
    v_mul_f32 v181, s70, v181
    v_mul_f32 v182, s70, v182
    v_mul_f32 v183, s70, v183
    v_mfma_f32_16x16x32_bf16 v[220:223], a[60:63], a[116:119], v[220:223]
    v_cvt_pk_bf16_f32 v82, v180, v181
    v_cvt_pk_bf16_f32 v83, v182, v183
    v_mul_f32 v184, s70, v184
    v_mul_f32 v185, s70, v185
    v_mul_f32 v186, s70, v186
    v_mfma_f32_16x16x32_bf16 v[224:227], a[0:3], a[120:123], v[224:227]
    v_mul_f32 v187, s70, v187
    v_cvt_pk_bf16_f32 v84, v184, v185
    v_cvt_pk_bf16_f32 v85, v186, v187
    v_mul_f32 v188, s70, v188
    v_mul_f32 v189, s70, v189
    v_mfma_f32_16x16x32_bf16 v[224:227], a[4:7], a[124:127], v[224:227]
    v_mul_f32 v190, s70, v190
    v_mul_f32 v191, s70, v191
    v_cvt_pk_bf16_f32 v86, v188, v189
    v_cvt_pk_bf16_f32 v87, v190, v191
    v_permlane32_swap_b32 v80, v82
    v_mfma_f32_16x16x32_bf16 v[228:231], a[8:11], a[120:123], v[228:231]
    s_waitcnt vmcnt(11)
    s_barrier
    v_permlane32_swap_b32 v81, v83
    v_permlane32_swap_b32 v84, v86
    v_permlane32_swap_b32 v85, v87
    v_permlane16_swap_b32 v80, v82
    v_permlane16_swap_b32 v81, v83
    v_mfma_f32_16x16x32_bf16 v[228:231], a[12:15], a[124:127], v[228:231]
    ds_read_b128 a[128:131], v8
    v_permlane16_swap_b32 v84, v86
    v_permlane16_swap_b32 v85, v87
    v_accvgpr_write_b32 a216, v80
    v_accvgpr_write_b32 a217, v81
    v_accvgpr_write_b32 a218, v82
    v_mfma_f32_16x16x32_bf16 v[232:235], a[16:19], a[120:123], v[232:235]
    ds_read_b128 a[132:135], v9
    v_accvgpr_write_b32 a219, v83
    v_accvgpr_write_b32 a220, v84
    v_accvgpr_write_b32 a221, v85
    v_accvgpr_write_b32 a222, v86
    v_accvgpr_write_b32 a223, v87
    v_mfma_f32_16x16x32_bf16 v[232:235], a[20:23], a[124:127], v[232:235]
    buffer_load_dwordx4 v25, s[16:19], s64 offen offset:3072 nt lds
    ds_read_b128 a[136:139], v10
    v_mul_f32 v192, s70, v192
    v_mul_f32 v193, s70, v193
    v_mul_f32 v194, s70, v194
    v_mul_f32 v195, s70, v195
    v_cvt_pk_bf16_f32 v80, v192, v193
    v_cvt_pk_bf16_f32 v81, v194, v195
    v_mul_f32 v196, s70, v196
    v_mul_f32 v197, s70, v197
    v_mfma_f32_16x16x32_bf16 v[236:239], a[24:27], a[120:123], v[236:239]
    ds_read_b128 a[140:143], v11
    v_mul_f32 v198, s70, v198
    v_mul_f32 v199, s70, v199
    v_cvt_pk_bf16_f32 v82, v196, v197
    v_cvt_pk_bf16_f32 v83, v198, v199
    v_mul_f32 v200, s70, v200
    v_mul_f32 v201, s70, v201
    v_mul_f32 v202, s70, v202
    v_mul_f32 v203, s70, v203
    v_mfma_f32_16x16x32_bf16 v[236:239], a[28:31], a[124:127], v[236:239]
    ds_read_b128 a[144:147], v8 offset:4096
    v_cvt_pk_bf16_f32 v84, v200, v201
    v_cvt_pk_bf16_f32 v85, v202, v203
    v_mul_f32 v204, s70, v204
    v_mul_f32 v205, s70, v205
    v_mul_f32 v206, s70, v206
    v_mul_f32 v207, s70, v207
    v_cvt_pk_bf16_f32 v86, v204, v205
    v_cvt_pk_bf16_f32 v87, v206, v207
    v_mfma_f32_16x16x32_bf16 v[240:243], a[32:35], a[120:123], v[240:243]
    ds_read_b128 a[148:151], v9 offset:4096
    v_permlane32_swap_b32 v80, v82
    v_permlane32_swap_b32 v81, v83
    v_permlane32_swap_b32 v84, v86
    v_permlane32_swap_b32 v85, v87
    v_permlane16_swap_b32 v80, v82
    v_permlane16_swap_b32 v81, v83
    v_permlane16_swap_b32 v84, v86
    v_mfma_f32_16x16x32_bf16 v[240:243], a[36:39], a[124:127], v[240:243]
    ds_read_b128 a[152:155], v10 offset:4096
    v_permlane16_swap_b32 v85, v87
    v_accvgpr_write_b32 a224, v80
    v_accvgpr_write_b32 a225, v81
    v_accvgpr_write_b32 a226, v82
    v_accvgpr_write_b32 a227, v83
    v_accvgpr_write_b32 a228, v84
    v_accvgpr_write_b32 a229, v85
    v_mfma_f32_16x16x32_bf16 v[244:247], a[40:43], a[120:123], v[244:247]
    ds_read_b128 a[156:159], v11 offset:4096
    v_accvgpr_write_b32 a230, v86
    v_accvgpr_write_b32 a231, v87
    v_mul_f32 v208, s70, v208
    v_mul_f32 v209, s70, v209
    v_mul_f32 v210, s70, v210
    v_mul_f32 v211, s70, v211
    v_cvt_pk_bf16_f32 v80, v208, v209
    v_mfma_f32_16x16x32_bf16 v[244:247], a[44:47], a[124:127], v[244:247]
    v_cvt_pk_bf16_f32 v81, v210, v211
    v_mul_f32 v212, s70, v212
    v_mul_f32 v213, s70, v213
    v_mul_f32 v214, s70, v214
    v_mul_f32 v215, s70, v215
    v_cvt_pk_bf16_f32 v82, v212, v213
    v_cvt_pk_bf16_f32 v83, v214, v215
    v_mfma_f32_16x16x32_bf16 v[248:251], a[48:51], a[120:123], v[248:251]
    v_mul_f32 v216, s70, v216
    v_mul_f32 v217, s70, v217
    v_mul_f32 v218, s70, v218
    v_mul_f32 v219, s70, v219
    v_cvt_pk_bf16_f32 v84, v216, v217
    v_cvt_pk_bf16_f32 v85, v218, v219
    v_mul_f32 v220, s70, v220
    v_mfma_f32_16x16x32_bf16 v[248:251], a[52:55], a[124:127], v[248:251]
    v_mul_f32 v221, s70, v221
    v_mul_f32 v222, s70, v222
    v_mul_f32 v223, s70, v223
    v_cvt_pk_bf16_f32 v86, v220, v221
    v_cvt_pk_bf16_f32 v87, v222, v223
    v_permlane32_swap_b32 v80, v82
    v_permlane32_swap_b32 v81, v83
    v_mfma_f32_16x16x32_bf16 v[252:255], a[56:59], a[120:123], v[252:255]
    v_permlane32_swap_b32 v84, v86
    v_permlane32_swap_b32 v85, v87
    v_permlane16_swap_b32 v80, v82
    v_permlane16_swap_b32 v81, v83
    v_permlane16_swap_b32 v84, v86
    v_permlane16_swap_b32 v85, v87
    v_accvgpr_write_b32 a232, v80
    v_mfma_f32_16x16x32_bf16 v[252:255], a[60:63], a[124:127], v[252:255]
    v_accvgpr_write_b32 a233, v81
    v_accvgpr_write_b32 a234, v82
    v_accvgpr_write_b32 a235, v83
    v_accvgpr_write_b32 a236, v84
    v_accvgpr_write_b32 a237, v85
    v_accvgpr_write_b32 a238, v86
    v_accvgpr_write_b32 a239, v87
    s_waitcnt lgkmcnt(0)
    v_mfma_f32_16x16x32_bf16 v[48:51], a[128:131], a[192:195], 0
    v_mul_f32 v224, s70, v224
    v_mul_f32 v225, s70, v225
    v_mul_f32 v226, s70, v226
    v_mul_f32 v227, s70, v227
    v_cvt_pk_bf16_f32 v80, v224, v225
    v_cvt_pk_bf16_f32 v81, v226, v227
    v_mul_f32 v228, s70, v228
    v_mfma_f32_16x16x32_bf16 v[48:51], a[132:135], a[196:199], v[48:51]
    v_mul_f32 v229, s70, v229
    v_mul_f32 v230, s70, v230
    v_mul_f32 v231, s70, v231
    v_cvt_pk_bf16_f32 v82, v228, v229
    v_cvt_pk_bf16_f32 v83, v230, v231
    v_mul_f32 v232, s70, v232
    v_mul_f32 v233, s70, v233
    v_mfma_f32_16x16x32_bf16 v[48:51], a[136:139], a[200:203], v[48:51]
    v_mul_f32 v234, s70, v234
    v_mul_f32 v235, s70, v235
    v_cvt_pk_bf16_f32 v84, v232, v233
    v_cvt_pk_bf16_f32 v85, v234, v235
    v_mul_f32 v236, s70, v236
    v_mul_f32 v237, s70, v237
    v_mul_f32 v238, s70, v238
    v_mfma_f32_16x16x32_bf16 v[48:51], a[140:143], a[204:207], v[48:51]
    v_mul_f32 v239, s70, v239
    v_cvt_pk_bf16_f32 v86, v236, v237
    v_cvt_pk_bf16_f32 v87, v238, v239
    v_permlane32_swap_b32 v80, v82
    v_permlane32_swap_b32 v81, v83
    v_permlane32_swap_b32 v84, v86
    v_permlane32_swap_b32 v85, v87
    v_mfma_f32_16x16x32_bf16 v[56:59], a[128:131], a[208:211], 0
    v_permlane16_swap_b32 v80, v82
    v_permlane16_swap_b32 v81, v83
    v_permlane16_swap_b32 v84, v86
    v_permlane16_swap_b32 v85, v87
    v_accvgpr_write_b32 a240, v80
    v_accvgpr_write_b32 a241, v81
    v_accvgpr_write_b32 a242, v82
    v_mfma_f32_16x16x32_bf16 v[56:59], a[132:135], a[212:215], v[56:59]
    v_accvgpr_write_b32 a243, v83
    v_accvgpr_write_b32 a244, v84
    v_accvgpr_write_b32 a245, v85
    v_accvgpr_write_b32 a246, v86
    v_accvgpr_write_b32 a247, v87
    v_mul_f32 v240, s70, v240
    v_mul_f32 v241, s70, v241
    v_mfma_f32_16x16x32_bf16 v[56:59], a[136:139], a[216:219], v[56:59]
    v_mul_f32 v242, s70, v242
    v_mul_f32 v243, s70, v243
    v_cvt_pk_bf16_f32 v80, v240, v241
    v_cvt_pk_bf16_f32 v81, v242, v243
    v_mul_f32 v244, s70, v244
    v_mul_f32 v245, s70, v245
    v_mul_f32 v246, s70, v246
    v_mfma_f32_16x16x32_bf16 v[56:59], a[140:143], a[220:223], v[56:59]
    v_mul_f32 v247, s70, v247
    v_cvt_pk_bf16_f32 v82, v244, v245
    v_cvt_pk_bf16_f32 v83, v246, v247
    v_mul_f32 v248, s70, v248
    v_mul_f32 v249, s70, v249
    v_mul_f32 v250, s70, v250
    v_mul_f32 v251, s70, v251
    v_max3_f32 v2, v48, v49, v50
    v_max_f32 v2, v2, v51
    v_mov_b32 v3, v2
    s_nop 1
    v_permlane32_swap_b32 v2, v3
    v_max_f32 v2, v2, v3
    v_mov_b32 v3, v2
    s_nop 1
    v_permlane16_swap_b32 v2, v3
    v_min_f32_e64 v96, -v2, -v3
    v_mov_b32 v97, v96
    v_mov_b32 v98, v96
    v_mov_b32 v99, v96
    v_mfma_f32_16x16x32_bf16 v[64:67], a[128:131], a[224:227], 0
    v_cvt_pk_bf16_f32 v84, v248, v249
    v_cvt_pk_bf16_f32 v85, v250, v251
    v_mul_f32 v252, s70, v252
    v_mul_f32 v253, s70, v253
    v_mul_f32 v254, s70, v254
    v_mul_f32 v255, s70, v255
    v_cvt_pk_bf16_f32 v86, v252, v253
    v_mfma_f32_16x16x32_bf16 v[64:67], a[132:135], a[228:231], v[64:67]
    v_cvt_pk_bf16_f32 v87, v254, v255
    v_permlane32_swap_b32 v80, v82
    v_permlane32_swap_b32 v81, v83
    v_permlane32_swap_b32 v84, v86
    v_permlane32_swap_b32 v85, v87
    v_permlane16_swap_b32 v80, v82
    v_permlane16_swap_b32 v81, v83
    v_mfma_f32_16x16x32_bf16 v[64:67], a[136:139], a[232:235], v[64:67]
    v_permlane16_swap_b32 v84, v86
    v_permlane16_swap_b32 v85, v87
    v_accvgpr_write_b32 a248, v80
    v_accvgpr_write_b32 a249, v81
    v_accvgpr_write_b32 a250, v82
    v_accvgpr_write_b32 a251, v83
    v_accvgpr_write_b32 a252, v84
    v_mfma_f32_16x16x32_bf16 v[64:67], a[140:143], a[236:239], v[64:67]
    v_accvgpr_write_b32 a253, v85
    v_accvgpr_write_b32 a254, v86
    v_accvgpr_write_b32 a255, v87
    v_max3_f32 v4, v56, v57, v58
    v_max_f32 v4, v4, v59
    v_mov_b32 v5, v4
    s_nop 1
    v_permlane32_swap_b32 v4, v5
    v_max_f32 v4, v4, v5
    v_mov_b32 v5, v4
    s_nop 1
    v_permlane16_swap_b32 v4, v5
    v_min_f32_e64 v100, -v4, -v5
    v_mov_b32 v101, v100
    v_mov_b32 v102, v100
    v_mov_b32 v103, v100
    v_mfma_f32_16x16x32_bf16 v[72:75], a[128:131], a[240:243], 0
    v_mfma_f32_16x16x32_bf16 v[72:75], a[132:135], a[244:247], v[72:75]
    v_mfma_f32_16x16x32_bf16 v[72:75], a[136:139], a[248:251], v[72:75]
    v_mfma_f32_16x16x32_bf16 v[72:75], a[140:143], a[252:255], v[72:75]
    v_max3_f32 v2, v64, v65, v66
    v_max_f32 v2, v2, v67
    v_mov_b32 v3, v2
    s_nop 1
    v_permlane32_swap_b32 v2, v3
    v_max_f32 v2, v2, v3
    v_mov_b32 v3, v2
    s_nop 1
    v_permlane16_swap_b32 v2, v3
    v_min_f32_e64 v104, -v2, -v3
    v_mov_b32 v105, v104
    v_mov_b32 v106, v104
    v_mov_b32 v107, v104
    v_max3_f32 v4, v72, v73, v74
    v_max_f32 v4, v4, v75
    v_mov_b32 v5, v4
    s_nop 1
    v_permlane32_swap_b32 v4, v5
    v_max_f32 v4, v4, v5
    v_mov_b32 v5, v4
    s_nop 1
    v_permlane16_swap_b32 v4, v5
    v_min_f32_e64 v108, -v4, -v5
    v_mov_b32 v109, v108
    v_mov_b32 v110, v108
    v_mov_b32 v111, v108
    v_mfma_f32_16x16x32_bf16 v[48:51], a[128:131], a[192:195], v[96:99]
    v_mfma_f32_16x16x32_bf16 v[48:51], a[132:135], a[196:199], v[48:51]
    v_mfma_f32_16x16x32_bf16 v[48:51], a[136:139], a[200:203], v[48:51]
    v_mfma_f32_16x16x32_bf16 v[48:51], a[140:143], a[204:207], v[48:51]
    v_mfma_f32_16x16x32_bf16 v[52:55], a[144:147], a[192:195], v[96:99]
    v_mfma_f32_16x16x32_bf16 v[52:55], a[148:151], a[196:199], v[52:55]
    v_mfma_f32_16x16x32_bf16 v[52:55], a[152:155], a[200:203], v[52:55]
    v_mfma_f32_16x16x32_bf16 v[52:55], a[156:159], a[204:207], v[52:55]
    s_add_u32 m0, s53, 0x8000
    s_mov_b32 s64, 0x8000
    buffer_load_dwordx4 v20, s[12:15], s64 offen nt lds
    s_nop 0
    v_exp_f32 v48, v48
    s_waitcnt vmcnt(9)
    s_barrier
    ds_read_b64_tr_b16 a[160:161], v12 offset:32768
    v_exp_f32 v49, v49
    ds_read_b64_tr_b16 a[162:163], v12 offset:36864
    v_cvt_pk_bf16_f32 v80, v48, v49
    ds_read_b64_tr_b16 a[164:165], v13 offset:32768
    v_exp_f32 v50, v50
    v_mfma_f32_16x16x32_bf16 v[56:59], a[128:131], a[208:211], v[100:103]
    ds_read_b64_tr_b16 a[166:167], v13 offset:36864
    v_mfma_f32_16x16x32_bf16 v[56:59], a[132:135], a[212:215], v[56:59]
    ds_read_b64_tr_b16 a[168:169], v14 offset:32768
    v_exp_f32 v51, v51
    v_mfma_f32_16x16x32_bf16 v[56:59], a[136:139], a[216:219], v[56:59]
    ds_read_b64_tr_b16 a[170:171], v14 offset:36864
    v_cvt_pk_bf16_f32 v81, v50, v51
    v_mfma_f32_16x16x32_bf16 v[56:59], a[140:143], a[220:223], v[56:59]
    ds_read_b64_tr_b16 a[172:173], v15 offset:32768
    v_exp_f32 v52, v52
    v_mfma_f32_16x16x32_bf16 v[60:63], a[144:147], a[208:211], v[100:103]
    ds_read_b64_tr_b16 a[174:175], v15 offset:36864
    v_mfma_f32_16x16x32_bf16 v[60:63], a[148:151], a[212:215], v[60:63]
    s_add_u32 m0, s53, 0x8000
    s_mov_b32 s64, 0x8000
    buffer_load_dwordx4 v21, s[12:15], s64 offen offset:1024 nt lds
    ds_read_b64_tr_b16 a[176:177], v16 offset:32768
    v_exp_f32 v53, v53
    v_mfma_f32_16x16x32_bf16 v[60:63], a[152:155], a[216:219], v[60:63]
    ds_read_b64_tr_b16 a[178:179], v16 offset:36864
    v_cvt_pk_bf16_f32 v82, v52, v53
    v_mfma_f32_16x16x32_bf16 v[60:63], a[156:159], a[220:223], v[60:63]
    ds_read_b64_tr_b16 a[180:181], v17 offset:32768
    v_exp_f32 v54, v54
    ds_read_b64_tr_b16 a[182:183], v17 offset:36864
    ds_read_b64_tr_b16 a[184:185], v18 offset:32768
    v_exp_f32 v55, v55
    ds_read_b64_tr_b16 a[186:187], v18 offset:36864
    v_cvt_pk_bf16_f32 v83, v54, v55
    ds_read_b64_tr_b16 a[188:189], v19 offset:32768
    ds_read_b64_tr_b16 a[190:191], v19 offset:36864
    v_exp_f32 v56, v56
    v_exp_f32 v57, v57
    s_nop 0
    v_cvt_pk_bf16_f32 v84, v56, v57
    v_exp_f32 v58, v58
    v_mfma_f32_16x16x32_bf16 v[64:67], a[128:131], a[224:227], v[104:107]
    v_mfma_f32_16x16x32_bf16 v[64:67], a[132:135], a[228:231], v[64:67]
    s_add_u32 m0, s53, 0x8000
    s_mov_b32 s64, 0x8000
    buffer_load_dwordx4 v22, s[12:15], s64 offen offset:2048 nt lds
    v_exp_f32 v59, v59
    v_mfma_f32_16x16x32_bf16 v[64:67], a[136:139], a[232:235], v[64:67]
    v_cvt_pk_bf16_f32 v85, v58, v59
    v_mfma_f32_16x16x32_bf16 v[64:67], a[140:143], a[236:239], v[64:67]
    v_exp_f32 v60, v60
    v_mfma_f32_16x16x32_bf16 v[68:71], a[144:147], a[224:227], v[104:107]
    v_mfma_f32_16x16x32_bf16 v[68:71], a[148:151], a[228:231], v[68:71]
    v_exp_f32 v61, v61
    v_mfma_f32_16x16x32_bf16 v[68:71], a[152:155], a[232:235], v[68:71]
    v_cvt_pk_bf16_f32 v86, v60, v61
    v_mfma_f32_16x16x32_bf16 v[68:71], a[156:159], a[236:239], v[68:71]
    v_exp_f32 v62, v62
    s_waitcnt lgkmcnt(0)
    v_mfma_f32_16x16x32_bf16 v[128:131], a[160:163], v[80:83], 0
    v_mfma_f32_16x16x32_bf16 v[132:135], a[164:167], v[80:83], 0
    v_exp_f32 v63, v63
    v_mfma_f32_16x16x32_bf16 v[136:139], a[168:171], v[80:83], 0
    v_cvt_pk_bf16_f32 v87, v62, v63
    v_mfma_f32_16x16x32_bf16 v[140:143], a[172:175], v[80:83], 0
    v_mfma_f32_16x16x32_bf16 v[144:147], a[176:179], v[80:83], 0
    v_exp_f32 v64, v64
    v_mfma_f32_16x16x32_bf16 v[148:151], a[180:183], v[80:83], 0
    ds_read_b128 a[0:3], v8 offset:8192
    v_mfma_f32_16x16x32_bf16 v[152:155], a[184:187], v[80:83], 0
    s_add_u32 m0, s53, 0x8000
    s_mov_b32 s64, 0x8000
    buffer_load_dwordx4 v23, s[12:15], s64 offen offset:3072 nt lds
    v_exp_f32 v65, v65
    v_mfma_f32_16x16x32_bf16 v[156:159], a[188:191], v[80:83], 0
    ds_read_b128 a[4:7], v9 offset:8192
    v_cvt_pk_bf16_f32 v88, v64, v65
    v_mfma_f32_16x16x32_bf16 v[112:115], v[28:31], v[80:83], 0
    v_exp_f32 v66, v66
    v_mfma_f32_16x16x32_bf16 v[72:75], a[128:131], a[240:243], v[108:111]
    ds_read_b128 a[8:11], v10 offset:8192
    v_mfma_f32_16x16x32_bf16 v[72:75], a[132:135], a[244:247], v[72:75]
    v_exp_f32 v67, v67
    v_mfma_f32_16x16x32_bf16 v[72:75], a[136:139], a[248:251], v[72:75]
    ds_read_b128 a[12:15], v11 offset:8192
    v_cvt_pk_bf16_f32 v89, v66, v67
    v_mfma_f32_16x16x32_bf16 v[72:75], a[140:143], a[252:255], v[72:75]
    v_exp_f32 v68, v68
    v_mfma_f32_16x16x32_bf16 v[76:79], a[144:147], a[240:243], v[108:111]
    ds_read_b128 a[16:19], v8 offset:12288
    v_mfma_f32_16x16x32_bf16 v[76:79], a[148:151], a[244:247], v[76:79]
    v_exp_f32 v69, v69
    v_mfma_f32_16x16x32_bf16 v[76:79], a[152:155], a[248:251], v[76:79]
    ds_read_b128 a[20:23], v9 offset:12288
    v_cvt_pk_bf16_f32 v90, v68, v69
    v_mfma_f32_16x16x32_bf16 v[76:79], a[156:159], a[252:255], v[76:79]
    v_exp_f32 v70, v70
    v_mfma_f32_16x16x32_bf16 v[160:163], a[160:163], v[84:87], 0
    v_mfma_f32_16x16x32_bf16 v[164:167], a[164:167], v[84:87], 0
    v_exp_f32 v71, v71
    v_mfma_f32_16x16x32_bf16 v[168:171], a[168:171], v[84:87], 0
    s_add_u32 m0, s53, 0x14000
    s_mov_b32 s64, 0x8000
    buffer_load_dwordx4 v24, s[16:19], s64 offen nt lds
    ds_read_b128 a[24:27], v10 offset:12288
    v_cvt_pk_bf16_f32 v91, v70, v71
    v_mfma_f32_16x16x32_bf16 v[172:175], a[172:175], v[84:87], 0
    v_mfma_f32_16x16x32_bf16 v[176:179], a[176:179], v[84:87], 0
    v_exp_f32 v72, v72
    v_mfma_f32_16x16x32_bf16 v[180:183], a[180:183], v[84:87], 0
    ds_read_b128 a[28:31], v11 offset:12288
    v_mfma_f32_16x16x32_bf16 v[184:187], a[184:187], v[84:87], 0
    v_exp_f32 v73, v73
    v_mfma_f32_16x16x32_bf16 v[188:191], a[188:191], v[84:87], 0
    v_cvt_pk_bf16_f32 v92, v72, v73
    v_mfma_f32_16x16x32_bf16 v[116:119], v[28:31], v[84:87], 0
    v_exp_f32 v74, v74
    s_waitcnt lgkmcnt(2)
    v_mfma_f32_16x16x32_bf16 v[48:51], a[0:3], a[192:195], v[96:99]
    ds_read_b64_tr_b16 a[32:33], v12 offset:40960
    v_mfma_f32_16x16x32_bf16 v[48:51], a[4:7], a[196:199], v[48:51]
    v_exp_f32 v75, v75
    v_mfma_f32_16x16x32_bf16 v[48:51], a[8:11], a[200:203], v[48:51]
    ds_read_b64_tr_b16 a[34:35], v12 offset:45056
    v_cvt_pk_bf16_f32 v93, v74, v75
    v_mfma_f32_16x16x32_bf16 v[48:51], a[12:15], a[204:207], v[48:51]
    v_exp_f32 v76, v76
    v_mfma_f32_16x16x32_bf16 v[52:55], a[16:19], a[192:195], v[96:99]
    ds_read_b64_tr_b16 a[36:37], v13 offset:40960
    v_mfma_f32_16x16x32_bf16 v[52:55], a[20:23], a[196:199], v[52:55]
    v_exp_f32 v77, v77
    s_waitcnt lgkmcnt(3)
    v_mfma_f32_16x16x32_bf16 v[52:55], a[24:27], a[200:203], v[52:55]
    s_add_u32 m0, s53, 0x14000
    s_mov_b32 s64, 0x8000
    buffer_load_dwordx4 v25, s[16:19], s64 offen offset:1024 nt lds
    ds_read_b64_tr_b16 a[38:39], v13 offset:45056
    v_cvt_pk_bf16_f32 v94, v76, v77
    v_mfma_f32_16x16x32_bf16 v[52:55], a[28:31], a[204:207], v[52:55]
    v_exp_f32 v78, v78
    v_mfma_f32_16x16x32_bf16 v[192:195], a[160:163], v[88:91], 0
    v_mfma_f32_16x16x32_bf16 v[196:199], a[164:167], v[88:91], 0
    v_exp_f32 v79, v79
    v_mfma_f32_16x16x32_bf16 v[200:203], a[168:171], v[88:91], 0
    ds_read_b64_tr_b16 a[40:41], v14 offset:40960
    v_cvt_pk_bf16_f32 v95, v78, v79
    v_mfma_f32_16x16x32_bf16 v[204:207], a[172:175], v[88:91], 0
    ds_read_b64_tr_b16 a[42:43], v14 offset:45056
    v_mfma_f32_16x16x32_bf16 v[208:211], a[176:179], v[88:91], 0
    v_exp_f32 v48, v48
    v_mfma_f32_16x16x32_bf16 v[212:215], a[180:183], v[88:91], 0
    ds_read_b64_tr_b16 a[44:45], v15 offset:40960
    v_mfma_f32_16x16x32_bf16 v[216:219], a[184:187], v[88:91], 0
    v_exp_f32 v49, v49
    v_mfma_f32_16x16x32_bf16 v[220:223], a[188:191], v[88:91], 0
    ds_read_b64_tr_b16 a[46:47], v15 offset:45056
    v_cvt_pk_bf16_f32 v80, v48, v49
    v_mfma_f32_16x16x32_bf16 v[120:123], v[28:31], v[88:91], 0
    v_exp_f32 v50, v50
    v_mfma_f32_16x16x32_bf16 v[56:59], a[0:3], a[208:211], v[100:103]
    ds_read_b64_tr_b16 a[48:49], v16 offset:40960
    v_mfma_f32_16x16x32_bf16 v[56:59], a[4:7], a[212:215], v[56:59]
    v_exp_f32 v51, v51
    v_mfma_f32_16x16x32_bf16 v[56:59], a[8:11], a[216:219], v[56:59]
    s_add_u32 m0, s53, 0x14000
    s_mov_b32 s64, 0x8000
    buffer_load_dwordx4 v24, s[16:19], s64 offen offset:2048 nt lds
    ds_read_b64_tr_b16 a[50:51], v16 offset:45056
    v_cvt_pk_bf16_f32 v81, v50, v51
    v_mfma_f32_16x16x32_bf16 v[56:59], a[12:15], a[220:223], v[56:59]
    v_exp_f32 v52, v52
    v_mfma_f32_16x16x32_bf16 v[60:63], a[16:19], a[208:211], v[100:103]
    ds_read_b64_tr_b16 a[52:53], v17 offset:40960
    v_mfma_f32_16x16x32_bf16 v[60:63], a[20:23], a[212:215], v[60:63]
    v_exp_f32 v53, v53
    v_mfma_f32_16x16x32_bf16 v[60:63], a[24:27], a[216:219], v[60:63]
    ds_read_b64_tr_b16 a[54:55], v17 offset:45056
    v_cvt_pk_bf16_f32 v82, v52, v53
    v_mfma_f32_16x16x32_bf16 v[60:63], a[28:31], a[220:223], v[60:63]
    v_exp_f32 v54, v54
    v_mfma_f32_16x16x32_bf16 v[224:227], a[160:163], v[92:95], 0
    v_mfma_f32_16x16x32_bf16 v[228:231], a[164:167], v[92:95], 0
    v_exp_f32 v55, v55
    v_mfma_f32_16x16x32_bf16 v[232:235], a[168:171], v[92:95], 0
    ds_read_b64_tr_b16 a[56:57], v18 offset:40960
    v_cvt_pk_bf16_f32 v83, v54, v55
    v_mfma_f32_16x16x32_bf16 v[236:239], a[172:175], v[92:95], 0
    ds_read_b64_tr_b16 a[58:59], v18 offset:45056
    v_mfma_f32_16x16x32_bf16 v[240:243], a[176:179], v[92:95], 0
    v_exp_f32 v56, v56
    v_mfma_f32_16x16x32_bf16 v[244:247], a[180:183], v[92:95], 0
    ds_read_b64_tr_b16 a[60:61], v19 offset:40960
    v_mfma_f32_16x16x32_bf16 v[248:251], a[184:187], v[92:95], 0
    v_exp_f32 v57, v57
    v_mfma_f32_16x16x32_bf16 v[252:255], a[188:191], v[92:95], 0
    s_add_u32 m0, s53, 0x14000
    s_mov_b32 s64, 0x8000
    buffer_load_dwordx4 v25, s[16:19], s64 offen offset:3072 nt lds
    ds_read_b64_tr_b16 a[62:63], v19 offset:45056
    v_cvt_pk_bf16_f32 v84, v56, v57
    v_mfma_f32_16x16x32_bf16 v[124:127], v[28:31], v[92:95], 0
    v_exp_f32 v58, v58
    v_mfma_f32_16x16x32_bf16 v[64:67], a[0:3], a[224:227], v[104:107]
    v_mfma_f32_16x16x32_bf16 v[64:67], a[4:7], a[228:231], v[64:67]
    v_exp_f32 v59, v59
    v_mfma_f32_16x16x32_bf16 v[64:67], a[8:11], a[232:235], v[64:67]
    v_cvt_pk_bf16_f32 v85, v58, v59
    v_mfma_f32_16x16x32_bf16 v[64:67], a[12:15], a[236:239], v[64:67]
    s_mov_b32 s64, 0x8000
    v_exp_f32 v60, v60
    v_mfma_f32_16x16x32_bf16 v[68:71], a[16:19], a[224:227], v[104:107]
    v_mfma_f32_16x16x32_bf16 v[68:71], a[20:23], a[228:231], v[68:71]
    v_exp_f32 v61, v61
    v_mfma_f32_16x16x32_bf16 v[68:71], a[24:27], a[232:235], v[68:71]
    s_add_u32 m0, s53, 0xc000
    v_cvt_pk_bf16_f32 v86, v60, v61
    v_mfma_f32_16x16x32_bf16 v[68:71], a[28:31], a[236:239], v[68:71]
    s_add_u32 s64, s64, 0x4000
    v_exp_f32 v62, v62
    s_waitcnt lgkmcnt(0)
    v_mfma_f32_16x16x32_bf16 v[128:131], a[32:35], v[80:83], v[128:131]
    buffer_load_dwordx4 v20, s[12:15], s64 offen nt lds
    v_mfma_f32_16x16x32_bf16 v[132:135], a[36:39], v[80:83], v[132:135]
    v_exp_f32 v63, v63
    v_mfma_f32_16x16x32_bf16 v[136:139], a[40:43], v[80:83], v[136:139]
    v_cvt_pk_bf16_f32 v87, v62, v63
    v_mfma_f32_16x16x32_bf16 v[140:143], a[44:47], v[80:83], v[140:143]
    s_waitcnt vmcnt(9) lgkmcnt(0)
    s_barrier
    v_mfma_f32_16x16x32_bf16 v[144:147], a[48:51], v[80:83], v[144:147]
    v_exp_f32 v64, v64
    v_mfma_f32_16x16x32_bf16 v[148:151], a[52:55], v[80:83], v[148:151]
    ds_read_b128 a[128:131], v8 offset:16384
    v_mfma_f32_16x16x32_bf16 v[152:155], a[56:59], v[80:83], v[152:155]
    v_exp_f32 v65, v65
    v_mfma_f32_16x16x32_bf16 v[156:159], a[60:63], v[80:83], v[156:159]
    ds_read_b128 a[132:135], v9 offset:16384
    v_cvt_pk_bf16_f32 v88, v64, v65
    v_mfma_f32_16x16x32_bf16 v[112:115], v[28:31], v[80:83], v[112:115]
    v_exp_f32 v66, v66
    v_mfma_f32_16x16x32_bf16 v[72:75], a[0:3], a[240:243], v[108:111]
    ds_read_b128 a[136:139], v10 offset:16384
    v_mfma_f32_16x16x32_bf16 v[72:75], a[4:7], a[244:247], v[72:75]
    v_exp_f32 v67, v67
    v_mfma_f32_16x16x32_bf16 v[72:75], a[8:11], a[248:251], v[72:75]
    ds_read_b128 a[140:143], v11 offset:16384
    v_cvt_pk_bf16_f32 v89, v66, v67
    v_mfma_f32_16x16x32_bf16 v[72:75], a[12:15], a[252:255], v[72:75]
    v_exp_f32 v68, v68
    v_mfma_f32_16x16x32_bf16 v[76:79], a[16:19], a[240:243], v[108:111]
    ds_read_b128 a[144:147], v8 offset:20480
    v_mfma_f32_16x16x32_bf16 v[76:79], a[20:23], a[244:247], v[76:79]
    v_exp_f32 v69, v69
    v_mfma_f32_16x16x32_bf16 v[76:79], a[24:27], a[248:251], v[76:79]
    ds_read_b128 a[148:151], v9 offset:20480
    v_cvt_pk_bf16_f32 v90, v68, v69
    v_mfma_f32_16x16x32_bf16 v[76:79], a[28:31], a[252:255], v[76:79]
    v_exp_f32 v70, v70
    v_mfma_f32_16x16x32_bf16 v[160:163], a[32:35], v[84:87], v[160:163]
    buffer_load_dwordx4 v21, s[12:15], s64 offen offset:1024 nt lds
    v_mfma_f32_16x16x32_bf16 v[164:167], a[36:39], v[84:87], v[164:167]
    v_exp_f32 v71, v71
    v_mfma_f32_16x16x32_bf16 v[168:171], a[40:43], v[84:87], v[168:171]
    ds_read_b128 a[152:155], v10 offset:20480
    v_cvt_pk_bf16_f32 v91, v70, v71
    v_mfma_f32_16x16x32_bf16 v[172:175], a[44:47], v[84:87], v[172:175]
    v_mfma_f32_16x16x32_bf16 v[176:179], a[48:51], v[84:87], v[176:179]
    v_exp_f32 v72, v72
    v_mfma_f32_16x16x32_bf16 v[180:183], a[52:55], v[84:87], v[180:183]
    ds_read_b128 a[156:159], v11 offset:20480
    v_mfma_f32_16x16x32_bf16 v[184:187], a[56:59], v[84:87], v[184:187]
    v_exp_f32 v73, v73
    v_mfma_f32_16x16x32_bf16 v[188:191], a[60:63], v[84:87], v[188:191]
    v_cvt_pk_bf16_f32 v92, v72, v73
    v_mfma_f32_16x16x32_bf16 v[116:119], v[28:31], v[84:87], v[116:119]
    v_exp_f32 v74, v74
    s_mov_b32 s66, 3
L_attn:
    s_waitcnt lgkmcnt(2)
    v_mfma_f32_16x16x32_bf16 v[48:51], a[128:131], a[192:195], v[96:99]
    ds_read_b64_tr_b16 a[160:161], v12
    v_mfma_f32_16x16x32_bf16 v[48:51], a[132:135], a[196:199], v[48:51]
    v_exp_f32 v75, v75
    v_mfma_f32_16x16x32_bf16 v[48:51], a[136:139], a[200:203], v[48:51]
    ds_read_b64_tr_b16 a[162:163], v12 offset:4096
    v_cvt_pk_bf16_f32 v93, v74, v75
    v_mfma_f32_16x16x32_bf16 v[48:51], a[140:143], a[204:207], v[48:51]
    v_exp_f32 v76, v76
    v_mfma_f32_16x16x32_bf16 v[52:55], a[144:147], a[192:195], v[96:99]
    ds_read_b64_tr_b16 a[164:165], v13
    v_mfma_f32_16x16x32_bf16 v[52:55], a[148:151], a[196:199], v[52:55]
    v_exp_f32 v77, v77
    s_waitcnt lgkmcnt(3)
    v_mfma_f32_16x16x32_bf16 v[52:55], a[152:155], a[200:203], v[52:55]
    ds_read_b64_tr_b16 a[166:167], v13 offset:4096
    v_cvt_pk_bf16_f32 v94, v76, v77
    v_mfma_f32_16x16x32_bf16 v[52:55], a[156:159], a[204:207], v[52:55]
    v_exp_f32 v78, v78
    v_mfma_f32_16x16x32_bf16 v[192:195], a[32:35], v[88:91], v[192:195]
    buffer_load_dwordx4 v22, s[12:15], s64 offen offset:2048 nt lds
    v_mfma_f32_16x16x32_bf16 v[196:199], a[36:39], v[88:91], v[196:199]
    v_exp_f32 v79, v79
    v_mfma_f32_16x16x32_bf16 v[200:203], a[40:43], v[88:91], v[200:203]
    ds_read_b64_tr_b16 a[168:169], v14
    v_cvt_pk_bf16_f32 v95, v78, v79
    v_mfma_f32_16x16x32_bf16 v[204:207], a[44:47], v[88:91], v[204:207]
    ds_read_b64_tr_b16 a[170:171], v14 offset:4096
    v_mfma_f32_16x16x32_bf16 v[208:211], a[48:51], v[88:91], v[208:211]
    v_exp_f32 v48, v48
    v_mfma_f32_16x16x32_bf16 v[212:215], a[52:55], v[88:91], v[212:215]
    ds_read_b64_tr_b16 a[172:173], v15
    v_mfma_f32_16x16x32_bf16 v[216:219], a[56:59], v[88:91], v[216:219]
    v_exp_f32 v49, v49
    v_mfma_f32_16x16x32_bf16 v[220:223], a[60:63], v[88:91], v[220:223]
    ds_read_b64_tr_b16 a[174:175], v15 offset:4096
    v_cvt_pk_bf16_f32 v80, v48, v49
    v_mfma_f32_16x16x32_bf16 v[120:123], v[28:31], v[88:91], v[120:123]
    v_exp_f32 v50, v50
    v_mfma_f32_16x16x32_bf16 v[56:59], a[128:131], a[208:211], v[100:103]
    ds_read_b64_tr_b16 a[176:177], v16
    v_mfma_f32_16x16x32_bf16 v[56:59], a[132:135], a[212:215], v[56:59]
    v_exp_f32 v51, v51
    v_mfma_f32_16x16x32_bf16 v[56:59], a[136:139], a[216:219], v[56:59]
    ds_read_b64_tr_b16 a[178:179], v16 offset:4096
    v_cvt_pk_bf16_f32 v81, v50, v51
    v_mfma_f32_16x16x32_bf16 v[56:59], a[140:143], a[220:223], v[56:59]
    v_exp_f32 v52, v52
    v_mfma_f32_16x16x32_bf16 v[60:63], a[144:147], a[208:211], v[100:103]
    ds_read_b64_tr_b16 a[180:181], v17
    v_mfma_f32_16x16x32_bf16 v[60:63], a[148:151], a[212:215], v[60:63]
    v_exp_f32 v53, v53
    v_mfma_f32_16x16x32_bf16 v[60:63], a[152:155], a[216:219], v[60:63]
    ds_read_b64_tr_b16 a[182:183], v17 offset:4096
    v_cvt_pk_bf16_f32 v82, v52, v53
    v_mfma_f32_16x16x32_bf16 v[60:63], a[156:159], a[220:223], v[60:63]
    v_exp_f32 v54, v54
    v_mfma_f32_16x16x32_bf16 v[224:227], a[32:35], v[92:95], v[224:227]
    buffer_load_dwordx4 v23, s[12:15], s64 offen offset:3072 nt lds
    v_mfma_f32_16x16x32_bf16 v[228:231], a[36:39], v[92:95], v[228:231]
    v_exp_f32 v55, v55
    v_mfma_f32_16x16x32_bf16 v[232:235], a[40:43], v[92:95], v[232:235]
    ds_read_b64_tr_b16 a[184:185], v18
    v_cvt_pk_bf16_f32 v83, v54, v55
    v_mfma_f32_16x16x32_bf16 v[236:239], a[44:47], v[92:95], v[236:239]
    ds_read_b64_tr_b16 a[186:187], v18 offset:4096
    v_mfma_f32_16x16x32_bf16 v[240:243], a[48:51], v[92:95], v[240:243]
    v_exp_f32 v56, v56
    v_mfma_f32_16x16x32_bf16 v[244:247], a[52:55], v[92:95], v[244:247]
    ds_read_b64_tr_b16 a[188:189], v19
    v_mfma_f32_16x16x32_bf16 v[248:251], a[56:59], v[92:95], v[248:251]
    v_exp_f32 v57, v57
    v_mfma_f32_16x16x32_bf16 v[252:255], a[60:63], v[92:95], v[252:255]
    ds_read_b64_tr_b16 a[190:191], v19 offset:4096
    v_cvt_pk_bf16_f32 v84, v56, v57
    v_mfma_f32_16x16x32_bf16 v[124:127], v[28:31], v[92:95], v[124:127]
    v_exp_f32 v58, v58
    v_mfma_f32_16x16x32_bf16 v[64:67], a[128:131], a[224:227], v[104:107]
    v_mfma_f32_16x16x32_bf16 v[64:67], a[132:135], a[228:231], v[64:67]
    v_exp_f32 v59, v59
    v_mfma_f32_16x16x32_bf16 v[64:67], a[136:139], a[232:235], v[64:67]
    v_cvt_pk_bf16_f32 v85, v58, v59
    v_mfma_f32_16x16x32_bf16 v[64:67], a[140:143], a[236:239], v[64:67]
    v_exp_f32 v60, v60
    v_mfma_f32_16x16x32_bf16 v[68:71], a[144:147], a[224:227], v[104:107]
    v_mfma_f32_16x16x32_bf16 v[68:71], a[148:151], a[228:231], v[68:71]
    v_exp_f32 v61, v61
    v_mfma_f32_16x16x32_bf16 v[68:71], a[152:155], a[232:235], v[68:71]
    s_add_u32 m0, s53, 0x1c000
    v_cvt_pk_bf16_f32 v86, v60, v61
    v_mfma_f32_16x16x32_bf16 v[68:71], a[156:159], a[236:239], v[68:71]
    v_exp_f32 v62, v62
    s_waitcnt lgkmcnt(0)
    v_mfma_f32_16x16x32_bf16 v[128:131], a[160:163], v[80:83], v[128:131]
    buffer_load_dwordx4 v24, s[16:19], s64 offen nt lds
    v_mfma_f32_16x16x32_bf16 v[132:135], a[164:167], v[80:83], v[132:135]
    v_exp_f32 v63, v63
    v_mfma_f32_16x16x32_bf16 v[136:139], a[168:171], v[80:83], v[136:139]
    v_cvt_pk_bf16_f32 v87, v62, v63
    v_mfma_f32_16x16x32_bf16 v[140:143], a[172:175], v[80:83], v[140:143]
    v_mfma_f32_16x16x32_bf16 v[144:147], a[176:179], v[80:83], v[144:147]
    v_exp_f32 v64, v64
    v_mfma_f32_16x16x32_bf16 v[148:151], a[180:183], v[80:83], v[148:151]
    ds_read_b128 a[0:3], v8 offset:24576
    v_mfma_f32_16x16x32_bf16 v[152:155], a[184:187], v[80:83], v[152:155]
    v_exp_f32 v65, v65
    v_mfma_f32_16x16x32_bf16 v[156:159], a[188:191], v[80:83], v[156:159]
    ds_read_b128 a[4:7], v9 offset:24576
    v_cvt_pk_bf16_f32 v88, v64, v65
    v_mfma_f32_16x16x32_bf16 v[112:115], v[28:31], v[80:83], v[112:115]
    v_exp_f32 v66, v66
    v_mfma_f32_16x16x32_bf16 v[72:75], a[128:131], a[240:243], v[108:111]
    ds_read_b128 a[8:11], v10 offset:24576
    v_mfma_f32_16x16x32_bf16 v[72:75], a[132:135], a[244:247], v[72:75]
    v_exp_f32 v67, v67
    v_mfma_f32_16x16x32_bf16 v[72:75], a[136:139], a[248:251], v[72:75]
    ds_read_b128 a[12:15], v11 offset:24576
    v_cvt_pk_bf16_f32 v89, v66, v67
    v_mfma_f32_16x16x32_bf16 v[72:75], a[140:143], a[252:255], v[72:75]
    v_exp_f32 v68, v68
    v_mfma_f32_16x16x32_bf16 v[76:79], a[144:147], a[240:243], v[108:111]
    ds_read_b128 a[16:19], v8 offset:28672
    v_mfma_f32_16x16x32_bf16 v[76:79], a[148:151], a[244:247], v[76:79]
    v_exp_f32 v69, v69
    v_mfma_f32_16x16x32_bf16 v[76:79], a[152:155], a[248:251], v[76:79]
    ds_read_b128 a[20:23], v9 offset:28672
    v_cvt_pk_bf16_f32 v90, v68, v69
    v_mfma_f32_16x16x32_bf16 v[76:79], a[156:159], a[252:255], v[76:79]
    v_exp_f32 v70, v70
    v_mfma_f32_16x16x32_bf16 v[160:163], a[160:163], v[84:87], v[160:163]
    buffer_load_dwordx4 v25, s[16:19], s64 offen offset:1024 nt lds
    v_mfma_f32_16x16x32_bf16 v[164:167], a[164:167], v[84:87], v[164:167]
    v_exp_f32 v71, v71
    v_mfma_f32_16x16x32_bf16 v[168:171], a[168:171], v[84:87], v[168:171]
    ds_read_b128 a[24:27], v10 offset:28672
    v_cvt_pk_bf16_f32 v91, v70, v71
    v_mfma_f32_16x16x32_bf16 v[172:175], a[172:175], v[84:87], v[172:175]
    v_mfma_f32_16x16x32_bf16 v[176:179], a[176:179], v[84:87], v[176:179]
    v_exp_f32 v72, v72
    v_mfma_f32_16x16x32_bf16 v[180:183], a[180:183], v[84:87], v[180:183]
    ds_read_b128 a[28:31], v11 offset:28672
    v_mfma_f32_16x16x32_bf16 v[184:187], a[184:187], v[84:87], v[184:187]
    v_exp_f32 v73, v73
    v_mfma_f32_16x16x32_bf16 v[188:191], a[188:191], v[84:87], v[188:191]
    v_cvt_pk_bf16_f32 v92, v72, v73
    v_mfma_f32_16x16x32_bf16 v[116:119], v[28:31], v[84:87], v[116:119]
    v_exp_f32 v74, v74
    s_waitcnt lgkmcnt(2)
    v_mfma_f32_16x16x32_bf16 v[48:51], a[0:3], a[192:195], v[96:99]
    ds_read_b64_tr_b16 a[32:33], v12 offset:8192
    v_mfma_f32_16x16x32_bf16 v[48:51], a[4:7], a[196:199], v[48:51]
    v_exp_f32 v75, v75
    v_mfma_f32_16x16x32_bf16 v[48:51], a[8:11], a[200:203], v[48:51]
    ds_read_b64_tr_b16 a[34:35], v12 offset:12288
    v_cvt_pk_bf16_f32 v93, v74, v75
    v_mfma_f32_16x16x32_bf16 v[48:51], a[12:15], a[204:207], v[48:51]
    v_exp_f32 v76, v76
    v_mfma_f32_16x16x32_bf16 v[52:55], a[16:19], a[192:195], v[96:99]
    ds_read_b64_tr_b16 a[36:37], v13 offset:8192
    v_mfma_f32_16x16x32_bf16 v[52:55], a[20:23], a[196:199], v[52:55]
    v_exp_f32 v77, v77
    s_waitcnt lgkmcnt(3)
    v_mfma_f32_16x16x32_bf16 v[52:55], a[24:27], a[200:203], v[52:55]
    ds_read_b64_tr_b16 a[38:39], v13 offset:12288
    v_cvt_pk_bf16_f32 v94, v76, v77
    v_mfma_f32_16x16x32_bf16 v[52:55], a[28:31], a[204:207], v[52:55]
    v_exp_f32 v78, v78
    v_mfma_f32_16x16x32_bf16 v[192:195], a[160:163], v[88:91], v[192:195]
    buffer_load_dwordx4 v24, s[16:19], s64 offen offset:2048 nt lds
    v_mfma_f32_16x16x32_bf16 v[196:199], a[164:167], v[88:91], v[196:199]
    v_exp_f32 v79, v79
    v_mfma_f32_16x16x32_bf16 v[200:203], a[168:171], v[88:91], v[200:203]
    ds_read_b64_tr_b16 a[40:41], v14 offset:8192
    v_cvt_pk_bf16_f32 v95, v78, v79
    v_mfma_f32_16x16x32_bf16 v[204:207], a[172:175], v[88:91], v[204:207]
    ds_read_b64_tr_b16 a[42:43], v14 offset:12288
    v_mfma_f32_16x16x32_bf16 v[208:211], a[176:179], v[88:91], v[208:211]
    v_exp_f32 v48, v48
    v_mfma_f32_16x16x32_bf16 v[212:215], a[180:183], v[88:91], v[212:215]
    ds_read_b64_tr_b16 a[44:45], v15 offset:8192
    v_mfma_f32_16x16x32_bf16 v[216:219], a[184:187], v[88:91], v[216:219]
    v_exp_f32 v49, v49
    v_mfma_f32_16x16x32_bf16 v[220:223], a[188:191], v[88:91], v[220:223]
    ds_read_b64_tr_b16 a[46:47], v15 offset:12288
    v_cvt_pk_bf16_f32 v80, v48, v49
    v_mfma_f32_16x16x32_bf16 v[120:123], v[28:31], v[88:91], v[120:123]
    v_exp_f32 v50, v50
    v_mfma_f32_16x16x32_bf16 v[56:59], a[0:3], a[208:211], v[100:103]
    ds_read_b64_tr_b16 a[48:49], v16 offset:8192
    v_mfma_f32_16x16x32_bf16 v[56:59], a[4:7], a[212:215], v[56:59]
    v_exp_f32 v51, v51
    v_mfma_f32_16x16x32_bf16 v[56:59], a[8:11], a[216:219], v[56:59]
    ds_read_b64_tr_b16 a[50:51], v16 offset:12288
    v_cvt_pk_bf16_f32 v81, v50, v51
    v_mfma_f32_16x16x32_bf16 v[56:59], a[12:15], a[220:223], v[56:59]
    v_exp_f32 v52, v52
    v_mfma_f32_16x16x32_bf16 v[60:63], a[16:19], a[208:211], v[100:103]
    ds_read_b64_tr_b16 a[52:53], v17 offset:8192
    v_mfma_f32_16x16x32_bf16 v[60:63], a[20:23], a[212:215], v[60:63]
    v_exp_f32 v53, v53
    v_mfma_f32_16x16x32_bf16 v[60:63], a[24:27], a[216:219], v[60:63]
    ds_read_b64_tr_b16 a[54:55], v17 offset:12288
    v_cvt_pk_bf16_f32 v82, v52, v53
    v_mfma_f32_16x16x32_bf16 v[60:63], a[28:31], a[220:223], v[60:63]
    v_exp_f32 v54, v54
    v_mfma_f32_16x16x32_bf16 v[224:227], a[160:163], v[92:95], v[224:227]
    buffer_load_dwordx4 v25, s[16:19], s64 offen offset:3072 nt lds
    v_mfma_f32_16x16x32_bf16 v[228:231], a[164:167], v[92:95], v[228:231]
    v_exp_f32 v55, v55
    v_mfma_f32_16x16x32_bf16 v[232:235], a[168:171], v[92:95], v[232:235]
    ds_read_b64_tr_b16 a[56:57], v18 offset:8192
    v_cvt_pk_bf16_f32 v83, v54, v55
    v_mfma_f32_16x16x32_bf16 v[236:239], a[172:175], v[92:95], v[236:239]
    ds_read_b64_tr_b16 a[58:59], v18 offset:12288
    v_mfma_f32_16x16x32_bf16 v[240:243], a[176:179], v[92:95], v[240:243]
    v_exp_f32 v56, v56
    v_mfma_f32_16x16x32_bf16 v[244:247], a[180:183], v[92:95], v[244:247]
    ds_read_b64_tr_b16 a[60:61], v19 offset:8192
    v_mfma_f32_16x16x32_bf16 v[248:251], a[184:187], v[92:95], v[248:251]
    v_exp_f32 v57, v57
    v_mfma_f32_16x16x32_bf16 v[252:255], a[188:191], v[92:95], v[252:255]
    ds_read_b64_tr_b16 a[62:63], v19 offset:12288
    v_cvt_pk_bf16_f32 v84, v56, v57
    v_mfma_f32_16x16x32_bf16 v[124:127], v[28:31], v[92:95], v[124:127]
    v_exp_f32 v58, v58
    v_mfma_f32_16x16x32_bf16 v[64:67], a[0:3], a[224:227], v[104:107]
    v_mfma_f32_16x16x32_bf16 v[64:67], a[4:7], a[228:231], v[64:67]
    v_exp_f32 v59, v59
    v_mfma_f32_16x16x32_bf16 v[64:67], a[8:11], a[232:235], v[64:67]
    v_cvt_pk_bf16_f32 v85, v58, v59
    v_mfma_f32_16x16x32_bf16 v[64:67], a[12:15], a[236:239], v[64:67]
    v_exp_f32 v60, v60
    v_mfma_f32_16x16x32_bf16 v[68:71], a[16:19], a[224:227], v[104:107]
    v_mfma_f32_16x16x32_bf16 v[68:71], a[20:23], a[228:231], v[68:71]
    v_exp_f32 v61, v61
    v_mfma_f32_16x16x32_bf16 v[68:71], a[24:27], a[232:235], v[68:71]
    s_add_u32 m0, s53, 0
    v_cvt_pk_bf16_f32 v86, v60, v61
    v_mfma_f32_16x16x32_bf16 v[68:71], a[28:31], a[236:239], v[68:71]
    s_add_u32 s64, s64, 0x4000
    v_exp_f32 v62, v62
    s_waitcnt lgkmcnt(0)
    v_mfma_f32_16x16x32_bf16 v[128:131], a[32:35], v[80:83], v[128:131]
    buffer_load_dwordx4 v20, s[12:15], s64 offen nt lds
    v_mfma_f32_16x16x32_bf16 v[132:135], a[36:39], v[80:83], v[132:135]
    v_exp_f32 v63, v63
    v_mfma_f32_16x16x32_bf16 v[136:139], a[40:43], v[80:83], v[136:139]
    v_cvt_pk_bf16_f32 v87, v62, v63
    v_mfma_f32_16x16x32_bf16 v[140:143], a[44:47], v[80:83], v[140:143]
    s_waitcnt vmcnt(9) lgkmcnt(0)
    s_barrier
    v_mfma_f32_16x16x32_bf16 v[144:147], a[48:51], v[80:83], v[144:147]
    v_exp_f32 v64, v64
    v_mfma_f32_16x16x32_bf16 v[148:151], a[52:55], v[80:83], v[148:151]
    ds_read_b128 a[128:131], v8 offset:32768
    v_mfma_f32_16x16x32_bf16 v[152:155], a[56:59], v[80:83], v[152:155]
    v_exp_f32 v65, v65
    v_mfma_f32_16x16x32_bf16 v[156:159], a[60:63], v[80:83], v[156:159]
    ds_read_b128 a[132:135], v9 offset:32768
    v_cvt_pk_bf16_f32 v88, v64, v65
    v_mfma_f32_16x16x32_bf16 v[112:115], v[28:31], v[80:83], v[112:115]
    v_exp_f32 v66, v66
    v_mfma_f32_16x16x32_bf16 v[72:75], a[0:3], a[240:243], v[108:111]
    ds_read_b128 a[136:139], v10 offset:32768
    v_mfma_f32_16x16x32_bf16 v[72:75], a[4:7], a[244:247], v[72:75]
    v_exp_f32 v67, v67
    v_mfma_f32_16x16x32_bf16 v[72:75], a[8:11], a[248:251], v[72:75]
    ds_read_b128 a[140:143], v11 offset:32768
    v_cvt_pk_bf16_f32 v89, v66, v67
    v_mfma_f32_16x16x32_bf16 v[72:75], a[12:15], a[252:255], v[72:75]
    v_exp_f32 v68, v68
    v_mfma_f32_16x16x32_bf16 v[76:79], a[16:19], a[240:243], v[108:111]
    ds_read_b128 a[144:147], v8 offset:36864
    v_mfma_f32_16x16x32_bf16 v[76:79], a[20:23], a[244:247], v[76:79]
    v_exp_f32 v69, v69
    v_mfma_f32_16x16x32_bf16 v[76:79], a[24:27], a[248:251], v[76:79]
    ds_read_b128 a[148:151], v9 offset:36864
    v_cvt_pk_bf16_f32 v90, v68, v69
    v_mfma_f32_16x16x32_bf16 v[76:79], a[28:31], a[252:255], v[76:79]
    v_exp_f32 v70, v70
    v_mfma_f32_16x16x32_bf16 v[160:163], a[32:35], v[84:87], v[160:163]
    buffer_load_dwordx4 v21, s[12:15], s64 offen offset:1024 nt lds
    v_mfma_f32_16x16x32_bf16 v[164:167], a[36:39], v[84:87], v[164:167]
    v_exp_f32 v71, v71
    v_mfma_f32_16x16x32_bf16 v[168:171], a[40:43], v[84:87], v[168:171]
    ds_read_b128 a[152:155], v10 offset:36864
    v_cvt_pk_bf16_f32 v91, v70, v71
    v_mfma_f32_16x16x32_bf16 v[172:175], a[44:47], v[84:87], v[172:175]
    v_mfma_f32_16x16x32_bf16 v[176:179], a[48:51], v[84:87], v[176:179]
    v_exp_f32 v72, v72
    v_mfma_f32_16x16x32_bf16 v[180:183], a[52:55], v[84:87], v[180:183]
    ds_read_b128 a[156:159], v11 offset:36864
    v_mfma_f32_16x16x32_bf16 v[184:187], a[56:59], v[84:87], v[184:187]
    v_exp_f32 v73, v73
    v_mfma_f32_16x16x32_bf16 v[188:191], a[60:63], v[84:87], v[188:191]
    v_cvt_pk_bf16_f32 v92, v72, v73
    v_mfma_f32_16x16x32_bf16 v[116:119], v[28:31], v[84:87], v[116:119]
    v_exp_f32 v74, v74
    s_waitcnt lgkmcnt(2)
    v_mfma_f32_16x16x32_bf16 v[48:51], a[128:131], a[192:195], v[96:99]
    ds_read_b64_tr_b16 a[160:161], v12 offset:16384
    v_mfma_f32_16x16x32_bf16 v[48:51], a[132:135], a[196:199], v[48:51]
    v_exp_f32 v75, v75
    v_mfma_f32_16x16x32_bf16 v[48:51], a[136:139], a[200:203], v[48:51]
    ds_read_b64_tr_b16 a[162:163], v12 offset:20480
    v_cvt_pk_bf16_f32 v93, v74, v75
    v_mfma_f32_16x16x32_bf16 v[48:51], a[140:143], a[204:207], v[48:51]
    v_exp_f32 v76, v76
    v_mfma_f32_16x16x32_bf16 v[52:55], a[144:147], a[192:195], v[96:99]
    ds_read_b64_tr_b16 a[164:165], v13 offset:16384
    v_mfma_f32_16x16x32_bf16 v[52:55], a[148:151], a[196:199], v[52:55]
    v_exp_f32 v77, v77
    s_waitcnt lgkmcnt(3)
    v_mfma_f32_16x16x32_bf16 v[52:55], a[152:155], a[200:203], v[52:55]
    ds_read_b64_tr_b16 a[166:167], v13 offset:20480
    v_cvt_pk_bf16_f32 v94, v76, v77
    v_mfma_f32_16x16x32_bf16 v[52:55], a[156:159], a[204:207], v[52:55]
    v_exp_f32 v78, v78
    v_mfma_f32_16x16x32_bf16 v[192:195], a[32:35], v[88:91], v[192:195]
    buffer_load_dwordx4 v22, s[12:15], s64 offen offset:2048 nt lds
    v_mfma_f32_16x16x32_bf16 v[196:199], a[36:39], v[88:91], v[196:199]
    v_exp_f32 v79, v79
    v_mfma_f32_16x16x32_bf16 v[200:203], a[40:43], v[88:91], v[200:203]
    ds_read_b64_tr_b16 a[168:169], v14 offset:16384
    v_cvt_pk_bf16_f32 v95, v78, v79
    v_mfma_f32_16x16x32_bf16 v[204:207], a[44:47], v[88:91], v[204:207]
    ds_read_b64_tr_b16 a[170:171], v14 offset:20480
    v_mfma_f32_16x16x32_bf16 v[208:211], a[48:51], v[88:91], v[208:211]
    v_exp_f32 v48, v48
    v_mfma_f32_16x16x32_bf16 v[212:215], a[52:55], v[88:91], v[212:215]
    ds_read_b64_tr_b16 a[172:173], v15 offset:16384
    v_mfma_f32_16x16x32_bf16 v[216:219], a[56:59], v[88:91], v[216:219]
    v_exp_f32 v49, v49
    v_mfma_f32_16x16x32_bf16 v[220:223], a[60:63], v[88:91], v[220:223]
    ds_read_b64_tr_b16 a[174:175], v15 offset:20480
    v_cvt_pk_bf16_f32 v80, v48, v49
    v_mfma_f32_16x16x32_bf16 v[120:123], v[28:31], v[88:91], v[120:123]
    v_exp_f32 v50, v50
    v_mfma_f32_16x16x32_bf16 v[56:59], a[128:131], a[208:211], v[100:103]
    ds_read_b64_tr_b16 a[176:177], v16 offset:16384
    v_mfma_f32_16x16x32_bf16 v[56:59], a[132:135], a[212:215], v[56:59]
    v_exp_f32 v51, v51
    v_mfma_f32_16x16x32_bf16 v[56:59], a[136:139], a[216:219], v[56:59]
    ds_read_b64_tr_b16 a[178:179], v16 offset:20480
    v_cvt_pk_bf16_f32 v81, v50, v51
    v_mfma_f32_16x16x32_bf16 v[56:59], a[140:143], a[220:223], v[56:59]
    v_exp_f32 v52, v52
    v_mfma_f32_16x16x32_bf16 v[60:63], a[144:147], a[208:211], v[100:103]
    ds_read_b64_tr_b16 a[180:181], v17 offset:16384
    v_mfma_f32_16x16x32_bf16 v[60:63], a[148:151], a[212:215], v[60:63]
    v_exp_f32 v53, v53
    v_mfma_f32_16x16x32_bf16 v[60:63], a[152:155], a[216:219], v[60:63]
    ds_read_b64_tr_b16 a[182:183], v17 offset:20480
    v_cvt_pk_bf16_f32 v82, v52, v53
    v_mfma_f32_16x16x32_bf16 v[60:63], a[156:159], a[220:223], v[60:63]
    v_exp_f32 v54, v54
    v_mfma_f32_16x16x32_bf16 v[224:227], a[32:35], v[92:95], v[224:227]
    buffer_load_dwordx4 v23, s[12:15], s64 offen offset:3072 nt lds
    v_mfma_f32_16x16x32_bf16 v[228:231], a[36:39], v[92:95], v[228:231]
    v_exp_f32 v55, v55
    v_mfma_f32_16x16x32_bf16 v[232:235], a[40:43], v[92:95], v[232:235]
    ds_read_b64_tr_b16 a[184:185], v18 offset:16384
    v_cvt_pk_bf16_f32 v83, v54, v55
    v_mfma_f32_16x16x32_bf16 v[236:239], a[44:47], v[92:95], v[236:239]
    ds_read_b64_tr_b16 a[186:187], v18 offset:20480
    v_mfma_f32_16x16x32_bf16 v[240:243], a[48:51], v[92:95], v[240:243]
    v_exp_f32 v56, v56
    v_mfma_f32_16x16x32_bf16 v[244:247], a[52:55], v[92:95], v[244:247]
    ds_read_b64_tr_b16 a[188:189], v19 offset:16384
    v_mfma_f32_16x16x32_bf16 v[248:251], a[56:59], v[92:95], v[248:251]
    v_exp_f32 v57, v57
    v_mfma_f32_16x16x32_bf16 v[252:255], a[60:63], v[92:95], v[252:255]
    ds_read_b64_tr_b16 a[190:191], v19 offset:20480
    v_cvt_pk_bf16_f32 v84, v56, v57
    v_mfma_f32_16x16x32_bf16 v[124:127], v[28:31], v[92:95], v[124:127]
    v_exp_f32 v58, v58
    v_mfma_f32_16x16x32_bf16 v[64:67], a[128:131], a[224:227], v[104:107]
    v_mfma_f32_16x16x32_bf16 v[64:67], a[132:135], a[228:231], v[64:67]
    v_exp_f32 v59, v59
    v_mfma_f32_16x16x32_bf16 v[64:67], a[136:139], a[232:235], v[64:67]
    v_cvt_pk_bf16_f32 v85, v58, v59
    v_mfma_f32_16x16x32_bf16 v[64:67], a[140:143], a[236:239], v[64:67]
    v_exp_f32 v60, v60
    v_mfma_f32_16x16x32_bf16 v[68:71], a[144:147], a[224:227], v[104:107]
    v_mfma_f32_16x16x32_bf16 v[68:71], a[148:151], a[228:231], v[68:71]
    v_exp_f32 v61, v61
    v_mfma_f32_16x16x32_bf16 v[68:71], a[152:155], a[232:235], v[68:71]
    s_add_u32 m0, s53, 0x18000
    v_cvt_pk_bf16_f32 v86, v60, v61
    v_mfma_f32_16x16x32_bf16 v[68:71], a[156:159], a[236:239], v[68:71]
    v_exp_f32 v62, v62
    s_waitcnt lgkmcnt(0)
    v_mfma_f32_16x16x32_bf16 v[128:131], a[160:163], v[80:83], v[128:131]
    buffer_load_dwordx4 v24, s[16:19], s64 offen nt lds
    v_mfma_f32_16x16x32_bf16 v[132:135], a[164:167], v[80:83], v[132:135]
    v_exp_f32 v63, v63
    v_mfma_f32_16x16x32_bf16 v[136:139], a[168:171], v[80:83], v[136:139]
    v_cvt_pk_bf16_f32 v87, v62, v63
    v_mfma_f32_16x16x32_bf16 v[140:143], a[172:175], v[80:83], v[140:143]
    v_mfma_f32_16x16x32_bf16 v[144:147], a[176:179], v[80:83], v[144:147]
    v_exp_f32 v64, v64
    v_mfma_f32_16x16x32_bf16 v[148:151], a[180:183], v[80:83], v[148:151]
    ds_read_b128 a[0:3], v8 offset:40960
    v_mfma_f32_16x16x32_bf16 v[152:155], a[184:187], v[80:83], v[152:155]
    v_exp_f32 v65, v65
    v_mfma_f32_16x16x32_bf16 v[156:159], a[188:191], v[80:83], v[156:159]
    ds_read_b128 a[4:7], v9 offset:40960
    v_cvt_pk_bf16_f32 v88, v64, v65
    v_mfma_f32_16x16x32_bf16 v[112:115], v[28:31], v[80:83], v[112:115]
    v_exp_f32 v66, v66
    v_mfma_f32_16x16x32_bf16 v[72:75], a[128:131], a[240:243], v[108:111]
    ds_read_b128 a[8:11], v10 offset:40960
    v_mfma_f32_16x16x32_bf16 v[72:75], a[132:135], a[244:247], v[72:75]
    v_exp_f32 v67, v67
    v_mfma_f32_16x16x32_bf16 v[72:75], a[136:139], a[248:251], v[72:75]
    ds_read_b128 a[12:15], v11 offset:40960
    v_cvt_pk_bf16_f32 v89, v66, v67
    v_mfma_f32_16x16x32_bf16 v[72:75], a[140:143], a[252:255], v[72:75]
    v_exp_f32 v68, v68
    v_mfma_f32_16x16x32_bf16 v[76:79], a[144:147], a[240:243], v[108:111]
    ds_read_b128 a[16:19], v8 offset:45056
    v_mfma_f32_16x16x32_bf16 v[76:79], a[148:151], a[244:247], v[76:79]
    v_exp_f32 v69, v69
    v_mfma_f32_16x16x32_bf16 v[76:79], a[152:155], a[248:251], v[76:79]
    ds_read_b128 a[20:23], v9 offset:45056
    v_cvt_pk_bf16_f32 v90, v68, v69
    v_mfma_f32_16x16x32_bf16 v[76:79], a[156:159], a[252:255], v[76:79]
    v_exp_f32 v70, v70
    v_mfma_f32_16x16x32_bf16 v[160:163], a[160:163], v[84:87], v[160:163]
    buffer_load_dwordx4 v25, s[16:19], s64 offen offset:1024 nt lds
    v_mfma_f32_16x16x32_bf16 v[164:167], a[164:167], v[84:87], v[164:167]
    v_exp_f32 v71, v71
    v_mfma_f32_16x16x32_bf16 v[168:171], a[168:171], v[84:87], v[168:171]
    ds_read_b128 a[24:27], v10 offset:45056
    v_cvt_pk_bf16_f32 v91, v70, v71
    v_mfma_f32_16x16x32_bf16 v[172:175], a[172:175], v[84:87], v[172:175]
    v_mfma_f32_16x16x32_bf16 v[176:179], a[176:179], v[84:87], v[176:179]
    v_exp_f32 v72, v72
    v_mfma_f32_16x16x32_bf16 v[180:183], a[180:183], v[84:87], v[180:183]
    ds_read_b128 a[28:31], v11 offset:45056
    v_mfma_f32_16x16x32_bf16 v[184:187], a[184:187], v[84:87], v[184:187]
    v_exp_f32 v73, v73
    v_mfma_f32_16x16x32_bf16 v[188:191], a[188:191], v[84:87], v[188:191]
    v_cvt_pk_bf16_f32 v92, v72, v73
    v_mfma_f32_16x16x32_bf16 v[116:119], v[28:31], v[84:87], v[116:119]
    v_exp_f32 v74, v74
    s_waitcnt lgkmcnt(2)
    v_mfma_f32_16x16x32_bf16 v[48:51], a[0:3], a[192:195], v[96:99]
    ds_read_b64_tr_b16 a[32:33], v12 offset:24576
    v_mfma_f32_16x16x32_bf16 v[48:51], a[4:7], a[196:199], v[48:51]
    v_exp_f32 v75, v75
    v_mfma_f32_16x16x32_bf16 v[48:51], a[8:11], a[200:203], v[48:51]
    ds_read_b64_tr_b16 a[34:35], v12 offset:28672
    v_cvt_pk_bf16_f32 v93, v74, v75
    v_mfma_f32_16x16x32_bf16 v[48:51], a[12:15], a[204:207], v[48:51]
    v_exp_f32 v76, v76
    v_mfma_f32_16x16x32_bf16 v[52:55], a[16:19], a[192:195], v[96:99]
    ds_read_b64_tr_b16 a[36:37], v13 offset:24576
    v_mfma_f32_16x16x32_bf16 v[52:55], a[20:23], a[196:199], v[52:55]
    v_exp_f32 v77, v77
    s_waitcnt lgkmcnt(3)
    v_mfma_f32_16x16x32_bf16 v[52:55], a[24:27], a[200:203], v[52:55]
    ds_read_b64_tr_b16 a[38:39], v13 offset:28672
    v_cvt_pk_bf16_f32 v94, v76, v77
    v_mfma_f32_16x16x32_bf16 v[52:55], a[28:31], a[204:207], v[52:55]
    v_exp_f32 v78, v78
    v_mfma_f32_16x16x32_bf16 v[192:195], a[160:163], v[88:91], v[192:195]
    buffer_load_dwordx4 v24, s[16:19], s64 offen offset:2048 nt lds
    v_mfma_f32_16x16x32_bf16 v[196:199], a[164:167], v[88:91], v[196:199]
    v_exp_f32 v79, v79
    v_mfma_f32_16x16x32_bf16 v[200:203], a[168:171], v[88:91], v[200:203]
    ds_read_b64_tr_b16 a[40:41], v14 offset:24576
    v_cvt_pk_bf16_f32 v95, v78, v79
    v_mfma_f32_16x16x32_bf16 v[204:207], a[172:175], v[88:91], v[204:207]
    ds_read_b64_tr_b16 a[42:43], v14 offset:28672
    v_mfma_f32_16x16x32_bf16 v[208:211], a[176:179], v[88:91], v[208:211]
    v_exp_f32 v48, v48
    v_mfma_f32_16x16x32_bf16 v[212:215], a[180:183], v[88:91], v[212:215]
    ds_read_b64_tr_b16 a[44:45], v15 offset:24576
    v_mfma_f32_16x16x32_bf16 v[216:219], a[184:187], v[88:91], v[216:219]
    v_exp_f32 v49, v49
    v_mfma_f32_16x16x32_bf16 v[220:223], a[188:191], v[88:91], v[220:223]
    ds_read_b64_tr_b16 a[46:47], v15 offset:28672
    v_cvt_pk_bf16_f32 v80, v48, v49
    v_mfma_f32_16x16x32_bf16 v[120:123], v[28:31], v[88:91], v[120:123]
    v_exp_f32 v50, v50
    v_mfma_f32_16x16x32_bf16 v[56:59], a[0:3], a[208:211], v[100:103]
    ds_read_b64_tr_b16 a[48:49], v16 offset:24576
    v_mfma_f32_16x16x32_bf16 v[56:59], a[4:7], a[212:215], v[56:59]
    v_exp_f32 v51, v51
    v_mfma_f32_16x16x32_bf16 v[56:59], a[8:11], a[216:219], v[56:59]
    ds_read_b64_tr_b16 a[50:51], v16 offset:28672
    v_cvt_pk_bf16_f32 v81, v50, v51
    v_mfma_f32_16x16x32_bf16 v[56:59], a[12:15], a[220:223], v[56:59]
    v_exp_f32 v52, v52
    v_mfma_f32_16x16x32_bf16 v[60:63], a[16:19], a[208:211], v[100:103]
    ds_read_b64_tr_b16 a[52:53], v17 offset:24576
    v_mfma_f32_16x16x32_bf16 v[60:63], a[20:23], a[212:215], v[60:63]
    v_exp_f32 v53, v53
    v_mfma_f32_16x16x32_bf16 v[60:63], a[24:27], a[216:219], v[60:63]
    ds_read_b64_tr_b16 a[54:55], v17 offset:28672
    v_cvt_pk_bf16_f32 v82, v52, v53
    v_mfma_f32_16x16x32_bf16 v[60:63], a[28:31], a[220:223], v[60:63]
    v_exp_f32 v54, v54
    v_mfma_f32_16x16x32_bf16 v[224:227], a[160:163], v[92:95], v[224:227]
    buffer_load_dwordx4 v25, s[16:19], s64 offen offset:3072 nt lds
    v_mfma_f32_16x16x32_bf16 v[228:231], a[164:167], v[92:95], v[228:231]
    v_exp_f32 v55, v55
    v_mfma_f32_16x16x32_bf16 v[232:235], a[168:171], v[92:95], v[232:235]
    ds_read_b64_tr_b16 a[56:57], v18 offset:24576
    v_cvt_pk_bf16_f32 v83, v54, v55
    v_mfma_f32_16x16x32_bf16 v[236:239], a[172:175], v[92:95], v[236:239]
    ds_read_b64_tr_b16 a[58:59], v18 offset:28672
    v_mfma_f32_16x16x32_bf16 v[240:243], a[176:179], v[92:95], v[240:243]
    v_exp_f32 v56, v56
    v_mfma_f32_16x16x32_bf16 v[244:247], a[180:183], v[92:95], v[244:247]
    ds_read_b64_tr_b16 a[60:61], v19 offset:24576
    v_mfma_f32_16x16x32_bf16 v[248:251], a[184:187], v[92:95], v[248:251]
    v_exp_f32 v57, v57
    v_mfma_f32_16x16x32_bf16 v[252:255], a[188:191], v[92:95], v[252:255]
    ds_read_b64_tr_b16 a[62:63], v19 offset:28672
    v_cvt_pk_bf16_f32 v84, v56, v57
    v_mfma_f32_16x16x32_bf16 v[124:127], v[28:31], v[92:95], v[124:127]
    v_exp_f32 v58, v58
    v_mfma_f32_16x16x32_bf16 v[64:67], a[0:3], a[224:227], v[104:107]
    v_mfma_f32_16x16x32_bf16 v[64:67], a[4:7], a[228:231], v[64:67]
    v_exp_f32 v59, v59
    v_mfma_f32_16x16x32_bf16 v[64:67], a[8:11], a[232:235], v[64:67]
    v_cvt_pk_bf16_f32 v85, v58, v59
    v_mfma_f32_16x16x32_bf16 v[64:67], a[12:15], a[236:239], v[64:67]
    v_exp_f32 v60, v60
    v_mfma_f32_16x16x32_bf16 v[68:71], a[16:19], a[224:227], v[104:107]
    v_mfma_f32_16x16x32_bf16 v[68:71], a[20:23], a[228:231], v[68:71]
    v_exp_f32 v61, v61
    v_mfma_f32_16x16x32_bf16 v[68:71], a[24:27], a[232:235], v[68:71]
    s_add_u32 m0, s53, 0x4000
    v_cvt_pk_bf16_f32 v86, v60, v61
    v_mfma_f32_16x16x32_bf16 v[68:71], a[28:31], a[236:239], v[68:71]
    s_add_u32 s64, s64, 0x4000
    v_exp_f32 v62, v62
    s_waitcnt lgkmcnt(0)
    v_mfma_f32_16x16x32_bf16 v[128:131], a[32:35], v[80:83], v[128:131]
    buffer_load_dwordx4 v20, s[12:15], s64 offen nt lds
    v_mfma_f32_16x16x32_bf16 v[132:135], a[36:39], v[80:83], v[132:135]
    v_exp_f32 v63, v63
    v_mfma_f32_16x16x32_bf16 v[136:139], a[40:43], v[80:83], v[136:139]
    v_cvt_pk_bf16_f32 v87, v62, v63
    v_mfma_f32_16x16x32_bf16 v[140:143], a[44:47], v[80:83], v[140:143]
    s_waitcnt vmcnt(9) lgkmcnt(0)
    s_barrier
    v_mfma_f32_16x16x32_bf16 v[144:147], a[48:51], v[80:83], v[144:147]
    v_exp_f32 v64, v64
    v_mfma_f32_16x16x32_bf16 v[148:151], a[52:55], v[80:83], v[148:151]
    ds_read_b128 a[128:131], v8 offset:49152
    v_mfma_f32_16x16x32_bf16 v[152:155], a[56:59], v[80:83], v[152:155]
    v_exp_f32 v65, v65
    v_mfma_f32_16x16x32_bf16 v[156:159], a[60:63], v[80:83], v[156:159]
    ds_read_b128 a[132:135], v9 offset:49152
    v_cvt_pk_bf16_f32 v88, v64, v65
    v_mfma_f32_16x16x32_bf16 v[112:115], v[28:31], v[80:83], v[112:115]
    v_exp_f32 v66, v66
    v_mfma_f32_16x16x32_bf16 v[72:75], a[0:3], a[240:243], v[108:111]
    ds_read_b128 a[136:139], v10 offset:49152
    v_mfma_f32_16x16x32_bf16 v[72:75], a[4:7], a[244:247], v[72:75]
    v_exp_f32 v67, v67
    v_mfma_f32_16x16x32_bf16 v[72:75], a[8:11], a[248:251], v[72:75]
    ds_read_b128 a[140:143], v11 offset:49152
    v_cvt_pk_bf16_f32 v89, v66, v67
    v_mfma_f32_16x16x32_bf16 v[72:75], a[12:15], a[252:255], v[72:75]
    v_exp_f32 v68, v68
    v_mfma_f32_16x16x32_bf16 v[76:79], a[16:19], a[240:243], v[108:111]
    ds_read_b128 a[144:147], v8 offset:53248
    v_mfma_f32_16x16x32_bf16 v[76:79], a[20:23], a[244:247], v[76:79]
    v_exp_f32 v69, v69
    v_mfma_f32_16x16x32_bf16 v[76:79], a[24:27], a[248:251], v[76:79]
    ds_read_b128 a[148:151], v9 offset:53248
    v_cvt_pk_bf16_f32 v90, v68, v69
    v_mfma_f32_16x16x32_bf16 v[76:79], a[28:31], a[252:255], v[76:79]
    v_exp_f32 v70, v70
    v_mfma_f32_16x16x32_bf16 v[160:163], a[32:35], v[84:87], v[160:163]
    buffer_load_dwordx4 v21, s[12:15], s64 offen offset:1024 nt lds
    v_mfma_f32_16x16x32_bf16 v[164:167], a[36:39], v[84:87], v[164:167]
    v_exp_f32 v71, v71
    v_mfma_f32_16x16x32_bf16 v[168:171], a[40:43], v[84:87], v[168:171]
    ds_read_b128 a[152:155], v10 offset:53248
    v_cvt_pk_bf16_f32 v91, v70, v71
    v_mfma_f32_16x16x32_bf16 v[172:175], a[44:47], v[84:87], v[172:175]
    v_mfma_f32_16x16x32_bf16 v[176:179], a[48:51], v[84:87], v[176:179]
    v_exp_f32 v72, v72
    v_mfma_f32_16x16x32_bf16 v[180:183], a[52:55], v[84:87], v[180:183]
    ds_read_b128 a[156:159], v11 offset:53248
    v_mfma_f32_16x16x32_bf16 v[184:187], a[56:59], v[84:87], v[184:187]
    v_exp_f32 v73, v73
    v_mfma_f32_16x16x32_bf16 v[188:191], a[60:63], v[84:87], v[188:191]
    v_cvt_pk_bf16_f32 v92, v72, v73
    v_mfma_f32_16x16x32_bf16 v[116:119], v[28:31], v[84:87], v[116:119]
    v_exp_f32 v74, v74
    s_waitcnt lgkmcnt(2)
    v_mfma_f32_16x16x32_bf16 v[48:51], a[128:131], a[192:195], v[96:99]
    ds_read_b64_tr_b16 a[160:161], v12 offset:49152
    v_mfma_f32_16x16x32_bf16 v[48:51], a[132:135], a[196:199], v[48:51]
    v_exp_f32 v75, v75
    v_mfma_f32_16x16x32_bf16 v[48:51], a[136:139], a[200:203], v[48:51]
    ds_read_b64_tr_b16 a[162:163], v12 offset:53248
    v_cvt_pk_bf16_f32 v93, v74, v75
    v_mfma_f32_16x16x32_bf16 v[48:51], a[140:143], a[204:207], v[48:51]
    v_exp_f32 v76, v76
    v_mfma_f32_16x16x32_bf16 v[52:55], a[144:147], a[192:195], v[96:99]
    ds_read_b64_tr_b16 a[164:165], v13 offset:49152
    v_mfma_f32_16x16x32_bf16 v[52:55], a[148:151], a[196:199], v[52:55]
    v_exp_f32 v77, v77
    s_waitcnt lgkmcnt(3)
    v_mfma_f32_16x16x32_bf16 v[52:55], a[152:155], a[200:203], v[52:55]
    ds_read_b64_tr_b16 a[166:167], v13 offset:53248
    v_cvt_pk_bf16_f32 v94, v76, v77
    v_mfma_f32_16x16x32_bf16 v[52:55], a[156:159], a[204:207], v[52:55]
    v_exp_f32 v78, v78
    v_mfma_f32_16x16x32_bf16 v[192:195], a[32:35], v[88:91], v[192:195]
    buffer_load_dwordx4 v22, s[12:15], s64 offen offset:2048 nt lds
    v_mfma_f32_16x16x32_bf16 v[196:199], a[36:39], v[88:91], v[196:199]
    v_exp_f32 v79, v79
    v_mfma_f32_16x16x32_bf16 v[200:203], a[40:43], v[88:91], v[200:203]
    ds_read_b64_tr_b16 a[168:169], v14 offset:49152
    v_cvt_pk_bf16_f32 v95, v78, v79
    v_mfma_f32_16x16x32_bf16 v[204:207], a[44:47], v[88:91], v[204:207]
    ds_read_b64_tr_b16 a[170:171], v14 offset:53248
    v_mfma_f32_16x16x32_bf16 v[208:211], a[48:51], v[88:91], v[208:211]
    v_exp_f32 v48, v48
    v_mfma_f32_16x16x32_bf16 v[212:215], a[52:55], v[88:91], v[212:215]
    ds_read_b64_tr_b16 a[172:173], v15 offset:49152
    v_mfma_f32_16x16x32_bf16 v[216:219], a[56:59], v[88:91], v[216:219]
    v_exp_f32 v49, v49
    v_mfma_f32_16x16x32_bf16 v[220:223], a[60:63], v[88:91], v[220:223]
    ds_read_b64_tr_b16 a[174:175], v15 offset:53248
    v_cvt_pk_bf16_f32 v80, v48, v49
    v_mfma_f32_16x16x32_bf16 v[120:123], v[28:31], v[88:91], v[120:123]
    v_exp_f32 v50, v50
    v_mfma_f32_16x16x32_bf16 v[56:59], a[128:131], a[208:211], v[100:103]
    ds_read_b64_tr_b16 a[176:177], v16 offset:49152
    v_mfma_f32_16x16x32_bf16 v[56:59], a[132:135], a[212:215], v[56:59]
    v_exp_f32 v51, v51
    v_mfma_f32_16x16x32_bf16 v[56:59], a[136:139], a[216:219], v[56:59]
    ds_read_b64_tr_b16 a[178:179], v16 offset:53248
    v_cvt_pk_bf16_f32 v81, v50, v51
    v_mfma_f32_16x16x32_bf16 v[56:59], a[140:143], a[220:223], v[56:59]
    v_exp_f32 v52, v52
    v_mfma_f32_16x16x32_bf16 v[60:63], a[144:147], a[208:211], v[100:103]
    ds_read_b64_tr_b16 a[180:181], v17 offset:49152
    v_mfma_f32_16x16x32_bf16 v[60:63], a[148:151], a[212:215], v[60:63]
    v_exp_f32 v53, v53
    v_mfma_f32_16x16x32_bf16 v[60:63], a[152:155], a[216:219], v[60:63]
    ds_read_b64_tr_b16 a[182:183], v17 offset:53248
    v_cvt_pk_bf16_f32 v82, v52, v53
    v_mfma_f32_16x16x32_bf16 v[60:63], a[156:159], a[220:223], v[60:63]
    v_exp_f32 v54, v54
    v_mfma_f32_16x16x32_bf16 v[224:227], a[32:35], v[92:95], v[224:227]
    buffer_load_dwordx4 v23, s[12:15], s64 offen offset:3072 nt lds
    v_mfma_f32_16x16x32_bf16 v[228:231], a[36:39], v[92:95], v[228:231]
    v_exp_f32 v55, v55
    v_mfma_f32_16x16x32_bf16 v[232:235], a[40:43], v[92:95], v[232:235]
    ds_read_b64_tr_b16 a[184:185], v18 offset:49152
    v_cvt_pk_bf16_f32 v83, v54, v55
    v_mfma_f32_16x16x32_bf16 v[236:239], a[44:47], v[92:95], v[236:239]
    ds_read_b64_tr_b16 a[186:187], v18 offset:53248
    v_mfma_f32_16x16x32_bf16 v[240:243], a[48:51], v[92:95], v[240:243]
    v_exp_f32 v56, v56
    v_mfma_f32_16x16x32_bf16 v[244:247], a[52:55], v[92:95], v[244:247]
    ds_read_b64_tr_b16 a[188:189], v19 offset:49152
    v_mfma_f32_16x16x32_bf16 v[248:251], a[56:59], v[92:95], v[248:251]
    v_exp_f32 v57, v57
    v_mfma_f32_16x16x32_bf16 v[252:255], a[60:63], v[92:95], v[252:255]
    ds_read_b64_tr_b16 a[190:191], v19 offset:53248
    v_cvt_pk_bf16_f32 v84, v56, v57
    v_mfma_f32_16x16x32_bf16 v[124:127], v[28:31], v[92:95], v[124:127]
    v_exp_f32 v58, v58
    v_mfma_f32_16x16x32_bf16 v[64:67], a[128:131], a[224:227], v[104:107]
    v_mfma_f32_16x16x32_bf16 v[64:67], a[132:135], a[228:231], v[64:67]
    v_exp_f32 v59, v59
    v_mfma_f32_16x16x32_bf16 v[64:67], a[136:139], a[232:235], v[64:67]
    v_cvt_pk_bf16_f32 v85, v58, v59
    v_mfma_f32_16x16x32_bf16 v[64:67], a[140:143], a[236:239], v[64:67]
    v_exp_f32 v60, v60
    v_mfma_f32_16x16x32_bf16 v[68:71], a[144:147], a[224:227], v[104:107]
    v_mfma_f32_16x16x32_bf16 v[68:71], a[148:151], a[228:231], v[68:71]
    v_exp_f32 v61, v61
    v_mfma_f32_16x16x32_bf16 v[68:71], a[152:155], a[232:235], v[68:71]
    s_add_u32 m0, s53, 0x10000
    v_cvt_pk_bf16_f32 v86, v60, v61
    v_mfma_f32_16x16x32_bf16 v[68:71], a[156:159], a[236:239], v[68:71]
    v_exp_f32 v62, v62
    s_waitcnt lgkmcnt(0)
    v_mfma_f32_16x16x32_bf16 v[128:131], a[160:163], v[80:83], v[128:131]
    buffer_load_dwordx4 v24, s[16:19], s64 offen nt lds
    v_mfma_f32_16x16x32_bf16 v[132:135], a[164:167], v[80:83], v[132:135]
    v_exp_f32 v63, v63
    v_mfma_f32_16x16x32_bf16 v[136:139], a[168:171], v[80:83], v[136:139]
    v_cvt_pk_bf16_f32 v87, v62, v63
    v_mfma_f32_16x16x32_bf16 v[140:143], a[172:175], v[80:83], v[140:143]
    v_mfma_f32_16x16x32_bf16 v[144:147], a[176:179], v[80:83], v[144:147]
    v_exp_f32 v64, v64
    v_mfma_f32_16x16x32_bf16 v[148:151], a[180:183], v[80:83], v[148:151]
    ds_read_b128 a[0:3], v8 offset:57344
    v_mfma_f32_16x16x32_bf16 v[152:155], a[184:187], v[80:83], v[152:155]
    v_exp_f32 v65, v65
    v_mfma_f32_16x16x32_bf16 v[156:159], a[188:191], v[80:83], v[156:159]
    ds_read_b128 a[4:7], v9 offset:57344
    v_cvt_pk_bf16_f32 v88, v64, v65
    v_mfma_f32_16x16x32_bf16 v[112:115], v[28:31], v[80:83], v[112:115]
    v_exp_f32 v66, v66
    v_mfma_f32_16x16x32_bf16 v[72:75], a[128:131], a[240:243], v[108:111]
    ds_read_b128 a[8:11], v10 offset:57344
    v_mfma_f32_16x16x32_bf16 v[72:75], a[132:135], a[244:247], v[72:75]
    v_exp_f32 v67, v67
    v_mfma_f32_16x16x32_bf16 v[72:75], a[136:139], a[248:251], v[72:75]
    ds_read_b128 a[12:15], v11 offset:57344
    v_cvt_pk_bf16_f32 v89, v66, v67
    v_mfma_f32_16x16x32_bf16 v[72:75], a[140:143], a[252:255], v[72:75]
    v_exp_f32 v68, v68
    v_mfma_f32_16x16x32_bf16 v[76:79], a[144:147], a[240:243], v[108:111]
    ds_read_b128 a[16:19], v8 offset:61440
    v_mfma_f32_16x16x32_bf16 v[76:79], a[148:151], a[244:247], v[76:79]
    v_exp_f32 v69, v69
    v_mfma_f32_16x16x32_bf16 v[76:79], a[152:155], a[248:251], v[76:79]
    ds_read_b128 a[20:23], v9 offset:61440
    v_cvt_pk_bf16_f32 v90, v68, v69
    v_mfma_f32_16x16x32_bf16 v[76:79], a[156:159], a[252:255], v[76:79]
    v_exp_f32 v70, v70
    v_mfma_f32_16x16x32_bf16 v[160:163], a[160:163], v[84:87], v[160:163]
    buffer_load_dwordx4 v25, s[16:19], s64 offen offset:1024 nt lds
    v_mfma_f32_16x16x32_bf16 v[164:167], a[164:167], v[84:87], v[164:167]
    v_exp_f32 v71, v71
    v_mfma_f32_16x16x32_bf16 v[168:171], a[168:171], v[84:87], v[168:171]
    ds_read_b128 a[24:27], v10 offset:61440
    v_cvt_pk_bf16_f32 v91, v70, v71
    v_mfma_f32_16x16x32_bf16 v[172:175], a[172:175], v[84:87], v[172:175]
    v_mfma_f32_16x16x32_bf16 v[176:179], a[176:179], v[84:87], v[176:179]
    v_exp_f32 v72, v72
    v_mfma_f32_16x16x32_bf16 v[180:183], a[180:183], v[84:87], v[180:183]
    ds_read_b128 a[28:31], v11 offset:61440
    v_mfma_f32_16x16x32_bf16 v[184:187], a[184:187], v[84:87], v[184:187]
    v_exp_f32 v73, v73
    v_mfma_f32_16x16x32_bf16 v[188:191], a[188:191], v[84:87], v[188:191]
    v_cvt_pk_bf16_f32 v92, v72, v73
    v_mfma_f32_16x16x32_bf16 v[116:119], v[28:31], v[84:87], v[116:119]
    v_exp_f32 v74, v74
    s_waitcnt lgkmcnt(2)
    v_mfma_f32_16x16x32_bf16 v[48:51], a[0:3], a[192:195], v[96:99]
    ds_read_b64_tr_b16 a[32:33], v12 offset:57344
    v_mfma_f32_16x16x32_bf16 v[48:51], a[4:7], a[196:199], v[48:51]
    v_exp_f32 v75, v75
    v_mfma_f32_16x16x32_bf16 v[48:51], a[8:11], a[200:203], v[48:51]
    ds_read_b64_tr_b16 a[34:35], v12 offset:61440
    v_cvt_pk_bf16_f32 v93, v74, v75
    v_mfma_f32_16x16x32_bf16 v[48:51], a[12:15], a[204:207], v[48:51]
    v_exp_f32 v76, v76
    v_mfma_f32_16x16x32_bf16 v[52:55], a[16:19], a[192:195], v[96:99]
    ds_read_b64_tr_b16 a[36:37], v13 offset:57344
    v_mfma_f32_16x16x32_bf16 v[52:55], a[20:23], a[196:199], v[52:55]
    v_exp_f32 v77, v77
    s_waitcnt lgkmcnt(3)
    v_mfma_f32_16x16x32_bf16 v[52:55], a[24:27], a[200:203], v[52:55]
    ds_read_b64_tr_b16 a[38:39], v13 offset:61440
    v_cvt_pk_bf16_f32 v94, v76, v77
    v_mfma_f32_16x16x32_bf16 v[52:55], a[28:31], a[204:207], v[52:55]
    v_exp_f32 v78, v78
    v_mfma_f32_16x16x32_bf16 v[192:195], a[160:163], v[88:91], v[192:195]
    buffer_load_dwordx4 v24, s[16:19], s64 offen offset:2048 nt lds
    v_mfma_f32_16x16x32_bf16 v[196:199], a[164:167], v[88:91], v[196:199]
    v_exp_f32 v79, v79
    v_mfma_f32_16x16x32_bf16 v[200:203], a[168:171], v[88:91], v[200:203]
    ds_read_b64_tr_b16 a[40:41], v14 offset:57344
    v_cvt_pk_bf16_f32 v95, v78, v79
    v_mfma_f32_16x16x32_bf16 v[204:207], a[172:175], v[88:91], v[204:207]
    ds_read_b64_tr_b16 a[42:43], v14 offset:61440
    v_mfma_f32_16x16x32_bf16 v[208:211], a[176:179], v[88:91], v[208:211]
    v_exp_f32 v48, v48
    v_mfma_f32_16x16x32_bf16 v[212:215], a[180:183], v[88:91], v[212:215]
    ds_read_b64_tr_b16 a[44:45], v15 offset:57344
    v_mfma_f32_16x16x32_bf16 v[216:219], a[184:187], v[88:91], v[216:219]
    v_exp_f32 v49, v49
    v_mfma_f32_16x16x32_bf16 v[220:223], a[188:191], v[88:91], v[220:223]
    ds_read_b64_tr_b16 a[46:47], v15 offset:61440
    v_cvt_pk_bf16_f32 v80, v48, v49
    v_mfma_f32_16x16x32_bf16 v[120:123], v[28:31], v[88:91], v[120:123]
    v_exp_f32 v50, v50
    v_mfma_f32_16x16x32_bf16 v[56:59], a[0:3], a[208:211], v[100:103]
    ds_read_b64_tr_b16 a[48:49], v16 offset:57344
    v_mfma_f32_16x16x32_bf16 v[56:59], a[4:7], a[212:215], v[56:59]
    v_exp_f32 v51, v51
    v_mfma_f32_16x16x32_bf16 v[56:59], a[8:11], a[216:219], v[56:59]
    ds_read_b64_tr_b16 a[50:51], v16 offset:61440
    v_cvt_pk_bf16_f32 v81, v50, v51
    v_mfma_f32_16x16x32_bf16 v[56:59], a[12:15], a[220:223], v[56:59]
    v_exp_f32 v52, v52
    v_mfma_f32_16x16x32_bf16 v[60:63], a[16:19], a[208:211], v[100:103]
    ds_read_b64_tr_b16 a[52:53], v17 offset:57344
    v_mfma_f32_16x16x32_bf16 v[60:63], a[20:23], a[212:215], v[60:63]
    v_exp_f32 v53, v53
    v_mfma_f32_16x16x32_bf16 v[60:63], a[24:27], a[216:219], v[60:63]
    ds_read_b64_tr_b16 a[54:55], v17 offset:61440
    v_cvt_pk_bf16_f32 v82, v52, v53
    v_mfma_f32_16x16x32_bf16 v[60:63], a[28:31], a[220:223], v[60:63]
    v_exp_f32 v54, v54
    v_mfma_f32_16x16x32_bf16 v[224:227], a[160:163], v[92:95], v[224:227]
    buffer_load_dwordx4 v25, s[16:19], s64 offen offset:3072 nt lds
    v_mfma_f32_16x16x32_bf16 v[228:231], a[164:167], v[92:95], v[228:231]
    v_exp_f32 v55, v55
    v_mfma_f32_16x16x32_bf16 v[232:235], a[168:171], v[92:95], v[232:235]
    ds_read_b64_tr_b16 a[56:57], v18 offset:57344
    v_cvt_pk_bf16_f32 v83, v54, v55
    v_mfma_f32_16x16x32_bf16 v[236:239], a[172:175], v[92:95], v[236:239]
    ds_read_b64_tr_b16 a[58:59], v18 offset:61440
    v_mfma_f32_16x16x32_bf16 v[240:243], a[176:179], v[92:95], v[240:243]
    v_exp_f32 v56, v56
    v_mfma_f32_16x16x32_bf16 v[244:247], a[180:183], v[92:95], v[244:247]
    ds_read_b64_tr_b16 a[60:61], v19 offset:57344
    v_mfma_f32_16x16x32_bf16 v[248:251], a[184:187], v[92:95], v[248:251]
    v_exp_f32 v57, v57
    v_mfma_f32_16x16x32_bf16 v[252:255], a[188:191], v[92:95], v[252:255]
    ds_read_b64_tr_b16 a[62:63], v19 offset:61440
    v_cvt_pk_bf16_f32 v84, v56, v57
    v_mfma_f32_16x16x32_bf16 v[124:127], v[28:31], v[92:95], v[124:127]
    v_exp_f32 v58, v58
    v_mfma_f32_16x16x32_bf16 v[64:67], a[0:3], a[224:227], v[104:107]
    v_mfma_f32_16x16x32_bf16 v[64:67], a[4:7], a[228:231], v[64:67]
    v_exp_f32 v59, v59
    v_mfma_f32_16x16x32_bf16 v[64:67], a[8:11], a[232:235], v[64:67]
    v_cvt_pk_bf16_f32 v85, v58, v59
    v_mfma_f32_16x16x32_bf16 v[64:67], a[12:15], a[236:239], v[64:67]
    v_exp_f32 v60, v60
    v_mfma_f32_16x16x32_bf16 v[68:71], a[16:19], a[224:227], v[104:107]
    v_mfma_f32_16x16x32_bf16 v[68:71], a[20:23], a[228:231], v[68:71]
    v_exp_f32 v61, v61
    v_mfma_f32_16x16x32_bf16 v[68:71], a[24:27], a[232:235], v[68:71]
    s_add_u32 m0, s53, 0x8000
    v_cvt_pk_bf16_f32 v86, v60, v61
    v_mfma_f32_16x16x32_bf16 v[68:71], a[28:31], a[236:239], v[68:71]
    s_add_u32 s64, s64, 0x4000
    v_exp_f32 v62, v62
    s_waitcnt lgkmcnt(0)
    v_mfma_f32_16x16x32_bf16 v[128:131], a[32:35], v[80:83], v[128:131]
    buffer_load_dwordx4 v20, s[12:15], s64 offen nt lds
    v_mfma_f32_16x16x32_bf16 v[132:135], a[36:39], v[80:83], v[132:135]
    v_exp_f32 v63, v63
    v_mfma_f32_16x16x32_bf16 v[136:139], a[40:43], v[80:83], v[136:139]
    v_cvt_pk_bf16_f32 v87, v62, v63
    v_mfma_f32_16x16x32_bf16 v[140:143], a[44:47], v[80:83], v[140:143]
    s_waitcnt vmcnt(9) lgkmcnt(0)
    s_barrier
    v_mfma_f32_16x16x32_bf16 v[144:147], a[48:51], v[80:83], v[144:147]
    v_exp_f32 v64, v64
    v_mfma_f32_16x16x32_bf16 v[148:151], a[52:55], v[80:83], v[148:151]
    ds_read_b128 a[128:131], v8
    v_mfma_f32_16x16x32_bf16 v[152:155], a[56:59], v[80:83], v[152:155]
    v_exp_f32 v65, v65
    v_mfma_f32_16x16x32_bf16 v[156:159], a[60:63], v[80:83], v[156:159]
    ds_read_b128 a[132:135], v9
    v_cvt_pk_bf16_f32 v88, v64, v65
    v_mfma_f32_16x16x32_bf16 v[112:115], v[28:31], v[80:83], v[112:115]
    v_exp_f32 v66, v66
    v_mfma_f32_16x16x32_bf16 v[72:75], a[0:3], a[240:243], v[108:111]
    ds_read_b128 a[136:139], v10
    v_mfma_f32_16x16x32_bf16 v[72:75], a[4:7], a[244:247], v[72:75]
    v_exp_f32 v67, v67
    v_mfma_f32_16x16x32_bf16 v[72:75], a[8:11], a[248:251], v[72:75]
    ds_read_b128 a[140:143], v11
    v_cvt_pk_bf16_f32 v89, v66, v67
    v_mfma_f32_16x16x32_bf16 v[72:75], a[12:15], a[252:255], v[72:75]
    v_exp_f32 v68, v68
    v_mfma_f32_16x16x32_bf16 v[76:79], a[16:19], a[240:243], v[108:111]
    ds_read_b128 a[144:147], v8 offset:4096
    v_mfma_f32_16x16x32_bf16 v[76:79], a[20:23], a[244:247], v[76:79]
    v_exp_f32 v69, v69
    v_mfma_f32_16x16x32_bf16 v[76:79], a[24:27], a[248:251], v[76:79]
    ds_read_b128 a[148:151], v9 offset:4096
    v_cvt_pk_bf16_f32 v90, v68, v69
    v_mfma_f32_16x16x32_bf16 v[76:79], a[28:31], a[252:255], v[76:79]
    v_exp_f32 v70, v70
    v_mfma_f32_16x16x32_bf16 v[160:163], a[32:35], v[84:87], v[160:163]
    buffer_load_dwordx4 v21, s[12:15], s64 offen offset:1024 nt lds
    v_mfma_f32_16x16x32_bf16 v[164:167], a[36:39], v[84:87], v[164:167]
    v_exp_f32 v71, v71
    v_mfma_f32_16x16x32_bf16 v[168:171], a[40:43], v[84:87], v[168:171]
    ds_read_b128 a[152:155], v10 offset:4096
    v_cvt_pk_bf16_f32 v91, v70, v71
    v_mfma_f32_16x16x32_bf16 v[172:175], a[44:47], v[84:87], v[172:175]
    v_mfma_f32_16x16x32_bf16 v[176:179], a[48:51], v[84:87], v[176:179]
    v_exp_f32 v72, v72
    v_mfma_f32_16x16x32_bf16 v[180:183], a[52:55], v[84:87], v[180:183]
    ds_read_b128 a[156:159], v11 offset:4096
    v_mfma_f32_16x16x32_bf16 v[184:187], a[56:59], v[84:87], v[184:187]
    v_exp_f32 v73, v73
    v_mfma_f32_16x16x32_bf16 v[188:191], a[60:63], v[84:87], v[188:191]
    v_cvt_pk_bf16_f32 v92, v72, v73
    v_mfma_f32_16x16x32_bf16 v[116:119], v[28:31], v[84:87], v[116:119]
    v_exp_f32 v74, v74
    s_waitcnt lgkmcnt(2)
    v_mfma_f32_16x16x32_bf16 v[48:51], a[128:131], a[192:195], v[96:99]
    ds_read_b64_tr_b16 a[160:161], v12 offset:32768
    v_mfma_f32_16x16x32_bf16 v[48:51], a[132:135], a[196:199], v[48:51]
    v_exp_f32 v75, v75
    v_mfma_f32_16x16x32_bf16 v[48:51], a[136:139], a[200:203], v[48:51]
    ds_read_b64_tr_b16 a[162:163], v12 offset:36864
    v_cvt_pk_bf16_f32 v93, v74, v75
    v_mfma_f32_16x16x32_bf16 v[48:51], a[140:143], a[204:207], v[48:51]
    v_exp_f32 v76, v76
    v_mfma_f32_16x16x32_bf16 v[52:55], a[144:147], a[192:195], v[96:99]
    ds_read_b64_tr_b16 a[164:165], v13 offset:32768
    v_mfma_f32_16x16x32_bf16 v[52:55], a[148:151], a[196:199], v[52:55]
    v_exp_f32 v77, v77
    s_waitcnt lgkmcnt(3)
    v_mfma_f32_16x16x32_bf16 v[52:55], a[152:155], a[200:203], v[52:55]
    ds_read_b64_tr_b16 a[166:167], v13 offset:36864
    v_cvt_pk_bf16_f32 v94, v76, v77
    v_mfma_f32_16x16x32_bf16 v[52:55], a[156:159], a[204:207], v[52:55]
    v_exp_f32 v78, v78
    v_mfma_f32_16x16x32_bf16 v[192:195], a[32:35], v[88:91], v[192:195]
    buffer_load_dwordx4 v22, s[12:15], s64 offen offset:2048 nt lds
    v_mfma_f32_16x16x32_bf16 v[196:199], a[36:39], v[88:91], v[196:199]
    v_exp_f32 v79, v79
    v_mfma_f32_16x16x32_bf16 v[200:203], a[40:43], v[88:91], v[200:203]
    ds_read_b64_tr_b16 a[168:169], v14 offset:32768
    v_cvt_pk_bf16_f32 v95, v78, v79
    v_mfma_f32_16x16x32_bf16 v[204:207], a[44:47], v[88:91], v[204:207]
    ds_read_b64_tr_b16 a[170:171], v14 offset:36864
    v_mfma_f32_16x16x32_bf16 v[208:211], a[48:51], v[88:91], v[208:211]
    v_exp_f32 v48, v48
    v_mfma_f32_16x16x32_bf16 v[212:215], a[52:55], v[88:91], v[212:215]
    ds_read_b64_tr_b16 a[172:173], v15 offset:32768
    v_mfma_f32_16x16x32_bf16 v[216:219], a[56:59], v[88:91], v[216:219]
    v_exp_f32 v49, v49
    v_mfma_f32_16x16x32_bf16 v[220:223], a[60:63], v[88:91], v[220:223]
    ds_read_b64_tr_b16 a[174:175], v15 offset:36864
    v_cvt_pk_bf16_f32 v80, v48, v49
    v_mfma_f32_16x16x32_bf16 v[120:123], v[28:31], v[88:91], v[120:123]
    v_exp_f32 v50, v50
    v_mfma_f32_16x16x32_bf16 v[56:59], a[128:131], a[208:211], v[100:103]
    ds_read_b64_tr_b16 a[176:177], v16 offset:32768
    v_mfma_f32_16x16x32_bf16 v[56:59], a[132:135], a[212:215], v[56:59]
    v_exp_f32 v51, v51
    v_mfma_f32_16x16x32_bf16 v[56:59], a[136:139], a[216:219], v[56:59]
    ds_read_b64_tr_b16 a[178:179], v16 offset:36864
    v_cvt_pk_bf16_f32 v81, v50, v51
    v_mfma_f32_16x16x32_bf16 v[56:59], a[140:143], a[220:223], v[56:59]
    v_exp_f32 v52, v52
    v_mfma_f32_16x16x32_bf16 v[60:63], a[144:147], a[208:211], v[100:103]
    ds_read_b64_tr_b16 a[180:181], v17 offset:32768
    v_mfma_f32_16x16x32_bf16 v[60:63], a[148:151], a[212:215], v[60:63]
    v_exp_f32 v53, v53
    v_mfma_f32_16x16x32_bf16 v[60:63], a[152:155], a[216:219], v[60:63]
    ds_read_b64_tr_b16 a[182:183], v17 offset:36864
    v_cvt_pk_bf16_f32 v82, v52, v53
    v_mfma_f32_16x16x32_bf16 v[60:63], a[156:159], a[220:223], v[60:63]
    v_exp_f32 v54, v54
    v_mfma_f32_16x16x32_bf16 v[224:227], a[32:35], v[92:95], v[224:227]
    buffer_load_dwordx4 v23, s[12:15], s64 offen offset:3072 nt lds
    v_mfma_f32_16x16x32_bf16 v[228:231], a[36:39], v[92:95], v[228:231]
    v_exp_f32 v55, v55
    v_mfma_f32_16x16x32_bf16 v[232:235], a[40:43], v[92:95], v[232:235]
    ds_read_b64_tr_b16 a[184:185], v18 offset:32768
    v_cvt_pk_bf16_f32 v83, v54, v55
    v_mfma_f32_16x16x32_bf16 v[236:239], a[44:47], v[92:95], v[236:239]
    ds_read_b64_tr_b16 a[186:187], v18 offset:36864
    v_mfma_f32_16x16x32_bf16 v[240:243], a[48:51], v[92:95], v[240:243]
    v_exp_f32 v56, v56
    v_mfma_f32_16x16x32_bf16 v[244:247], a[52:55], v[92:95], v[244:247]
    ds_read_b64_tr_b16 a[188:189], v19 offset:32768
    v_mfma_f32_16x16x32_bf16 v[248:251], a[56:59], v[92:95], v[248:251]
    v_exp_f32 v57, v57
    v_mfma_f32_16x16x32_bf16 v[252:255], a[60:63], v[92:95], v[252:255]
    ds_read_b64_tr_b16 a[190:191], v19 offset:36864
    v_cvt_pk_bf16_f32 v84, v56, v57
    v_mfma_f32_16x16x32_bf16 v[124:127], v[28:31], v[92:95], v[124:127]
    v_exp_f32 v58, v58
    v_mfma_f32_16x16x32_bf16 v[64:67], a[128:131], a[224:227], v[104:107]
    v_mfma_f32_16x16x32_bf16 v[64:67], a[132:135], a[228:231], v[64:67]
    v_exp_f32 v59, v59
    v_mfma_f32_16x16x32_bf16 v[64:67], a[136:139], a[232:235], v[64:67]
    v_cvt_pk_bf16_f32 v85, v58, v59
    v_mfma_f32_16x16x32_bf16 v[64:67], a[140:143], a[236:239], v[64:67]
    v_exp_f32 v60, v60
    v_mfma_f32_16x16x32_bf16 v[68:71], a[144:147], a[224:227], v[104:107]
    v_mfma_f32_16x16x32_bf16 v[68:71], a[148:151], a[228:231], v[68:71]
    v_exp_f32 v61, v61
    v_mfma_f32_16x16x32_bf16 v[68:71], a[152:155], a[232:235], v[68:71]
    s_add_u32 m0, s53, 0x14000
    v_cvt_pk_bf16_f32 v86, v60, v61
    v_mfma_f32_16x16x32_bf16 v[68:71], a[156:159], a[236:239], v[68:71]
    v_exp_f32 v62, v62
    s_waitcnt lgkmcnt(0)
    v_mfma_f32_16x16x32_bf16 v[128:131], a[160:163], v[80:83], v[128:131]
    buffer_load_dwordx4 v24, s[16:19], s64 offen nt lds
    v_mfma_f32_16x16x32_bf16 v[132:135], a[164:167], v[80:83], v[132:135]
    v_exp_f32 v63, v63
    v_mfma_f32_16x16x32_bf16 v[136:139], a[168:171], v[80:83], v[136:139]
    v_cvt_pk_bf16_f32 v87, v62, v63
    v_mfma_f32_16x16x32_bf16 v[140:143], a[172:175], v[80:83], v[140:143]
    v_mfma_f32_16x16x32_bf16 v[144:147], a[176:179], v[80:83], v[144:147]
    v_exp_f32 v64, v64
    v_mfma_f32_16x16x32_bf16 v[148:151], a[180:183], v[80:83], v[148:151]
    ds_read_b128 a[0:3], v8 offset:8192
    v_mfma_f32_16x16x32_bf16 v[152:155], a[184:187], v[80:83], v[152:155]
    v_exp_f32 v65, v65
    v_mfma_f32_16x16x32_bf16 v[156:159], a[188:191], v[80:83], v[156:159]
    ds_read_b128 a[4:7], v9 offset:8192
    v_cvt_pk_bf16_f32 v88, v64, v65
    v_mfma_f32_16x16x32_bf16 v[112:115], v[28:31], v[80:83], v[112:115]
    v_exp_f32 v66, v66
    v_mfma_f32_16x16x32_bf16 v[72:75], a[128:131], a[240:243], v[108:111]
    ds_read_b128 a[8:11], v10 offset:8192
    v_mfma_f32_16x16x32_bf16 v[72:75], a[132:135], a[244:247], v[72:75]
    v_exp_f32 v67, v67
    v_mfma_f32_16x16x32_bf16 v[72:75], a[136:139], a[248:251], v[72:75]
    ds_read_b128 a[12:15], v11 offset:8192
    v_cvt_pk_bf16_f32 v89, v66, v67
    v_mfma_f32_16x16x32_bf16 v[72:75], a[140:143], a[252:255], v[72:75]
    v_exp_f32 v68, v68
    v_mfma_f32_16x16x32_bf16 v[76:79], a[144:147], a[240:243], v[108:111]
    ds_read_b128 a[16:19], v8 offset:12288
    v_mfma_f32_16x16x32_bf16 v[76:79], a[148:151], a[244:247], v[76:79]
    v_exp_f32 v69, v69
    v_mfma_f32_16x16x32_bf16 v[76:79], a[152:155], a[248:251], v[76:79]
    ds_read_b128 a[20:23], v9 offset:12288
    v_cvt_pk_bf16_f32 v90, v68, v69
    v_mfma_f32_16x16x32_bf16 v[76:79], a[156:159], a[252:255], v[76:79]
    v_exp_f32 v70, v70
    v_mfma_f32_16x16x32_bf16 v[160:163], a[160:163], v[84:87], v[160:163]
    buffer_load_dwordx4 v25, s[16:19], s64 offen offset:1024 nt lds
    v_mfma_f32_16x16x32_bf16 v[164:167], a[164:167], v[84:87], v[164:167]
    v_exp_f32 v71, v71
    v_mfma_f32_16x16x32_bf16 v[168:171], a[168:171], v[84:87], v[168:171]
    ds_read_b128 a[24:27], v10 offset:12288
    v_cvt_pk_bf16_f32 v91, v70, v71
    v_mfma_f32_16x16x32_bf16 v[172:175], a[172:175], v[84:87], v[172:175]
    v_mfma_f32_16x16x32_bf16 v[176:179], a[176:179], v[84:87], v[176:179]
    v_exp_f32 v72, v72
    v_mfma_f32_16x16x32_bf16 v[180:183], a[180:183], v[84:87], v[180:183]
    ds_read_b128 a[28:31], v11 offset:12288
    v_mfma_f32_16x16x32_bf16 v[184:187], a[184:187], v[84:87], v[184:187]
    v_exp_f32 v73, v73
    v_mfma_f32_16x16x32_bf16 v[188:191], a[188:191], v[84:87], v[188:191]
    v_cvt_pk_bf16_f32 v92, v72, v73
    v_mfma_f32_16x16x32_bf16 v[116:119], v[28:31], v[84:87], v[116:119]
    v_exp_f32 v74, v74
    s_waitcnt lgkmcnt(2)
    v_mfma_f32_16x16x32_bf16 v[48:51], a[0:3], a[192:195], v[96:99]
    ds_read_b64_tr_b16 a[32:33], v12 offset:40960
    v_mfma_f32_16x16x32_bf16 v[48:51], a[4:7], a[196:199], v[48:51]
    v_exp_f32 v75, v75
    v_mfma_f32_16x16x32_bf16 v[48:51], a[8:11], a[200:203], v[48:51]
    ds_read_b64_tr_b16 a[34:35], v12 offset:45056
    v_cvt_pk_bf16_f32 v93, v74, v75
    v_mfma_f32_16x16x32_bf16 v[48:51], a[12:15], a[204:207], v[48:51]
    v_exp_f32 v76, v76
    v_mfma_f32_16x16x32_bf16 v[52:55], a[16:19], a[192:195], v[96:99]
    ds_read_b64_tr_b16 a[36:37], v13 offset:40960
    v_mfma_f32_16x16x32_bf16 v[52:55], a[20:23], a[196:199], v[52:55]
    v_exp_f32 v77, v77
    s_waitcnt lgkmcnt(3)
    v_mfma_f32_16x16x32_bf16 v[52:55], a[24:27], a[200:203], v[52:55]
    ds_read_b64_tr_b16 a[38:39], v13 offset:45056
    v_cvt_pk_bf16_f32 v94, v76, v77
    v_mfma_f32_16x16x32_bf16 v[52:55], a[28:31], a[204:207], v[52:55]
    v_exp_f32 v78, v78
    v_mfma_f32_16x16x32_bf16 v[192:195], a[160:163], v[88:91], v[192:195]
    buffer_load_dwordx4 v24, s[16:19], s64 offen offset:2048 nt lds
    v_mfma_f32_16x16x32_bf16 v[196:199], a[164:167], v[88:91], v[196:199]
    v_exp_f32 v79, v79
    v_mfma_f32_16x16x32_bf16 v[200:203], a[168:171], v[88:91], v[200:203]
    ds_read_b64_tr_b16 a[40:41], v14 offset:40960
    v_cvt_pk_bf16_f32 v95, v78, v79
    v_mfma_f32_16x16x32_bf16 v[204:207], a[172:175], v[88:91], v[204:207]
    ds_read_b64_tr_b16 a[42:43], v14 offset:45056
    v_mfma_f32_16x16x32_bf16 v[208:211], a[176:179], v[88:91], v[208:211]
    v_exp_f32 v48, v48
    v_mfma_f32_16x16x32_bf16 v[212:215], a[180:183], v[88:91], v[212:215]
    ds_read_b64_tr_b16 a[44:45], v15 offset:40960
    v_mfma_f32_16x16x32_bf16 v[216:219], a[184:187], v[88:91], v[216:219]
    v_exp_f32 v49, v49
    v_mfma_f32_16x16x32_bf16 v[220:223], a[188:191], v[88:91], v[220:223]
    ds_read_b64_tr_b16 a[46:47], v15 offset:45056
    v_cvt_pk_bf16_f32 v80, v48, v49
    v_mfma_f32_16x16x32_bf16 v[120:123], v[28:31], v[88:91], v[120:123]
    v_exp_f32 v50, v50
    v_mfma_f32_16x16x32_bf16 v[56:59], a[0:3], a[208:211], v[100:103]
    ds_read_b64_tr_b16 a[48:49], v16 offset:40960
    v_mfma_f32_16x16x32_bf16 v[56:59], a[4:7], a[212:215], v[56:59]
    v_exp_f32 v51, v51
    v_mfma_f32_16x16x32_bf16 v[56:59], a[8:11], a[216:219], v[56:59]
    ds_read_b64_tr_b16 a[50:51], v16 offset:45056
    v_cvt_pk_bf16_f32 v81, v50, v51
    v_mfma_f32_16x16x32_bf16 v[56:59], a[12:15], a[220:223], v[56:59]
    v_exp_f32 v52, v52
    v_mfma_f32_16x16x32_bf16 v[60:63], a[16:19], a[208:211], v[100:103]
    ds_read_b64_tr_b16 a[52:53], v17 offset:40960
    v_mfma_f32_16x16x32_bf16 v[60:63], a[20:23], a[212:215], v[60:63]
    v_exp_f32 v53, v53
    v_mfma_f32_16x16x32_bf16 v[60:63], a[24:27], a[216:219], v[60:63]
    ds_read_b64_tr_b16 a[54:55], v17 offset:45056
    v_cvt_pk_bf16_f32 v82, v52, v53
    v_mfma_f32_16x16x32_bf16 v[60:63], a[28:31], a[220:223], v[60:63]
    v_exp_f32 v54, v54
    v_mfma_f32_16x16x32_bf16 v[224:227], a[160:163], v[92:95], v[224:227]
    buffer_load_dwordx4 v25, s[16:19], s64 offen offset:3072 nt lds
    v_mfma_f32_16x16x32_bf16 v[228:231], a[164:167], v[92:95], v[228:231]
    v_exp_f32 v55, v55
    v_mfma_f32_16x16x32_bf16 v[232:235], a[168:171], v[92:95], v[232:235]
    ds_read_b64_tr_b16 a[56:57], v18 offset:40960
    v_cvt_pk_bf16_f32 v83, v54, v55
    v_mfma_f32_16x16x32_bf16 v[236:239], a[172:175], v[92:95], v[236:239]
    ds_read_b64_tr_b16 a[58:59], v18 offset:45056
    v_mfma_f32_16x16x32_bf16 v[240:243], a[176:179], v[92:95], v[240:243]
    v_exp_f32 v56, v56
    v_mfma_f32_16x16x32_bf16 v[244:247], a[180:183], v[92:95], v[244:247]
    ds_read_b64_tr_b16 a[60:61], v19 offset:40960
    v_mfma_f32_16x16x32_bf16 v[248:251], a[184:187], v[92:95], v[248:251]
    v_exp_f32 v57, v57
    v_mfma_f32_16x16x32_bf16 v[252:255], a[188:191], v[92:95], v[252:255]
    ds_read_b64_tr_b16 a[62:63], v19 offset:45056
    v_cvt_pk_bf16_f32 v84, v56, v57
    v_mfma_f32_16x16x32_bf16 v[124:127], v[28:31], v[92:95], v[124:127]
    v_exp_f32 v58, v58
    v_mfma_f32_16x16x32_bf16 v[64:67], a[0:3], a[224:227], v[104:107]
    v_mfma_f32_16x16x32_bf16 v[64:67], a[4:7], a[228:231], v[64:67]
    v_exp_f32 v59, v59
    v_mfma_f32_16x16x32_bf16 v[64:67], a[8:11], a[232:235], v[64:67]
    v_cvt_pk_bf16_f32 v85, v58, v59
    v_mfma_f32_16x16x32_bf16 v[64:67], a[12:15], a[236:239], v[64:67]
    v_exp_f32 v60, v60
    v_mfma_f32_16x16x32_bf16 v[68:71], a[16:19], a[224:227], v[104:107]
    v_mfma_f32_16x16x32_bf16 v[68:71], a[20:23], a[228:231], v[68:71]
    v_exp_f32 v61, v61
    v_mfma_f32_16x16x32_bf16 v[68:71], a[24:27], a[232:235], v[68:71]
    s_add_u32 m0, s53, 0xc000
    v_cvt_pk_bf16_f32 v86, v60, v61
    v_mfma_f32_16x16x32_bf16 v[68:71], a[28:31], a[236:239], v[68:71]
    s_add_u32 s64, s64, 0x4000
    v_exp_f32 v62, v62
    s_waitcnt lgkmcnt(0)
    v_mfma_f32_16x16x32_bf16 v[128:131], a[32:35], v[80:83], v[128:131]
    buffer_load_dwordx4 v20, s[12:15], s64 offen nt lds
    v_mfma_f32_16x16x32_bf16 v[132:135], a[36:39], v[80:83], v[132:135]
    v_exp_f32 v63, v63
    v_mfma_f32_16x16x32_bf16 v[136:139], a[40:43], v[80:83], v[136:139]
    v_cvt_pk_bf16_f32 v87, v62, v63
    v_mfma_f32_16x16x32_bf16 v[140:143], a[44:47], v[80:83], v[140:143]
    s_waitcnt vmcnt(9) lgkmcnt(0)
    s_barrier
    v_mfma_f32_16x16x32_bf16 v[144:147], a[48:51], v[80:83], v[144:147]
    v_exp_f32 v64, v64
    v_mfma_f32_16x16x32_bf16 v[148:151], a[52:55], v[80:83], v[148:151]
    ds_read_b128 a[128:131], v8 offset:16384
    v_mfma_f32_16x16x32_bf16 v[152:155], a[56:59], v[80:83], v[152:155]
    v_exp_f32 v65, v65
    v_mfma_f32_16x16x32_bf16 v[156:159], a[60:63], v[80:83], v[156:159]
    ds_read_b128 a[132:135], v9 offset:16384
    v_cvt_pk_bf16_f32 v88, v64, v65
    v_mfma_f32_16x16x32_bf16 v[112:115], v[28:31], v[80:83], v[112:115]
    v_exp_f32 v66, v66
    v_mfma_f32_16x16x32_bf16 v[72:75], a[0:3], a[240:243], v[108:111]
    ds_read_b128 a[136:139], v10 offset:16384
    v_mfma_f32_16x16x32_bf16 v[72:75], a[4:7], a[244:247], v[72:75]
    v_exp_f32 v67, v67
    v_mfma_f32_16x16x32_bf16 v[72:75], a[8:11], a[248:251], v[72:75]
    ds_read_b128 a[140:143], v11 offset:16384
    v_cvt_pk_bf16_f32 v89, v66, v67
    v_mfma_f32_16x16x32_bf16 v[72:75], a[12:15], a[252:255], v[72:75]
    v_exp_f32 v68, v68
    v_mfma_f32_16x16x32_bf16 v[76:79], a[16:19], a[240:243], v[108:111]
    ds_read_b128 a[144:147], v8 offset:20480
    v_mfma_f32_16x16x32_bf16 v[76:79], a[20:23], a[244:247], v[76:79]
    v_exp_f32 v69, v69
    v_mfma_f32_16x16x32_bf16 v[76:79], a[24:27], a[248:251], v[76:79]
    ds_read_b128 a[148:151], v9 offset:20480
    v_cvt_pk_bf16_f32 v90, v68, v69
    v_mfma_f32_16x16x32_bf16 v[76:79], a[28:31], a[252:255], v[76:79]
    v_exp_f32 v70, v70
    v_mfma_f32_16x16x32_bf16 v[160:163], a[32:35], v[84:87], v[160:163]
    buffer_load_dwordx4 v21, s[12:15], s64 offen offset:1024 nt lds
    v_mfma_f32_16x16x32_bf16 v[164:167], a[36:39], v[84:87], v[164:167]
    v_exp_f32 v71, v71
    v_mfma_f32_16x16x32_bf16 v[168:171], a[40:43], v[84:87], v[168:171]
    ds_read_b128 a[152:155], v10 offset:20480
    v_cvt_pk_bf16_f32 v91, v70, v71
    v_mfma_f32_16x16x32_bf16 v[172:175], a[44:47], v[84:87], v[172:175]
    v_mfma_f32_16x16x32_bf16 v[176:179], a[48:51], v[84:87], v[176:179]
    v_exp_f32 v72, v72
    v_mfma_f32_16x16x32_bf16 v[180:183], a[52:55], v[84:87], v[180:183]
    ds_read_b128 a[156:159], v11 offset:20480
    v_mfma_f32_16x16x32_bf16 v[184:187], a[56:59], v[84:87], v[184:187]
    v_exp_f32 v73, v73
    v_mfma_f32_16x16x32_bf16 v[188:191], a[60:63], v[84:87], v[188:191]
    v_cvt_pk_bf16_f32 v92, v72, v73
    v_mfma_f32_16x16x32_bf16 v[116:119], v[28:31], v[84:87], v[116:119]
    v_exp_f32 v74, v74
    s_sub_u32 s66, s66, 1
    s_cmp_lg_u32 s66, 0
    s_cbranch_scc1 L_attn
L_tail:
    s_waitcnt lgkmcnt(2)
    v_mfma_f32_16x16x32_bf16 v[48:51], a[128:131], a[192:195], v[96:99]
    ds_read_b64_tr_b16 a[160:161], v12
    v_mfma_f32_16x16x32_bf16 v[48:51], a[132:135], a[196:199], v[48:51]
    v_exp_f32 v75, v75
    v_mfma_f32_16x16x32_bf16 v[48:51], a[136:139], a[200:203], v[48:51]
    ds_read_b64_tr_b16 a[162:163], v12 offset:4096
    v_cvt_pk_bf16_f32 v93, v74, v75
    v_mfma_f32_16x16x32_bf16 v[48:51], a[140:143], a[204:207], v[48:51]
    v_exp_f32 v76, v76
    v_mfma_f32_16x16x32_bf16 v[52:55], a[144:147], a[192:195], v[96:99]
    ds_read_b64_tr_b16 a[164:165], v13
    v_mfma_f32_16x16x32_bf16 v[52:55], a[148:151], a[196:199], v[52:55]
    v_exp_f32 v77, v77
    s_waitcnt lgkmcnt(3)
    v_mfma_f32_16x16x32_bf16 v[52:55], a[152:155], a[200:203], v[52:55]
    ds_read_b64_tr_b16 a[166:167], v13 offset:4096
    v_cvt_pk_bf16_f32 v94, v76, v77
    v_mfma_f32_16x16x32_bf16 v[52:55], a[156:159], a[204:207], v[52:55]
    v_exp_f32 v78, v78
    v_mfma_f32_16x16x32_bf16 v[192:195], a[32:35], v[88:91], v[192:195]
    buffer_load_dwordx4 v22, s[12:15], s64 offen offset:2048 nt lds
    v_mfma_f32_16x16x32_bf16 v[196:199], a[36:39], v[88:91], v[196:199]
    v_exp_f32 v79, v79
    v_mfma_f32_16x16x32_bf16 v[200:203], a[40:43], v[88:91], v[200:203]
    ds_read_b64_tr_b16 a[168:169], v14
    v_cvt_pk_bf16_f32 v95, v78, v79
    v_mfma_f32_16x16x32_bf16 v[204:207], a[44:47], v[88:91], v[204:207]
    ds_read_b64_tr_b16 a[170:171], v14 offset:4096
    v_mfma_f32_16x16x32_bf16 v[208:211], a[48:51], v[88:91], v[208:211]
    v_exp_f32 v48, v48
    v_mfma_f32_16x16x32_bf16 v[212:215], a[52:55], v[88:91], v[212:215]
    ds_read_b64_tr_b16 a[172:173], v15
    v_mfma_f32_16x16x32_bf16 v[216:219], a[56:59], v[88:91], v[216:219]
    v_exp_f32 v49, v49
    v_mfma_f32_16x16x32_bf16 v[220:223], a[60:63], v[88:91], v[220:223]
    ds_read_b64_tr_b16 a[174:175], v15 offset:4096
    v_cvt_pk_bf16_f32 v80, v48, v49
    v_mfma_f32_16x16x32_bf16 v[120:123], v[28:31], v[88:91], v[120:123]
    v_exp_f32 v50, v50
    v_mfma_f32_16x16x32_bf16 v[56:59], a[128:131], a[208:211], v[100:103]
    ds_read_b64_tr_b16 a[176:177], v16
    v_mfma_f32_16x16x32_bf16 v[56:59], a[132:135], a[212:215], v[56:59]
    v_exp_f32 v51, v51
    v_mfma_f32_16x16x32_bf16 v[56:59], a[136:139], a[216:219], v[56:59]
    ds_read_b64_tr_b16 a[178:179], v16 offset:4096
    v_cvt_pk_bf16_f32 v81, v50, v51
    v_mfma_f32_16x16x32_bf16 v[56:59], a[140:143], a[220:223], v[56:59]
    v_exp_f32 v52, v52
    v_mfma_f32_16x16x32_bf16 v[60:63], a[144:147], a[208:211], v[100:103]
    ds_read_b64_tr_b16 a[180:181], v17
    v_mfma_f32_16x16x32_bf16 v[60:63], a[148:151], a[212:215], v[60:63]
    v_exp_f32 v53, v53
    v_mfma_f32_16x16x32_bf16 v[60:63], a[152:155], a[216:219], v[60:63]
    ds_read_b64_tr_b16 a[182:183], v17 offset:4096
    v_cvt_pk_bf16_f32 v82, v52, v53
    v_mfma_f32_16x16x32_bf16 v[60:63], a[156:159], a[220:223], v[60:63]
    v_exp_f32 v54, v54
    v_mfma_f32_16x16x32_bf16 v[224:227], a[32:35], v[92:95], v[224:227]
    buffer_load_dwordx4 v23, s[12:15], s64 offen offset:3072 nt lds
    v_mfma_f32_16x16x32_bf16 v[228:231], a[36:39], v[92:95], v[228:231]
    v_exp_f32 v55, v55
    v_mfma_f32_16x16x32_bf16 v[232:235], a[40:43], v[92:95], v[232:235]
    ds_read_b64_tr_b16 a[184:185], v18
    v_cvt_pk_bf16_f32 v83, v54, v55
    v_mfma_f32_16x16x32_bf16 v[236:239], a[44:47], v[92:95], v[236:239]
    ds_read_b64_tr_b16 a[186:187], v18 offset:4096
    v_mfma_f32_16x16x32_bf16 v[240:243], a[48:51], v[92:95], v[240:243]
    v_exp_f32 v56, v56
    v_mfma_f32_16x16x32_bf16 v[244:247], a[52:55], v[92:95], v[244:247]
    ds_read_b64_tr_b16 a[188:189], v19
    s_add_u32 m0, s53, 0x1c000
    s_nop 0
    buffer_load_dwordx4 v24, s[16:19], s64 offen nt lds
    v_mfma_f32_16x16x32_bf16 v[248:251], a[56:59], v[92:95], v[248:251]
    v_exp_f32 v57, v57
    v_mfma_f32_16x16x32_bf16 v[252:255], a[60:63], v[92:95], v[252:255]
    ds_read_b64_tr_b16 a[190:191], v19 offset:4096
    v_cvt_pk_bf16_f32 v84, v56, v57
    v_mfma_f32_16x16x32_bf16 v[124:127], v[28:31], v[92:95], v[124:127]
    v_exp_f32 v58, v58
    v_mfma_f32_16x16x32_bf16 v[64:67], a[128:131], a[224:227], v[104:107]
    v_mfma_f32_16x16x32_bf16 v[64:67], a[132:135], a[228:231], v[64:67]
    v_exp_f32 v59, v59
    v_mfma_f32_16x16x32_bf16 v[64:67], a[136:139], a[232:235], v[64:67]
    v_cvt_pk_bf16_f32 v85, v58, v59
    v_mfma_f32_16x16x32_bf16 v[64:67], a[140:143], a[236:239], v[64:67]
    v_exp_f32 v60, v60
    v_mfma_f32_16x16x32_bf16 v[68:71], a[144:147], a[224:227], v[104:107]
    s_add_u32 m0, s53, 0x1c000
    s_nop 0
    buffer_load_dwordx4 v25, s[16:19], s64 offen offset:1024 nt lds
    v_mfma_f32_16x16x32_bf16 v[68:71], a[148:151], a[228:231], v[68:71]
    v_exp_f32 v61, v61
    v_mfma_f32_16x16x32_bf16 v[68:71], a[152:155], a[232:235], v[68:71]
    v_cvt_pk_bf16_f32 v86, v60, v61
    v_mfma_f32_16x16x32_bf16 v[68:71], a[156:159], a[236:239], v[68:71]
    v_exp_f32 v62, v62
    s_waitcnt lgkmcnt(0)
    v_mfma_f32_16x16x32_bf16 v[128:131], a[160:163], v[80:83], v[128:131]
    v_mfma_f32_16x16x32_bf16 v[132:135], a[164:167], v[80:83], v[132:135]
    v_exp_f32 v63, v63
    v_mfma_f32_16x16x32_bf16 v[136:139], a[168:171], v[80:83], v[136:139]
    v_cvt_pk_bf16_f32 v87, v62, v63
    v_mfma_f32_16x16x32_bf16 v[140:143], a[172:175], v[80:83], v[140:143]
    v_mfma_f32_16x16x32_bf16 v[144:147], a[176:179], v[80:83], v[144:147]
    s_add_u32 m0, s53, 0x1c000
    s_nop 0
    buffer_load_dwordx4 v24, s[16:19], s64 offen offset:2048 nt lds
    v_exp_f32 v64, v64
    v_mfma_f32_16x16x32_bf16 v[148:151], a[180:183], v[80:83], v[148:151]
    ds_read_b128 a[0:3], v8 offset:24576
    v_mfma_f32_16x16x32_bf16 v[152:155], a[184:187], v[80:83], v[152:155]
    v_exp_f32 v65, v65
    v_mfma_f32_16x16x32_bf16 v[156:159], a[188:191], v[80:83], v[156:159]
    ds_read_b128 a[4:7], v9 offset:24576
    v_cvt_pk_bf16_f32 v88, v64, v65
    v_mfma_f32_16x16x32_bf16 v[112:115], v[28:31], v[80:83], v[112:115]
    v_exp_f32 v66, v66
    v_mfma_f32_16x16x32_bf16 v[72:75], a[128:131], a[240:243], v[108:111]
    ds_read_b128 a[8:11], v10 offset:24576
    v_mfma_f32_16x16x32_bf16 v[72:75], a[132:135], a[244:247], v[72:75]
    v_exp_f32 v67, v67
    v_mfma_f32_16x16x32_bf16 v[72:75], a[136:139], a[248:251], v[72:75]
    ds_read_b128 a[12:15], v11 offset:24576
    v_cvt_pk_bf16_f32 v89, v66, v67
    v_mfma_f32_16x16x32_bf16 v[72:75], a[140:143], a[252:255], v[72:75]
    s_add_u32 m0, s53, 0x1c000
    s_nop 0
    buffer_load_dwordx4 v25, s[16:19], s64 offen offset:3072 nt lds
    v_exp_f32 v68, v68
    v_mfma_f32_16x16x32_bf16 v[76:79], a[144:147], a[240:243], v[108:111]
    ds_read_b128 a[16:19], v8 offset:28672
    v_mfma_f32_16x16x32_bf16 v[76:79], a[148:151], a[244:247], v[76:79]
    v_exp_f32 v69, v69
    v_mfma_f32_16x16x32_bf16 v[76:79], a[152:155], a[248:251], v[76:79]
    ds_read_b128 a[20:23], v9 offset:28672
    v_cvt_pk_bf16_f32 v90, v68, v69
    v_mfma_f32_16x16x32_bf16 v[76:79], a[156:159], a[252:255], v[76:79]
    v_exp_f32 v70, v70
    v_mfma_f32_16x16x32_bf16 v[160:163], a[160:163], v[84:87], v[160:163]
    v_mfma_f32_16x16x32_bf16 v[164:167], a[164:167], v[84:87], v[164:167]
    v_exp_f32 v71, v71
    v_mfma_f32_16x16x32_bf16 v[168:171], a[168:171], v[84:87], v[168:171]
    ds_read_b128 a[24:27], v10 offset:28672
    v_cvt_pk_bf16_f32 v91, v70, v71
    v_mfma_f32_16x16x32_bf16 v[172:175], a[172:175], v[84:87], v[172:175]
    v_mfma_f32_16x16x32_bf16 v[176:179], a[176:179], v[84:87], v[176:179]
    v_exp_f32 v72, v72
    v_mfma_f32_16x16x32_bf16 v[180:183], a[180:183], v[84:87], v[180:183]
    ds_read_b128 a[28:31], v11 offset:28672
    v_mfma_f32_16x16x32_bf16 v[184:187], a[184:187], v[84:87], v[184:187]
    v_exp_f32 v73, v73
    v_mfma_f32_16x16x32_bf16 v[188:191], a[188:191], v[84:87], v[188:191]
    v_cvt_pk_bf16_f32 v92, v72, v73
    v_mfma_f32_16x16x32_bf16 v[116:119], v[28:31], v[84:87], v[116:119]
    v_exp_f32 v74, v74
    s_waitcnt lgkmcnt(2)
    v_mfma_f32_16x16x32_bf16 v[48:51], a[0:3], a[192:195], v[96:99]
    ds_read_b64_tr_b16 a[32:33], v12 offset:8192
    v_mfma_f32_16x16x32_bf16 v[48:51], a[4:7], a[196:199], v[48:51]
    v_exp_f32 v75, v75
    v_mfma_f32_16x16x32_bf16 v[48:51], a[8:11], a[200:203], v[48:51]
    ds_read_b64_tr_b16 a[34:35], v12 offset:12288
    v_cvt_pk_bf16_f32 v93, v74, v75
    v_mfma_f32_16x16x32_bf16 v[48:51], a[12:15], a[204:207], v[48:51]
    v_exp_f32 v76, v76
    v_mfma_f32_16x16x32_bf16 v[52:55], a[16:19], a[192:195], v[96:99]
    ds_read_b64_tr_b16 a[36:37], v13 offset:8192
    s_lshl_b32 s67, s52, 9
    v_mul_u32_u24 v2, 0x500, v0
    v_mfma_f32_16x16x32_bf16 v[52:55], a[20:23], a[196:199], v[52:55]
    v_exp_f32 v77, v77
    s_waitcnt lgkmcnt(3)
    v_mfma_f32_16x16x32_bf16 v[52:55], a[24:27], a[200:203], v[52:55]
    ds_read_b64_tr_b16 a[38:39], v13 offset:12288
    s_mul_i32 s68, s75, 38
    v_cvt_pk_bf16_f32 v94, v76, v77
    v_cmp_gt_u32 vcc, 38, v0
    v_mfma_f32_16x16x32_bf16 v[52:55], a[28:31], a[204:207], v[52:55]
    s_add_u32 s68, s68, s67
    s_add_u32 s68, s68, 0
    v_exp_f32 v78, v78
    v_mfma_f32_16x16x32_bf16 v[192:195], a[160:163], v[88:91], v[192:195]
    s_mul_i32 s68, s68, 0x500
    v_cndmask_b32 v3, -1, v2, vcc
    v_mfma_f32_16x16x32_bf16 v[196:199], a[164:167], v[88:91], v[196:199]
    v_exp_f32 v79, v79
    v_mfma_f32_16x16x32_bf16 v[200:203], a[168:171], v[88:91], v[200:203]
    ds_read_b64_tr_b16 a[40:41], v14 offset:8192
    buffer_load_dword v42, v3, s[24:27], s68 offen
    v_cvt_pk_bf16_f32 v95, v78, v79
    v_mfma_f32_16x16x32_bf16 v[204:207], a[172:175], v[88:91], v[204:207]
    ds_read_b64_tr_b16 a[42:43], v14 offset:12288
    v_mfma_f32_16x16x32_bf16 v[208:211], a[176:179], v[88:91], v[208:211]
    s_mul_i32 s68, s75, 48
    v_exp_f32 v48, v48
    v_cmp_gt_u32 vcc, 48, v0
    v_mfma_f32_16x16x32_bf16 v[212:215], a[180:183], v[88:91], v[212:215]
    ds_read_b64_tr_b16 a[44:45], v15 offset:8192
    s_add_u32 s68, s68, s67
    s_add_u32 s68, s68, 0xe0
    v_mfma_f32_16x16x32_bf16 v[216:219], a[184:187], v[88:91], v[216:219]
    s_mul_i32 s68, s68, 0x500
    v_exp_f32 v49, v49
    v_cndmask_b32 v3, -1, v2, vcc
    v_mfma_f32_16x16x32_bf16 v[220:223], a[188:191], v[88:91], v[220:223]
    ds_read_b64_tr_b16 a[46:47], v15 offset:12288
    v_cvt_pk_bf16_f32 v80, v48, v49
    v_mfma_f32_16x16x32_bf16 v[120:123], v[28:31], v[88:91], v[120:123]
    buffer_load_dword v43, v3, s[24:27], s68 offen
    v_exp_f32 v50, v50
    v_mfma_f32_16x16x32_bf16 v[56:59], a[0:3], a[208:211], v[100:103]
    ds_read_b64_tr_b16 a[48:49], v16 offset:8192
    v_mfma_f32_16x16x32_bf16 v[56:59], a[4:7], a[212:215], v[56:59]
    v_exp_f32 v51, v51
    v_mfma_f32_16x16x32_bf16 v[56:59], a[8:11], a[216:219], v[56:59]
    ds_read_b64_tr_b16 a[50:51], v16 offset:12288
    v_cvt_pk_bf16_f32 v81, v50, v51
    v_mfma_f32_16x16x32_bf16 v[56:59], a[12:15], a[220:223], v[56:59]
    v_exp_f32 v52, v52
    v_mfma_f32_16x16x32_bf16 v[60:63], a[16:19], a[208:211], v[100:103]
    ds_read_b64_tr_b16 a[52:53], v17 offset:8192
    v_mfma_f32_16x16x32_bf16 v[60:63], a[20:23], a[212:215], v[60:63]
    v_exp_f32 v53, v53
    v_mfma_f32_16x16x32_bf16 v[60:63], a[24:27], a[216:219], v[60:63]
    ds_read_b64_tr_b16 a[54:55], v17 offset:12288
    v_cvt_pk_bf16_f32 v82, v52, v53
    v_mfma_f32_16x16x32_bf16 v[60:63], a[28:31], a[220:223], v[60:63]
    v_exp_f32 v54, v54
    v_mfma_f32_16x16x32_bf16 v[224:227], a[160:163], v[92:95], v[224:227]
    v_mfma_f32_16x16x32_bf16 v[228:231], a[164:167], v[92:95], v[228:231]
    v_exp_f32 v55, v55
    v_mfma_f32_16x16x32_bf16 v[232:235], a[168:171], v[92:95], v[232:235]
    ds_read_b64_tr_b16 a[56:57], v18 offset:8192
    v_cvt_pk_bf16_f32 v83, v54, v55
    v_mfma_f32_16x16x32_bf16 v[236:239], a[172:175], v[92:95], v[236:239]
    ds_read_b64_tr_b16 a[58:59], v18 offset:12288
    v_mfma_f32_16x16x32_bf16 v[240:243], a[176:179], v[92:95], v[240:243]
    v_exp_f32 v56, v56
    v_mfma_f32_16x16x32_bf16 v[244:247], a[180:183], v[92:95], v[244:247]
    ds_read_b64_tr_b16 a[60:61], v19 offset:8192
    v_mfma_f32_16x16x32_bf16 v[248:251], a[184:187], v[92:95], v[248:251]
    v_exp_f32 v57, v57
    v_mfma_f32_16x16x32_bf16 v[252:255], a[188:191], v[92:95], v[252:255]
    ds_read_b64_tr_b16 a[62:63], v19 offset:12288
    v_cvt_pk_bf16_f32 v84, v56, v57
    v_mfma_f32_16x16x32_bf16 v[124:127], v[28:31], v[92:95], v[124:127]
    v_exp_f32 v58, v58
    v_mfma_f32_16x16x32_bf16 v[64:67], a[0:3], a[224:227], v[104:107]
    v_mfma_f32_16x16x32_bf16 v[64:67], a[4:7], a[228:231], v[64:67]
    v_exp_f32 v59, v59
    v_mfma_f32_16x16x32_bf16 v[64:67], a[8:11], a[232:235], v[64:67]
    v_cvt_pk_bf16_f32 v85, v58, v59
    v_mfma_f32_16x16x32_bf16 v[64:67], a[12:15], a[236:239], v[64:67]
    v_exp_f32 v60, v60
    v_mfma_f32_16x16x32_bf16 v[68:71], a[16:19], a[224:227], v[104:107]
    v_mfma_f32_16x16x32_bf16 v[68:71], a[20:23], a[228:231], v[68:71]
    v_exp_f32 v61, v61
    v_mfma_f32_16x16x32_bf16 v[68:71], a[24:27], a[232:235], v[68:71]
    v_cvt_pk_bf16_f32 v86, v60, v61
    v_mfma_f32_16x16x32_bf16 v[68:71], a[28:31], a[236:239], v[68:71]
    v_exp_f32 v62, v62
    s_waitcnt lgkmcnt(0)
    v_mfma_f32_16x16x32_bf16 v[128:131], a[32:35], v[80:83], v[128:131]
    v_mfma_f32_16x16x32_bf16 v[132:135], a[36:39], v[80:83], v[132:135]
    v_exp_f32 v63, v63
    v_mfma_f32_16x16x32_bf16 v[136:139], a[40:43], v[80:83], v[136:139]
    v_cvt_pk_bf16_f32 v87, v62, v63
    v_mfma_f32_16x16x32_bf16 v[140:143], a[44:47], v[80:83], v[140:143]
    s_waitcnt vmcnt(10) lgkmcnt(0)
    s_barrier
    v_mfma_f32_16x16x32_bf16 v[144:147], a[48:51], v[80:83], v[144:147]
    v_exp_f32 v64, v64
    v_mfma_f32_16x16x32_bf16 v[148:151], a[52:55], v[80:83], v[148:151]
    ds_read_b128 a[128:131], v8 offset:32768
    v_mfma_f32_16x16x32_bf16 v[152:155], a[56:59], v[80:83], v[152:155]
    v_exp_f32 v65, v65
    v_mfma_f32_16x16x32_bf16 v[156:159], a[60:63], v[80:83], v[156:159]
    ds_read_b128 a[132:135], v9 offset:32768
    v_cvt_pk_bf16_f32 v88, v64, v65
    v_mfma_f32_16x16x32_bf16 v[112:115], v[28:31], v[80:83], v[112:115]
    v_exp_f32 v66, v66
    v_mfma_f32_16x16x32_bf16 v[72:75], a[0:3], a[240:243], v[108:111]
    ds_read_b128 a[136:139], v10 offset:32768
    v_mfma_f32_16x16x32_bf16 v[72:75], a[4:7], a[244:247], v[72:75]
    v_exp_f32 v67, v67
    v_mfma_f32_16x16x32_bf16 v[72:75], a[8:11], a[248:251], v[72:75]
    ds_read_b128 a[140:143], v11 offset:32768
    v_cvt_pk_bf16_f32 v89, v66, v67
    v_mfma_f32_16x16x32_bf16 v[72:75], a[12:15], a[252:255], v[72:75]
    v_exp_f32 v68, v68
    v_mfma_f32_16x16x32_bf16 v[76:79], a[16:19], a[240:243], v[108:111]
    ds_read_b128 a[144:147], v8 offset:36864
    v_mfma_f32_16x16x32_bf16 v[76:79], a[20:23], a[244:247], v[76:79]
    v_exp_f32 v69, v69
    v_mfma_f32_16x16x32_bf16 v[76:79], a[24:27], a[248:251], v[76:79]
    ds_read_b128 a[148:151], v9 offset:36864
    v_cvt_pk_bf16_f32 v90, v68, v69
    v_mfma_f32_16x16x32_bf16 v[76:79], a[28:31], a[252:255], v[76:79]
    v_exp_f32 v70, v70
    v_mfma_f32_16x16x32_bf16 v[160:163], a[32:35], v[84:87], v[160:163]
    v_mfma_f32_16x16x32_bf16 v[164:167], a[36:39], v[84:87], v[164:167]
    v_exp_f32 v71, v71
    v_mfma_f32_16x16x32_bf16 v[168:171], a[40:43], v[84:87], v[168:171]
    ds_read_b128 a[152:155], v10 offset:36864
    v_cvt_pk_bf16_f32 v91, v70, v71
    v_mfma_f32_16x16x32_bf16 v[172:175], a[44:47], v[84:87], v[172:175]
    v_mfma_f32_16x16x32_bf16 v[176:179], a[48:51], v[84:87], v[176:179]
    v_exp_f32 v72, v72
    v_mfma_f32_16x16x32_bf16 v[180:183], a[52:55], v[84:87], v[180:183]
    ds_read_b128 a[156:159], v11 offset:36864
    v_mfma_f32_16x16x32_bf16 v[184:187], a[56:59], v[84:87], v[184:187]
    v_exp_f32 v73, v73
    v_mfma_f32_16x16x32_bf16 v[188:191], a[60:63], v[84:87], v[188:191]
    v_cvt_pk_bf16_f32 v92, v72, v73
    v_mfma_f32_16x16x32_bf16 v[116:119], v[28:31], v[84:87], v[116:119]
    v_exp_f32 v74, v74
    s_waitcnt lgkmcnt(2)
    v_mfma_f32_16x16x32_bf16 v[48:51], a[128:131], a[192:195], v[96:99]
    ds_read_b64_tr_b16 a[160:161], v12 offset:16384
    v_mfma_f32_16x16x32_bf16 v[48:51], a[132:135], a[196:199], v[48:51]
    v_exp_f32 v75, v75
    v_mfma_f32_16x16x32_bf16 v[48:51], a[136:139], a[200:203], v[48:51]
    ds_read_b64_tr_b16 a[162:163], v12 offset:20480
    v_cvt_pk_bf16_f32 v93, v74, v75
    v_mfma_f32_16x16x32_bf16 v[48:51], a[140:143], a[204:207], v[48:51]
    v_exp_f32 v76, v76
    v_mfma_f32_16x16x32_bf16 v[52:55], a[144:147], a[192:195], v[96:99]
    ds_read_b64_tr_b16 a[164:165], v13 offset:16384
    v_mfma_f32_16x16x32_bf16 v[52:55], a[148:151], a[196:199], v[52:55]
    v_exp_f32 v77, v77
    s_waitcnt lgkmcnt(3)
    v_mfma_f32_16x16x32_bf16 v[52:55], a[152:155], a[200:203], v[52:55]
    ds_read_b64_tr_b16 a[166:167], v13 offset:20480
    v_cvt_pk_bf16_f32 v94, v76, v77
    v_mfma_f32_16x16x32_bf16 v[52:55], a[156:159], a[204:207], v[52:55]
    v_exp_f32 v78, v78
    v_mfma_f32_16x16x32_bf16 v[192:195], a[32:35], v[88:91], v[192:195]
    v_mfma_f32_16x16x32_bf16 v[196:199], a[36:39], v[88:91], v[196:199]
    v_exp_f32 v79, v79
    v_mfma_f32_16x16x32_bf16 v[200:203], a[40:43], v[88:91], v[200:203]
    ds_read_b64_tr_b16 a[168:169], v14 offset:16384
    v_cvt_pk_bf16_f32 v95, v78, v79
    v_mfma_f32_16x16x32_bf16 v[204:207], a[44:47], v[88:91], v[204:207]
    ds_read_b64_tr_b16 a[170:171], v14 offset:20480
    v_mfma_f32_16x16x32_bf16 v[208:211], a[48:51], v[88:91], v[208:211]
    v_exp_f32 v48, v48
    v_mfma_f32_16x16x32_bf16 v[212:215], a[52:55], v[88:91], v[212:215]
    ds_read_b64_tr_b16 a[172:173], v15 offset:16384
    v_mfma_f32_16x16x32_bf16 v[216:219], a[56:59], v[88:91], v[216:219]
    v_exp_f32 v49, v49
    v_mfma_f32_16x16x32_bf16 v[220:223], a[60:63], v[88:91], v[220:223]
    ds_read_b64_tr_b16 a[174:175], v15 offset:20480
    v_cvt_pk_bf16_f32 v80, v48, v49
    v_mfma_f32_16x16x32_bf16 v[120:123], v[28:31], v[88:91], v[120:123]
    v_exp_f32 v50, v50
    v_mfma_f32_16x16x32_bf16 v[56:59], a[128:131], a[208:211], v[100:103]
    ds_read_b64_tr_b16 a[176:177], v16 offset:16384
    v_mfma_f32_16x16x32_bf16 v[56:59], a[132:135], a[212:215], v[56:59]
    v_exp_f32 v51, v51
    v_mfma_f32_16x16x32_bf16 v[56:59], a[136:139], a[216:219], v[56:59]
    ds_read_b64_tr_b16 a[178:179], v16 offset:20480
    v_cvt_pk_bf16_f32 v81, v50, v51
    v_mfma_f32_16x16x32_bf16 v[56:59], a[140:143], a[220:223], v[56:59]
    v_exp_f32 v52, v52
    v_mov_b32 v45, 0
    v_mfma_f32_16x16x32_bf16 v[60:63], a[144:147], a[208:211], v[100:103]
    ds_read_b64_tr_b16 a[180:181], v17 offset:16384
    buffer_load_dword v44, v45, s[32:35], 0 offen sc1
    v_mfma_f32_16x16x32_bf16 v[60:63], a[148:151], a[212:215], v[60:63]
    v_exp_f32 v53, v53
    v_mfma_f32_16x16x32_bf16 v[60:63], a[152:155], a[216:219], v[60:63]
    ds_read_b64_tr_b16 a[182:183], v17 offset:20480
    v_cvt_pk_bf16_f32 v82, v52, v53
    v_mfma_f32_16x16x32_bf16 v[60:63], a[156:159], a[220:223], v[60:63]
    v_exp_f32 v54, v54
    v_mfma_f32_16x16x32_bf16 v[224:227], a[32:35], v[92:95], v[224:227]
    v_mfma_f32_16x16x32_bf16 v[228:231], a[36:39], v[92:95], v[228:231]
    v_exp_f32 v55, v55
    v_mfma_f32_16x16x32_bf16 v[232:235], a[40:43], v[92:95], v[232:235]
    ds_read_b64_tr_b16 a[184:185], v18 offset:16384
    v_cvt_pk_bf16_f32 v83, v54, v55
    v_mfma_f32_16x16x32_bf16 v[236:239], a[44:47], v[92:95], v[236:239]
    ds_read_b64_tr_b16 a[186:187], v18 offset:20480
    v_mfma_f32_16x16x32_bf16 v[240:243], a[48:51], v[92:95], v[240:243]
    v_exp_f32 v56, v56
    v_mfma_f32_16x16x32_bf16 v[244:247], a[52:55], v[92:95], v[244:247]
    ds_read_b64_tr_b16 a[188:189], v19 offset:16384
    v_mfma_f32_16x16x32_bf16 v[248:251], a[56:59], v[92:95], v[248:251]
    v_exp_f32 v57, v57
    v_mfma_f32_16x16x32_bf16 v[252:255], a[60:63], v[92:95], v[252:255]
    ds_read_b64_tr_b16 a[190:191], v19 offset:20480
    v_cvt_pk_bf16_f32 v84, v56, v57
    v_mfma_f32_16x16x32_bf16 v[124:127], v[28:31], v[92:95], v[124:127]
    v_exp_f32 v58, v58
    v_mfma_f32_16x16x32_bf16 v[64:67], a[128:131], a[224:227], v[104:107]
    v_mfma_f32_16x16x32_bf16 v[64:67], a[132:135], a[228:231], v[64:67]
    v_exp_f32 v59, v59
    v_mfma_f32_16x16x32_bf16 v[64:67], a[136:139], a[232:235], v[64:67]
    v_cvt_pk_bf16_f32 v85, v58, v59
    v_mfma_f32_16x16x32_bf16 v[64:67], a[140:143], a[236:239], v[64:67]
    v_exp_f32 v60, v60
    v_mfma_f32_16x16x32_bf16 v[68:71], a[144:147], a[224:227], v[104:107]
    v_mfma_f32_16x16x32_bf16 v[68:71], a[148:151], a[228:231], v[68:71]
    v_exp_f32 v61, v61
    v_mfma_f32_16x16x32_bf16 v[68:71], a[152:155], a[232:235], v[68:71]
    v_cvt_pk_bf16_f32 v86, v60, v61
    v_mfma_f32_16x16x32_bf16 v[68:71], a[156:159], a[236:239], v[68:71]
    v_exp_f32 v62, v62
    s_waitcnt lgkmcnt(0)
    v_mfma_f32_16x16x32_bf16 v[128:131], a[160:163], v[80:83], v[128:131]
    v_mfma_f32_16x16x32_bf16 v[132:135], a[164:167], v[80:83], v[132:135]
    v_exp_f32 v63, v63
    v_mfma_f32_16x16x32_bf16 v[136:139], a[168:171], v[80:83], v[136:139]
    v_cvt_pk_bf16_f32 v87, v62, v63
    v_mfma_f32_16x16x32_bf16 v[140:143], a[172:175], v[80:83], v[140:143]
    v_mfma_f32_16x16x32_bf16 v[144:147], a[176:179], v[80:83], v[144:147]
    v_exp_f32 v64, v64
    v_mfma_f32_16x16x32_bf16 v[148:151], a[180:183], v[80:83], v[148:151]
    ds_read_b128 a[0:3], v8 offset:40960
    v_mfma_f32_16x16x32_bf16 v[152:155], a[184:187], v[80:83], v[152:155]
    v_exp_f32 v65, v65
    v_mfma_f32_16x16x32_bf16 v[156:159], a[188:191], v[80:83], v[156:159]
    ds_read_b128 a[4:7], v9 offset:40960
    v_cvt_pk_bf16_f32 v88, v64, v65
    v_mfma_f32_16x16x32_bf16 v[112:115], v[28:31], v[80:83], v[112:115]
    v_exp_f32 v66, v66
    v_mfma_f32_16x16x32_bf16 v[72:75], a[128:131], a[240:243], v[108:111]
    ds_read_b128 a[8:11], v10 offset:40960
    v_mfma_f32_16x16x32_bf16 v[72:75], a[132:135], a[244:247], v[72:75]
    v_exp_f32 v67, v67
    v_mfma_f32_16x16x32_bf16 v[72:75], a[136:139], a[248:251], v[72:75]
    ds_read_b128 a[12:15], v11 offset:40960
    v_cvt_pk_bf16_f32 v89, v66, v67
    v_mfma_f32_16x16x32_bf16 v[72:75], a[140:143], a[252:255], v[72:75]
    v_exp_f32 v68, v68
    v_mfma_f32_16x16x32_bf16 v[76:79], a[144:147], a[240:243], v[108:111]
    ds_read_b128 a[16:19], v8 offset:45056
    v_mfma_f32_16x16x32_bf16 v[76:79], a[148:151], a[244:247], v[76:79]
    v_exp_f32 v69, v69
    v_mfma_f32_16x16x32_bf16 v[76:79], a[152:155], a[248:251], v[76:79]
    ds_read_b128 a[20:23], v9 offset:45056
    v_cvt_pk_bf16_f32 v90, v68, v69
    v_mfma_f32_16x16x32_bf16 v[76:79], a[156:159], a[252:255], v[76:79]
    v_exp_f32 v70, v70
    v_mfma_f32_16x16x32_bf16 v[160:163], a[160:163], v[84:87], v[160:163]
    v_mfma_f32_16x16x32_bf16 v[164:167], a[164:167], v[84:87], v[164:167]
    v_exp_f32 v71, v71
    v_mfma_f32_16x16x32_bf16 v[168:171], a[168:171], v[84:87], v[168:171]
    ds_read_b128 a[24:27], v10 offset:45056
    v_cvt_pk_bf16_f32 v91, v70, v71
    v_mfma_f32_16x16x32_bf16 v[172:175], a[172:175], v[84:87], v[172:175]
    v_mfma_f32_16x16x32_bf16 v[176:179], a[176:179], v[84:87], v[176:179]
    v_exp_f32 v72, v72
    v_mfma_f32_16x16x32_bf16 v[180:183], a[180:183], v[84:87], v[180:183]
    ds_read_b128 a[28:31], v11 offset:45056
    v_mfma_f32_16x16x32_bf16 v[184:187], a[184:187], v[84:87], v[184:187]
    v_exp_f32 v73, v73
    v_mfma_f32_16x16x32_bf16 v[188:191], a[188:191], v[84:87], v[188:191]
    v_cvt_pk_bf16_f32 v92, v72, v73
    v_mfma_f32_16x16x32_bf16 v[116:119], v[28:31], v[84:87], v[116:119]
    v_exp_f32 v74, v74
    s_waitcnt lgkmcnt(2)
    v_mfma_f32_16x16x32_bf16 v[48:51], a[0:3], a[192:195], v[96:99]
    ds_read_b64_tr_b16 a[32:33], v12 offset:24576
    v_mfma_f32_16x16x32_bf16 v[48:51], a[4:7], a[196:199], v[48:51]
    v_exp_f32 v75, v75
    v_mfma_f32_16x16x32_bf16 v[48:51], a[8:11], a[200:203], v[48:51]
    ds_read_b64_tr_b16 a[34:35], v12 offset:28672
    v_cvt_pk_bf16_f32 v93, v74, v75
    v_mfma_f32_16x16x32_bf16 v[48:51], a[12:15], a[204:207], v[48:51]
    v_exp_f32 v76, v76
    v_mfma_f32_16x16x32_bf16 v[52:55], a[16:19], a[192:195], v[96:99]
    ds_read_b64_tr_b16 a[36:37], v13 offset:24576
    v_mfma_f32_16x16x32_bf16 v[52:55], a[20:23], a[196:199], v[52:55]
    v_exp_f32 v77, v77
    s_waitcnt lgkmcnt(3)
    v_mfma_f32_16x16x32_bf16 v[52:55], a[24:27], a[200:203], v[52:55]
    ds_read_b64_tr_b16 a[38:39], v13 offset:28672
    v_cvt_pk_bf16_f32 v94, v76, v77
    v_mfma_f32_16x16x32_bf16 v[52:55], a[28:31], a[204:207], v[52:55]
    v_exp_f32 v78, v78
    v_mfma_f32_16x16x32_bf16 v[192:195], a[160:163], v[88:91], v[192:195]
    v_mfma_f32_16x16x32_bf16 v[196:199], a[164:167], v[88:91], v[196:199]
    v_exp_f32 v79, v79
    v_mfma_f32_16x16x32_bf16 v[200:203], a[168:171], v[88:91], v[200:203]
    ds_read_b64_tr_b16 a[40:41], v14 offset:24576
    v_cvt_pk_bf16_f32 v95, v78, v79
    v_mfma_f32_16x16x32_bf16 v[204:207], a[172:175], v[88:91], v[204:207]
    ds_read_b64_tr_b16 a[42:43], v14 offset:28672
    v_mfma_f32_16x16x32_bf16 v[208:211], a[176:179], v[88:91], v[208:211]
    v_exp_f32 v48, v48
    v_mfma_f32_16x16x32_bf16 v[212:215], a[180:183], v[88:91], v[212:215]
    ds_read_b64_tr_b16 a[44:45], v15 offset:24576
    v_mfma_f32_16x16x32_bf16 v[216:219], a[184:187], v[88:91], v[216:219]
    v_exp_f32 v49, v49
    v_mfma_f32_16x16x32_bf16 v[220:223], a[188:191], v[88:91], v[220:223]
    ds_read_b64_tr_b16 a[46:47], v15 offset:28672
    v_cvt_pk_bf16_f32 v80, v48, v49
    v_mfma_f32_16x16x32_bf16 v[120:123], v[28:31], v[88:91], v[120:123]
    v_exp_f32 v50, v50
    v_mfma_f32_16x16x32_bf16 v[56:59], a[0:3], a[208:211], v[100:103]
    ds_read_b64_tr_b16 a[48:49], v16 offset:24576
    v_mfma_f32_16x16x32_bf16 v[56:59], a[4:7], a[212:215], v[56:59]
    v_exp_f32 v51, v51
    v_mfma_f32_16x16x32_bf16 v[56:59], a[8:11], a[216:219], v[56:59]
    ds_read_b64_tr_b16 a[50:51], v16 offset:28672
    v_cvt_pk_bf16_f32 v81, v50, v51
    v_mfma_f32_16x16x32_bf16 v[56:59], a[12:15], a[220:223], v[56:59]
    v_exp_f32 v52, v52
    v_mfma_f32_16x16x32_bf16 v[60:63], a[16:19], a[208:211], v[100:103]
    ds_read_b64_tr_b16 a[52:53], v17 offset:24576
    v_mfma_f32_16x16x32_bf16 v[60:63], a[20:23], a[212:215], v[60:63]
    v_exp_f32 v53, v53
    v_mfma_f32_16x16x32_bf16 v[60:63], a[24:27], a[216:219], v[60:63]
    ds_read_b64_tr_b16 a[54:55], v17 offset:28672
    v_cvt_pk_bf16_f32 v82, v52, v53
    v_mfma_f32_16x16x32_bf16 v[60:63], a[28:31], a[220:223], v[60:63]
    v_exp_f32 v54, v54
    v_mfma_f32_16x16x32_bf16 v[224:227], a[160:163], v[92:95], v[224:227]
    v_mfma_f32_16x16x32_bf16 v[228:231], a[164:167], v[92:95], v[228:231]
    v_exp_f32 v55, v55
    v_mfma_f32_16x16x32_bf16 v[232:235], a[168:171], v[92:95], v[232:235]
    ds_read_b64_tr_b16 a[56:57], v18 offset:24576
    v_cvt_pk_bf16_f32 v83, v54, v55
    v_mfma_f32_16x16x32_bf16 v[236:239], a[172:175], v[92:95], v[236:239]
    ds_read_b64_tr_b16 a[58:59], v18 offset:28672
    v_mfma_f32_16x16x32_bf16 v[240:243], a[176:179], v[92:95], v[240:243]
    v_exp_f32 v56, v56
    v_mfma_f32_16x16x32_bf16 v[244:247], a[180:183], v[92:95], v[244:247]
    ds_read_b64_tr_b16 a[60:61], v19 offset:24576
    s_add_u32 m0, s53, 0x20000
    s_mov_b32 s65, 0
    buffer_load_dwordx4 v32, s[24:27], s65 offen lds
    v_mfma_f32_16x16x32_bf16 v[248:251], a[184:187], v[92:95], v[248:251]
    v_exp_f32 v57, v57
    v_mfma_f32_16x16x32_bf16 v[252:255], a[188:191], v[92:95], v[252:255]
    ds_read_b64_tr_b16 a[62:63], v19 offset:28672
    v_cvt_pk_bf16_f32 v84, v56, v57
    v_mfma_f32_16x16x32_bf16 v[124:127], v[28:31], v[92:95], v[124:127]
    v_exp_f32 v58, v58
    v_mfma_f32_16x16x32_bf16 v[64:67], a[0:3], a[224:227], v[104:107]
    v_mfma_f32_16x16x32_bf16 v[64:67], a[4:7], a[228:231], v[64:67]
    v_exp_f32 v59, v59
    v_mfma_f32_16x16x32_bf16 v[64:67], a[8:11], a[232:235], v[64:67]
    v_cvt_pk_bf16_f32 v85, v58, v59
    v_mfma_f32_16x16x32_bf16 v[64:67], a[12:15], a[236:239], v[64:67]
    v_exp_f32 v60, v60
    v_mfma_f32_16x16x32_bf16 v[68:71], a[16:19], a[224:227], v[104:107]
    buffer_load_dwordx4 v33, s[24:27], s65 offen offset:1024 lds
    v_mfma_f32_16x16x32_bf16 v[68:71], a[20:23], a[228:231], v[68:71]
    v_exp_f32 v61, v61
    v_mfma_f32_16x16x32_bf16 v[68:71], a[24:27], a[232:235], v[68:71]
    v_cvt_pk_bf16_f32 v86, v60, v61
    v_mfma_f32_16x16x32_bf16 v[68:71], a[28:31], a[236:239], v[68:71]
    v_exp_f32 v62, v62
    s_waitcnt lgkmcnt(0)
    v_mfma_f32_16x16x32_bf16 v[128:131], a[32:35], v[80:83], v[128:131]
    buffer_load_dwordx4 v34, s[24:27], s65 offen offset:2048 lds
    v_mfma_f32_16x16x32_bf16 v[132:135], a[36:39], v[80:83], v[132:135]
    v_exp_f32 v63, v63
    v_mfma_f32_16x16x32_bf16 v[136:139], a[40:43], v[80:83], v[136:139]
    v_cvt_pk_bf16_f32 v87, v62, v63
    v_mfma_f32_16x16x32_bf16 v[140:143], a[44:47], v[80:83], v[140:143]
    s_waitcnt vmcnt(6) lgkmcnt(0)
    s_barrier
    v_mfma_f32_16x16x32_bf16 v[144:147], a[48:51], v[80:83], v[144:147]
    v_exp_f32 v64, v64
    v_mfma_f32_16x16x32_bf16 v[148:151], a[52:55], v[80:83], v[148:151]
    ds_read_b128 a[128:131], v8 offset:49152
    v_mfma_f32_16x16x32_bf16 v[152:155], a[56:59], v[80:83], v[152:155]
    v_exp_f32 v65, v65
    v_mfma_f32_16x16x32_bf16 v[156:159], a[60:63], v[80:83], v[156:159]
    ds_read_b128 a[132:135], v9 offset:49152
    v_cvt_pk_bf16_f32 v88, v64, v65
    v_mfma_f32_16x16x32_bf16 v[112:115], v[28:31], v[80:83], v[112:115]
    v_exp_f32 v66, v66
    v_mfma_f32_16x16x32_bf16 v[72:75], a[0:3], a[240:243], v[108:111]
    ds_read_b128 a[136:139], v10 offset:49152
    buffer_load_dwordx4 v35, s[24:27], s65 offen offset:3072 lds
    v_mfma_f32_16x16x32_bf16 v[72:75], a[4:7], a[244:247], v[72:75]
    v_exp_f32 v67, v67
    v_mfma_f32_16x16x32_bf16 v[72:75], a[8:11], a[248:251], v[72:75]
    ds_read_b128 a[140:143], v11 offset:49152
    v_cvt_pk_bf16_f32 v89, v66, v67
    v_mfma_f32_16x16x32_bf16 v[72:75], a[12:15], a[252:255], v[72:75]
    v_exp_f32 v68, v68
    v_mfma_f32_16x16x32_bf16 v[76:79], a[16:19], a[240:243], v[108:111]
    ds_read_b128 a[144:147], v8 offset:53248
    s_add_u32 m0, s53, 0x24000
    s_mov_b32 s65, 0xa000
    buffer_load_dwordx4 v32, s[24:27], s65 offen lds
    v_mfma_f32_16x16x32_bf16 v[76:79], a[20:23], a[244:247], v[76:79]
    v_exp_f32 v69, v69
    v_mfma_f32_16x16x32_bf16 v[76:79], a[24:27], a[248:251], v[76:79]
    ds_read_b128 a[148:151], v9 offset:53248
    v_cvt_pk_bf16_f32 v90, v68, v69
    v_mfma_f32_16x16x32_bf16 v[76:79], a[28:31], a[252:255], v[76:79]
    v_exp_f32 v70, v70
    v_mfma_f32_16x16x32_bf16 v[160:163], a[32:35], v[84:87], v[160:163]
    v_mfma_f32_16x16x32_bf16 v[164:167], a[36:39], v[84:87], v[164:167]
    v_exp_f32 v71, v71
    v_mfma_f32_16x16x32_bf16 v[168:171], a[40:43], v[84:87], v[168:171]
    ds_read_b128 a[152:155], v10 offset:53248
    v_cvt_pk_bf16_f32 v91, v70, v71
    v_mfma_f32_16x16x32_bf16 v[172:175], a[44:47], v[84:87], v[172:175]
    buffer_load_dwordx4 v33, s[24:27], s65 offen offset:1024 lds
    v_mfma_f32_16x16x32_bf16 v[176:179], a[48:51], v[84:87], v[176:179]
    v_exp_f32 v72, v72
    v_mfma_f32_16x16x32_bf16 v[180:183], a[52:55], v[84:87], v[180:183]
    ds_read_b128 a[156:159], v11 offset:53248
    v_mfma_f32_16x16x32_bf16 v[184:187], a[56:59], v[84:87], v[184:187]
    v_exp_f32 v73, v73
    v_mfma_f32_16x16x32_bf16 v[188:191], a[60:63], v[84:87], v[188:191]
    buffer_load_dwordx4 v34, s[24:27], s65 offen offset:2048 lds
    v_cvt_pk_bf16_f32 v92, v72, v73
    v_mfma_f32_16x16x32_bf16 v[116:119], v[28:31], v[84:87], v[116:119]
    v_exp_f32 v74, v74
    s_waitcnt lgkmcnt(2)
    v_mfma_f32_16x16x32_bf16 v[48:51], a[128:131], a[192:195], v[96:99]
    ds_read_b64_tr_b16 a[160:161], v12 offset:49152
    v_mfma_f32_16x16x32_bf16 v[48:51], a[132:135], a[196:199], v[48:51]
    v_exp_f32 v75, v75
    v_mfma_f32_16x16x32_bf16 v[48:51], a[136:139], a[200:203], v[48:51]
    ds_read_b64_tr_b16 a[162:163], v12 offset:53248
    v_cvt_pk_bf16_f32 v93, v74, v75
    v_mfma_f32_16x16x32_bf16 v[48:51], a[140:143], a[204:207], v[48:51]
    v_exp_f32 v76, v76
    v_mfma_f32_16x16x32_bf16 v[52:55], a[144:147], a[192:195], v[96:99]
    ds_read_b64_tr_b16 a[164:165], v13 offset:49152
    buffer_load_dwordx4 v35, s[24:27], s65 offen offset:3072 lds
    v_mfma_f32_16x16x32_bf16 v[52:55], a[148:151], a[196:199], v[52:55]
    v_exp_f32 v77, v77
    s_waitcnt lgkmcnt(3)
    v_mfma_f32_16x16x32_bf16 v[52:55], a[152:155], a[200:203], v[52:55]
    ds_read_b64_tr_b16 a[166:167], v13 offset:53248
    v_cvt_pk_bf16_f32 v94, v76, v77
    v_mfma_f32_16x16x32_bf16 v[52:55], a[156:159], a[204:207], v[52:55]
    v_exp_f32 v78, v78
    v_mfma_f32_16x16x32_bf16 v[192:195], a[32:35], v[88:91], v[192:195]
    v_mfma_f32_16x16x32_bf16 v[196:199], a[36:39], v[88:91], v[196:199]
    v_exp_f32 v79, v79
    v_mfma_f32_16x16x32_bf16 v[200:203], a[40:43], v[88:91], v[200:203]
    ds_read_b64_tr_b16 a[168:169], v14 offset:49152
    v_cvt_pk_bf16_f32 v95, v78, v79
    v_mfma_f32_16x16x32_bf16 v[204:207], a[44:47], v[88:91], v[204:207]
    ds_read_b64_tr_b16 a[170:171], v14 offset:53248
    s_add_u32 m0, s53, 0
    s_mov_b32 s65, 0x14000
    buffer_load_dwordx4 v32, s[24:27], s65 offen lds
    v_mfma_f32_16x16x32_bf16 v[208:211], a[48:51], v[88:91], v[208:211]
    v_exp_f32 v48, v48
    v_mfma_f32_16x16x32_bf16 v[212:215], a[52:55], v[88:91], v[212:215]
    ds_read_b64_tr_b16 a[172:173], v15 offset:49152
    v_mfma_f32_16x16x32_bf16 v[216:219], a[56:59], v[88:91], v[216:219]
    v_exp_f32 v49, v49
    v_mfma_f32_16x16x32_bf16 v[220:223], a[60:63], v[88:91], v[220:223]
    ds_read_b64_tr_b16 a[174:175], v15 offset:53248
    v_cvt_pk_bf16_f32 v80, v48, v49
    v_mfma_f32_16x16x32_bf16 v[120:123], v[28:31], v[88:91], v[120:123]
    v_exp_f32 v50, v50
    v_mfma_f32_16x16x32_bf16 v[56:59], a[128:131], a[208:211], v[100:103]
    ds_read_b64_tr_b16 a[176:177], v16 offset:49152
    buffer_load_dwordx4 v33, s[24:27], s65 offen offset:1024 lds
    v_mfma_f32_16x16x32_bf16 v[56:59], a[132:135], a[212:215], v[56:59]
    v_exp_f32 v51, v51
    v_mfma_f32_16x16x32_bf16 v[56:59], a[136:139], a[216:219], v[56:59]
    ds_read_b64_tr_b16 a[178:179], v16 offset:53248
    v_cvt_pk_bf16_f32 v81, v50, v51
    v_mfma_f32_16x16x32_bf16 v[56:59], a[140:143], a[220:223], v[56:59]
    v_exp_f32 v52, v52
    v_mfma_f32_16x16x32_bf16 v[60:63], a[144:147], a[208:211], v[100:103]
    ds_read_b64_tr_b16 a[180:181], v17 offset:49152
    v_mfma_f32_16x16x32_bf16 v[60:63], a[148:151], a[212:215], v[60:63]
    v_exp_f32 v53, v53
    v_mfma_f32_16x16x32_bf16 v[60:63], a[152:155], a[216:219], v[60:63]
    ds_read_b64_tr_b16 a[182:183], v17 offset:53248
    v_cvt_pk_bf16_f32 v82, v52, v53
    v_mfma_f32_16x16x32_bf16 v[60:63], a[156:159], a[220:223], v[60:63]
    v_exp_f32 v54, v54
    v_mfma_f32_16x16x32_bf16 v[224:227], a[32:35], v[92:95], v[224:227]
    buffer_load_dwordx4 v34, s[24:27], s65 offen offset:2048 lds
    v_mfma_f32_16x16x32_bf16 v[228:231], a[36:39], v[92:95], v[228:231]
    v_exp_f32 v55, v55
    v_mfma_f32_16x16x32_bf16 v[232:235], a[40:43], v[92:95], v[232:235]
    ds_read_b64_tr_b16 a[184:185], v18 offset:49152
    v_cvt_pk_bf16_f32 v83, v54, v55
    v_mfma_f32_16x16x32_bf16 v[236:239], a[44:47], v[92:95], v[236:239]
    ds_read_b64_tr_b16 a[186:187], v18 offset:53248
    buffer_load_dwordx4 v35, s[24:27], s65 offen offset:3072 lds
    v_mfma_f32_16x16x32_bf16 v[240:243], a[48:51], v[92:95], v[240:243]
    v_exp_f32 v56, v56
    v_mfma_f32_16x16x32_bf16 v[244:247], a[52:55], v[92:95], v[244:247]
    ds_read_b64_tr_b16 a[188:189], v19 offset:49152
    v_mfma_f32_16x16x32_bf16 v[248:251], a[56:59], v[92:95], v[248:251]
    v_exp_f32 v57, v57
    v_mfma_f32_16x16x32_bf16 v[252:255], a[60:63], v[92:95], v[252:255]
    ds_read_b64_tr_b16 a[190:191], v19 offset:53248
    v_cvt_pk_bf16_f32 v84, v56, v57
    v_mfma_f32_16x16x32_bf16 v[124:127], v[28:31], v[92:95], v[124:127]
    v_exp_f32 v58, v58
    v_mfma_f32_16x16x32_bf16 v[64:67], a[128:131], a[224:227], v[104:107]
    s_add_u32 m0, s53, 0x18000
    s_mov_b32 s65, 0x1e000
    buffer_load_dwordx4 v32, s[24:27], s65 offen lds
    v_mfma_f32_16x16x32_bf16 v[64:67], a[132:135], a[228:231], v[64:67]
    v_exp_f32 v59, v59
    v_mfma_f32_16x16x32_bf16 v[64:67], a[136:139], a[232:235], v[64:67]
    v_cvt_pk_bf16_f32 v85, v58, v59
    v_mfma_f32_16x16x32_bf16 v[64:67], a[140:143], a[236:239], v[64:67]
    v_exp_f32 v60, v60
    v_mfma_f32_16x16x32_bf16 v[68:71], a[144:147], a[224:227], v[104:107]
    v_mfma_f32_16x16x32_bf16 v[68:71], a[148:151], a[228:231], v[68:71]
    v_exp_f32 v61, v61
    v_mfma_f32_16x16x32_bf16 v[68:71], a[152:155], a[232:235], v[68:71]
    v_cvt_pk_bf16_f32 v86, v60, v61
    v_mfma_f32_16x16x32_bf16 v[68:71], a[156:159], a[236:239], v[68:71]
    v_exp_f32 v62, v62
    s_waitcnt lgkmcnt(0)
    v_mfma_f32_16x16x32_bf16 v[128:131], a[160:163], v[80:83], v[128:131]
    buffer_load_dwordx4 v33, s[24:27], s65 offen offset:1024 lds
    v_mfma_f32_16x16x32_bf16 v[132:135], a[164:167], v[80:83], v[132:135]
    v_exp_f32 v63, v63
    v_mfma_f32_16x16x32_bf16 v[136:139], a[168:171], v[80:83], v[136:139]
    v_cvt_pk_bf16_f32 v87, v62, v63
    v_mfma_f32_16x16x32_bf16 v[140:143], a[172:175], v[80:83], v[140:143]
    v_mfma_f32_16x16x32_bf16 v[144:147], a[176:179], v[80:83], v[144:147]
    v_exp_f32 v64, v64
    v_mfma_f32_16x16x32_bf16 v[148:151], a[180:183], v[80:83], v[148:151]
    ds_read_b128 a[0:3], v8 offset:57344
    buffer_load_dwordx4 v34, s[24:27], s65 offen offset:2048 lds
    v_mfma_f32_16x16x32_bf16 v[152:155], a[184:187], v[80:83], v[152:155]
    v_exp_f32 v65, v65
    v_mfma_f32_16x16x32_bf16 v[156:159], a[188:191], v[80:83], v[156:159]
    ds_read_b128 a[4:7], v9 offset:57344
    v_cvt_pk_bf16_f32 v88, v64, v65
    v_mfma_f32_16x16x32_bf16 v[112:115], v[28:31], v[80:83], v[112:115]
    v_exp_f32 v66, v66
    v_mfma_f32_16x16x32_bf16 v[72:75], a[128:131], a[240:243], v[108:111]
    ds_read_b128 a[8:11], v10 offset:57344
    v_mfma_f32_16x16x32_bf16 v[72:75], a[132:135], a[244:247], v[72:75]
    v_exp_f32 v67, v67
    v_mfma_f32_16x16x32_bf16 v[72:75], a[136:139], a[248:251], v[72:75]
    ds_read_b128 a[12:15], v11 offset:57344
    v_cvt_pk_bf16_f32 v89, v66, v67
    v_mfma_f32_16x16x32_bf16 v[72:75], a[140:143], a[252:255], v[72:75]
    v_exp_f32 v68, v68
    v_mfma_f32_16x16x32_bf16 v[76:79], a[144:147], a[240:243], v[108:111]
    ds_read_b128 a[16:19], v8 offset:61440
    buffer_load_dwordx4 v35, s[24:27], s65 offen offset:3072 lds
    v_mfma_f32_16x16x32_bf16 v[76:79], a[148:151], a[244:247], v[76:79]
    v_exp_f32 v69, v69
    v_mfma_f32_16x16x32_bf16 v[76:79], a[152:155], a[248:251], v[76:79]
    ds_read_b128 a[20:23], v9 offset:61440
    v_cvt_pk_bf16_f32 v90, v68, v69
    v_mfma_f32_16x16x32_bf16 v[76:79], a[156:159], a[252:255], v[76:79]
    v_exp_f32 v70, v70
    v_mfma_f32_16x16x32_bf16 v[160:163], a[160:163], v[84:87], v[160:163]
    s_add_u32 m0, s53, 0x4000
    s_mov_b32 s65, 0x28000
    buffer_load_dwordx4 v32, s[24:27], s65 offen lds
    v_mfma_f32_16x16x32_bf16 v[164:167], a[164:167], v[84:87], v[164:167]
    v_exp_f32 v71, v71
    v_mfma_f32_16x16x32_bf16 v[168:171], a[168:171], v[84:87], v[168:171]
    ds_read_b128 a[24:27], v10 offset:61440
    v_cvt_pk_bf16_f32 v91, v70, v71
    v_mfma_f32_16x16x32_bf16 v[172:175], a[172:175], v[84:87], v[172:175]
    v_mfma_f32_16x16x32_bf16 v[176:179], a[176:179], v[84:87], v[176:179]
    v_exp_f32 v72, v72
    v_mfma_f32_16x16x32_bf16 v[180:183], a[180:183], v[84:87], v[180:183]
    ds_read_b128 a[28:31], v11 offset:61440
    buffer_load_dwordx4 v33, s[24:27], s65 offen offset:1024 lds
    v_mfma_f32_16x16x32_bf16 v[184:187], a[184:187], v[84:87], v[184:187]
    v_exp_f32 v73, v73
    v_mfma_f32_16x16x32_bf16 v[188:191], a[188:191], v[84:87], v[188:191]
    v_cvt_pk_bf16_f32 v92, v72, v73
    v_mfma_f32_16x16x32_bf16 v[116:119], v[28:31], v[84:87], v[116:119]
    v_exp_f32 v74, v74
    s_waitcnt lgkmcnt(2)
    v_mfma_f32_16x16x32_bf16 v[48:51], a[0:3], a[192:195], v[96:99]
    ds_read_b64_tr_b16 a[32:33], v12 offset:57344
    v_mfma_f32_16x16x32_bf16 v[48:51], a[4:7], a[196:199], v[48:51]
    v_exp_f32 v75, v75
    v_mfma_f32_16x16x32_bf16 v[48:51], a[8:11], a[200:203], v[48:51]
    ds_read_b64_tr_b16 a[34:35], v12 offset:61440
    v_cvt_pk_bf16_f32 v93, v74, v75
    v_mfma_f32_16x16x32_bf16 v[48:51], a[12:15], a[204:207], v[48:51]
    v_exp_f32 v76, v76
    v_mfma_f32_16x16x32_bf16 v[52:55], a[16:19], a[192:195], v[96:99]
    ds_read_b64_tr_b16 a[36:37], v13 offset:57344
    buffer_load_dwordx4 v34, s[24:27], s65 offen offset:2048 lds
    v_mfma_f32_16x16x32_bf16 v[52:55], a[20:23], a[196:199], v[52:55]
    v_exp_f32 v77, v77
    s_waitcnt lgkmcnt(3)
    v_mfma_f32_16x16x32_bf16 v[52:55], a[24:27], a[200:203], v[52:55]
    ds_read_b64_tr_b16 a[38:39], v13 offset:61440
    v_cvt_pk_bf16_f32 v94, v76, v77
    v_mfma_f32_16x16x32_bf16 v[52:55], a[28:31], a[204:207], v[52:55]
    v_exp_f32 v78, v78
    v_mfma_f32_16x16x32_bf16 v[192:195], a[160:163], v[88:91], v[192:195]
    buffer_load_dwordx4 v35, s[24:27], s65 offen offset:3072 lds
    v_mfma_f32_16x16x32_bf16 v[196:199], a[164:167], v[88:91], v[196:199]
    v_exp_f32 v79, v79
    v_mfma_f32_16x16x32_bf16 v[200:203], a[168:171], v[88:91], v[200:203]
    ds_read_b64_tr_b16 a[40:41], v14 offset:57344
    v_cvt_pk_bf16_f32 v95, v78, v79
    v_mfma_f32_16x16x32_bf16 v[204:207], a[172:175], v[88:91], v[204:207]
    ds_read_b64_tr_b16 a[42:43], v14 offset:61440
    v_mfma_f32_16x16x32_bf16 v[208:211], a[176:179], v[88:91], v[208:211]
    v_exp_f32 v48, v48
    v_mfma_f32_16x16x32_bf16 v[212:215], a[180:183], v[88:91], v[212:215]
    ds_read_b64_tr_b16 a[44:45], v15 offset:57344
    v_mfma_f32_16x16x32_bf16 v[216:219], a[184:187], v[88:91], v[216:219]
    v_exp_f32 v49, v49
    v_mfma_f32_16x16x32_bf16 v[220:223], a[188:191], v[88:91], v[220:223]
    ds_read_b64_tr_b16 a[46:47], v15 offset:61440
    v_cvt_pk_bf16_f32 v80, v48, v49
    v_mfma_f32_16x16x32_bf16 v[120:123], v[28:31], v[88:91], v[120:123]
    v_exp_f32 v50, v50
    v_mfma_f32_16x16x32_bf16 v[56:59], a[0:3], a[208:211], v[100:103]
    ds_read_b64_tr_b16 a[48:49], v16 offset:57344
    s_add_u32 m0, s53, 0x10000
    s_mov_b32 s65, 0x32000
    buffer_load_dwordx4 v32, s[24:27], s65 offen lds
    v_mfma_f32_16x16x32_bf16 v[56:59], a[4:7], a[212:215], v[56:59]
    v_exp_f32 v51, v51
    v_mfma_f32_16x16x32_bf16 v[56:59], a[8:11], a[216:219], v[56:59]
    ds_read_b64_tr_b16 a[50:51], v16 offset:61440
    v_cvt_pk_bf16_f32 v81, v50, v51
    v_mfma_f32_16x16x32_bf16 v[56:59], a[12:15], a[220:223], v[56:59]
    v_exp_f32 v52, v52
    v_mfma_f32_16x16x32_bf16 v[60:63], a[16:19], a[208:211], v[100:103]
    ds_read_b64_tr_b16 a[52:53], v17 offset:57344
    buffer_load_dwordx4 v33, s[24:27], s65 offen offset:1024 lds
    v_mfma_f32_16x16x32_bf16 v[60:63], a[20:23], a[212:215], v[60:63]
    v_exp_f32 v53, v53
    v_mfma_f32_16x16x32_bf16 v[60:63], a[24:27], a[216:219], v[60:63]
    ds_read_b64_tr_b16 a[54:55], v17 offset:61440
    v_cvt_pk_bf16_f32 v82, v52, v53
    v_mfma_f32_16x16x32_bf16 v[60:63], a[28:31], a[220:223], v[60:63]
    v_exp_f32 v54, v54
    v_mfma_f32_16x16x32_bf16 v[224:227], a[160:163], v[92:95], v[224:227]
    v_mfma_f32_16x16x32_bf16 v[228:231], a[164:167], v[92:95], v[228:231]
    v_exp_f32 v55, v55
    v_mfma_f32_16x16x32_bf16 v[232:235], a[168:171], v[92:95], v[232:235]
    ds_read_b64_tr_b16 a[56:57], v18 offset:57344
    v_cvt_pk_bf16_f32 v83, v54, v55
    v_mfma_f32_16x16x32_bf16 v[236:239], a[172:175], v[92:95], v[236:239]
    ds_read_b64_tr_b16 a[58:59], v18 offset:61440
    buffer_load_dwordx4 v34, s[24:27], s65 offen offset:2048 lds
    v_mfma_f32_16x16x32_bf16 v[240:243], a[176:179], v[92:95], v[240:243]
    v_exp_f32 v56, v56
    v_mfma_f32_16x16x32_bf16 v[244:247], a[180:183], v[92:95], v[244:247]
    ds_read_b64_tr_b16 a[60:61], v19 offset:57344
    v_mfma_f32_16x16x32_bf16 v[248:251], a[184:187], v[92:95], v[248:251]
    v_exp_f32 v57, v57
    v_mfma_f32_16x16x32_bf16 v[252:255], a[188:191], v[92:95], v[252:255]
    ds_read_b64_tr_b16 a[62:63], v19 offset:61440
    v_cvt_pk_bf16_f32 v84, v56, v57
    v_mfma_f32_16x16x32_bf16 v[124:127], v[28:31], v[92:95], v[124:127]
    v_exp_f32 v58, v58
    v_mfma_f32_16x16x32_bf16 v[64:67], a[0:3], a[224:227], v[104:107]
    buffer_load_dwordx4 v35, s[24:27], s65 offen offset:3072 lds
    v_mfma_f32_16x16x32_bf16 v[64:67], a[4:7], a[228:231], v[64:67]
    v_exp_f32 v59, v59
    v_mfma_f32_16x16x32_bf16 v[64:67], a[8:11], a[232:235], v[64:67]
    v_cvt_pk_bf16_f32 v85, v58, v59
    v_mfma_f32_16x16x32_bf16 v[64:67], a[12:15], a[236:239], v[64:67]
    v_exp_f32 v60, v60
    v_mfma_f32_16x16x32_bf16 v[68:71], a[16:19], a[224:227], v[104:107]
    s_add_u32 m0, s53, 0x8000
    s_mov_b32 s65, 0x3c000
    buffer_load_dwordx4 v32, s[24:27], s65 offen lds
    v_mfma_f32_16x16x32_bf16 v[68:71], a[20:23], a[228:231], v[68:71]
    v_exp_f32 v61, v61
    v_mfma_f32_16x16x32_bf16 v[68:71], a[24:27], a[232:235], v[68:71]
    v_cvt_pk_bf16_f32 v86, v60, v61
    v_mfma_f32_16x16x32_bf16 v[68:71], a[28:31], a[236:239], v[68:71]
    v_exp_f32 v62, v62
    s_waitcnt lgkmcnt(0)
    v_mfma_f32_16x16x32_bf16 v[128:131], a[32:35], v[80:83], v[128:131]
    v_mfma_f32_16x16x32_bf16 v[132:135], a[36:39], v[80:83], v[132:135]
    v_exp_f32 v63, v63
    v_mfma_f32_16x16x32_bf16 v[136:139], a[40:43], v[80:83], v[136:139]
    v_cvt_pk_bf16_f32 v87, v62, v63
    v_mfma_f32_16x16x32_bf16 v[140:143], a[44:47], v[80:83], v[140:143]
    buffer_load_dwordx4 v33, s[24:27], s65 offen offset:1024 lds
    v_mfma_f32_16x16x32_bf16 v[144:147], a[48:51], v[80:83], v[144:147]
    v_exp_f32 v64, v64
    v_mfma_f32_16x16x32_bf16 v[148:151], a[52:55], v[80:83], v[148:151]
    v_mfma_f32_16x16x32_bf16 v[152:155], a[56:59], v[80:83], v[152:155]
    v_exp_f32 v65, v65
    v_mfma_f32_16x16x32_bf16 v[156:159], a[60:63], v[80:83], v[156:159]
    v_cvt_pk_bf16_f32 v88, v64, v65
    v_mfma_f32_16x16x32_bf16 v[112:115], v[28:31], v[80:83], v[112:115]
    v_exp_f32 v66, v66
    v_mfma_f32_16x16x32_bf16 v[72:75], a[0:3], a[240:243], v[108:111]
    buffer_load_dwordx4 v34, s[24:27], s65 offen offset:2048 lds
    v_mfma_f32_16x16x32_bf16 v[72:75], a[4:7], a[244:247], v[72:75]
    v_exp_f32 v67, v67
    v_mfma_f32_16x16x32_bf16 v[72:75], a[8:11], a[248:251], v[72:75]
    v_cvt_pk_bf16_f32 v89, v66, v67
    v_mfma_f32_16x16x32_bf16 v[72:75], a[12:15], a[252:255], v[72:75]
    v_exp_f32 v68, v68
    v_mfma_f32_16x16x32_bf16 v[76:79], a[16:19], a[240:243], v[108:111]
    v_mfma_f32_16x16x32_bf16 v[76:79], a[20:23], a[244:247], v[76:79]
    v_exp_f32 v69, v69
    v_mfma_f32_16x16x32_bf16 v[76:79], a[24:27], a[248:251], v[76:79]
    v_cvt_pk_bf16_f32 v90, v68, v69
    v_rcp_f32 v40, v112
    s_nop 0
    v_mul_f32 v128, v40, v128
    v_mul_f32 v129, v40, v129
    v_mul_f32 v130, v40, v130
    v_mfma_f32_16x16x32_bf16 v[76:79], a[28:31], a[252:255], v[76:79]
    v_exp_f32 v70, v70
    v_mfma_f32_16x16x32_bf16 v[160:163], a[32:35], v[84:87], v[160:163]
    buffer_load_dwordx4 v35, s[24:27], s65 offen offset:3072 lds
    v_mul_f32 v131, v40, v131
    v_cvt_pk_bf16_f32 v128, v128, v129
    v_cvt_pk_bf16_f32 v129, v130, v131
    v_mul_f32 v132, v40, v132
    v_mfma_f32_16x16x32_bf16 v[164:167], a[36:39], v[84:87], v[164:167]
    v_exp_f32 v71, v71
    v_mfma_f32_16x16x32_bf16 v[168:171], a[40:43], v[84:87], v[168:171]
    v_cvt_pk_bf16_f32 v91, v70, v71
    v_mul_f32 v133, v40, v133
    v_mul_f32 v134, v40, v134
    v_mul_f32 v135, v40, v135
    v_mfma_f32_16x16x32_bf16 v[172:175], a[44:47], v[84:87], v[172:175]
    v_cvt_pk_bf16_f32 v130, v132, v133
    v_cvt_pk_bf16_f32 v131, v134, v135
    v_mfma_f32_16x16x32_bf16 v[176:179], a[48:51], v[84:87], v[176:179]
    v_exp_f32 v72, v72
    v_mfma_f32_16x16x32_bf16 v[180:183], a[52:55], v[84:87], v[180:183]
    buffer_store_dwordx4 v[128:131], v47, s[20:23], s56 offen sc1
    v_mul_f32 v136, v40, v136
    v_mul_f32 v137, v40, v137
    v_mfma_f32_16x16x32_bf16 v[184:187], a[56:59], v[84:87], v[184:187]
    v_exp_f32 v73, v73
    v_mfma_f32_16x16x32_bf16 v[188:191], a[60:63], v[84:87], v[188:191]
    v_cvt_pk_bf16_f32 v92, v72, v73
    v_mul_f32 v138, v40, v138
    v_mul_f32 v139, v40, v139
    v_cvt_pk_bf16_f32 v136, v136, v137
    v_cvt_pk_bf16_f32 v137, v138, v139
    v_mfma_f32_16x16x32_bf16 v[116:119], v[28:31], v[84:87], v[116:119]
    v_exp_f32 v74, v74
    v_mfma_f32_16x16x32_bf16 v[192:195], a[32:35], v[88:91], v[192:195]
    v_exp_f32 v75, v75
    v_mul_f32 v140, v40, v140
    v_mul_f32 v141, v40, v141
    v_mul_f32 v142, v40, v142
    v_mfma_f32_16x16x32_bf16 v[196:199], a[36:39], v[88:91], v[196:199]
    v_cvt_pk_bf16_f32 v93, v74, v75
    v_mul_f32 v143, v40, v143
    v_mfma_f32_16x16x32_bf16 v[200:203], a[40:43], v[88:91], v[200:203]
    v_exp_f32 v76, v76
    v_cvt_pk_bf16_f32 v138, v140, v141
    v_cvt_pk_bf16_f32 v139, v142, v143
    buffer_store_dwordx4 v[136:139], v47, s[20:23], s56 offen offset:1024 sc1
    v_mfma_f32_16x16x32_bf16 v[204:207], a[44:47], v[88:91], v[204:207]
    v_exp_f32 v77, v77
    v_mfma_f32_16x16x32_bf16 v[208:211], a[48:51], v[88:91], v[208:211]
    v_exp_f32 v78, v78
    v_cvt_pk_bf16_f32 v94, v76, v77
    v_mul_f32 v144, v40, v144
    v_mul_f32 v145, v40, v145
    v_mul_f32 v146, v40, v146
    v_mul_f32 v147, v40, v147
    v_mfma_f32_16x16x32_bf16 v[212:215], a[52:55], v[88:91], v[212:215]
    v_cvt_pk_bf16_f32 v144, v144, v145
    v_cvt_pk_bf16_f32 v145, v146, v147
    v_mfma_f32_16x16x32_bf16 v[216:219], a[56:59], v[88:91], v[216:219]
    v_exp_f32 v79, v79
    s_nop 0
    v_cvt_pk_bf16_f32 v95, v78, v79
    v_mfma_f32_16x16x32_bf16 v[220:223], a[60:63], v[88:91], v[220:223]
    v_mul_f32 v148, v40, v148
    v_mul_f32 v149, v40, v149
    v_mul_f32 v150, v40, v150
    v_mfma_f32_16x16x32_bf16 v[120:123], v[28:31], v[88:91], v[120:123]
    v_mul_f32 v151, v40, v151
    v_cvt_pk_bf16_f32 v146, v148, v149
    v_mfma_f32_16x16x32_bf16 v[224:227], a[32:35], v[92:95], v[224:227]
    v_cvt_pk_bf16_f32 v147, v150, v151
    buffer_store_dwordx4 v[144:147], v47, s[20:23], s56 offen offset:2048 sc1
    v_mfma_f32_16x16x32_bf16 v[228:231], a[36:39], v[92:95], v[228:231]
    v_mul_f32 v152, v40, v152
    v_mul_f32 v153, v40, v153
    v_mfma_f32_16x16x32_bf16 v[232:235], a[40:43], v[92:95], v[232:235]
    v_mul_f32 v154, v40, v154
    v_mul_f32 v155, v40, v155
    v_mfma_f32_16x16x32_bf16 v[236:239], a[44:47], v[92:95], v[236:239]
    v_cvt_pk_bf16_f32 v152, v152, v153
    v_cvt_pk_bf16_f32 v153, v154, v155
    v_mfma_f32_16x16x32_bf16 v[240:243], a[48:51], v[92:95], v[240:243]
    v_mul_f32 v156, v40, v156
    v_mul_f32 v157, v40, v157
    v_mfma_f32_16x16x32_bf16 v[244:247], a[52:55], v[92:95], v[244:247]
    v_mul_f32 v158, v40, v158
    v_mul_f32 v159, v40, v159
    v_mfma_f32_16x16x32_bf16 v[248:251], a[56:59], v[92:95], v[248:251]
    v_cvt_pk_bf16_f32 v154, v156, v157
    v_cvt_pk_bf16_f32 v155, v158, v159
    v_mfma_f32_16x16x32_bf16 v[252:255], a[60:63], v[92:95], v[252:255]
    buffer_store_dwordx4 v[152:155], v47, s[20:23], s56 offen offset:3072 sc1
    v_mfma_f32_16x16x32_bf16 v[124:127], v[28:31], v[92:95], v[124:127]
L_norm:
    s_mov_b32 s67, 0x4b800000
    v_lshrrev_b32 v3, 4, v0
    v_bfe_u32 v4, v0, 2, 2
    v_lshl_add_u32 v5, v3, 2, v4
    v_lshlrev_b32 v5, 7, v5
    v_and_b32 v6, 3, v0
    v_lshl_add_u32 v5, v6, 3, v5
    v_add_u32 v5, s53, v5
    v_and_b32 v3, 1, v3
    v_lshlrev_b32 v3, 1, v3
    v_lshrrev_b32 v4, 1, v4
    v_or_b32 v3, v3, v4
    v_xor_b32 v3, s52, v3
    v_xor_b32 v6, 0, v3
    v_lshl_add_u32 v96, v6, 5, v5
    v_add_u32 v100, 0x10000, v96
    v_add_u32 v104, 0x20000, v96
    v_xor_b32 v6, 1, v3
    v_lshl_add_u32 v97, v6, 5, v5
    v_add_u32 v101, 0x10000, v97
    v_add_u32 v105, 0x20000, v97
    v_xor_b32 v6, 2, v3
    v_lshl_add_u32 v98, v6, 5, v5
    v_add_u32 v102, 0x10000, v98
    v_add_u32 v106, 0x20000, v98
    v_xor_b32 v6, 3, v3
    v_lshl_add_u32 v99, v6, 5, v5
    v_add_u32 v103, 0x10000, v99
    v_add_u32 v107, 0x20000, v99
    v_rcp_f32 v41, v116
    s_waitcnt vmcnt(34)
    v_rcp_f32 v42, v120
    s_waitcnt vmcnt(33)
    v_rcp_f32 v43, v124
    v_add_f32 v3, v112, v116
    v_add_f32 v4, v120, v124
    v_add_f32 v2, v3, v4
    v_cmp_nge_f32 vcc, s67, v2
    s_nop 0
    s_cmp_lg_u64 vcc, 0
    s_cselect_b32 s67, 1, 0
    s_andn2_b32 s67, s67, s71
    s_add_u32 s68, s53, 0x14000
    v_mov_b32 v4, s67
    v_mov_b32 v5, s68
    ds_write_b32 v5, v4
    v_mov_b32 v6, 0x14000
    s_waitcnt vmcnt(28)
    ds_read_b64_tr_b16 a[0:1], v104
    ds_read_b64_tr_b16 a[2:3], v104 offset:2048
    ds_read_b64_tr_b16 a[4:5], v105
    ds_read_b64_tr_b16 a[6:7], v105 offset:2048
    ds_read_b64_tr_b16 a[8:9], v106
    ds_read_b64_tr_b16 a[10:11], v106 offset:2048
    ds_read_b64_tr_b16 a[12:13], v107
    ds_read_b64_tr_b16 a[14:15], v107 offset:2048
    v_pk_mul_f32 v[160:161], v[160:161], v[40:41] op_sel:[0,1] op_sel_hi:[1,1]
    v_pk_mul_f32 v[162:163], v[162:163], v[40:41] op_sel:[0,1] op_sel_hi:[1,1]
    v_cvt_pk_bf16_f32 v64, v160, v161
    v_cvt_pk_bf16_f32 v65, v162, v163
    v_pk_mul_f32 v[164:165], v[164:165], v[40:41] op_sel:[0,1] op_sel_hi:[1,1]
    v_pk_mul_f32 v[166:167], v[166:167], v[40:41] op_sel:[0,1] op_sel_hi:[1,1]
    v_cvt_pk_bf16_f32 v66, v164, v165
    v_cvt_pk_bf16_f32 v67, v166, v167
    buffer_store_dwordx4 v[64:67], v47, s[20:23], s57 offen sc1
    s_waitcnt vmcnt(25)
    ds_read_b64_tr_b16 a[16:17], v104 offset:16384
    ds_read_b64_tr_b16 a[18:19], v104 offset:18432
    ds_read_b64_tr_b16 a[20:21], v105 offset:16384
    ds_read_b64_tr_b16 a[22:23], v105 offset:18432
    ds_read_b64_tr_b16 a[24:25], v106 offset:16384
    ds_read_b64_tr_b16 a[26:27], v106 offset:18432
    ds_read_b64_tr_b16 a[28:29], v107 offset:16384
    ds_read_b64_tr_b16 a[30:31], v107 offset:18432
    v_pk_mul_f32 v[168:169], v[168:169], v[40:41] op_sel:[0,1] op_sel_hi:[1,1]
    v_pk_mul_f32 v[170:171], v[170:171], v[40:41] op_sel:[0,1] op_sel_hi:[1,1]
    v_cvt_pk_bf16_f32 v72, v168, v169
    v_cvt_pk_bf16_f32 v73, v170, v171
    v_pk_mul_f32 v[172:173], v[172:173], v[40:41] op_sel:[0,1] op_sel_hi:[1,1]
    v_pk_mul_f32 v[174:175], v[174:175], v[40:41] op_sel:[0,1] op_sel_hi:[1,1]
    v_cvt_pk_bf16_f32 v74, v172, v173
    v_cvt_pk_bf16_f32 v75, v174, v175
    buffer_store_dwordx4 v[72:75], v47, s[20:23], s57 offen offset:1024 sc1
    s_waitcnt vmcnt(22)
    ds_read_b64_tr_b16 a[32:33], v96
    ds_read_b64_tr_b16 a[34:35], v96 offset:2048
    ds_read_b64_tr_b16 a[36:37], v97
    ds_read_b64_tr_b16 a[38:39], v97 offset:2048
    ds_read_b64_tr_b16 a[40:41], v98
    ds_read_b64_tr_b16 a[42:43], v98 offset:2048
    ds_read_b64_tr_b16 a[44:45], v99
    ds_read_b64_tr_b16 a[46:47], v99 offset:2048
    v_pk_mul_f32 v[176:177], v[176:177], v[40:41] op_sel:[0,1] op_sel_hi:[1,1]
    v_pk_mul_f32 v[178:179], v[178:179], v[40:41] op_sel:[0,1] op_sel_hi:[1,1]
    v_cvt_pk_bf16_f32 v48, v176, v177
    v_cvt_pk_bf16_f32 v49, v178, v179
    v_pk_mul_f32 v[180:181], v[180:181], v[40:41] op_sel:[0,1] op_sel_hi:[1,1]
    v_pk_mul_f32 v[182:183], v[182:183], v[40:41] op_sel:[0,1] op_sel_hi:[1,1]
    v_cvt_pk_bf16_f32 v50, v180, v181
    v_cvt_pk_bf16_f32 v51, v182, v183
    buffer_store_dwordx4 v[48:51], v47, s[20:23], s57 offen offset:2048 sc1
    s_waitcnt vmcnt(19)
    ds_read_b64_tr_b16 a[48:49], v100 offset:32768
    ds_read_b64_tr_b16 a[50:51], v100 offset:34816
    ds_read_b64_tr_b16 a[52:53], v101 offset:32768
    ds_read_b64_tr_b16 a[54:55], v101 offset:34816
    ds_read_b64_tr_b16 a[56:57], v102 offset:32768
    ds_read_b64_tr_b16 a[58:59], v102 offset:34816
    ds_read_b64_tr_b16 a[60:61], v103 offset:32768
    ds_read_b64_tr_b16 a[62:63], v103 offset:34816
    v_pk_mul_f32 v[184:185], v[184:185], v[40:41] op_sel:[0,1] op_sel_hi:[1,1]
    v_pk_mul_f32 v[186:187], v[186:187], v[40:41] op_sel:[0,1] op_sel_hi:[1,1]
    v_cvt_pk_bf16_f32 v56, v184, v185
    v_cvt_pk_bf16_f32 v57, v186, v187
    v_pk_mul_f32 v[188:189], v[188:189], v[40:41] op_sel:[0,1] op_sel_hi:[1,1]
    v_pk_mul_f32 v[190:191], v[190:191], v[40:41] op_sel:[0,1] op_sel_hi:[1,1]
    v_cvt_pk_bf16_f32 v58, v188, v189
    v_cvt_pk_bf16_f32 v59, v190, v191
    buffer_store_dwordx4 v[56:59], v47, s[20:23], s57 offen offset:3072 sc1
    s_waitcnt vmcnt(16)
    ds_read_b64_tr_b16 a[64:65], v96 offset:16384
    ds_read_b64_tr_b16 a[66:67], v96 offset:18432
    ds_read_b64_tr_b16 a[68:69], v97 offset:16384
    ds_read_b64_tr_b16 a[70:71], v97 offset:18432
    ds_read_b64_tr_b16 a[72:73], v98 offset:16384
    ds_read_b64_tr_b16 a[74:75], v98 offset:18432
    ds_read_b64_tr_b16 a[76:77], v99 offset:16384
    ds_read_b64_tr_b16 a[78:79], v99 offset:18432
    v_pk_mul_f32 v[192:193], v[192:193], v[42:43] op_sel:[0,0] op_sel_hi:[1,0]
    v_pk_mul_f32 v[194:195], v[194:195], v[42:43] op_sel:[0,0] op_sel_hi:[1,0]
    v_cvt_pk_bf16_f32 v68, v192, v193
    v_cvt_pk_bf16_f32 v69, v194, v195
    v_pk_mul_f32 v[196:197], v[196:197], v[42:43] op_sel:[0,0] op_sel_hi:[1,0]
    v_pk_mul_f32 v[198:199], v[198:199], v[42:43] op_sel:[0,0] op_sel_hi:[1,0]
    v_cvt_pk_bf16_f32 v70, v196, v197
    v_cvt_pk_bf16_f32 v71, v198, v199
    buffer_store_dwordx4 v[68:71], v47, s[20:23], s58 offen sc1
    v_pk_mul_f32 v[200:201], v[200:201], v[42:43] op_sel:[0,0] op_sel_hi:[1,0]
    v_pk_mul_f32 v[202:203], v[202:203], v[42:43] op_sel:[0,0] op_sel_hi:[1,0]
    v_cvt_pk_bf16_f32 v76, v200, v201
    v_cvt_pk_bf16_f32 v77, v202, v203
    v_pk_mul_f32 v[204:205], v[204:205], v[42:43] op_sel:[0,0] op_sel_hi:[1,0]
    v_pk_mul_f32 v[206:207], v[206:207], v[42:43] op_sel:[0,0] op_sel_hi:[1,0]
    v_cvt_pk_bf16_f32 v78, v204, v205
    v_cvt_pk_bf16_f32 v79, v206, v207
    buffer_store_dwordx4 v[76:79], v47, s[20:23], s58 offen offset:1024 sc1
    s_waitcnt vmcnt(14)
    ds_read_b64_tr_b16 a[80:81], v100
    ds_read_b64_tr_b16 a[82:83], v100 offset:2048
    ds_read_b64_tr_b16 a[84:85], v101
    ds_read_b64_tr_b16 a[86:87], v101 offset:2048
    ds_read_b64_tr_b16 a[88:89], v102
    ds_read_b64_tr_b16 a[90:91], v102 offset:2048
    ds_read_b64_tr_b16 a[92:93], v103
    ds_read_b64_tr_b16 a[94:95], v103 offset:2048
    v_pk_mul_f32 v[208:209], v[208:209], v[42:43] op_sel:[0,0] op_sel_hi:[1,0]
    v_pk_mul_f32 v[210:211], v[210:211], v[42:43] op_sel:[0,0] op_sel_hi:[1,0]
    v_cvt_pk_bf16_f32 v52, v208, v209
    v_cvt_pk_bf16_f32 v53, v210, v211
    v_pk_mul_f32 v[212:213], v[212:213], v[42:43] op_sel:[0,0] op_sel_hi:[1,0]
    v_pk_mul_f32 v[214:215], v[214:215], v[42:43] op_sel:[0,0] op_sel_hi:[1,0]
    v_cvt_pk_bf16_f32 v54, v212, v213
    v_cvt_pk_bf16_f32 v55, v214, v215
    buffer_store_dwordx4 v[52:55], v47, s[20:23], s58 offen offset:2048 sc1
    v_pk_mul_f32 v[216:217], v[216:217], v[42:43] op_sel:[0,0] op_sel_hi:[1,0]
    v_pk_mul_f32 v[218:219], v[218:219], v[42:43] op_sel:[0,0] op_sel_hi:[1,0]
    v_cvt_pk_bf16_f32 v60, v216, v217
    v_cvt_pk_bf16_f32 v61, v218, v219
    v_pk_mul_f32 v[220:221], v[220:221], v[42:43] op_sel:[0,0] op_sel_hi:[1,0]
    v_pk_mul_f32 v[222:223], v[222:223], v[42:43] op_sel:[0,0] op_sel_hi:[1,0]
    v_cvt_pk_bf16_f32 v62, v220, v221
    v_cvt_pk_bf16_f32 v63, v222, v223
    buffer_store_dwordx4 v[60:63], v47, s[20:23], s58 offen offset:3072 sc1
    s_waitcnt vmcnt(12)
    ds_read_b64_tr_b16 a[96:97], v96 offset:32768
    ds_read_b64_tr_b16 a[98:99], v96 offset:34816
    ds_read_b64_tr_b16 a[100:101], v97 offset:32768
    ds_read_b64_tr_b16 a[102:103], v97 offset:34816
    ds_read_b64_tr_b16 a[104:105], v98 offset:32768
    ds_read_b64_tr_b16 a[106:107], v98 offset:34816
    ds_read_b64_tr_b16 a[108:109], v99 offset:32768
    ds_read_b64_tr_b16 a[110:111], v99 offset:34816
    v_pk_mul_f32 v[224:225], v[224:225], v[42:43] op_sel:[0,1] op_sel_hi:[1,1]
    v_pk_mul_f32 v[226:227], v[226:227], v[42:43] op_sel:[0,1] op_sel_hi:[1,1]
    v_cvt_pk_bf16_f32 v64, v224, v225
    v_cvt_pk_bf16_f32 v65, v226, v227
    v_pk_mul_f32 v[228:229], v[228:229], v[42:43] op_sel:[0,1] op_sel_hi:[1,1]
    v_pk_mul_f32 v[230:231], v[230:231], v[42:43] op_sel:[0,1] op_sel_hi:[1,1]
    v_cvt_pk_bf16_f32 v66, v228, v229
    v_cvt_pk_bf16_f32 v67, v230, v231
    buffer_store_dwordx4 v[64:67], v47, s[20:23], s59 offen sc1
    v_pk_mul_f32 v[232:233], v[232:233], v[42:43] op_sel:[0,1] op_sel_hi:[1,1]
    v_pk_mul_f32 v[234:235], v[234:235], v[42:43] op_sel:[0,1] op_sel_hi:[1,1]
    v_cvt_pk_bf16_f32 v72, v232, v233
    v_cvt_pk_bf16_f32 v73, v234, v235
    v_pk_mul_f32 v[236:237], v[236:237], v[42:43] op_sel:[0,1] op_sel_hi:[1,1]
    v_pk_mul_f32 v[238:239], v[238:239], v[42:43] op_sel:[0,1] op_sel_hi:[1,1]
    v_cvt_pk_bf16_f32 v74, v236, v237
    v_cvt_pk_bf16_f32 v75, v238, v239
    buffer_store_dwordx4 v[72:75], v47, s[20:23], s59 offen offset:1024 sc1
    v_pk_mul_f32 v[240:241], v[240:241], v[42:43] op_sel:[0,1] op_sel_hi:[1,1]
    v_pk_mul_f32 v[242:243], v[242:243], v[42:43] op_sel:[0,1] op_sel_hi:[1,1]
    v_cvt_pk_bf16_f32 v48, v240, v241
    v_cvt_pk_bf16_f32 v49, v242, v243
    v_pk_mul_f32 v[244:245], v[244:245], v[42:43] op_sel:[0,1] op_sel_hi:[1,1]
    v_pk_mul_f32 v[246:247], v[246:247], v[42:43] op_sel:[0,1] op_sel_hi:[1,1]
    v_cvt_pk_bf16_f32 v50, v244, v245
    v_cvt_pk_bf16_f32 v51, v246, v247
    buffer_store_dwordx4 v[48:51], v47, s[20:23], s59 offen offset:2048 sc1
    v_pk_mul_f32 v[248:249], v[248:249], v[42:43] op_sel:[0,1] op_sel_hi:[1,1]
    v_pk_mul_f32 v[250:251], v[250:251], v[42:43] op_sel:[0,1] op_sel_hi:[1,1]
    v_cvt_pk_bf16_f32 v56, v248, v249
    v_cvt_pk_bf16_f32 v57, v250, v251
    v_pk_mul_f32 v[252:253], v[252:253], v[42:43] op_sel:[0,1] op_sel_hi:[1,1]
    v_pk_mul_f32 v[254:255], v[254:255], v[42:43] op_sel:[0,1] op_sel_hi:[1,1]
    v_cvt_pk_bf16_f32 v58, v252, v253
    v_cvt_pk_bf16_f32 v59, v254, v255
    buffer_store_dwordx4 v[56:59], v47, s[20:23], s59 offen offset:3072 sc1
    s_waitcnt lgkmcnt(0)
    s_barrier
    ds_read_b32 v36, v6
    ds_read_b32 v37, v6 offset:4096
    ds_read_b32 v38, v6 offset:8192
    ds_read_b32 v39, v6 offset:12288
    s_waitcnt lgkmcnt(1)
    v_or3_b32 v4, v36, v37, v38
    s_waitcnt lgkmcnt(0)
    v_or_b32 v4, v4, v39
    s_nop 0
    v_readfirstlane_b32 s67, v4
    s_nop 0
    s_cmp_lg_u32 s67, 0
    s_cbranch_scc1 L_slow
    v_cmp_ne_u32 vcc, 0, v44
    s_mov_b32 s66, 0x40000
    s_nop 2
    s_cbranch_vccnz L_tag_go
L_tag:
    buffer_load_dword v44, v45, s[32:35], 0 offen sc1
    s_waitcnt vmcnt(0)
    s_sub_u32 s66, s66, 1
    s_cbranch_scc1 L_tag_go
    v_cmp_ne_u32 vcc, 0, v44
    s_nop 3
    s_cbranch_vccz L_tag
L_tag_go:
    s_add_u32 s32, s50, 0x1500000
    s_addc_u32 s33, s51, 0
    s_mov_b32 s34, 0x20000
    s_mov_b32 s35, 0x20000
    s_add_u32 m0, s53, 0x20000
    s_mov_b32 s65, 0x46000
    buffer_load_dwordx4 v32, s[24:27], s65 offen lds
    buffer_load_dwordx4 v33, s[24:27], s65 offen offset:1024 lds
    buffer_load_dwordx4 v34, s[24:27], s65 offen offset:2048 lds
    buffer_load_dwordx4 v35, s[24:27], s65 offen offset:3072 lds
    s_add_u32 m0, s53, 0x24000
    s_mov_b32 s65, 0x50000
    buffer_load_dwordx4 v32, s[24:27], s65 offen lds
    buffer_load_dwordx4 v33, s[24:27], s65 offen offset:1024 lds
    buffer_load_dwordx4 v34, s[24:27], s65 offen offset:2048 lds
    buffer_load_dwordx4 v35, s[24:27], s65 offen offset:3072 lds
    s_and_b32 s67, s2, 1
    s_lshl_b32 s67, s67, 2
    s_add_u32 s67, s67, s52
    s_lshl_b32 s69, s67, 14
    v_lshlrev_b32 v3, 4, v0
    v_add_u32 v8, s69, v3
    v_add_u32 v9, 0x1000, v8
    v_add_u32 v10, 0x2000, v8
    v_add_u32 v11, 0x3000, v8
    s_xor_b32 s68, s61, 1
    s_mul_i32 s69, s68, 0xa0000
    s_add_u32 s8, s50, s69
    s_addc_u32 s9, s51, 0
    s_mov_b32 s10, 0xa0000
    s_mov_b32 s11, 0x20000
    s_mul_i32 s69, s61, 0xa0000
    s_add_u32 s12, s50, s69
    s_addc_u32 s13, s51, 0
    s_mov_b32 s14, 0xa0000
    s_mov_b32 s15, 0x20000
    s_mul_i32 s68, s68, 0x56
    s_lshr_b32 s68, s68, 8
    s_lshl_b32 s68, s68, 3
    s_add_u32 s68, s68, s67
    s_lshl_b32 s68, s68, 7
    s_mul_i32 s69, s61, 0x56
    s_lshr_b32 s69, s69, 8
    s_lshl_b32 s69, s69, 3
    s_add_u32 s69, s69, s67
    s_lshl_b32 s69, s69, 7
    v_and_b32 v6, 4, v0
    v_cmp_eq_u32 vcc, 0, v6
    v_mov_b32 v5, s69
    v_mov_b32 v6, s68
    v_cndmask_b32 v5, v5, v6, vcc
    v_and_b32 v6, 3, v0
    v_lshl_add_u32 v5, v6, 2, v5
    s_mul_i32 s67, s2, 0x5000
    s_add_u32 s67, s67, 0x1000000
    s_add_u32 s16, s50, s67
    s_addc_u32 s17, s51, 0
    s_mov_b32 s18, 0x5000
    s_mov_b32 s19, 0x20000
    s_xor_b32 s68, s2, 1
    s_mul_i32 s67, s68, 0x5000
    s_add_u32 s67, s67, 0x1000000
    s_add_u32 s4, s50, s67
    s_addc_u32 s5, s51, 0
    s_mov_b32 s6, 0x5000
    s_mov_b32 s7, 0x20000
    s_mul_i32 s67, s52, 0x1400
    v_add_u32 v37, s67, v3
    s_lshl_b32 s67, s2, 2
    s_add_u32 s67, s67, s52
    s_add_u32 s67, s67, 64
    s_lshl_b32 s67, s67, 7
    v_mov_b32 v38, s67
    v_xor_b32 v39, 0x200, v38
    v_add_u32 v28, s53, v3
    v_add_u32 v40, 0x10000, v28
    v_xor_b32 v29, 0x1000, v28
    v_xor_b32 v30, 0x2000, v28
    v_xor_b32 v31, 0x3000, v28
    s_lshl_b32 s69, s52, 5
    v_and_b32 v3, 15, v0
    v_mul_u32_u24 v3, 0x500, v3
    v_lshrrev_b32 v4, 4, v0
    v_add_u32 v3, s69, v3
    v_lshl_add_u32 v36, v4, 3, v3
    v_and_b32 v6, 1, v4
    v_mul_u32_u24 v6, 0x5000, v6
    v_add_u32 v3, v3, v6
    v_lshrrev_b32 v4, 1, v4
    v_lshl_add_u32 v41, v4, 4, v3
    s_mul_i32 s67, s61, 0x19000
    s_lshl_b32 s68, s62, 7
    s_add_u32 s67, s67, s68
    s_add_u32 s28, s46, s67
    s_addc_u32 s29, s47, 0
    s_mov_b32 s30, 0x18b80
    s_mov_b32 s31, 0x20000
    s_waitcnt vmcnt(8)
    s_barrier
    s_lshl_b32 s67, s54, 3
    s_lshr_b32 s68, s55, 2
    s_add_u32 s67, s67, s68
    s_lshl_b32 s67, s67, 5
    s_and_b32 s68, s55, 3
    s_add_u32 s67, s67, s68
    s_lshl_b32 s67, s67, 2
    v_mov_b32 v3, s67
    s_cmp_lg_u32 s52, 0
    s_cbranch_scc1 L_nopub
    s_mov_b64 exec, 1
    buffer_store_dword v44, v3, s[32:35], 0 offen sc1
    s_mov_b64 exec, -1
L_nopub:
    s_cmp_ge_u32 s2, 0xf0
    s_cbranch_scc1 L_end
    s_add_u32 m0, s53, 0
    s_mov_b32 s65, 0x5a000
    buffer_load_dwordx4 v32, s[24:27], s65 offen lds
    buffer_load_dwordx4 v33, s[24:27], s65 offen offset:1024 lds
    buffer_load_dwordx4 v34, s[24:27], s65 offen offset:2048 lds
    buffer_load_dwordx4 v35, s[24:27], s65 offen offset:3072 lds
    s_add_u32 m0, s53, 0x18000
    s_mov_b32 s65, 0x64000
    buffer_load_dwordx4 v32, s[24:27], s65 offen lds
    buffer_load_dwordx4 v33, s[24:27], s65 offen offset:1024 lds
    buffer_load_dwordx4 v34, s[24:27], s65 offen offset:2048 lds
    buffer_load_dwordx4 v35, s[24:27], s65 offen offset:3072 lds
    s_add_u32 m0, s53, 0x4000
    s_mov_b32 s65, 0x6e000
    buffer_load_dwordx4 v32, s[24:27], s65 offen lds
    buffer_load_dwordx4 v33, s[24:27], s65 offen offset:1024 lds
    buffer_load_dwordx4 v34, s[24:27], s65 offen offset:2048 lds
    buffer_load_dwordx4 v35, s[24:27], s65 offen offset:3072 lds
    s_add_u32 m0, s53, 0x10000
    s_mov_b32 s65, 0x78000
    buffer_load_dwordx4 v32, s[24:27], s65 offen lds
    buffer_load_dwordx4 v33, s[24:27], s65 offen offset:1024 lds
    buffer_load_dwordx4 v34, s[24:27], s65 offen offset:2048 lds
    buffer_load_dwordx4 v35, s[24:27], s65 offen offset:3072 lds
    s_add_u32 m0, s53, 0x8000
    s_mov_b32 s65, 0x82000
    buffer_load_dwordx4 v32, s[24:27], s65 offen lds
    buffer_load_dwordx4 v33, s[24:27], s65 offen offset:1024 lds
    buffer_load_dwordx4 v34, s[24:27], s65 offen offset:2048 lds
    buffer_load_dwordx4 v35, s[24:27], s65 offen offset:3072 lds
    s_add_u32 m0, s53, 0xc000
    s_mov_b32 s65, 0x8c000
    buffer_load_dwordx4 v32, s[24:27], s65 offen lds
    buffer_load_dwordx4 v33, s[24:27], s65 offen offset:1024 lds
    buffer_load_dwordx4 v34, s[24:27], s65 offen offset:2048 lds
    buffer_load_dwordx4 v35, s[24:27], s65 offen offset:3072 lds
    s_waitcnt vmcnt(28)
    ds_read_b64_tr_b16 a[112:113], v104
    ds_read_b64_tr_b16 a[114:115], v104 offset:2048
    ds_read_b64_tr_b16 a[116:117], v105
    ds_read_b64_tr_b16 a[118:119], v105 offset:2048
    ds_read_b64_tr_b16 a[120:121], v106
    ds_read_b64_tr_b16 a[122:123], v106 offset:2048
    ds_read_b64_tr_b16 a[124:125], v107
    ds_read_b64_tr_b16 a[126:127], v107 offset:2048
    s_waitcnt vmcnt(24)
    ds_read_b64_tr_b16 a[128:129], v104 offset:16384
    ds_read_b64_tr_b16 a[130:131], v104 offset:18432
    ds_read_b64_tr_b16 a[132:133], v105 offset:16384
    ds_read_b64_tr_b16 a[134:135], v105 offset:18432
    ds_read_b64_tr_b16 a[136:137], v106 offset:16384
    ds_read_b64_tr_b16 a[138:139], v106 offset:18432
    ds_read_b64_tr_b16 a[140:141], v107 offset:16384
    ds_read_b64_tr_b16 a[142:143], v107 offset:18432
    s_waitcnt vmcnt(20)
    ds_read_b64_tr_b16 a[144:145], v96
    ds_read_b64_tr_b16 a[146:147], v96 offset:2048
    ds_read_b64_tr_b16 a[148:149], v97
    ds_read_b64_tr_b16 a[150:151], v97 offset:2048
    ds_read_b64_tr_b16 a[152:153], v98
    ds_read_b64_tr_b16 a[154:155], v98 offset:2048
    ds_read_b64_tr_b16 a[156:157], v99
    ds_read_b64_tr_b16 a[158:159], v99 offset:2048
    s_waitcnt vmcnt(16)
    ds_read_b64_tr_b16 a[160:161], v100 offset:32768
    ds_read_b64_tr_b16 a[162:163], v100 offset:34816
    ds_read_b64_tr_b16 a[164:165], v101 offset:32768
    ds_read_b64_tr_b16 a[166:167], v101 offset:34816
    ds_read_b64_tr_b16 a[168:169], v102 offset:32768
    ds_read_b64_tr_b16 a[170:171], v102 offset:34816
    ds_read_b64_tr_b16 a[172:173], v103 offset:32768
    ds_read_b64_tr_b16 a[174:175], v103 offset:34816
    s_waitcnt vmcnt(12)
    ds_read_b64_tr_b16 v[80:81], v96 offset:16384
    ds_read_b64_tr_b16 v[82:83], v96 offset:18432
    ds_read_b64_tr_b16 v[84:85], v97 offset:16384
    ds_read_b64_tr_b16 v[86:87], v97 offset:18432
    ds_read_b64_tr_b16 v[88:89], v98 offset:16384
    ds_read_b64_tr_b16 v[90:91], v98 offset:18432
    ds_read_b64_tr_b16 v[92:93], v99 offset:16384
    ds_read_b64_tr_b16 v[94:95], v99 offset:18432
    s_waitcnt vmcnt(8)
    ds_read_b64_tr_b16 v[112:113], v100
    ds_read_b64_tr_b16 v[114:115], v100 offset:2048
    ds_read_b64_tr_b16 v[116:117], v101
    ds_read_b64_tr_b16 v[118:119], v101 offset:2048
    ds_read_b64_tr_b16 v[120:121], v102
    ds_read_b64_tr_b16 v[122:123], v102 offset:2048
    ds_read_b64_tr_b16 v[124:125], v103
    ds_read_b64_tr_b16 v[126:127], v103 offset:2048
    s_waitcnt vmcnt(4)
    ds_read_b64_tr_b16 v[228:229], v96 offset:32768
    ds_read_b64_tr_b16 v[230:231], v96 offset:34816
    ds_read_b64_tr_b16 v[232:233], v97 offset:32768
    ds_read_b64_tr_b16 v[234:235], v97 offset:34816
    ds_read_b64_tr_b16 v[236:237], v98 offset:32768
    ds_read_b64_tr_b16 v[238:239], v98 offset:34816
    ds_read_b64_tr_b16 v[240:241], v99 offset:32768
    ds_read_b64_tr_b16 v[242:243], v99 offset:34816
    buffer_load_dword v4, v5, s[32:35], 0 offen sc1
    s_mov_b32 s66, 0x40000
    s_add_u32 m0, s53, 0x1c000
    s_mov_b32 s65, 0x96000
    buffer_load_dwordx4 v32, s[24:27], s65 offen lds
    buffer_load_dwordx4 v33, s[24:27], s65 offen offset:1024 lds
    buffer_load_dwordx4 v34, s[24:27], s65 offen offset:2048 lds
    buffer_load_dwordx4 v35, s[24:27], s65 offen offset:3072 lds
    s_waitcnt vmcnt(4)
    v_cmp_ne_u32 vcc, v44, v4
    s_nop 0
    s_cmp_eq_u64 vcc, 0
    s_cbranch_scc1 L_poll_go
L_poll:
    s_sleep 1
    buffer_load_dword v4, v5, s[32:35], 0 offen sc1
    s_waitcnt vmcnt(0)
    s_sub_u32 s66, s66, 1
    s_cbranch_scc1 L_poll_go
    v_cmp_ne_u32 vcc, v44, v4
    s_nop 0
    s_cmp_eq_u64 vcc, 0
    s_cbranch_scc0 L_poll
L_poll_go:
    buffer_load_dwordx4 a[176:179], v8, s[8:11], s56 offen sc1
    buffer_load_dwordx4 a[196:199], v8, s[8:11], s56 offen offset:1024 sc1
    buffer_load_dwordx4 a[216:219], v8, s[8:11], s56 offen offset:2048 sc1
    buffer_load_dwordx4 a[236:239], v8, s[8:11], s56 offen offset:3072 sc1
    buffer_load_dwordx4 a[180:183], v8, s[8:11], s57 offen sc1
    buffer_load_dwordx4 a[200:203], v8, s[8:11], s57 offen offset:1024 sc1
    buffer_load_dwordx4 a[220:223], v8, s[8:11], s57 offen offset:2048 sc1
    buffer_load_dwordx4 a[240:243], v8, s[8:11], s57 offen offset:3072 sc1
    buffer_load_dwordx4 a[184:187], v8, s[8:11], s58 offen sc1
    buffer_load_dwordx4 a[204:207], v8, s[8:11], s58 offen offset:1024 sc1
    buffer_load_dwordx4 a[224:227], v8, s[8:11], s58 offen offset:2048 sc1
    buffer_load_dwordx4 a[244:247], v8, s[8:11], s58 offen offset:3072 sc1
    buffer_load_dwordx4 a[188:191], v8, s[8:11], s59 offen sc1
    buffer_load_dwordx4 a[208:211], v8, s[8:11], s59 offen offset:1024 sc1
    buffer_load_dwordx4 a[228:231], v8, s[8:11], s59 offen offset:2048 sc1
    buffer_load_dwordx4 a[248:251], v8, s[8:11], s59 offen offset:3072 sc1
    buffer_load_dwordx4 a[192:195], v8, s[8:11], s60 offen sc1
    buffer_load_dwordx4 a[212:215], v8, s[8:11], s60 offen offset:1024 sc1
    buffer_load_dwordx4 a[232:235], v8, s[8:11], s60 offen offset:2048 sc1
    buffer_load_dwordx4 a[252:255], v8, s[8:11], s60 offen offset:3072 sc1
    ds_read_b64_tr_b16 v[64:65], v96 offset:49152
    ds_read_b64_tr_b16 v[66:67], v96 offset:51200
    ds_read_b64_tr_b16 v[68:69], v97 offset:49152
    ds_read_b64_tr_b16 v[70:71], v97 offset:51200
    ds_read_b64_tr_b16 v[72:73], v98 offset:49152
    ds_read_b64_tr_b16 v[74:75], v98 offset:51200
    ds_read_b64_tr_b16 v[76:77], v99 offset:49152
    ds_read_b64_tr_b16 v[78:79], v99 offset:51200
    s_waitcnt vmcnt(20)
    ds_read_b64_tr_b16 v[12:13], v100 offset:49152
    ds_read_b64_tr_b16 v[14:15], v100 offset:51200
    ds_read_b64_tr_b16 v[16:17], v101 offset:49152
    ds_read_b64_tr_b16 v[18:19], v101 offset:51200
    ds_read_b64_tr_b16 v[20:21], v102 offset:49152
    ds_read_b64_tr_b16 v[22:23], v102 offset:51200
    ds_read_b64_tr_b16 v[24:25], v103 offset:49152
    ds_read_b64_tr_b16 v[26:27], v103 offset:51200
    s_mov_b32 s64, 0x1000
    s_waitcnt vmcnt(19)
    v_mfma_f32_16x16x32_bf16 v[128:131], a[0:3], a[176:179], 0
    s_waitcnt vmcnt(18)
    v_mfma_f32_16x16x32_bf16 v[128:131], a[16:19], a[196:199], v[128:131]
    s_waitcnt vmcnt(17)
    v_mfma_f32_16x16x32_bf16 v[128:131], a[32:35], a[216:219], v[128:131]
    s_waitcnt vmcnt(16)
    v_mfma_f32_16x16x32_bf16 v[128:131], a[48:51], a[236:239], v[128:131]
    v_mfma_f32_16x16x32_bf16 v[168:171], a[4:7], a[176:179], 0
    v_mfma_f32_16x16x32_bf16 v[168:171], a[20:23], a[196:199], v[168:171]
    v_mfma_f32_16x16x32_bf16 v[168:171], a[36:39], a[216:219], v[168:171]
    v_mfma_f32_16x16x32_bf16 v[168:171], a[52:55], a[236:239], v[168:171]
    v_mfma_f32_16x16x32_bf16 v[172:175], a[8:11], a[176:179], 0
    v_mfma_f32_16x16x32_bf16 v[172:175], a[24:27], a[196:199], v[172:175]
    v_mfma_f32_16x16x32_bf16 v[172:175], a[40:43], a[216:219], v[172:175]
    v_mfma_f32_16x16x32_bf16 v[172:175], a[56:59], a[236:239], v[172:175]
    v_mfma_f32_16x16x32_bf16 v[176:179], a[12:15], a[176:179], 0
    v_mfma_f32_16x16x32_bf16 v[176:179], a[28:31], a[196:199], v[176:179]
    v_mfma_f32_16x16x32_bf16 v[176:179], a[44:47], a[216:219], v[176:179]
    v_mfma_f32_16x16x32_bf16 v[176:179], a[60:63], a[236:239], v[176:179]
    s_waitcnt vmcnt(15)
    v_mfma_f32_16x16x32_bf16 v[132:135], a[0:3], a[180:183], 0
    buffer_load_dwordx4 a[176:179], v9, s[8:11], s56 offen sc1
    s_waitcnt vmcnt(15)
    v_mfma_f32_16x16x32_bf16 v[132:135], a[16:19], a[200:203], v[132:135]
    s_waitcnt vmcnt(14)
    v_mfma_f32_16x16x32_bf16 v[132:135], a[32:35], a[220:223], v[132:135]
    s_waitcnt vmcnt(13)
    v_mfma_f32_16x16x32_bf16 v[132:135], a[48:51], a[240:243], v[132:135]
    v_mfma_f32_16x16x32_bf16 v[180:183], a[4:7], a[180:183], 0
    buffer_load_dwordx4 a[196:199], v9, s[8:11], s56 offen offset:1024 sc1
    v_mfma_f32_16x16x32_bf16 v[180:183], a[20:23], a[200:203], v[180:183]
    v_mfma_f32_16x16x32_bf16 v[180:183], a[36:39], a[220:223], v[180:183]
    v_mfma_f32_16x16x32_bf16 v[180:183], a[52:55], a[240:243], v[180:183]
    v_mfma_f32_16x16x32_bf16 v[184:187], a[8:11], a[180:183], 0
    buffer_load_dwordx4 a[216:219], v9, s[8:11], s56 offen offset:2048 sc1
    v_mfma_f32_16x16x32_bf16 v[184:187], a[24:27], a[200:203], v[184:187]
    v_mfma_f32_16x16x32_bf16 v[184:187], a[40:43], a[220:223], v[184:187]
    v_mfma_f32_16x16x32_bf16 v[184:187], a[56:59], a[240:243], v[184:187]
    v_mfma_f32_16x16x32_bf16 v[188:191], a[12:15], a[180:183], 0
    buffer_load_dwordx4 a[236:239], v9, s[8:11], s56 offen offset:3072 sc1
    v_mfma_f32_16x16x32_bf16 v[188:191], a[28:31], a[200:203], v[188:191]
    v_mfma_f32_16x16x32_bf16 v[188:191], a[44:47], a[220:223], v[188:191]
    v_mfma_f32_16x16x32_bf16 v[188:191], a[60:63], a[240:243], v[188:191]
    s_waitcnt vmcnt(15)
    v_mfma_f32_16x16x32_bf16 v[136:139], a[0:3], a[184:187], 0
    buffer_load_dwordx4 a[180:183], v9, s[8:11], s57 offen sc1
    s_waitcnt vmcnt(15)
    v_mfma_f32_16x16x32_bf16 v[136:139], a[16:19], a[204:207], v[136:139]
    s_waitcnt vmcnt(14)
    v_mfma_f32_16x16x32_bf16 v[136:139], a[32:35], a[224:227], v[136:139]
    s_waitcnt vmcnt(13)
    v_mfma_f32_16x16x32_bf16 v[136:139], a[48:51], a[244:247], v[136:139]
    v_mfma_f32_16x16x32_bf16 v[192:195], a[4:7], a[184:187], 0
    buffer_load_dwordx4 a[200:203], v9, s[8:11], s57 offen offset:1024 sc1
    v_mfma_f32_16x16x32_bf16 v[192:195], a[20:23], a[204:207], v[192:195]
    v_mfma_f32_16x16x32_bf16 v[192:195], a[36:39], a[224:227], v[192:195]
    v_mfma_f32_16x16x32_bf16 v[192:195], a[52:55], a[244:247], v[192:195]
    v_mfma_f32_16x16x32_bf16 v[196:199], a[8:11], a[184:187], 0
    buffer_load_dwordx4 a[220:223], v9, s[8:11], s57 offen offset:2048 sc1
    v_mfma_f32_16x16x32_bf16 v[196:199], a[24:27], a[204:207], v[196:199]
    v_mfma_f32_16x16x32_bf16 v[196:199], a[40:43], a[224:227], v[196:199]
    v_mfma_f32_16x16x32_bf16 v[196:199], a[56:59], a[244:247], v[196:199]
    v_mfma_f32_16x16x32_bf16 v[200:203], a[12:15], a[184:187], 0
    buffer_load_dwordx4 a[240:243], v9, s[8:11], s57 offen offset:3072 sc1
    v_mfma_f32_16x16x32_bf16 v[200:203], a[28:31], a[204:207], v[200:203]
    v_mfma_f32_16x16x32_bf16 v[200:203], a[44:47], a[224:227], v[200:203]
    v_mfma_f32_16x16x32_bf16 v[200:203], a[60:63], a[244:247], v[200:203]
    s_waitcnt vmcnt(15)
    v_mfma_f32_16x16x32_bf16 v[140:143], a[0:3], a[188:191], 0
    buffer_load_dwordx4 a[184:187], v9, s[8:11], s58 offen sc1
    s_waitcnt vmcnt(15)
    v_mfma_f32_16x16x32_bf16 v[140:143], a[16:19], a[208:211], v[140:143]
    s_waitcnt vmcnt(14)
    v_mfma_f32_16x16x32_bf16 v[140:143], a[32:35], a[228:231], v[140:143]
    s_waitcnt vmcnt(13)
    v_mfma_f32_16x16x32_bf16 v[140:143], a[48:51], a[248:251], v[140:143]
    v_mfma_f32_16x16x32_bf16 v[204:207], a[4:7], a[188:191], 0
    buffer_load_dwordx4 a[204:207], v9, s[8:11], s58 offen offset:1024 sc1
    v_mfma_f32_16x16x32_bf16 v[204:207], a[20:23], a[208:211], v[204:207]
    v_mfma_f32_16x16x32_bf16 v[204:207], a[36:39], a[228:231], v[204:207]
    v_mfma_f32_16x16x32_bf16 v[204:207], a[52:55], a[248:251], v[204:207]
    v_mfma_f32_16x16x32_bf16 v[208:211], a[8:11], a[188:191], 0
    buffer_load_dwordx4 a[224:227], v9, s[8:11], s58 offen offset:2048 sc1
    v_mfma_f32_16x16x32_bf16 v[208:211], a[24:27], a[208:211], v[208:211]
    v_mfma_f32_16x16x32_bf16 v[208:211], a[40:43], a[228:231], v[208:211]
    v_mfma_f32_16x16x32_bf16 v[208:211], a[56:59], a[248:251], v[208:211]
    v_mfma_f32_16x16x32_bf16 v[212:215], a[12:15], a[188:191], 0
    buffer_load_dwordx4 a[244:247], v9, s[8:11], s58 offen offset:3072 sc1
    v_mfma_f32_16x16x32_bf16 v[212:215], a[28:31], a[208:211], v[212:215]
    v_mfma_f32_16x16x32_bf16 v[212:215], a[44:47], a[228:231], v[212:215]
    v_mfma_f32_16x16x32_bf16 v[212:215], a[60:63], a[248:251], v[212:215]
    s_waitcnt vmcnt(15)
    v_mfma_f32_16x16x32_bf16 v[144:147], a[0:3], a[192:195], 0
    buffer_load_dwordx4 a[188:191], v9, s[8:11], s59 offen sc1
    s_waitcnt vmcnt(15)
    v_mfma_f32_16x16x32_bf16 v[144:147], a[16:19], a[212:215], v[144:147]
    s_waitcnt vmcnt(14)
    v_mfma_f32_16x16x32_bf16 v[144:147], a[32:35], a[232:235], v[144:147]
    s_waitcnt vmcnt(13)
    v_mfma_f32_16x16x32_bf16 v[144:147], a[48:51], a[252:255], v[144:147]
    v_mfma_f32_16x16x32_bf16 v[216:219], a[4:7], a[192:195], 0
    buffer_load_dwordx4 a[208:211], v9, s[8:11], s59 offen offset:1024 sc1
    v_mfma_f32_16x16x32_bf16 v[216:219], a[20:23], a[212:215], v[216:219]
    v_mfma_f32_16x16x32_bf16 v[216:219], a[36:39], a[232:235], v[216:219]
    v_mfma_f32_16x16x32_bf16 v[216:219], a[52:55], a[252:255], v[216:219]
    v_mfma_f32_16x16x32_bf16 v[220:223], a[8:11], a[192:195], 0
    buffer_load_dwordx4 a[228:231], v9, s[8:11], s59 offen offset:2048 sc1
    v_mfma_f32_16x16x32_bf16 v[220:223], a[24:27], a[212:215], v[220:223]
    v_mfma_f32_16x16x32_bf16 v[220:223], a[40:43], a[232:235], v[220:223]
    v_mfma_f32_16x16x32_bf16 v[220:223], a[56:59], a[252:255], v[220:223]
    v_mfma_f32_16x16x32_bf16 v[224:227], a[12:15], a[192:195], 0
    buffer_load_dwordx4 a[248:251], v9, s[8:11], s59 offen offset:3072 sc1
    v_mfma_f32_16x16x32_bf16 v[224:227], a[28:31], a[212:215], v[224:227]
    v_mfma_f32_16x16x32_bf16 v[224:227], a[44:47], a[232:235], v[224:227]
    v_mfma_f32_16x16x32_bf16 v[224:227], a[60:63], a[252:255], v[224:227]
    s_waitcnt vmcnt(15)
    v_mfma_f32_16x16x32_bf16 v[128:131], a[64:67], a[176:179], v[128:131]
    buffer_load_dwordx4 a[192:195], v9, s[8:11], s60 offen sc1
    s_waitcnt vmcnt(15)
    v_mfma_f32_16x16x32_bf16 v[128:131], a[80:83], a[196:199], v[128:131]
    s_waitcnt vmcnt(14)
    v_mfma_f32_16x16x32_bf16 v[128:131], a[96:99], a[216:219], v[128:131]
    s_waitcnt vmcnt(13) lgkmcnt(0)
    v_mfma_f32_16x16x32_bf16 v[128:131], a[112:115], a[236:239], v[128:131]
    v_mfma_f32_16x16x32_bf16 v[168:171], a[68:71], a[176:179], v[168:171]
    buffer_load_dwordx4 a[212:215], v9, s[8:11], s60 offen offset:1024 sc1
    v_mfma_f32_16x16x32_bf16 v[168:171], a[84:87], a[196:199], v[168:171]
    v_mfma_f32_16x16x32_bf16 v[168:171], a[100:103], a[216:219], v[168:171]
    v_mfma_f32_16x16x32_bf16 v[168:171], a[116:119], a[236:239], v[168:171]
    v_mfma_f32_16x16x32_bf16 v[172:175], a[72:75], a[176:179], v[172:175]
    buffer_load_dwordx4 a[232:235], v9, s[8:11], s60 offen offset:2048 sc1
    v_mfma_f32_16x16x32_bf16 v[172:175], a[88:91], a[196:199], v[172:175]
    v_mfma_f32_16x16x32_bf16 v[172:175], a[104:107], a[216:219], v[172:175]
    v_mfma_f32_16x16x32_bf16 v[172:175], a[120:123], a[236:239], v[172:175]
    v_mfma_f32_16x16x32_bf16 v[176:179], a[76:79], a[176:179], v[176:179]
    buffer_load_dwordx4 a[252:255], v9, s[8:11], s60 offen offset:3072 sc1
    v_mfma_f32_16x16x32_bf16 v[176:179], a[92:95], a[196:199], v[176:179]
    v_mfma_f32_16x16x32_bf16 v[176:179], a[108:111], a[216:219], v[176:179]
    v_mfma_f32_16x16x32_bf16 v[176:179], a[124:127], a[236:239], v[176:179]
    s_waitcnt vmcnt(15)
    v_mfma_f32_16x16x32_bf16 v[132:135], a[64:67], a[180:183], v[132:135]
    buffer_load_dwordx4 a[176:179], v10, s[8:11], s56 offen sc1
    s_waitcnt vmcnt(15)
    v_mfma_f32_16x16x32_bf16 v[132:135], a[80:83], a[200:203], v[132:135]
    s_waitcnt vmcnt(14)
    v_mfma_f32_16x16x32_bf16 v[132:135], a[96:99], a[220:223], v[132:135]
    s_waitcnt vmcnt(13)
    v_mfma_f32_16x16x32_bf16 v[132:135], a[112:115], a[240:243], v[132:135]
    v_mfma_f32_16x16x32_bf16 v[180:183], a[68:71], a[180:183], v[180:183]
    buffer_load_dwordx4 a[196:199], v10, s[8:11], s56 offen offset:1024 sc1
    v_mfma_f32_16x16x32_bf16 v[180:183], a[84:87], a[200:203], v[180:183]
    v_mfma_f32_16x16x32_bf16 v[180:183], a[100:103], a[220:223], v[180:183]
    v_mfma_f32_16x16x32_bf16 v[180:183], a[116:119], a[240:243], v[180:183]
    v_mfma_f32_16x16x32_bf16 v[184:187], a[72:75], a[180:183], v[184:187]
    buffer_load_dwordx4 a[216:219], v10, s[8:11], s56 offen offset:2048 sc1
    v_mfma_f32_16x16x32_bf16 v[184:187], a[88:91], a[200:203], v[184:187]
    v_mfma_f32_16x16x32_bf16 v[184:187], a[104:107], a[220:223], v[184:187]
    v_mfma_f32_16x16x32_bf16 v[184:187], a[120:123], a[240:243], v[184:187]
    v_mfma_f32_16x16x32_bf16 v[188:191], a[76:79], a[180:183], v[188:191]
    buffer_load_dwordx4 a[236:239], v10, s[8:11], s56 offen offset:3072 sc1
    v_mfma_f32_16x16x32_bf16 v[188:191], a[92:95], a[200:203], v[188:191]
    v_mfma_f32_16x16x32_bf16 v[188:191], a[108:111], a[220:223], v[188:191]
    v_mfma_f32_16x16x32_bf16 v[188:191], a[124:127], a[240:243], v[188:191]
    s_waitcnt vmcnt(15)
    v_mfma_f32_16x16x32_bf16 v[136:139], a[64:67], a[184:187], v[136:139]
    buffer_load_dwordx4 a[180:183], v10, s[8:11], s57 offen sc1
    s_waitcnt vmcnt(15)
    v_mfma_f32_16x16x32_bf16 v[136:139], a[80:83], a[204:207], v[136:139]
    s_waitcnt vmcnt(14)
    v_mfma_f32_16x16x32_bf16 v[136:139], a[96:99], a[224:227], v[136:139]
    s_waitcnt vmcnt(13)
    v_mfma_f32_16x16x32_bf16 v[136:139], a[112:115], a[244:247], v[136:139]
    v_mfma_f32_16x16x32_bf16 v[192:195], a[68:71], a[184:187], v[192:195]
    buffer_load_dwordx4 a[200:203], v10, s[8:11], s57 offen offset:1024 sc1
    v_mfma_f32_16x16x32_bf16 v[192:195], a[84:87], a[204:207], v[192:195]
    v_mfma_f32_16x16x32_bf16 v[192:195], a[100:103], a[224:227], v[192:195]
    v_mfma_f32_16x16x32_bf16 v[192:195], a[116:119], a[244:247], v[192:195]
    v_mfma_f32_16x16x32_bf16 v[196:199], a[72:75], a[184:187], v[196:199]
    buffer_load_dwordx4 a[220:223], v10, s[8:11], s57 offen offset:2048 sc1
    v_mfma_f32_16x16x32_bf16 v[196:199], a[88:91], a[204:207], v[196:199]
    v_mfma_f32_16x16x32_bf16 v[196:199], a[104:107], a[224:227], v[196:199]
    v_mfma_f32_16x16x32_bf16 v[196:199], a[120:123], a[244:247], v[196:199]
    v_mfma_f32_16x16x32_bf16 v[200:203], a[76:79], a[184:187], v[200:203]
    buffer_load_dwordx4 a[240:243], v10, s[8:11], s57 offen offset:3072 sc1
    v_mfma_f32_16x16x32_bf16 v[200:203], a[92:95], a[204:207], v[200:203]
    v_mfma_f32_16x16x32_bf16 v[200:203], a[108:111], a[224:227], v[200:203]
    v_mfma_f32_16x16x32_bf16 v[200:203], a[124:127], a[244:247], v[200:203]
    s_waitcnt vmcnt(15)
    v_mfma_f32_16x16x32_bf16 v[140:143], a[64:67], a[188:191], v[140:143]
    buffer_load_dwordx4 a[184:187], v10, s[8:11], s58 offen sc1
    s_waitcnt vmcnt(15)
    v_mfma_f32_16x16x32_bf16 v[140:143], a[80:83], a[208:211], v[140:143]
    s_waitcnt vmcnt(14)
    v_mfma_f32_16x16x32_bf16 v[140:143], a[96:99], a[228:231], v[140:143]
    s_waitcnt vmcnt(13)
    v_mfma_f32_16x16x32_bf16 v[140:143], a[112:115], a[248:251], v[140:143]
    v_mfma_f32_16x16x32_bf16 v[204:207], a[68:71], a[188:191], v[204:207]
    buffer_load_dwordx4 a[204:207], v10, s[8:11], s58 offen offset:1024 sc1
    v_mfma_f32_16x16x32_bf16 v[204:207], a[84:87], a[208:211], v[204:207]
    v_mfma_f32_16x16x32_bf16 v[204:207], a[100:103], a[228:231], v[204:207]
    v_mfma_f32_16x16x32_bf16 v[204:207], a[116:119], a[248:251], v[204:207]
    v_mfma_f32_16x16x32_bf16 v[208:211], a[72:75], a[188:191], v[208:211]
    buffer_load_dwordx4 a[224:227], v10, s[8:11], s58 offen offset:2048 sc1
    v_mfma_f32_16x16x32_bf16 v[208:211], a[88:91], a[208:211], v[208:211]
    v_mfma_f32_16x16x32_bf16 v[208:211], a[104:107], a[228:231], v[208:211]
    v_mfma_f32_16x16x32_bf16 v[208:211], a[120:123], a[248:251], v[208:211]
    v_mfma_f32_16x16x32_bf16 v[212:215], a[76:79], a[188:191], v[212:215]
    buffer_load_dwordx4 a[244:247], v10, s[8:11], s58 offen offset:3072 sc1
    v_mfma_f32_16x16x32_bf16 v[212:215], a[92:95], a[208:211], v[212:215]
    v_mfma_f32_16x16x32_bf16 v[212:215], a[108:111], a[228:231], v[212:215]
    v_mfma_f32_16x16x32_bf16 v[212:215], a[124:127], a[248:251], v[212:215]
    s_waitcnt vmcnt(15)
    v_mfma_f32_16x16x32_bf16 v[144:147], a[64:67], a[192:195], v[144:147]
    buffer_load_dwordx4 a[188:191], v10, s[8:11], s59 offen sc1
    s_waitcnt vmcnt(15)
    v_mfma_f32_16x16x32_bf16 v[144:147], a[80:83], a[212:215], v[144:147]
    s_waitcnt vmcnt(14)
    v_mfma_f32_16x16x32_bf16 v[144:147], a[96:99], a[232:235], v[144:147]
    s_waitcnt vmcnt(13)
    v_mfma_f32_16x16x32_bf16 v[144:147], a[112:115], a[252:255], v[144:147]
    v_mfma_f32_16x16x32_bf16 v[216:219], a[68:71], a[192:195], v[216:219]
    buffer_load_dwordx4 a[208:211], v10, s[8:11], s59 offen offset:1024 sc1
    v_mfma_f32_16x16x32_bf16 v[216:219], a[84:87], a[212:215], v[216:219]
    v_mfma_f32_16x16x32_bf16 v[216:219], a[100:103], a[232:235], v[216:219]
    v_mfma_f32_16x16x32_bf16 v[216:219], a[116:119], a[252:255], v[216:219]
    v_mfma_f32_16x16x32_bf16 v[220:223], a[72:75], a[192:195], v[220:223]
    buffer_load_dwordx4 a[228:231], v10, s[8:11], s59 offen offset:2048 sc1
    v_mfma_f32_16x16x32_bf16 v[220:223], a[88:91], a[212:215], v[220:223]
    v_mfma_f32_16x16x32_bf16 v[220:223], a[104:107], a[232:235], v[220:223]
    v_mfma_f32_16x16x32_bf16 v[220:223], a[120:123], a[252:255], v[220:223]
    v_mfma_f32_16x16x32_bf16 v[224:227], a[76:79], a[192:195], v[224:227]
    buffer_load_dwordx4 a[248:251], v10, s[8:11], s59 offen offset:3072 sc1
    v_mfma_f32_16x16x32_bf16 v[224:227], a[92:95], a[212:215], v[224:227]
    v_mfma_f32_16x16x32_bf16 v[224:227], a[108:111], a[232:235], v[224:227]
    v_mfma_f32_16x16x32_bf16 v[224:227], a[124:127], a[252:255], v[224:227]
    s_waitcnt vmcnt(15)
    v_mfma_f32_16x16x32_bf16 v[128:131], a[128:131], a[176:179], v[128:131]
    buffer_load_dwordx4 a[192:195], v10, s[8:11], s60 offen sc1
    s_waitcnt vmcnt(15)
    v_mfma_f32_16x16x32_bf16 v[128:131], a[144:147], a[196:199], v[128:131]
    s_waitcnt vmcnt(14)
    v_mfma_f32_16x16x32_bf16 v[128:131], a[160:163], a[216:219], v[128:131]
    s_waitcnt vmcnt(13)
    v_mfma_f32_16x16x32_bf16 v[128:131], v[80:83], a[236:239], v[128:131]
    v_mfma_f32_16x16x32_bf16 v[168:171], a[132:135], a[176:179], v[168:171]
    buffer_load_dwordx4 a[212:215], v10, s[8:11], s60 offen offset:1024 sc1
    v_mfma_f32_16x16x32_bf16 v[168:171], a[148:151], a[196:199], v[168:171]
    v_mfma_f32_16x16x32_bf16 v[168:171], a[164:167], a[216:219], v[168:171]
    v_mfma_f32_16x16x32_bf16 v[168:171], v[84:87], a[236:239], v[168:171]
    v_mfma_f32_16x16x32_bf16 v[172:175], a[136:139], a[176:179], v[172:175]
    buffer_load_dwordx4 a[232:235], v10, s[8:11], s60 offen offset:2048 sc1
    v_mfma_f32_16x16x32_bf16 v[172:175], a[152:155], a[196:199], v[172:175]
    v_mfma_f32_16x16x32_bf16 v[172:175], a[168:171], a[216:219], v[172:175]
    v_mfma_f32_16x16x32_bf16 v[172:175], v[88:91], a[236:239], v[172:175]
    v_mfma_f32_16x16x32_bf16 v[176:179], a[140:143], a[176:179], v[176:179]
    buffer_load_dwordx4 a[252:255], v10, s[8:11], s60 offen offset:3072 sc1
    v_mfma_f32_16x16x32_bf16 v[176:179], a[156:159], a[196:199], v[176:179]
    v_mfma_f32_16x16x32_bf16 v[176:179], a[172:175], a[216:219], v[176:179]
    v_mfma_f32_16x16x32_bf16 v[176:179], v[92:95], a[236:239], v[176:179]
    s_waitcnt vmcnt(15)
    v_mfma_f32_16x16x32_bf16 v[132:135], a[128:131], a[180:183], v[132:135]
    buffer_load_dwordx4 a[176:179], v11, s[8:11], s56 offen sc1
    s_waitcnt vmcnt(15)
    v_mfma_f32_16x16x32_bf16 v[132:135], a[144:147], a[200:203], v[132:135]
    s_waitcnt vmcnt(14)
    v_mfma_f32_16x16x32_bf16 v[132:135], a[160:163], a[220:223], v[132:135]
    s_waitcnt vmcnt(13)
    v_mfma_f32_16x16x32_bf16 v[132:135], v[80:83], a[240:243], v[132:135]
    v_mfma_f32_16x16x32_bf16 v[180:183], a[132:135], a[180:183], v[180:183]
    buffer_load_dwordx4 a[196:199], v11, s[8:11], s56 offen offset:1024 sc1
    v_mfma_f32_16x16x32_bf16 v[180:183], a[148:151], a[200:203], v[180:183]
    v_mfma_f32_16x16x32_bf16 v[180:183], a[164:167], a[220:223], v[180:183]
    v_mfma_f32_16x16x32_bf16 v[180:183], v[84:87], a[240:243], v[180:183]
    v_mfma_f32_16x16x32_bf16 v[184:187], a[136:139], a[180:183], v[184:187]
    buffer_load_dwordx4 a[216:219], v11, s[8:11], s56 offen offset:2048 sc1
    v_mfma_f32_16x16x32_bf16 v[184:187], a[152:155], a[200:203], v[184:187]
    v_mfma_f32_16x16x32_bf16 v[184:187], a[168:171], a[220:223], v[184:187]
    v_mfma_f32_16x16x32_bf16 v[184:187], v[88:91], a[240:243], v[184:187]
    v_mfma_f32_16x16x32_bf16 v[188:191], a[140:143], a[180:183], v[188:191]
    buffer_load_dwordx4 a[236:239], v11, s[8:11], s56 offen offset:3072 sc1
    v_mfma_f32_16x16x32_bf16 v[188:191], a[156:159], a[200:203], v[188:191]
    v_mfma_f32_16x16x32_bf16 v[188:191], a[172:175], a[220:223], v[188:191]
    v_mfma_f32_16x16x32_bf16 v[188:191], v[92:95], a[240:243], v[188:191]
    s_waitcnt vmcnt(15)
    v_mfma_f32_16x16x32_bf16 v[136:139], a[128:131], a[184:187], v[136:139]
    buffer_load_dwordx4 a[180:183], v11, s[8:11], s57 offen sc1
    s_waitcnt vmcnt(15)
    v_mfma_f32_16x16x32_bf16 v[136:139], a[144:147], a[204:207], v[136:139]
    s_waitcnt vmcnt(14)
    v_mfma_f32_16x16x32_bf16 v[136:139], a[160:163], a[224:227], v[136:139]
    s_waitcnt vmcnt(13)
    v_mfma_f32_16x16x32_bf16 v[136:139], v[80:83], a[244:247], v[136:139]
    v_mfma_f32_16x16x32_bf16 v[192:195], a[132:135], a[184:187], v[192:195]
    buffer_load_dwordx4 a[200:203], v11, s[8:11], s57 offen offset:1024 sc1
    v_mfma_f32_16x16x32_bf16 v[192:195], a[148:151], a[204:207], v[192:195]
    v_mfma_f32_16x16x32_bf16 v[192:195], a[164:167], a[224:227], v[192:195]
    v_mfma_f32_16x16x32_bf16 v[192:195], v[84:87], a[244:247], v[192:195]
    v_mfma_f32_16x16x32_bf16 v[196:199], a[136:139], a[184:187], v[196:199]
    buffer_load_dwordx4 a[220:223], v11, s[8:11], s57 offen offset:2048 sc1
    v_mfma_f32_16x16x32_bf16 v[196:199], a[152:155], a[204:207], v[196:199]
    v_mfma_f32_16x16x32_bf16 v[196:199], a[168:171], a[224:227], v[196:199]
    v_mfma_f32_16x16x32_bf16 v[196:199], v[88:91], a[244:247], v[196:199]
    v_mfma_f32_16x16x32_bf16 v[200:203], a[140:143], a[184:187], v[200:203]
    buffer_load_dwordx4 a[240:243], v11, s[8:11], s57 offen offset:3072 sc1
    v_mfma_f32_16x16x32_bf16 v[200:203], a[156:159], a[204:207], v[200:203]
    v_mfma_f32_16x16x32_bf16 v[200:203], a[172:175], a[224:227], v[200:203]
    v_mfma_f32_16x16x32_bf16 v[200:203], v[92:95], a[244:247], v[200:203]
    s_waitcnt vmcnt(15)
    v_mfma_f32_16x16x32_bf16 v[140:143], a[128:131], a[188:191], v[140:143]
    buffer_load_dwordx4 a[184:187], v11, s[8:11], s58 offen sc1
    s_waitcnt vmcnt(15)
    v_mfma_f32_16x16x32_bf16 v[140:143], a[144:147], a[208:211], v[140:143]
    s_waitcnt vmcnt(14)
    v_mfma_f32_16x16x32_bf16 v[140:143], a[160:163], a[228:231], v[140:143]
    s_waitcnt vmcnt(13)
    v_mfma_f32_16x16x32_bf16 v[140:143], v[80:83], a[248:251], v[140:143]
    v_mfma_f32_16x16x32_bf16 v[204:207], a[132:135], a[188:191], v[204:207]
    buffer_load_dwordx4 a[204:207], v11, s[8:11], s58 offen offset:1024 sc1
    v_mfma_f32_16x16x32_bf16 v[204:207], a[148:151], a[208:211], v[204:207]
    v_mfma_f32_16x16x32_bf16 v[204:207], a[164:167], a[228:231], v[204:207]
    v_mfma_f32_16x16x32_bf16 v[204:207], v[84:87], a[248:251], v[204:207]
    v_mfma_f32_16x16x32_bf16 v[208:211], a[136:139], a[188:191], v[208:211]
    buffer_load_dwordx4 a[224:227], v11, s[8:11], s58 offen offset:2048 sc1
    v_mfma_f32_16x16x32_bf16 v[208:211], a[152:155], a[208:211], v[208:211]
    v_mfma_f32_16x16x32_bf16 v[208:211], a[168:171], a[228:231], v[208:211]
    v_mfma_f32_16x16x32_bf16 v[208:211], v[88:91], a[248:251], v[208:211]
    v_mfma_f32_16x16x32_bf16 v[212:215], a[140:143], a[188:191], v[212:215]
    buffer_load_dwordx4 a[244:247], v11, s[8:11], s58 offen offset:3072 sc1
    v_mfma_f32_16x16x32_bf16 v[212:215], a[156:159], a[208:211], v[212:215]
    v_mfma_f32_16x16x32_bf16 v[212:215], a[172:175], a[228:231], v[212:215]
    v_mfma_f32_16x16x32_bf16 v[212:215], v[92:95], a[248:251], v[212:215]
    s_waitcnt vmcnt(15)
    v_mfma_f32_16x16x32_bf16 v[144:147], a[128:131], a[192:195], v[144:147]
    buffer_load_dwordx4 a[188:191], v11, s[8:11], s59 offen sc1
    s_waitcnt vmcnt(15)
    v_mfma_f32_16x16x32_bf16 v[144:147], a[144:147], a[212:215], v[144:147]
    s_waitcnt vmcnt(14)
    v_mfma_f32_16x16x32_bf16 v[144:147], a[160:163], a[232:235], v[144:147]
    s_waitcnt vmcnt(13)
    v_mfma_f32_16x16x32_bf16 v[144:147], v[80:83], a[252:255], v[144:147]
    v_mfma_f32_16x16x32_bf16 v[216:219], a[132:135], a[192:195], v[216:219]
    buffer_load_dwordx4 a[208:211], v11, s[8:11], s59 offen offset:1024 sc1
    v_mfma_f32_16x16x32_bf16 v[216:219], a[148:151], a[212:215], v[216:219]
    v_mfma_f32_16x16x32_bf16 v[216:219], a[164:167], a[232:235], v[216:219]
    v_mfma_f32_16x16x32_bf16 v[216:219], v[84:87], a[252:255], v[216:219]
    v_mfma_f32_16x16x32_bf16 v[220:223], a[136:139], a[192:195], v[220:223]
    buffer_load_dwordx4 a[228:231], v11, s[8:11], s59 offen offset:2048 sc1
    v_mfma_f32_16x16x32_bf16 v[220:223], a[152:155], a[212:215], v[220:223]
    v_mfma_f32_16x16x32_bf16 v[220:223], a[168:171], a[232:235], v[220:223]
    v_mfma_f32_16x16x32_bf16 v[220:223], v[88:91], a[252:255], v[220:223]
    v_mfma_f32_16x16x32_bf16 v[224:227], a[140:143], a[192:195], v[224:227]
    buffer_load_dwordx4 a[248:251], v11, s[8:11], s59 offen offset:3072 sc1
    v_mfma_f32_16x16x32_bf16 v[224:227], a[156:159], a[212:215], v[224:227]
    v_mfma_f32_16x16x32_bf16 v[224:227], a[172:175], a[232:235], v[224:227]
    v_mfma_f32_16x16x32_bf16 v[224:227], v[92:95], a[252:255], v[224:227]
    s_waitcnt vmcnt(15)
    v_mfma_f32_16x16x32_bf16 v[128:131], v[112:115], a[176:179], v[128:131]
    buffer_load_dwordx4 a[192:195], v11, s[8:11], s60 offen sc1
    s_waitcnt vmcnt(15)
    v_mfma_f32_16x16x32_bf16 v[128:131], v[228:231], a[196:199], v[128:131]
    s_waitcnt vmcnt(14)
    v_mfma_f32_16x16x32_bf16 v[128:131], v[64:67], a[216:219], v[128:131]
    s_waitcnt vmcnt(13)
    v_mfma_f32_16x16x32_bf16 v[128:131], v[12:15], a[236:239], v[128:131]
    v_mfma_f32_16x16x32_bf16 v[168:171], v[116:119], a[176:179], v[168:171]
    buffer_load_dwordx4 a[212:215], v11, s[8:11], s60 offen offset:1024 sc1
    v_mfma_f32_16x16x32_bf16 v[168:171], v[232:235], a[196:199], v[168:171]
    v_mfma_f32_16x16x32_bf16 v[168:171], v[68:71], a[216:219], v[168:171]
    v_mfma_f32_16x16x32_bf16 v[168:171], v[16:19], a[236:239], v[168:171]
    v_mfma_f32_16x16x32_bf16 v[172:175], v[120:123], a[176:179], v[172:175]
    buffer_load_dwordx4 a[232:235], v11, s[8:11], s60 offen offset:2048 sc1
    v_mfma_f32_16x16x32_bf16 v[172:175], v[236:239], a[196:199], v[172:175]
    v_mfma_f32_16x16x32_bf16 v[172:175], v[72:75], a[216:219], v[172:175]
    v_mfma_f32_16x16x32_bf16 v[172:175], v[20:23], a[236:239], v[172:175]
    v_mfma_f32_16x16x32_bf16 v[176:179], v[124:127], a[176:179], v[176:179]
    buffer_load_dwordx4 a[252:255], v11, s[8:11], s60 offen offset:3072 sc1
    v_mfma_f32_16x16x32_bf16 v[176:179], v[240:243], a[196:199], v[176:179]
    v_mfma_f32_16x16x32_bf16 v[176:179], v[76:79], a[216:219], v[176:179]
    v_mfma_f32_16x16x32_bf16 v[176:179], v[24:27], a[236:239], v[176:179]
    ds_write_b128 v28, v[168:171]
    s_waitcnt vmcnt(15)
    v_mfma_f32_16x16x32_bf16 v[132:135], v[112:115], a[180:183], v[132:135]
    buffer_load_dwordx4 a[176:179], v8, s[12:15], s56 offen sc1
    s_waitcnt vmcnt(15)
    v_mfma_f32_16x16x32_bf16 v[132:135], v[228:231], a[200:203], v[132:135]
    s_waitcnt vmcnt(14)
    v_mfma_f32_16x16x32_bf16 v[132:135], v[64:67], a[220:223], v[132:135]
    s_waitcnt vmcnt(13)
    v_mfma_f32_16x16x32_bf16 v[132:135], v[12:15], a[240:243], v[132:135]
    ds_write_b128 v28, v[172:175] offset:17408
    v_mfma_f32_16x16x32_bf16 v[180:183], v[116:119], a[180:183], v[180:183]
    buffer_load_dwordx4 a[196:199], v8, s[12:15], s56 offen offset:1024 sc1
    v_mfma_f32_16x16x32_bf16 v[180:183], v[232:235], a[200:203], v[180:183]
    v_mfma_f32_16x16x32_bf16 v[180:183], v[68:71], a[220:223], v[180:183]
    v_mfma_f32_16x16x32_bf16 v[180:183], v[16:19], a[240:243], v[180:183]
    ds_write_b128 v28, v[176:179] offset:34816
    v_mfma_f32_16x16x32_bf16 v[184:187], v[120:123], a[180:183], v[184:187]
    buffer_load_dwordx4 a[216:219], v8, s[12:15], s56 offen offset:2048 sc1
    v_mfma_f32_16x16x32_bf16 v[184:187], v[236:239], a[200:203], v[184:187]
    v_mfma_f32_16x16x32_bf16 v[184:187], v[72:75], a[220:223], v[184:187]
    v_mfma_f32_16x16x32_bf16 v[184:187], v[20:23], a[240:243], v[184:187]
    v_mfma_f32_16x16x32_bf16 v[188:191], v[124:127], a[180:183], v[188:191]
    buffer_load_dwordx4 a[236:239], v8, s[12:15], s56 offen offset:3072 sc1
    v_mfma_f32_16x16x32_bf16 v[188:191], v[240:243], a[200:203], v[188:191]
    v_mfma_f32_16x16x32_bf16 v[188:191], v[76:79], a[220:223], v[188:191]
    v_mfma_f32_16x16x32_bf16 v[188:191], v[24:27], a[240:243], v[188:191]
    ds_write_b128 v28, v[180:183] offset:1024
    s_waitcnt vmcnt(15)
    v_mfma_f32_16x16x32_bf16 v[136:139], v[112:115], a[184:187], v[136:139]
    buffer_load_dwordx4 a[180:183], v8, s[12:15], s57 offen sc1
    s_waitcnt vmcnt(15)
    v_mfma_f32_16x16x32_bf16 v[136:139], v[228:231], a[204:207], v[136:139]
    s_waitcnt vmcnt(14)
    v_mfma_f32_16x16x32_bf16 v[136:139], v[64:67], a[224:227], v[136:139]
    s_waitcnt vmcnt(13)
    v_mfma_f32_16x16x32_bf16 v[136:139], v[12:15], a[244:247], v[136:139]
    ds_write_b128 v28, v[184:187] offset:18432
    v_mfma_f32_16x16x32_bf16 v[192:195], v[116:119], a[184:187], v[192:195]
    buffer_load_dwordx4 a[200:203], v8, s[12:15], s57 offen offset:1024 sc1
    v_mfma_f32_16x16x32_bf16 v[192:195], v[232:235], a[204:207], v[192:195]
    v_mfma_f32_16x16x32_bf16 v[192:195], v[68:71], a[224:227], v[192:195]
    v_mfma_f32_16x16x32_bf16 v[192:195], v[16:19], a[244:247], v[192:195]
    ds_write_b128 v28, v[188:191] offset:35840
    v_mfma_f32_16x16x32_bf16 v[196:199], v[120:123], a[184:187], v[196:199]
    buffer_load_dwordx4 a[220:223], v8, s[12:15], s57 offen offset:2048 sc1
    v_mfma_f32_16x16x32_bf16 v[196:199], v[236:239], a[204:207], v[196:199]
    v_mfma_f32_16x16x32_bf16 v[196:199], v[72:75], a[224:227], v[196:199]
    v_mfma_f32_16x16x32_bf16 v[196:199], v[20:23], a[244:247], v[196:199]
    v_mfma_f32_16x16x32_bf16 v[200:203], v[124:127], a[184:187], v[200:203]
    buffer_load_dwordx4 a[240:243], v8, s[12:15], s57 offen offset:3072 sc1
    v_mfma_f32_16x16x32_bf16 v[200:203], v[240:243], a[204:207], v[200:203]
    v_mfma_f32_16x16x32_bf16 v[200:203], v[76:79], a[224:227], v[200:203]
    v_mfma_f32_16x16x32_bf16 v[200:203], v[24:27], a[244:247], v[200:203]
    ds_write_b128 v28, v[192:195] offset:2048
    s_waitcnt vmcnt(15)
    v_mfma_f32_16x16x32_bf16 v[140:143], v[112:115], a[188:191], v[140:143]
    buffer_load_dwordx4 a[184:187], v8, s[12:15], s58 offen sc1
    s_waitcnt vmcnt(15)
    v_mfma_f32_16x16x32_bf16 v[140:143], v[228:231], a[208:211], v[140:143]
    s_waitcnt vmcnt(14)
    v_mfma_f32_16x16x32_bf16 v[140:143], v[64:67], a[228:231], v[140:143]
    s_waitcnt vmcnt(13)
    v_mfma_f32_16x16x32_bf16 v[140:143], v[12:15], a[248:251], v[140:143]
    ds_write_b128 v28, v[196:199] offset:19456
    v_mfma_f32_16x16x32_bf16 v[204:207], v[116:119], a[188:191], v[204:207]
    buffer_load_dwordx4 a[204:207], v8, s[12:15], s58 offen offset:1024 sc1
    v_mfma_f32_16x16x32_bf16 v[204:207], v[232:235], a[208:211], v[204:207]
    v_mfma_f32_16x16x32_bf16 v[204:207], v[68:71], a[228:231], v[204:207]
    v_mfma_f32_16x16x32_bf16 v[204:207], v[16:19], a[248:251], v[204:207]
    ds_write_b128 v28, v[200:203] offset:49152
    v_mfma_f32_16x16x32_bf16 v[208:211], v[120:123], a[188:191], v[208:211]
    buffer_load_dwordx4 a[224:227], v8, s[12:15], s58 offen offset:2048 sc1
    v_mfma_f32_16x16x32_bf16 v[208:211], v[236:239], a[208:211], v[208:211]
    v_mfma_f32_16x16x32_bf16 v[208:211], v[72:75], a[228:231], v[208:211]
    v_mfma_f32_16x16x32_bf16 v[208:211], v[20:23], a[248:251], v[208:211]
    v_mfma_f32_16x16x32_bf16 v[212:215], v[124:127], a[188:191], v[212:215]
    buffer_load_dwordx4 a[244:247], v8, s[12:15], s58 offen offset:3072 sc1
    v_mfma_f32_16x16x32_bf16 v[212:215], v[240:243], a[208:211], v[212:215]
    v_mfma_f32_16x16x32_bf16 v[212:215], v[76:79], a[228:231], v[212:215]
    v_mfma_f32_16x16x32_bf16 v[212:215], v[24:27], a[248:251], v[212:215]
    ds_write_b128 v28, v[204:207] offset:3072
    s_waitcnt vmcnt(15)
    v_mfma_f32_16x16x32_bf16 v[144:147], v[112:115], a[192:195], v[144:147]
    buffer_load_dwordx4 a[188:191], v8, s[12:15], s59 offen sc1
    s_waitcnt vmcnt(15)
    v_mfma_f32_16x16x32_bf16 v[144:147], v[228:231], a[212:215], v[144:147]
    s_waitcnt vmcnt(14)
    v_mfma_f32_16x16x32_bf16 v[144:147], v[64:67], a[232:235], v[144:147]
    s_waitcnt vmcnt(13)
    v_mfma_f32_16x16x32_bf16 v[144:147], v[12:15], a[252:255], v[144:147]
    ds_write_b128 v28, v[208:211] offset:32768
    v_mfma_f32_16x16x32_bf16 v[216:219], v[116:119], a[192:195], v[216:219]
    buffer_load_dwordx4 a[208:211], v8, s[12:15], s59 offen offset:1024 sc1
    v_mfma_f32_16x16x32_bf16 v[216:219], v[232:235], a[212:215], v[216:219]
    v_mfma_f32_16x16x32_bf16 v[216:219], v[68:71], a[232:235], v[216:219]
    v_mfma_f32_16x16x32_bf16 v[216:219], v[16:19], a[252:255], v[216:219]
    ds_write_b128 v28, v[212:215] offset:50176
    v_mfma_f32_16x16x32_bf16 v[220:223], v[120:123], a[192:195], v[220:223]
    buffer_load_dwordx4 a[228:231], v8, s[12:15], s59 offen offset:2048 sc1
    v_mfma_f32_16x16x32_bf16 v[220:223], v[236:239], a[212:215], v[220:223]
    v_mfma_f32_16x16x32_bf16 v[220:223], v[72:75], a[232:235], v[220:223]
    v_mfma_f32_16x16x32_bf16 v[220:223], v[20:23], a[252:255], v[220:223]
    v_mfma_f32_16x16x32_bf16 v[224:227], v[124:127], a[192:195], v[224:227]
    buffer_load_dwordx4 a[248:251], v8, s[12:15], s59 offen offset:3072 sc1
    v_mfma_f32_16x16x32_bf16 v[224:227], v[240:243], a[212:215], v[224:227]
    v_mfma_f32_16x16x32_bf16 v[224:227], v[76:79], a[232:235], v[224:227]
    v_mfma_f32_16x16x32_bf16 v[224:227], v[24:27], a[252:255], v[224:227]
    ds_write_b128 v28, v[216:219] offset:16384
    s_waitcnt vmcnt(15)
    v_mfma_f32_16x16x32_bf16 v[148:151], a[0:3], a[176:179], 0
    buffer_load_dwordx4 a[192:195], v8, s[12:15], s60 offen sc1
    s_waitcnt vmcnt(15)
    v_mfma_f32_16x16x32_bf16 v[148:151], a[16:19], a[196:199], v[148:151]
    s_waitcnt vmcnt(14)
    v_mfma_f32_16x16x32_bf16 v[148:151], a[32:35], a[216:219], v[148:151]
    s_waitcnt vmcnt(13)
    v_mfma_f32_16x16x32_bf16 v[148:151], a[48:51], a[236:239], v[148:151]
    ds_write_b128 v28, v[220:223] offset:33792
    s_waitcnt lgkmcnt(2)
    v_mfma_f32_16x16x32_bf16 v[168:171], a[4:7], a[176:179], 0
    buffer_load_dwordx4 a[212:215], v8, s[12:15], s60 offen offset:1024 sc1
    v_mfma_f32_16x16x32_bf16 v[168:171], a[20:23], a[196:199], v[168:171]
    v_mfma_f32_16x16x32_bf16 v[168:171], a[36:39], a[216:219], v[168:171]
    v_mfma_f32_16x16x32_bf16 v[168:171], a[52:55], a[236:239], v[168:171]
    ds_write_b128 v28, v[224:227] offset:51200
    v_mfma_f32_16x16x32_bf16 v[172:175], a[8:11], a[176:179], 0
    buffer_load_dwordx4 a[232:235], v8, s[12:15], s60 offen offset:2048 sc1
    v_mfma_f32_16x16x32_bf16 v[172:175], a[24:27], a[196:199], v[172:175]
    v_mfma_f32_16x16x32_bf16 v[172:175], a[40:43], a[216:219], v[172:175]
    v_mfma_f32_16x16x32_bf16 v[172:175], a[56:59], a[236:239], v[172:175]
    v_mfma_f32_16x16x32_bf16 v[176:179], a[12:15], a[176:179], 0
    buffer_load_dwordx4 a[252:255], v8, s[12:15], s60 offen offset:3072 sc1
    v_mfma_f32_16x16x32_bf16 v[176:179], a[28:31], a[196:199], v[176:179]
    v_mfma_f32_16x16x32_bf16 v[176:179], a[44:47], a[216:219], v[176:179]
    v_mfma_f32_16x16x32_bf16 v[176:179], a[60:63], a[236:239], v[176:179]
    s_waitcnt vmcnt(15)
    v_mfma_f32_16x16x32_bf16 v[152:155], a[0:3], a[180:183], 0
    buffer_load_dwordx4 a[176:179], v9, s[12:15], s56 offen sc1
    s_waitcnt vmcnt(15)
    v_mfma_f32_16x16x32_bf16 v[152:155], a[16:19], a[200:203], v[152:155]
    s_waitcnt vmcnt(14)
    v_mfma_f32_16x16x32_bf16 v[152:155], a[32:35], a[220:223], v[152:155]
    s_waitcnt vmcnt(13)
    v_mfma_f32_16x16x32_bf16 v[152:155], a[48:51], a[240:243], v[152:155]
    v_mfma_f32_16x16x32_bf16 v[180:183], a[4:7], a[180:183], 0
    buffer_load_dwordx4 a[196:199], v9, s[12:15], s56 offen offset:1024 sc1
    v_mfma_f32_16x16x32_bf16 v[180:183], a[20:23], a[200:203], v[180:183]
    v_mfma_f32_16x16x32_bf16 v[180:183], a[36:39], a[220:223], v[180:183]
    s_waitcnt lgkmcnt(0)
    s_barrier
    v_mfma_f32_16x16x32_bf16 v[180:183], a[52:55], a[240:243], v[180:183]
    v_mfma_f32_16x16x32_bf16 v[184:187], a[8:11], a[180:183], 0
    buffer_load_dwordx4 a[216:219], v9, s[12:15], s56 offen offset:2048 sc1
    v_mfma_f32_16x16x32_bf16 v[184:187], a[24:27], a[200:203], v[184:187]
    ds_read_b128 v[48:51], v29
    v_mfma_f32_16x16x32_bf16 v[184:187], a[40:43], a[220:223], v[184:187]
    ds_read_b128 v[52:55], v30 offset:17408
    v_mfma_f32_16x16x32_bf16 v[184:187], a[56:59], a[240:243], v[184:187]
    ds_read_b128 v[56:59], v31 offset:34816
    v_mfma_f32_16x16x32_bf16 v[188:191], a[12:15], a[180:183], 0
    buffer_load_dwordx4 a[236:239], v9, s[12:15], s56 offen offset:3072 sc1
    v_mfma_f32_16x16x32_bf16 v[188:191], a[28:31], a[200:203], v[188:191]
    v_mfma_f32_16x16x32_bf16 v[188:191], a[44:47], a[220:223], v[188:191]
    v_mfma_f32_16x16x32_bf16 v[188:191], a[60:63], a[240:243], v[188:191]
    s_waitcnt vmcnt(15)
    v_mfma_f32_16x16x32_bf16 v[156:159], a[0:3], a[184:187], 0
    buffer_load_dwordx4 a[180:183], v9, s[12:15], s57 offen sc1
    s_waitcnt vmcnt(15)
    v_mfma_f32_16x16x32_bf16 v[156:159], a[16:19], a[204:207], v[156:159]
    s_waitcnt vmcnt(14)
    v_mfma_f32_16x16x32_bf16 v[156:159], a[32:35], a[224:227], v[156:159]
    s_waitcnt vmcnt(13)
    v_mfma_f32_16x16x32_bf16 v[156:159], a[48:51], a[244:247], v[156:159]
    v_mfma_f32_16x16x32_bf16 v[192:195], a[4:7], a[184:187], 0
    buffer_load_dwordx4 a[200:203], v9, s[12:15], s57 offen offset:1024 sc1
    s_waitcnt lgkmcnt(0)
    v_add_f32 v128, v128, v48
    v_add_f32 v52, v52, v56
    v_mfma_f32_16x16x32_bf16 v[192:195], a[20:23], a[204:207], v[192:195]
    v_add_f32 v129, v129, v49
    v_add_f32 v53, v53, v57
    v_mfma_f32_16x16x32_bf16 v[192:195], a[36:39], a[224:227], v[192:195]
    v_add_f32 v130, v130, v50
    v_add_f32 v54, v54, v58
    v_mfma_f32_16x16x32_bf16 v[192:195], a[52:55], a[244:247], v[192:195]
    v_add_f32 v131, v131, v51
    v_add_f32 v55, v55, v59
    v_mfma_f32_16x16x32_bf16 v[196:199], a[8:11], a[184:187], 0
    buffer_load_dwordx4 a[220:223], v9, s[12:15], s57 offen offset:2048 sc1
    v_add_f32 v128, v128, v52
    v_add_f32 v129, v129, v53
    v_mfma_f32_16x16x32_bf16 v[196:199], a[24:27], a[204:207], v[196:199]
    v_add_f32 v130, v130, v54
    v_add_f32 v131, v131, v55
    v_mfma_f32_16x16x32_bf16 v[196:199], a[40:43], a[224:227], v[196:199]
    buffer_store_dwordx4 v[128:131], v37, s[16:19], 0 offen sc1
    v_mfma_f32_16x16x32_bf16 v[196:199], a[56:59], a[244:247], v[196:199]
    v_mfma_f32_16x16x32_bf16 v[200:203], a[12:15], a[184:187], 0
    buffer_load_dwordx4 a[240:243], v9, s[12:15], s57 offen offset:3072 sc1
    v_mfma_f32_16x16x32_bf16 v[200:203], a[28:31], a[204:207], v[200:203]
    ds_read_b128 v[244:247], v29 offset:1024
    v_mfma_f32_16x16x32_bf16 v[200:203], a[44:47], a[224:227], v[200:203]
    ds_read_b128 v[248:251], v30 offset:18432
    v_mfma_f32_16x16x32_bf16 v[200:203], a[60:63], a[244:247], v[200:203]
    ds_read_b128 v[252:255], v31 offset:35840
    s_waitcnt vmcnt(16)
    v_mfma_f32_16x16x32_bf16 v[160:163], a[0:3], a[188:191], 0
    buffer_load_dwordx4 a[184:187], v9, s[12:15], s58 offen sc1
    s_waitcnt vmcnt(16)
    v_mfma_f32_16x16x32_bf16 v[160:163], a[16:19], a[208:211], v[160:163]
    s_waitcnt vmcnt(15)
    v_mfma_f32_16x16x32_bf16 v[160:163], a[32:35], a[228:231], v[160:163]
    s_waitcnt vmcnt(14)
    v_mfma_f32_16x16x32_bf16 v[160:163], a[48:51], a[248:251], v[160:163]
    v_mfma_f32_16x16x32_bf16 v[204:207], a[4:7], a[188:191], 0
    buffer_load_dwordx4 a[204:207], v9, s[12:15], s58 offen offset:1024 sc1
    v_mfma_f32_16x16x32_bf16 v[204:207], a[20:23], a[208:211], v[204:207]
    v_mfma_f32_16x16x32_bf16 v[204:207], a[36:39], a[228:231], v[204:207]
    v_mfma_f32_16x16x32_bf16 v[204:207], a[52:55], a[248:251], v[204:207]
    v_mfma_f32_16x16x32_bf16 v[208:211], a[8:11], a[188:191], 0
    buffer_load_dwordx4 a[224:227], v9, s[12:15], s58 offen offset:2048 sc1
    s_waitcnt lgkmcnt(0)
    v_add_f32 v132, v132, v244
    v_add_f32 v248, v248, v252
    v_mfma_f32_16x16x32_bf16 v[208:211], a[24:27], a[208:211], v[208:211]
    v_add_f32 v133, v133, v245
    v_add_f32 v249, v249, v253
    v_mfma_f32_16x16x32_bf16 v[208:211], a[40:43], a[228:231], v[208:211]
    v_add_f32 v134, v134, v246
    v_add_f32 v250, v250, v254
    v_mfma_f32_16x16x32_bf16 v[208:211], a[56:59], a[248:251], v[208:211]
    v_add_f32 v135, v135, v247
    v_add_f32 v251, v251, v255
    v_mfma_f32_16x16x32_bf16 v[212:215], a[12:15], a[188:191], 0
    buffer_load_dwordx4 a[244:247], v9, s[12:15], s58 offen offset:3072 sc1
    v_add_f32 v132, v132, v248
    v_add_f32 v133, v133, v249
    v_mfma_f32_16x16x32_bf16 v[212:215], a[28:31], a[208:211], v[212:215]
    v_add_f32 v134, v134, v250
    v_add_f32 v135, v135, v251
    v_mfma_f32_16x16x32_bf16 v[212:215], a[44:47], a[228:231], v[212:215]
    buffer_store_dwordx4 v[132:135], v37, s[16:19], 0 offen offset:1024 sc1
    v_mfma_f32_16x16x32_bf16 v[212:215], a[60:63], a[248:251], v[212:215]
    s_waitcnt vmcnt(17)
    v_mfma_f32_16x16x32_bf16 v[164:167], a[0:3], a[192:195], 0
    buffer_load_dwordx4 a[188:191], v9, s[12:15], s59 offen sc1
    s_waitcnt vmcnt(17)
    v_mfma_f32_16x16x32_bf16 v[164:167], a[16:19], a[212:215], v[164:167]
    ds_read_b128 v[48:51], v29 offset:2048
    s_waitcnt vmcnt(16)
    v_mfma_f32_16x16x32_bf16 v[164:167], a[32:35], a[232:235], v[164:167]
    ds_read_b128 v[52:55], v30 offset:19456
    s_waitcnt vmcnt(15)
    v_mfma_f32_16x16x32_bf16 v[164:167], a[48:51], a[252:255], v[164:167]
    ds_read_b128 v[56:59], v31 offset:49152
    v_mfma_f32_16x16x32_bf16 v[216:219], a[4:7], a[192:195], 0
    buffer_load_dwordx4 a[208:211], v9, s[12:15], s59 offen offset:1024 sc1
    v_mfma_f32_16x16x32_bf16 v[216:219], a[20:23], a[212:215], v[216:219]
    v_mfma_f32_16x16x32_bf16 v[216:219], a[36:39], a[232:235], v[216:219]
    v_mfma_f32_16x16x32_bf16 v[216:219], a[52:55], a[252:255], v[216:219]
    v_mfma_f32_16x16x32_bf16 v[220:223], a[8:11], a[192:195], 0
    buffer_load_dwordx4 a[228:231], v9, s[12:15], s59 offen offset:2048 sc1
    v_mfma_f32_16x16x32_bf16 v[220:223], a[24:27], a[212:215], v[220:223]
    v_mfma_f32_16x16x32_bf16 v[220:223], a[40:43], a[232:235], v[220:223]
    v_mfma_f32_16x16x32_bf16 v[220:223], a[56:59], a[252:255], v[220:223]
    v_mfma_f32_16x16x32_bf16 v[224:227], a[12:15], a[192:195], 0
    buffer_load_dwordx4 a[248:251], v9, s[12:15], s59 offen offset:3072 sc1
    s_waitcnt lgkmcnt(0)
    v_add_f32 v136, v136, v48
    v_add_f32 v52, v52, v56
    v_mfma_f32_16x16x32_bf16 v[224:227], a[28:31], a[212:215], v[224:227]
    v_add_f32 v137, v137, v49
    v_add_f32 v53, v53, v57
    v_mfma_f32_16x16x32_bf16 v[224:227], a[44:47], a[232:235], v[224:227]
    v_add_f32 v138, v138, v50
    v_add_f32 v54, v54, v58
    v_mfma_f32_16x16x32_bf16 v[224:227], a[60:63], a[252:255], v[224:227]
    v_add_f32 v139, v139, v51
    v_add_f32 v55, v55, v59
    s_waitcnt vmcnt(17)
    v_mfma_f32_16x16x32_bf16 v[148:151], a[64:67], a[176:179], v[148:151]
    buffer_load_dwordx4 a[192:195], v9, s[12:15], s60 offen sc1
    v_add_f32 v136, v136, v52
    v_add_f32 v137, v137, v53
    s_waitcnt vmcnt(17)
    v_mfma_f32_16x16x32_bf16 v[148:151], a[80:83], a[196:199], v[148:151]
    v_add_f32 v138, v138, v54
    v_add_f32 v139, v139, v55
    s_waitcnt vmcnt(16)
    v_mfma_f32_16x16x32_bf16 v[148:151], a[96:99], a[216:219], v[148:151]
    buffer_store_dwordx4 v[136:139], v37, s[16:19], 0 offen offset:2048 sc1
    s_waitcnt vmcnt(16)
    v_mfma_f32_16x16x32_bf16 v[148:151], a[112:115], a[236:239], v[148:151]
    v_mfma_f32_16x16x32_bf16 v[168:171], a[68:71], a[176:179], v[168:171]
    buffer_load_dwordx4 a[212:215], v9, s[12:15], s60 offen offset:1024 sc1
    v_mfma_f32_16x16x32_bf16 v[168:171], a[84:87], a[196:199], v[168:171]
    ds_read_b128 v[244:247], v29 offset:3072
    v_mfma_f32_16x16x32_bf16 v[168:171], a[100:103], a[216:219], v[168:171]
    ds_read_b128 v[248:251], v30 offset:32768
    v_mfma_f32_16x16x32_bf16 v[168:171], a[116:119], a[236:239], v[168:171]
    ds_read_b128 v[252:255], v31 offset:50176
    v_mfma_f32_16x16x32_bf16 v[172:175], a[72:75], a[176:179], v[172:175]
    buffer_load_dwordx4 a[232:235], v9, s[12:15], s60 offen offset:2048 sc1
    v_mfma_f32_16x16x32_bf16 v[172:175], a[88:91], a[196:199], v[172:175]
    v_mfma_f32_16x16x32_bf16 v[172:175], a[104:107], a[216:219], v[172:175]
    v_mfma_f32_16x16x32_bf16 v[172:175], a[120:123], a[236:239], v[172:175]
    v_mfma_f32_16x16x32_bf16 v[176:179], a[76:79], a[176:179], v[176:179]
    buffer_load_dwordx4 a[252:255], v9, s[12:15], s60 offen offset:3072 sc1
    v_mfma_f32_16x16x32_bf16 v[176:179], a[92:95], a[196:199], v[176:179]
    v_mfma_f32_16x16x32_bf16 v[176:179], a[108:111], a[216:219], v[176:179]
    v_mfma_f32_16x16x32_bf16 v[176:179], a[124:127], a[236:239], v[176:179]
    s_waitcnt vmcnt(18)
    v_mfma_f32_16x16x32_bf16 v[152:155], a[64:67], a[180:183], v[152:155]
    buffer_load_dwordx4 a[176:179], v10, s[12:15], s56 offen sc1
    s_waitcnt lgkmcnt(0)
    v_add_f32 v140, v140, v244
    v_add_f32 v248, v248, v252
    s_waitcnt vmcnt(18)
    v_mfma_f32_16x16x32_bf16 v[152:155], a[80:83], a[200:203], v[152:155]
    v_add_f32 v141, v141, v245
    v_add_f32 v249, v249, v253
    s_waitcnt vmcnt(17)
    v_mfma_f32_16x16x32_bf16 v[152:155], a[96:99], a[220:223], v[152:155]
    v_add_f32 v142, v142, v246
    v_add_f32 v250, v250, v254
    s_waitcnt vmcnt(15)
    v_mfma_f32_16x16x32_bf16 v[152:155], a[112:115], a[240:243], v[152:155]
    v_add_f32 v143, v143, v247
    v_add_f32 v251, v251, v255
    v_mfma_f32_16x16x32_bf16 v[180:183], a[68:71], a[180:183], v[180:183]
    buffer_load_dwordx4 a[196:199], v10, s[12:15], s56 offen offset:1024 sc1
    v_add_f32 v140, v140, v248
    v_add_f32 v141, v141, v249
    v_mfma_f32_16x16x32_bf16 v[180:183], a[84:87], a[200:203], v[180:183]
    v_add_f32 v142, v142, v250
    v_add_f32 v143, v143, v251
    v_mfma_f32_16x16x32_bf16 v[180:183], a[100:103], a[220:223], v[180:183]
    buffer_store_dwordx4 v[140:143], v37, s[16:19], 0 offen offset:3072 sc1
    v_mfma_f32_16x16x32_bf16 v[180:183], a[116:119], a[240:243], v[180:183]
    v_mfma_f32_16x16x32_bf16 v[184:187], a[72:75], a[180:183], v[184:187]
    buffer_load_dwordx4 a[216:219], v10, s[12:15], s56 offen offset:2048 sc1
    v_mfma_f32_16x16x32_bf16 v[184:187], a[88:91], a[200:203], v[184:187]
    ds_read_b128 v[48:51], v29 offset:16384
    v_mfma_f32_16x16x32_bf16 v[184:187], a[104:107], a[220:223], v[184:187]
    ds_read_b128 v[52:55], v30 offset:33792
    v_mfma_f32_16x16x32_bf16 v[184:187], a[120:123], a[240:243], v[184:187]
    ds_read_b128 v[56:59], v31 offset:51200
    v_mfma_f32_16x16x32_bf16 v[188:191], a[76:79], a[180:183], v[188:191]
    buffer_load_dwordx4 a[236:239], v10, s[12:15], s56 offen offset:3072 sc1
    v_mfma_f32_16x16x32_bf16 v[188:191], a[92:95], a[200:203], v[188:191]
    v_mfma_f32_16x16x32_bf16 v[188:191], a[108:111], a[220:223], v[188:191]
    v_mfma_f32_16x16x32_bf16 v[188:191], a[124:127], a[240:243], v[188:191]
    s_waitcnt vmcnt(18)
    v_mfma_f32_16x16x32_bf16 v[156:159], a[64:67], a[184:187], v[156:159]
    buffer_load_dwordx4 a[180:183], v10, s[12:15], s57 offen sc1
    s_waitcnt vmcnt(18)
    v_mfma_f32_16x16x32_bf16 v[156:159], a[80:83], a[204:207], v[156:159]
    s_waitcnt vmcnt(17)
    v_mfma_f32_16x16x32_bf16 v[156:159], a[96:99], a[224:227], v[156:159]
    s_waitcnt vmcnt(16)
    v_mfma_f32_16x16x32_bf16 v[156:159], a[112:115], a[244:247], v[156:159]
    v_mfma_f32_16x16x32_bf16 v[192:195], a[68:71], a[184:187], v[192:195]
    buffer_load_dwordx4 a[200:203], v10, s[12:15], s57 offen offset:1024 sc1
    s_waitcnt lgkmcnt(0)
    v_add_f32 v144, v144, v48
    v_add_f32 v52, v52, v56
    v_mfma_f32_16x16x32_bf16 v[192:195], a[84:87], a[204:207], v[192:195]
    v_add_f32 v145, v145, v49
    v_add_f32 v53, v53, v57
    v_mfma_f32_16x16x32_bf16 v[192:195], a[100:103], a[224:227], v[192:195]
    v_add_f32 v146, v146, v50
    v_add_f32 v54, v54, v58
    v_mfma_f32_16x16x32_bf16 v[192:195], a[116:119], a[244:247], v[192:195]
    v_add_f32 v147, v147, v51
    v_add_f32 v55, v55, v59
    v_mfma_f32_16x16x32_bf16 v[196:199], a[72:75], a[184:187], v[196:199]
    buffer_load_dwordx4 a[220:223], v10, s[12:15], s57 offen offset:2048 sc1
    v_add_f32 v144, v144, v52
    v_add_f32 v145, v145, v53
    v_mfma_f32_16x16x32_bf16 v[196:199], a[88:91], a[204:207], v[196:199]
    v_add_f32 v146, v146, v54
    v_add_f32 v147, v147, v55
    v_mfma_f32_16x16x32_bf16 v[196:199], a[104:107], a[224:227], v[196:199]
    buffer_store_dwordx4 v[144:147], v37, s[16:19], s64 offen sc1
    v_mfma_f32_16x16x32_bf16 v[196:199], a[120:123], a[244:247], v[196:199]
    v_mfma_f32_16x16x32_bf16 v[200:203], a[76:79], a[184:187], v[200:203]
    buffer_load_dwordx4 a[240:243], v10, s[12:15], s57 offen offset:3072 sc1
    v_mfma_f32_16x16x32_bf16 v[200:203], a[92:95], a[204:207], v[200:203]
    v_mfma_f32_16x16x32_bf16 v[200:203], a[108:111], a[224:227], v[200:203]
    v_mfma_f32_16x16x32_bf16 v[200:203], a[124:127], a[244:247], v[200:203]
    s_waitcnt vmcnt(18)
    v_mfma_f32_16x16x32_bf16 v[160:163], a[64:67], a[188:191], v[160:163]
    buffer_load_dwordx4 a[184:187], v10, s[12:15], s58 offen sc1
    s_waitcnt vmcnt(18)
    v_mfma_f32_16x16x32_bf16 v[160:163], a[80:83], a[208:211], v[160:163]
    s_waitcnt vmcnt(17)
    v_mfma_f32_16x16x32_bf16 v[160:163], a[96:99], a[228:231], v[160:163]
    s_waitcnt vmcnt(16)
    v_mfma_f32_16x16x32_bf16 v[160:163], a[112:115], a[248:251], v[160:163]
    v_mfma_f32_16x16x32_bf16 v[204:207], a[68:71], a[188:191], v[204:207]
    buffer_load_dwordx4 a[204:207], v10, s[12:15], s58 offen offset:1024 sc1
    v_mfma_f32_16x16x32_bf16 v[204:207], a[84:87], a[208:211], v[204:207]
    v_mfma_f32_16x16x32_bf16 v[204:207], a[100:103], a[228:231], v[204:207]
    v_mfma_f32_16x16x32_bf16 v[204:207], a[116:119], a[248:251], v[204:207]
    v_mfma_f32_16x16x32_bf16 v[208:211], a[72:75], a[188:191], v[208:211]
    buffer_load_dwordx4 a[224:227], v10, s[12:15], s58 offen offset:2048 sc1
    v_mfma_f32_16x16x32_bf16 v[208:211], a[88:91], a[208:211], v[208:211]
    v_mfma_f32_16x16x32_bf16 v[208:211], a[104:107], a[228:231], v[208:211]
    v_mfma_f32_16x16x32_bf16 v[208:211], a[120:123], a[248:251], v[208:211]
    v_mfma_f32_16x16x32_bf16 v[212:215], a[76:79], a[188:191], v[212:215]
    buffer_load_dwordx4 a[244:247], v10, s[12:15], s58 offen offset:3072 sc1
    v_mfma_f32_16x16x32_bf16 v[212:215], a[92:95], a[208:211], v[212:215]
    v_mfma_f32_16x16x32_bf16 v[212:215], a[108:111], a[228:231], v[212:215]
    v_mfma_f32_16x16x32_bf16 v[212:215], a[124:127], a[248:251], v[212:215]
    s_waitcnt vmcnt(18)
    v_mfma_f32_16x16x32_bf16 v[164:167], a[64:67], a[192:195], v[164:167]
    buffer_load_dwordx4 a[188:191], v10, s[12:15], s59 offen sc1
    s_waitcnt vmcnt(17)
    v_mfma_f32_16x16x32_bf16 v[164:167], a[80:83], a[212:215], v[164:167]
    s_waitcnt vmcnt(16)
    v_mfma_f32_16x16x32_bf16 v[164:167], a[96:99], a[232:235], v[164:167]
    s_waitcnt vmcnt(15)
    v_mfma_f32_16x16x32_bf16 v[164:167], a[112:115], a[252:255], v[164:167]
    v_mfma_f32_16x16x32_bf16 v[216:219], a[68:71], a[192:195], v[216:219]
    buffer_load_dwordx4 a[208:211], v10, s[12:15], s59 offen offset:1024 sc1
    v_mfma_f32_16x16x32_bf16 v[216:219], a[84:87], a[212:215], v[216:219]
    v_mfma_f32_16x16x32_bf16 v[216:219], a[100:103], a[232:235], v[216:219]
    v_mfma_f32_16x16x32_bf16 v[216:219], a[116:119], a[252:255], v[216:219]
    v_mfma_f32_16x16x32_bf16 v[220:223], a[72:75], a[192:195], v[220:223]
    buffer_load_dwordx4 a[228:231], v10, s[12:15], s59 offen offset:2048 sc1
    v_mfma_f32_16x16x32_bf16 v[220:223], a[88:91], a[212:215], v[220:223]
    v_mfma_f32_16x16x32_bf16 v[220:223], a[104:107], a[232:235], v[220:223]
    v_mfma_f32_16x16x32_bf16 v[220:223], a[120:123], a[252:255], v[220:223]
    v_mfma_f32_16x16x32_bf16 v[224:227], a[76:79], a[192:195], v[224:227]
    buffer_load_dwordx4 a[248:251], v10, s[12:15], s59 offen offset:3072 sc1
    v_mfma_f32_16x16x32_bf16 v[224:227], a[92:95], a[212:215], v[224:227]
    v_mfma_f32_16x16x32_bf16 v[224:227], a[108:111], a[232:235], v[224:227]
    v_mfma_f32_16x16x32_bf16 v[224:227], a[124:127], a[252:255], v[224:227]
    s_waitcnt vmcnt(17)
    v_mfma_f32_16x16x32_bf16 v[148:151], a[128:131], a[176:179], v[148:151]
    buffer_load_dwordx4 a[192:195], v10, s[12:15], s60 offen sc1
    s_waitcnt vmcnt(17)
    v_mfma_f32_16x16x32_bf16 v[148:151], a[144:147], a[196:199], v[148:151]
    s_waitcnt vmcnt(15)
    v_mfma_f32_16x16x32_bf16 v[148:151], a[160:163], a[216:219], v[148:151]
    s_waitcnt vmcnt(14)
    v_mfma_f32_16x16x32_bf16 v[148:151], v[80:83], a[236:239], v[148:151]
    v_mfma_f32_16x16x32_bf16 v[168:171], a[132:135], a[176:179], v[168:171]
    buffer_load_dwordx4 a[212:215], v10, s[12:15], s60 offen offset:1024 sc1
    v_mfma_f32_16x16x32_bf16 v[168:171], a[148:151], a[196:199], v[168:171]
    v_mfma_f32_16x16x32_bf16 v[168:171], a[164:167], a[216:219], v[168:171]
    v_mfma_f32_16x16x32_bf16 v[168:171], v[84:87], a[236:239], v[168:171]
    v_mfma_f32_16x16x32_bf16 v[172:175], a[136:139], a[176:179], v[172:175]
    buffer_load_dwordx4 a[232:235], v10, s[12:15], s60 offen offset:2048 sc1
    v_mfma_f32_16x16x32_bf16 v[172:175], a[152:155], a[196:199], v[172:175]
    v_mfma_f32_16x16x32_bf16 v[172:175], a[168:171], a[216:219], v[172:175]
    v_mfma_f32_16x16x32_bf16 v[172:175], v[88:91], a[236:239], v[172:175]
    v_mfma_f32_16x16x32_bf16 v[176:179], a[140:143], a[176:179], v[176:179]
    buffer_load_dwordx4 a[252:255], v10, s[12:15], s60 offen offset:3072 sc1
    v_mfma_f32_16x16x32_bf16 v[176:179], a[156:159], a[196:199], v[176:179]
    v_mfma_f32_16x16x32_bf16 v[176:179], a[172:175], a[216:219], v[176:179]
    v_mfma_f32_16x16x32_bf16 v[176:179], v[92:95], a[236:239], v[176:179]
    s_waitcnt vmcnt(16)
    v_mfma_f32_16x16x32_bf16 v[152:155], a[128:131], a[180:183], v[152:155]
    buffer_load_dwordx4 a[176:179], v11, s[12:15], s56 offen sc1
    s_waitcnt vmcnt(16)
    v_mfma_f32_16x16x32_bf16 v[152:155], a[144:147], a[200:203], v[152:155]
    s_waitcnt vmcnt(15)
    v_mfma_f32_16x16x32_bf16 v[152:155], a[160:163], a[220:223], v[152:155]
    s_waitcnt vmcnt(13)
    v_mfma_f32_16x16x32_bf16 v[152:155], v[80:83], a[240:243], v[152:155]
    s_mov_b64 exec, 1
    buffer_store_dword v44, v38, s[32:35], 0 offen sc1
    s_mov_b64 exec, -1
    v_mfma_f32_16x16x32_bf16 v[180:183], a[132:135], a[180:183], v[180:183]
    buffer_load_dwordx4 a[196:199], v11, s[12:15], s56 offen offset:1024 sc1
    v_mfma_f32_16x16x32_bf16 v[180:183], a[148:151], a[200:203], v[180:183]
    v_mfma_f32_16x16x32_bf16 v[180:183], a[164:167], a[220:223], v[180:183]
    v_mfma_f32_16x16x32_bf16 v[180:183], v[84:87], a[240:243], v[180:183]
    v_mfma_f32_16x16x32_bf16 v[184:187], a[136:139], a[180:183], v[184:187]
    buffer_load_dwordx4 a[216:219], v11, s[12:15], s56 offen offset:2048 sc1
    v_mfma_f32_16x16x32_bf16 v[184:187], a[152:155], a[200:203], v[184:187]
    v_mfma_f32_16x16x32_bf16 v[184:187], a[168:171], a[220:223], v[184:187]
    v_mfma_f32_16x16x32_bf16 v[184:187], v[88:91], a[240:243], v[184:187]
    v_mfma_f32_16x16x32_bf16 v[188:191], a[140:143], a[180:183], v[188:191]
    buffer_load_dwordx4 a[236:239], v11, s[12:15], s56 offen offset:3072 sc1
    v_mfma_f32_16x16x32_bf16 v[188:191], a[156:159], a[200:203], v[188:191]
    v_mfma_f32_16x16x32_bf16 v[188:191], a[172:175], a[220:223], v[188:191]
    v_mfma_f32_16x16x32_bf16 v[188:191], v[92:95], a[240:243], v[188:191]
    s_waitcnt vmcnt(15)
    v_mfma_f32_16x16x32_bf16 v[156:159], a[128:131], a[184:187], v[156:159]
    buffer_load_dwordx4 a[180:183], v11, s[12:15], s57 offen sc1
    s_waitcnt vmcnt(15)
    v_mfma_f32_16x16x32_bf16 v[156:159], a[144:147], a[204:207], v[156:159]
    s_waitcnt vmcnt(14)
    v_mfma_f32_16x16x32_bf16 v[156:159], a[160:163], a[224:227], v[156:159]
    s_waitcnt vmcnt(13)
    v_mfma_f32_16x16x32_bf16 v[156:159], v[80:83], a[244:247], v[156:159]
    v_mfma_f32_16x16x32_bf16 v[192:195], a[132:135], a[184:187], v[192:195]
    buffer_load_dwordx4 a[200:203], v11, s[12:15], s57 offen offset:1024 sc1
    v_mfma_f32_16x16x32_bf16 v[192:195], a[148:151], a[204:207], v[192:195]
    v_mfma_f32_16x16x32_bf16 v[192:195], a[164:167], a[224:227], v[192:195]
    v_mfma_f32_16x16x32_bf16 v[192:195], v[84:87], a[244:247], v[192:195]
    v_mfma_f32_16x16x32_bf16 v[196:199], a[136:139], a[184:187], v[196:199]
    buffer_load_dwordx4 a[220:223], v11, s[12:15], s57 offen offset:2048 sc1
    v_mfma_f32_16x16x32_bf16 v[196:199], a[152:155], a[204:207], v[196:199]
    v_mfma_f32_16x16x32_bf16 v[196:199], a[168:171], a[224:227], v[196:199]
    v_mfma_f32_16x16x32_bf16 v[196:199], v[88:91], a[244:247], v[196:199]
    v_mfma_f32_16x16x32_bf16 v[200:203], a[140:143], a[184:187], v[200:203]
    buffer_load_dwordx4 a[240:243], v11, s[12:15], s57 offen offset:3072 sc1
    v_mfma_f32_16x16x32_bf16 v[200:203], a[156:159], a[204:207], v[200:203]
    v_mfma_f32_16x16x32_bf16 v[200:203], a[172:175], a[224:227], v[200:203]
    v_mfma_f32_16x16x32_bf16 v[200:203], v[92:95], a[244:247], v[200:203]
    s_waitcnt vmcnt(15)
    v_mfma_f32_16x16x32_bf16 v[160:163], a[128:131], a[188:191], v[160:163]
    buffer_load_dwordx4 a[184:187], v11, s[12:15], s58 offen sc1
    s_waitcnt vmcnt(15)
    v_mfma_f32_16x16x32_bf16 v[160:163], a[144:147], a[208:211], v[160:163]
    s_waitcnt vmcnt(14)
    v_mfma_f32_16x16x32_bf16 v[160:163], a[160:163], a[228:231], v[160:163]
    s_waitcnt vmcnt(13)
    v_mfma_f32_16x16x32_bf16 v[160:163], v[80:83], a[248:251], v[160:163]
    v_mfma_f32_16x16x32_bf16 v[204:207], a[132:135], a[188:191], v[204:207]
    buffer_load_dwordx4 a[204:207], v11, s[12:15], s58 offen offset:1024 sc1
    v_mfma_f32_16x16x32_bf16 v[204:207], a[148:151], a[208:211], v[204:207]
    v_mfma_f32_16x16x32_bf16 v[204:207], a[164:167], a[228:231], v[204:207]
    v_mfma_f32_16x16x32_bf16 v[204:207], v[84:87], a[248:251], v[204:207]
    v_mfma_f32_16x16x32_bf16 v[208:211], a[136:139], a[188:191], v[208:211]
    buffer_load_dwordx4 a[224:227], v11, s[12:15], s58 offen offset:2048 sc1
    v_mfma_f32_16x16x32_bf16 v[208:211], a[152:155], a[208:211], v[208:211]
    v_mfma_f32_16x16x32_bf16 v[208:211], a[168:171], a[228:231], v[208:211]
    v_mfma_f32_16x16x32_bf16 v[208:211], v[88:91], a[248:251], v[208:211]
    buffer_load_dword v4, v39, s[32:35], 0 offen sc1
    s_mov_b32 s66, 0x40000
    v_mfma_f32_16x16x32_bf16 v[212:215], a[140:143], a[188:191], v[212:215]
    buffer_load_dwordx4 a[244:247], v11, s[12:15], s58 offen offset:3072 sc1
    v_mfma_f32_16x16x32_bf16 v[212:215], a[156:159], a[208:211], v[212:215]
    v_mfma_f32_16x16x32_bf16 v[212:215], a[172:175], a[228:231], v[212:215]
    v_mfma_f32_16x16x32_bf16 v[212:215], v[92:95], a[248:251], v[212:215]
    s_waitcnt vmcnt(16)
    v_mfma_f32_16x16x32_bf16 v[164:167], a[128:131], a[192:195], v[164:167]
    buffer_load_dwordx4 a[188:191], v11, s[12:15], s59 offen sc1
    s_waitcnt vmcnt(16)
    v_mfma_f32_16x16x32_bf16 v[164:167], a[144:147], a[212:215], v[164:167]
    s_waitcnt vmcnt(15)
    v_mfma_f32_16x16x32_bf16 v[164:167], a[160:163], a[232:235], v[164:167]
    s_waitcnt vmcnt(14)
    v_mfma_f32_16x16x32_bf16 v[164:167], v[80:83], a[252:255], v[164:167]
    v_mfma_f32_16x16x32_bf16 v[216:219], a[132:135], a[192:195], v[216:219]
    buffer_load_dwordx4 a[208:211], v11, s[12:15], s59 offen offset:1024 sc1
    v_mfma_f32_16x16x32_bf16 v[216:219], a[148:151], a[212:215], v[216:219]
    v_mfma_f32_16x16x32_bf16 v[216:219], a[164:167], a[232:235], v[216:219]
    v_mfma_f32_16x16x32_bf16 v[216:219], v[84:87], a[252:255], v[216:219]
    v_mfma_f32_16x16x32_bf16 v[220:223], a[136:139], a[192:195], v[220:223]
    buffer_load_dwordx4 a[228:231], v11, s[12:15], s59 offen offset:2048 sc1
    v_mfma_f32_16x16x32_bf16 v[220:223], a[152:155], a[212:215], v[220:223]
    v_mfma_f32_16x16x32_bf16 v[220:223], a[168:171], a[232:235], v[220:223]
    v_mfma_f32_16x16x32_bf16 v[220:223], v[88:91], a[252:255], v[220:223]
    v_mfma_f32_16x16x32_bf16 v[224:227], a[140:143], a[192:195], v[224:227]
    buffer_load_dwordx4 a[248:251], v11, s[12:15], s59 offen offset:3072 sc1
    v_mfma_f32_16x16x32_bf16 v[224:227], a[156:159], a[212:215], v[224:227]
    v_mfma_f32_16x16x32_bf16 v[224:227], a[172:175], a[232:235], v[224:227]
    v_mfma_f32_16x16x32_bf16 v[224:227], v[92:95], a[252:255], v[224:227]
    s_waitcnt vmcnt(16)
    v_mfma_f32_16x16x32_bf16 v[148:151], v[112:115], a[176:179], v[148:151]
    buffer_load_dwordx4 a[192:195], v11, s[12:15], s60 offen sc1
    s_waitcnt vmcnt(16)
    v_mfma_f32_16x16x32_bf16 v[148:151], v[228:231], a[196:199], v[148:151]
    s_waitcnt vmcnt(15)
    v_mfma_f32_16x16x32_bf16 v[148:151], v[64:67], a[216:219], v[148:151]
    s_waitcnt vmcnt(14)
    v_mfma_f32_16x16x32_bf16 v[148:151], v[12:15], a[236:239], v[148:151]
    v_mfma_f32_16x16x32_bf16 v[168:171], v[116:119], a[176:179], v[168:171]
    buffer_load_dwordx4 a[212:215], v11, s[12:15], s60 offen offset:1024 sc1
    v_mfma_f32_16x16x32_bf16 v[168:171], v[232:235], a[196:199], v[168:171]
    v_mfma_f32_16x16x32_bf16 v[168:171], v[68:71], a[216:219], v[168:171]
    v_mfma_f32_16x16x32_bf16 v[168:171], v[16:19], a[236:239], v[168:171]
    v_mfma_f32_16x16x32_bf16 v[172:175], v[120:123], a[176:179], v[172:175]
    buffer_load_dwordx4 a[232:235], v11, s[12:15], s60 offen offset:2048 sc1
    v_mfma_f32_16x16x32_bf16 v[172:175], v[236:239], a[196:199], v[172:175]
    v_mfma_f32_16x16x32_bf16 v[172:175], v[72:75], a[216:219], v[172:175]
    v_mfma_f32_16x16x32_bf16 v[172:175], v[20:23], a[236:239], v[172:175]
    v_mfma_f32_16x16x32_bf16 v[176:179], v[124:127], a[176:179], v[176:179]
    buffer_load_dwordx4 a[252:255], v11, s[12:15], s60 offen offset:3072 sc1
    v_mfma_f32_16x16x32_bf16 v[176:179], v[240:243], a[196:199], v[176:179]
    v_mfma_f32_16x16x32_bf16 v[176:179], v[76:79], a[216:219], v[176:179]
    v_mfma_f32_16x16x32_bf16 v[176:179], v[24:27], a[236:239], v[176:179]
    ds_write_b128 v40, v[168:171]
    s_waitcnt vmcnt(16)
    v_mfma_f32_16x16x32_bf16 v[152:155], v[112:115], a[180:183], v[152:155]
    s_waitcnt vmcnt(15)
    v_mfma_f32_16x16x32_bf16 v[152:155], v[228:231], a[200:203], v[152:155]
    s_waitcnt vmcnt(14)
    v_mfma_f32_16x16x32_bf16 v[152:155], v[64:67], a[220:223], v[152:155]
    s_waitcnt vmcnt(13)
    v_mfma_f32_16x16x32_bf16 v[152:155], v[12:15], a[240:243], v[152:155]
    ds_write_b128 v40, v[172:175] offset:17408
    s_waitcnt vmcnt(9)
    v_cmp_ne_u32 vcc, v44, v4
    s_nop 0
    s_cmp_eq_u64 vcc, 0
    s_cbranch_scc1 L_part_go
L_part:
    s_sleep 1
    buffer_load_dword v4, v39, s[32:35], 0 offen sc1
    s_waitcnt vmcnt(0)
    s_sub_u32 s66, s66, 1
    s_cbranch_scc1 L_part_go
    v_cmp_ne_u32 vcc, v44, v4
    s_nop 0
    s_cmp_eq_u64 vcc, 0
    s_cbranch_scc0 L_part
L_part_go:
    v_mfma_f32_16x16x32_bf16 v[180:183], v[116:119], a[180:183], v[180:183]
    v_mfma_f32_16x16x32_bf16 v[180:183], v[232:235], a[200:203], v[180:183]
    s_mov_b32 s67, 0xa000
    s_mov_b32 s68, 0x14000
    v_mfma_f32_16x16x32_bf16 v[180:183], v[68:71], a[220:223], v[180:183]
    buffer_load_dwordx4 v[128:131], v37, s[4:7], 0 offen sc1
    v_add_u32 v29, 0x10000, v29
    v_mfma_f32_16x16x32_bf16 v[180:183], v[16:19], a[240:243], v[180:183]
    ds_write_b128 v40, v[176:179] offset:34816
    v_add_u32 v30, 0x10000, v30
    v_mfma_f32_16x16x32_bf16 v[184:187], v[120:123], a[180:183], v[184:187]
    v_add_u32 v31, 0x10000, v31
    v_mfma_f32_16x16x32_bf16 v[184:187], v[236:239], a[200:203], v[184:187]
    v_mfma_f32_16x16x32_bf16 v[184:187], v[72:75], a[220:223], v[184:187]
    buffer_load_dwordx4 v[132:135], v37, s[4:7], 0 offen offset:1024 sc1
    v_mfma_f32_16x16x32_bf16 v[184:187], v[20:23], a[240:243], v[184:187]
    v_mfma_f32_16x16x32_bf16 v[188:191], v[124:127], a[180:183], v[188:191]
    v_mfma_f32_16x16x32_bf16 v[188:191], v[240:243], a[200:203], v[188:191]
    v_mfma_f32_16x16x32_bf16 v[188:191], v[76:79], a[220:223], v[188:191]
    buffer_load_dwordx4 v[136:139], v37, s[4:7], 0 offen offset:2048 sc1
    v_mfma_f32_16x16x32_bf16 v[188:191], v[24:27], a[240:243], v[188:191]
    ds_write_b128 v40, v[180:183] offset:1024
    v_mfma_f32_16x16x32_bf16 v[156:159], v[112:115], a[184:187], v[156:159]
    v_mfma_f32_16x16x32_bf16 v[156:159], v[228:231], a[204:207], v[156:159]
    v_mfma_f32_16x16x32_bf16 v[156:159], v[64:67], a[224:227], v[156:159]
    buffer_load_dwordx4 v[140:143], v37, s[4:7], 0 offen offset:3072 sc1
    s_waitcnt vmcnt(12)
    v_mfma_f32_16x16x32_bf16 v[156:159], v[12:15], a[244:247], v[156:159]
    ds_write_b128 v40, v[184:187] offset:18432
    v_mfma_f32_16x16x32_bf16 v[192:195], v[116:119], a[184:187], v[192:195]
    v_mfma_f32_16x16x32_bf16 v[192:195], v[232:235], a[204:207], v[192:195]
    v_mfma_f32_16x16x32_bf16 v[192:195], v[68:71], a[224:227], v[192:195]
    buffer_load_dwordx4 v[144:147], v37, s[4:7], s64 offen sc1
    v_mfma_f32_16x16x32_bf16 v[192:195], v[16:19], a[244:247], v[192:195]
    ds_write_b128 v40, v[188:191] offset:35840
    v_mfma_f32_16x16x32_bf16 v[196:199], v[120:123], a[184:187], v[196:199]
    v_mfma_f32_16x16x32_bf16 v[196:199], v[236:239], a[204:207], v[196:199]
    v_mfma_f32_16x16x32_bf16 v[196:199], v[72:75], a[224:227], v[196:199]
    v_mfma_f32_16x16x32_bf16 v[196:199], v[20:23], a[244:247], v[196:199]
    v_mfma_f32_16x16x32_bf16 v[200:203], v[124:127], a[184:187], v[200:203]
    v_mfma_f32_16x16x32_bf16 v[200:203], v[240:243], a[204:207], v[200:203]
    v_mfma_f32_16x16x32_bf16 v[200:203], v[76:79], a[224:227], v[200:203]
    v_mfma_f32_16x16x32_bf16 v[200:203], v[24:27], a[244:247], v[200:203]
    ds_write_b128 v40, v[192:195] offset:2048
    s_waitcnt vmcnt(12)
    v_mfma_f32_16x16x32_bf16 v[160:163], v[112:115], a[188:191], v[160:163]
    s_waitcnt vmcnt(11)
    v_mfma_f32_16x16x32_bf16 v[160:163], v[228:231], a[208:211], v[160:163]
    s_waitcnt vmcnt(10)
    v_mfma_f32_16x16x32_bf16 v[160:163], v[64:67], a[228:231], v[160:163]
    s_waitcnt vmcnt(9)
    v_mfma_f32_16x16x32_bf16 v[160:163], v[12:15], a[248:251], v[160:163]
    ds_write_b128 v40, v[196:199] offset:19456
    v_mfma_f32_16x16x32_bf16 v[204:207], v[116:119], a[188:191], v[204:207]
    v_mfma_f32_16x16x32_bf16 v[204:207], v[232:235], a[208:211], v[204:207]
    v_mfma_f32_16x16x32_bf16 v[204:207], v[68:71], a[228:231], v[204:207]
    v_mfma_f32_16x16x32_bf16 v[204:207], v[16:19], a[248:251], v[204:207]
    ds_write_b128 v40, v[200:203] offset:49152
    v_mfma_f32_16x16x32_bf16 v[208:211], v[120:123], a[188:191], v[208:211]
    v_mfma_f32_16x16x32_bf16 v[208:211], v[236:239], a[208:211], v[208:211]
    v_mfma_f32_16x16x32_bf16 v[208:211], v[72:75], a[228:231], v[208:211]
    v_mfma_f32_16x16x32_bf16 v[208:211], v[20:23], a[248:251], v[208:211]
    v_mfma_f32_16x16x32_bf16 v[212:215], v[124:127], a[188:191], v[212:215]
    v_mfma_f32_16x16x32_bf16 v[212:215], v[240:243], a[208:211], v[212:215]
    v_mfma_f32_16x16x32_bf16 v[212:215], v[76:79], a[228:231], v[212:215]
    v_mfma_f32_16x16x32_bf16 v[212:215], v[24:27], a[248:251], v[212:215]
    ds_write_b128 v40, v[204:207] offset:3072
    s_waitcnt vmcnt(8)
    v_mfma_f32_16x16x32_bf16 v[164:167], v[112:115], a[192:195], v[164:167]
    s_waitcnt vmcnt(7)
    v_mfma_f32_16x16x32_bf16 v[164:167], v[228:231], a[212:215], v[164:167]
    s_waitcnt vmcnt(6)
    v_mfma_f32_16x16x32_bf16 v[164:167], v[64:67], a[232:235], v[164:167]
    s_waitcnt vmcnt(5)
    v_mfma_f32_16x16x32_bf16 v[164:167], v[12:15], a[252:255], v[164:167]
    ds_write_b128 v40, v[208:211] offset:32768
    v_mfma_f32_16x16x32_bf16 v[216:219], v[116:119], a[192:195], v[216:219]
    v_mfma_f32_16x16x32_bf16 v[216:219], v[232:235], a[212:215], v[216:219]
    v_mfma_f32_16x16x32_bf16 v[216:219], v[68:71], a[232:235], v[216:219]
    v_mfma_f32_16x16x32_bf16 v[216:219], v[16:19], a[252:255], v[216:219]
    ds_write_b128 v40, v[212:215] offset:50176
    v_mfma_f32_16x16x32_bf16 v[220:223], v[120:123], a[192:195], v[220:223]
    v_mfma_f32_16x16x32_bf16 v[220:223], v[236:239], a[212:215], v[220:223]
    v_mfma_f32_16x16x32_bf16 v[220:223], v[72:75], a[232:235], v[220:223]
    v_mfma_f32_16x16x32_bf16 v[220:223], v[20:23], a[252:255], v[220:223]
    v_mfma_f32_16x16x32_bf16 v[224:227], v[124:127], a[192:195], v[224:227]
    v_mfma_f32_16x16x32_bf16 v[224:227], v[240:243], a[212:215], v[224:227]
    v_mfma_f32_16x16x32_bf16 v[224:227], v[76:79], a[232:235], v[224:227]
    v_mfma_f32_16x16x32_bf16 v[224:227], v[24:27], a[252:255], v[224:227]
    ds_write_b128 v40, v[216:219] offset:16384
    s_nop 2
    ds_write_b128 v40, v[220:223] offset:33792
    s_nop 2
    ds_write_b128 v40, v[224:227] offset:51200
    s_waitcnt vmcnt(4)
    v_add_f32 v148, v148, v128
    v_add_f32 v149, v149, v129
    v_add_f32 v150, v150, v130
    v_add_f32 v151, v151, v131
    s_waitcnt vmcnt(3)
    v_add_f32 v152, v152, v132
    v_add_f32 v153, v153, v133
    v_add_f32 v154, v154, v134
    v_add_f32 v155, v155, v135
    s_waitcnt vmcnt(2)
    v_add_f32 v156, v156, v136
    v_add_f32 v157, v157, v137
    v_add_f32 v158, v158, v138
    v_add_f32 v159, v159, v139
    s_waitcnt vmcnt(1)
    v_add_f32 v160, v160, v140
    v_add_f32 v161, v161, v141
    v_add_f32 v162, v162, v142
    v_add_f32 v163, v163, v143
    s_waitcnt vmcnt(0)
    v_add_f32 v164, v164, v144
    v_add_f32 v165, v165, v145
    v_add_f32 v166, v166, v146
    v_add_f32 v167, v167, v147
    s_waitcnt lgkmcnt(0)
    s_barrier
    ds_read_b128 v[168:171], v29
    ds_read_b128 v[172:175], v30 offset:17408
    ds_read_b128 v[176:179], v31 offset:34816
    ds_read_b128 v[180:183], v29 offset:1024
    ds_read_b128 v[184:187], v30 offset:18432
    ds_read_b128 v[188:191], v31 offset:35840
    ds_read_b128 v[192:195], v29 offset:2048
    ds_read_b128 v[196:199], v30 offset:19456
    ds_read_b128 v[200:203], v31 offset:49152
    ds_read_b128 v[204:207], v29 offset:3072
    ds_read_b128 v[208:211], v30 offset:32768
    ds_read_b128 v[212:215], v31 offset:50176
    ds_read_b128 v[216:219], v29 offset:16384
    ds_read_b128 v[220:223], v30 offset:33792
    ds_read_b128 v[224:227], v31 offset:51200
    s_waitcnt lgkmcnt(14)
    v_add_f32 v148, v148, v168
    s_waitcnt lgkmcnt(12)
    v_add_f32 v172, v172, v176
    v_add_f32 v149, v149, v169
    v_add_f32 v173, v173, v177
    v_add_f32 v150, v150, v170
    v_add_f32 v174, v174, v178
    v_add_f32 v151, v151, v171
    v_add_f32 v175, v175, v179
    v_add_f32 v148, v148, v172
    v_add_f32 v149, v149, v173
    v_add_f32 v150, v150, v174
    v_add_f32 v151, v151, v175
    v_cvt_pk_bf16_f32 v168, v148, v149
    v_cvt_pk_bf16_f32 v169, v150, v151
    s_waitcnt lgkmcnt(11)
    v_add_f32 v152, v152, v180
    s_waitcnt lgkmcnt(9)
    v_add_f32 v184, v184, v188
    v_add_f32 v153, v153, v181
    v_add_f32 v185, v185, v189
    v_add_f32 v154, v154, v182
    v_add_f32 v186, v186, v190
    v_add_f32 v155, v155, v183
    v_add_f32 v187, v187, v191
    v_add_f32 v152, v152, v184
    v_add_f32 v153, v153, v185
    v_add_f32 v154, v154, v186
    v_add_f32 v155, v155, v187
    v_cvt_pk_bf16_f32 v170, v152, v153
    v_cvt_pk_bf16_f32 v171, v154, v155
    s_nop 0
    v_permlane16_swap_b32 v168, v170
    v_permlane16_swap_b32 v169, v171
    buffer_store_dwordx4 v[168:171], v41, s[28:31], 0 offen
    s_waitcnt lgkmcnt(0)
    v_add_f32 v156, v156, v192
    v_add_f32 v196, v196, v200
    v_add_f32 v157, v157, v193
    v_add_f32 v197, v197, v201
    v_add_f32 v158, v158, v194
    v_add_f32 v198, v198, v202
    v_add_f32 v159, v159, v195
    v_add_f32 v199, v199, v203
    v_add_f32 v156, v156, v196
    v_add_f32 v157, v157, v197
    v_add_f32 v158, v158, v198
    v_add_f32 v159, v159, v199
    v_cvt_pk_bf16_f32 v192, v156, v157
    v_cvt_pk_bf16_f32 v193, v158, v159
    v_add_f32 v160, v160, v204
    v_add_f32 v208, v208, v212
    v_add_f32 v161, v161, v205
    v_add_f32 v209, v209, v213
    v_add_f32 v162, v162, v206
    v_add_f32 v210, v210, v214
    v_add_f32 v163, v163, v207
    v_add_f32 v211, v211, v215
    v_add_f32 v160, v160, v208
    v_add_f32 v161, v161, v209
    v_add_f32 v162, v162, v210
    v_add_f32 v163, v163, v211
    v_cvt_pk_bf16_f32 v194, v160, v161
    v_cvt_pk_bf16_f32 v195, v162, v163
    s_nop 0
    v_permlane16_swap_b32 v192, v194
    v_permlane16_swap_b32 v193, v195
    buffer_store_dwordx4 v[192:195], v41, s[28:31], s67 offen
    v_add_f32 v164, v164, v216
    v_add_f32 v220, v220, v224
    v_add_f32 v165, v165, v217
    v_add_f32 v221, v221, v225
    v_add_f32 v166, v166, v218
    v_add_f32 v222, v222, v226
    v_add_f32 v167, v167, v219
    v_add_f32 v223, v223, v227
    v_add_f32 v164, v164, v220
    v_add_f32 v165, v165, v221
    v_add_f32 v166, v166, v222
    v_add_f32 v167, v167, v223
    v_cvt_pk_bf16_f32 v216, v164, v165
    v_cvt_pk_bf16_f32 v217, v166, v167
    buffer_store_dwordx2 v[216:217], v36, s[28:31], s68 offen
L_end:
    s_endpgm
L_w3:
    ds_read_b64_tr_b16 a[0:1], v48 offset:32768
    ds_read_b64_tr_b16 a[2:3], v48 offset:33792
    ds_read_b64_tr_b16 a[4:5], v48 offset:40960
    ds_read_b64_tr_b16 a[6:7], v48 offset:41984
    ds_read_b128 a[64:67], v62 offset:32768
    ds_read_b128 a[68:71], v63 offset:32768
    ds_read_b128 a[72:75], v62 offset:34816
    ds_read_b128 a[76:79], v63 offset:34816
    ds_read_b128 a[80:83], v62
    ds_read_b128 a[84:87], v63
    ds_read_b64_tr_b16 a[8:9], v49 offset:32768
    ds_read_b64_tr_b16 a[10:11], v49 offset:33792
    ds_read_b64_tr_b16 a[12:13], v49 offset:40960
    ds_read_b64_tr_b16 a[14:15], v49 offset:41984
    s_waitcnt lgkmcnt(9)
    v_mfma_f32_16x16x32_bf16 v[128:131], a[0:3], a[64:67], 0
    ds_read_b64_tr_b16 a[16:17], v50 offset:32768
    s_add_u32 m0, s53, 0x20000
    s_waitcnt lgkmcnt(9)
    v_mfma_f32_16x16x32_bf16 v[128:131], a[4:7], a[68:71], v[128:131]
    ds_read_b64_tr_b16 a[18:19], v50 offset:33792
    s_mov_b32 s65, 0x100000
    s_waitcnt lgkmcnt(9)
    v_mfma_f32_16x16x32_bf16 v[160:163], a[0:3], a[72:75], 0
    ds_read_b64_tr_b16 a[20:21], v50 offset:40960
    buffer_load_dwordx4 v56, s[8:11], s65 offen lds
    s_waitcnt lgkmcnt(9)
    v_mfma_f32_16x16x32_bf16 v[160:163], a[4:7], a[76:79], v[160:163]
    ds_read_b64_tr_b16 a[22:23], v50 offset:41984
    s_waitcnt lgkmcnt(9)
    v_mfma_f32_16x16x32_bf16 v[192:195], a[0:3], a[80:83], 0
    ds_read_b64_tr_b16 a[24:25], v51 offset:32768
    s_waitcnt lgkmcnt(9)
    v_mfma_f32_16x16x32_bf16 v[192:195], a[4:7], a[84:87], v[192:195]
    ds_read_b64_tr_b16 a[26:27], v51 offset:33792
    ds_read_b64_tr_b16 a[28:29], v51 offset:40960
    ds_read_b64_tr_b16 a[30:31], v51 offset:41984
    buffer_load_dwordx4 v57, s[8:11], s65 offen offset:1024 lds
    s_waitcnt lgkmcnt(10)
    v_mfma_f32_16x16x32_bf16 v[132:135], a[8:11], a[64:67], 0
    ds_read_b64_tr_b16 a[32:33], v52 offset:32768
    s_waitcnt lgkmcnt(9)
    v_mfma_f32_16x16x32_bf16 v[132:135], a[12:15], a[68:71], v[132:135]
    ds_read_b64_tr_b16 a[34:35], v52 offset:33792
    v_mfma_f32_16x16x32_bf16 v[164:167], a[8:11], a[72:75], 0
    ds_read_b64_tr_b16 a[36:37], v52 offset:40960
    v_mfma_f32_16x16x32_bf16 v[164:167], a[12:15], a[76:79], v[164:167]
    ds_read_b64_tr_b16 a[38:39], v52 offset:41984
    v_mfma_f32_16x16x32_bf16 v[196:199], a[8:11], a[80:83], 0
    ds_read_b64_tr_b16 a[40:41], v53 offset:32768
    buffer_load_dwordx4 v58, s[8:11], s65 offen offset:2048 lds
    v_mfma_f32_16x16x32_bf16 v[196:199], a[12:15], a[84:87], v[196:199]
    ds_read_b64_tr_b16 a[42:43], v53 offset:33792
    ds_read_b64_tr_b16 a[44:45], v53 offset:40960
    ds_read_b64_tr_b16 a[46:47], v53 offset:41984
    s_waitcnt lgkmcnt(11)
    v_mfma_f32_16x16x32_bf16 v[136:139], a[16:19], a[64:67], 0
    ds_read_b64_tr_b16 a[48:49], v54 offset:32768
    v_mfma_f32_16x16x32_bf16 v[136:139], a[20:23], a[68:71], v[136:139]
    ds_read_b64_tr_b16 a[50:51], v54 offset:33792
    buffer_load_dwordx4 v59, s[8:11], s65 offen offset:3072 lds
    v_mfma_f32_16x16x32_bf16 v[168:171], a[16:19], a[72:75], 0
    ds_read_b64_tr_b16 a[52:53], v54 offset:40960
    v_mfma_f32_16x16x32_bf16 v[168:171], a[20:23], a[76:79], v[168:171]
    ds_read_b64_tr_b16 a[54:55], v54 offset:41984
    s_add_u32 m0, s53, 0x10000
    v_mfma_f32_16x16x32_bf16 v[200:203], a[16:19], a[80:83], 0
    ds_read_b64_tr_b16 a[56:57], v55 offset:32768
    s_mov_b32 s63, 0x100
    v_mfma_f32_16x16x32_bf16 v[200:203], a[20:23], a[84:87], v[200:203]
    ds_read_b64_tr_b16 a[58:59], v55 offset:33792
    buffer_load_dwordx4 v60, s[4:7], s63 offen lds
    ds_read_b64_tr_b16 a[60:61], v55 offset:40960
    ds_read_b64_tr_b16 a[62:63], v55 offset:41984
    s_waitcnt lgkmcnt(11)
    v_mfma_f32_16x16x32_bf16 v[140:143], a[24:27], a[64:67], 0
    v_mfma_f32_16x16x32_bf16 v[140:143], a[28:31], a[68:71], v[140:143]
    v_mfma_f32_16x16x32_bf16 v[172:175], a[24:27], a[72:75], 0
    buffer_load_dwordx4 v61, s[4:7], s63 offen offset:1024 lds
    v_mfma_f32_16x16x32_bf16 v[172:175], a[28:31], a[76:79], v[172:175]
    v_mfma_f32_16x16x32_bf16 v[204:207], a[24:27], a[80:83], 0
    s_waitcnt vmcnt(16) lgkmcnt(0)
    s_barrier
    v_mfma_f32_16x16x32_bf16 v[204:207], a[28:31], a[84:87], v[204:207]
    ds_read_b64_tr_b16 a[0:1], v48
    s_add_u32 m0, s53, 0x10800
    s_mov_b32 s63, 0x5100
    ds_read_b64_tr_b16 a[2:3], v48 offset:1024
    buffer_load_dwordx4 v60, s[4:7], s63 offen lds
    v_mfma_f32_16x16x32_bf16 v[144:147], a[32:35], a[64:67], 0
    v_mfma_f32_16x16x32_bf16 v[144:147], a[36:39], a[68:71], v[144:147]
    ds_read_b64_tr_b16 a[4:5], v48 offset:8192
    v_mfma_f32_16x16x32_bf16 v[176:179], a[32:35], a[72:75], 0
    v_mfma_f32_16x16x32_bf16 v[176:179], a[36:39], a[76:79], v[176:179]
    ds_read_b64_tr_b16 a[6:7], v48 offset:9216
    v_mfma_f32_16x16x32_bf16 v[208:211], a[32:35], a[80:83], 0
    buffer_load_dwordx4 v61, s[4:7], s63 offen offset:1024 lds
    v_mfma_f32_16x16x32_bf16 v[208:211], a[36:39], a[84:87], v[208:211]
    ds_read_b64_tr_b16 a[8:9], v49
    ds_read_b64_tr_b16 a[10:11], v49 offset:1024
    s_add_u32 m0, s53, 0x8000
    v_mfma_f32_16x16x32_bf16 v[148:151], a[40:43], a[64:67], 0
    s_mov_b32 s63, 0xa100
    v_mfma_f32_16x16x32_bf16 v[148:151], a[44:47], a[68:71], v[148:151]
    ds_read_b64_tr_b16 a[12:13], v49 offset:8192
    buffer_load_dwordx4 v60, s[4:7], s63 offen lds
    v_mfma_f32_16x16x32_bf16 v[180:183], a[40:43], a[72:75], 0
    v_mfma_f32_16x16x32_bf16 v[180:183], a[44:47], a[76:79], v[180:183]
    ds_read_b64_tr_b16 a[14:15], v49 offset:9216
    v_mfma_f32_16x16x32_bf16 v[212:215], a[40:43], a[80:83], 0
    s_waitcnt vmcnt(17)
    ds_read_b128 a[96:99], v62 offset:16384
    v_mfma_f32_16x16x32_bf16 v[212:215], a[44:47], a[84:87], v[212:215]
    ds_read_b64_tr_b16 a[16:17], v50
    ds_read_b128 a[100:103], v63 offset:16384
    buffer_load_dwordx4 v61, s[4:7], s63 offen offset:1024 lds
    ds_read_b64_tr_b16 a[18:19], v50 offset:1024
    v_mfma_f32_16x16x32_bf16 v[152:155], a[48:51], a[64:67], 0
    s_waitcnt vmcnt(16)
    ds_read_b128 a[104:107], v62 offset:18432
    v_mfma_f32_16x16x32_bf16 v[152:155], a[52:55], a[68:71], v[152:155]
    ds_read_b64_tr_b16 a[20:21], v50 offset:8192
    v_mfma_f32_16x16x32_bf16 v[184:187], a[48:51], a[72:75], 0
    ds_read_b128 a[108:111], v63 offset:18432
    v_mfma_f32_16x16x32_bf16 v[184:187], a[52:55], a[76:79], v[184:187]
    ds_read_b64_tr_b16 a[22:23], v50 offset:9216
    v_mfma_f32_16x16x32_bf16 v[216:219], a[48:51], a[80:83], 0
    s_waitcnt vmcnt(14)
    ds_read_b128 a[112:115], v62 offset:49152
    v_mfma_f32_16x16x32_bf16 v[216:219], a[52:55], a[84:87], v[216:219]
    ds_read_b64_tr_b16 a[24:25], v51
    ds_read_b128 a[116:119], v63 offset:49152
    ds_read_b64_tr_b16 a[26:27], v51 offset:1024
    v_mfma_f32_16x16x32_bf16 v[156:159], a[56:59], a[64:67], 0
    v_mfma_f32_16x16x32_bf16 v[156:159], a[60:63], a[68:71], v[156:159]
    ds_read_b64_tr_b16 a[28:29], v51 offset:8192
    v_mfma_f32_16x16x32_bf16 v[188:191], a[56:59], a[72:75], 0
    v_mfma_f32_16x16x32_bf16 v[188:191], a[60:63], a[76:79], v[188:191]
    ds_read_b64_tr_b16 a[30:31], v51 offset:9216
    v_mfma_f32_16x16x32_bf16 v[220:223], a[56:59], a[80:83], 0
    v_mfma_f32_16x16x32_bf16 v[220:223], a[60:63], a[84:87], v[220:223]
    s_waitcnt lgkmcnt(6)
    v_mfma_f32_16x16x32_bf16 v[128:131], a[0:3], a[96:99], v[128:131]
    ds_read_b64_tr_b16 a[32:33], v52
    s_add_u32 m0, s53, 0x24000
    v_mfma_f32_16x16x32_bf16 v[128:131], a[4:7], a[100:103], v[128:131]
    ds_read_b64_tr_b16 a[34:35], v52 offset:1024
    s_mov_b32 s65, 0x180000
    v_mfma_f32_16x16x32_bf16 v[160:163], a[0:3], a[104:107], v[160:163]
    ds_read_b64_tr_b16 a[36:37], v52 offset:8192
    buffer_load_dwordx4 v56, s[8:11], s65 offen lds
    v_mfma_f32_16x16x32_bf16 v[160:163], a[4:7], a[108:111], v[160:163]
    s_waitcnt lgkmcnt(4)
    v_mfma_f32_16x16x32_bf16 v[192:195], a[0:3], a[112:115], v[192:195]
    ds_read_b64_tr_b16 a[38:39], v52 offset:9216
    v_mfma_f32_16x16x32_bf16 v[192:195], a[4:7], a[116:119], v[192:195]
    ds_read_b64_tr_b16 a[40:41], v53
    ds_read_b64_tr_b16 a[42:43], v53 offset:1024
    buffer_load_dwordx4 v57, s[8:11], s65 offen offset:1024 lds
    v_mfma_f32_16x16x32_bf16 v[132:135], a[8:11], a[96:99], v[132:135]
    ds_read_b64_tr_b16 a[44:45], v53 offset:8192
    v_mfma_f32_16x16x32_bf16 v[132:135], a[12:15], a[100:103], v[132:135]
    ds_read_b64_tr_b16 a[46:47], v53 offset:9216
    v_mfma_f32_16x16x32_bf16 v[164:167], a[8:11], a[104:107], v[164:167]
    ds_read_b64_tr_b16 a[48:49], v54
    v_mfma_f32_16x16x32_bf16 v[164:167], a[12:15], a[108:111], v[164:167]
    v_mfma_f32_16x16x32_bf16 v[196:199], a[8:11], a[112:115], v[196:199]
    ds_read_b64_tr_b16 a[50:51], v54 offset:1024
    buffer_load_dwordx4 v58, s[8:11], s65 offen offset:2048 lds
    v_mfma_f32_16x16x32_bf16 v[196:199], a[12:15], a[116:119], v[196:199]
    ds_read_b64_tr_b16 a[52:53], v54 offset:8192
    ds_read_b64_tr_b16 a[54:55], v54 offset:9216
    v_mfma_f32_16x16x32_bf16 v[136:139], a[16:19], a[96:99], v[136:139]
    ds_read_b64_tr_b16 a[56:57], v55
    v_mfma_f32_16x16x32_bf16 v[136:139], a[20:23], a[100:103], v[136:139]
    ds_read_b64_tr_b16 a[58:59], v55 offset:1024
    buffer_load_dwordx4 v59, s[8:11], s65 offen offset:3072 lds
    v_mfma_f32_16x16x32_bf16 v[168:171], a[16:19], a[104:107], v[168:171]
    ds_read_b64_tr_b16 a[60:61], v55 offset:8192
    v_mfma_f32_16x16x32_bf16 v[168:171], a[20:23], a[108:111], v[168:171]
    s_add_u32 m0, s53, 0xc000
    s_mov_b32 s63, 0x180
    v_mfma_f32_16x16x32_bf16 v[200:203], a[16:19], a[112:115], v[200:203]
    ds_read_b64_tr_b16 a[62:63], v55 offset:9216
    buffer_load_dwordx4 v60, s[4:7], s63 offen lds
    v_mfma_f32_16x16x32_bf16 v[200:203], a[20:23], a[116:119], v[200:203]
    v_mfma_f32_16x16x32_bf16 v[140:143], a[24:27], a[96:99], v[140:143]
    s_waitcnt lgkmcnt(6)
    v_mfma_f32_16x16x32_bf16 v[140:143], a[28:31], a[100:103], v[140:143]
    v_mfma_f32_16x16x32_bf16 v[172:175], a[24:27], a[104:107], v[172:175]
    buffer_load_dwordx4 v61, s[4:7], s63 offen offset:1024 lds
    v_mfma_f32_16x16x32_bf16 v[172:175], a[28:31], a[108:111], v[172:175]
    v_mfma_f32_16x16x32_bf16 v[204:207], a[24:27], a[112:115], v[204:207]
    s_waitcnt vmcnt(12) lgkmcnt(0)
    s_barrier
    v_mfma_f32_16x16x32_bf16 v[204:207], a[28:31], a[116:119], v[204:207]
    ds_read_b64_tr_b16 a[0:1], v48 offset:16384
    s_add_u32 m0, s53, 0xc800
    s_mov_b32 s63, 0x5180
    ds_read_b64_tr_b16 a[2:3], v48 offset:17408
    buffer_load_dwordx4 v60, s[4:7], s63 offen lds
    v_mfma_f32_16x16x32_bf16 v[144:147], a[32:35], a[96:99], v[144:147]
    v_mfma_f32_16x16x32_bf16 v[144:147], a[36:39], a[100:103], v[144:147]
    ds_read_b64_tr_b16 a[4:5], v48 offset:24576
    v_mfma_f32_16x16x32_bf16 v[176:179], a[32:35], a[104:107], v[176:179]
    v_mfma_f32_16x16x32_bf16 v[176:179], a[36:39], a[108:111], v[176:179]
    ds_read_b64_tr_b16 a[6:7], v48 offset:25600
    v_mfma_f32_16x16x32_bf16 v[208:211], a[32:35], a[112:115], v[208:211]
    buffer_load_dwordx4 v61, s[4:7], s63 offen offset:1024 lds
    v_mfma_f32_16x16x32_bf16 v[208:211], a[36:39], a[116:119], v[208:211]
    ds_read_b64_tr_b16 a[8:9], v49 offset:16384
    ds_read_b64_tr_b16 a[10:11], v49 offset:17408
    s_add_u32 m0, s53, 0x14000
    v_mfma_f32_16x16x32_bf16 v[148:151], a[40:43], a[96:99], v[148:151]
    s_mov_b32 s63, 0xa180
    v_mfma_f32_16x16x32_bf16 v[148:151], a[44:47], a[100:103], v[148:151]
    ds_read_b64_tr_b16 a[12:13], v49 offset:24576
    buffer_load_dwordx4 v60, s[4:7], s63 offen lds
    v_mfma_f32_16x16x32_bf16 v[180:183], a[40:43], a[104:107], v[180:183]
    v_mfma_f32_16x16x32_bf16 v[180:183], a[44:47], a[108:111], v[180:183]
    ds_read_b64_tr_b16 a[14:15], v49 offset:25600
    v_mfma_f32_16x16x32_bf16 v[212:215], a[40:43], a[112:115], v[212:215]
    s_waitcnt vmcnt(13)
    ds_read_b128 a[64:67], v62 offset:32768
    v_mfma_f32_16x16x32_bf16 v[212:215], a[44:47], a[116:119], v[212:215]
    ds_read_b64_tr_b16 a[16:17], v50 offset:16384
    ds_read_b128 a[68:71], v63 offset:32768
    buffer_load_dwordx4 v61, s[4:7], s63 offen offset:1024 lds
    ds_read_b64_tr_b16 a[18:19], v50 offset:17408
    v_mfma_f32_16x16x32_bf16 v[152:155], a[48:51], a[96:99], v[152:155]
    s_waitcnt vmcnt(12)
    ds_read_b128 a[72:75], v62 offset:34816
    v_mfma_f32_16x16x32_bf16 v[152:155], a[52:55], a[100:103], v[152:155]
    ds_read_b64_tr_b16 a[20:21], v50 offset:24576
    v_mfma_f32_16x16x32_bf16 v[184:187], a[48:51], a[104:107], v[184:187]
    ds_read_b128 a[76:79], v63 offset:34816
    v_mfma_f32_16x16x32_bf16 v[184:187], a[52:55], a[108:111], v[184:187]
    ds_read_b64_tr_b16 a[22:23], v50 offset:25600
    v_mfma_f32_16x16x32_bf16 v[216:219], a[48:51], a[112:115], v[216:219]
    s_waitcnt vmcnt(10)
    ds_read_b128 a[80:83], v62
    v_mfma_f32_16x16x32_bf16 v[216:219], a[52:55], a[116:119], v[216:219]
    ds_read_b64_tr_b16 a[24:25], v51 offset:16384
    ds_read_b128 a[84:87], v63
    ds_read_b64_tr_b16 a[26:27], v51 offset:17408
    v_mfma_f32_16x16x32_bf16 v[156:159], a[56:59], a[96:99], v[156:159]
    v_mfma_f32_16x16x32_bf16 v[156:159], a[60:63], a[100:103], v[156:159]
    ds_read_b64_tr_b16 a[28:29], v51 offset:24576
    v_mfma_f32_16x16x32_bf16 v[188:191], a[56:59], a[104:107], v[188:191]
    v_mfma_f32_16x16x32_bf16 v[188:191], a[60:63], a[108:111], v[188:191]
    ds_read_b64_tr_b16 a[30:31], v51 offset:25600
    v_mfma_f32_16x16x32_bf16 v[220:223], a[56:59], a[112:115], v[220:223]
    v_mfma_f32_16x16x32_bf16 v[220:223], a[60:63], a[116:119], v[220:223]
    s_waitcnt lgkmcnt(6)
    v_mfma_f32_16x16x32_bf16 v[128:131], a[0:3], a[64:67], v[128:131]
    ds_read_b64_tr_b16 a[32:33], v52 offset:16384
    s_add_u32 m0, s53, 0x1c000
    v_mfma_f32_16x16x32_bf16 v[128:131], a[4:7], a[68:71], v[128:131]
    ds_read_b64_tr_b16 a[34:35], v52 offset:17408
    s_mov_b32 s65, 0x200000
    v_mfma_f32_16x16x32_bf16 v[160:163], a[0:3], a[72:75], v[160:163]
    ds_read_b64_tr_b16 a[36:37], v52 offset:24576
    buffer_load_dwordx4 v56, s[8:11], s65 offen lds
    v_mfma_f32_16x16x32_bf16 v[160:163], a[4:7], a[76:79], v[160:163]
    s_waitcnt lgkmcnt(4)
    v_mfma_f32_16x16x32_bf16 v[192:195], a[0:3], a[80:83], v[192:195]
    ds_read_b64_tr_b16 a[38:39], v52 offset:25600
    v_mfma_f32_16x16x32_bf16 v[192:195], a[4:7], a[84:87], v[192:195]
    ds_read_b64_tr_b16 a[40:41], v53 offset:16384
    ds_read_b64_tr_b16 a[42:43], v53 offset:17408
    buffer_load_dwordx4 v57, s[8:11], s65 offen offset:1024 lds
    v_mfma_f32_16x16x32_bf16 v[132:135], a[8:11], a[64:67], v[132:135]
    ds_read_b64_tr_b16 a[44:45], v53 offset:24576
    v_mfma_f32_16x16x32_bf16 v[132:135], a[12:15], a[68:71], v[132:135]
    ds_read_b64_tr_b16 a[46:47], v53 offset:25600
    v_mfma_f32_16x16x32_bf16 v[164:167], a[8:11], a[72:75], v[164:167]
    ds_read_b64_tr_b16 a[48:49], v54 offset:16384
    v_mfma_f32_16x16x32_bf16 v[164:167], a[12:15], a[76:79], v[164:167]
    v_mfma_f32_16x16x32_bf16 v[196:199], a[8:11], a[80:83], v[196:199]
    ds_read_b64_tr_b16 a[50:51], v54 offset:17408
    buffer_load_dwordx4 v58, s[8:11], s65 offen offset:2048 lds
    v_mfma_f32_16x16x32_bf16 v[196:199], a[12:15], a[84:87], v[196:199]
    ds_read_b64_tr_b16 a[52:53], v54 offset:24576
    ds_read_b64_tr_b16 a[54:55], v54 offset:25600
    v_mfma_f32_16x16x32_bf16 v[136:139], a[16:19], a[64:67], v[136:139]
    ds_read_b64_tr_b16 a[56:57], v55 offset:16384
    v_mfma_f32_16x16x32_bf16 v[136:139], a[20:23], a[68:71], v[136:139]
    ds_read_b64_tr_b16 a[58:59], v55 offset:17408
    buffer_load_dwordx4 v59, s[8:11], s65 offen offset:3072 lds
    v_mfma_f32_16x16x32_bf16 v[168:171], a[16:19], a[72:75], v[168:171]
    ds_read_b64_tr_b16 a[60:61], v55 offset:24576
    v_mfma_f32_16x16x32_bf16 v[168:171], a[20:23], a[76:79], v[168:171]
    s_add_u32 m0, s53, 0x10000
    s_mov_b32 s63, 0x200
    v_mfma_f32_16x16x32_bf16 v[200:203], a[16:19], a[80:83], v[200:203]
    ds_read_b64_tr_b16 a[62:63], v55 offset:25600
    buffer_load_dwordx4 v60, s[4:7], s63 offen lds
    v_mfma_f32_16x16x32_bf16 v[200:203], a[20:23], a[84:87], v[200:203]
    v_mfma_f32_16x16x32_bf16 v[140:143], a[24:27], a[64:67], v[140:143]
    s_waitcnt lgkmcnt(6)
    v_mfma_f32_16x16x32_bf16 v[140:143], a[28:31], a[68:71], v[140:143]
    v_mfma_f32_16x16x32_bf16 v[172:175], a[24:27], a[72:75], v[172:175]
    buffer_load_dwordx4 v61, s[4:7], s63 offen offset:1024 lds
    v_mfma_f32_16x16x32_bf16 v[172:175], a[28:31], a[76:79], v[172:175]
    v_mfma_f32_16x16x32_bf16 v[204:207], a[24:27], a[80:83], v[204:207]
    s_waitcnt vmcnt(12) lgkmcnt(0)
    s_barrier
    v_mfma_f32_16x16x32_bf16 v[204:207], a[28:31], a[84:87], v[204:207]
    ds_read_b64_tr_b16 a[0:1], v48 offset:32768
    s_add_u32 m0, s53, 0x10800
    s_mov_b32 s63, 0x5200
    ds_read_b64_tr_b16 a[2:3], v48 offset:33792
    buffer_load_dwordx4 v60, s[4:7], s63 offen lds
    v_mfma_f32_16x16x32_bf16 v[144:147], a[32:35], a[64:67], v[144:147]
    v_mfma_f32_16x16x32_bf16 v[144:147], a[36:39], a[68:71], v[144:147]
    ds_read_b64_tr_b16 a[4:5], v48 offset:40960
    v_mfma_f32_16x16x32_bf16 v[176:179], a[32:35], a[72:75], v[176:179]
    v_mfma_f32_16x16x32_bf16 v[176:179], a[36:39], a[76:79], v[176:179]
    ds_read_b64_tr_b16 a[6:7], v48 offset:41984
    v_mfma_f32_16x16x32_bf16 v[208:211], a[32:35], a[80:83], v[208:211]
    buffer_load_dwordx4 v61, s[4:7], s63 offen offset:1024 lds
    v_mfma_f32_16x16x32_bf16 v[208:211], a[36:39], a[84:87], v[208:211]
    ds_read_b64_tr_b16 a[8:9], v49 offset:32768
    ds_read_b64_tr_b16 a[10:11], v49 offset:33792
    s_add_u32 m0, s53, 0x8000
    v_mfma_f32_16x16x32_bf16 v[148:151], a[40:43], a[64:67], v[148:151]
    s_mov_b32 s63, 0xa200
    v_mfma_f32_16x16x32_bf16 v[148:151], a[44:47], a[68:71], v[148:151]
    ds_read_b64_tr_b16 a[12:13], v49 offset:40960
    buffer_load_dwordx4 v60, s[4:7], s63 offen lds
    v_mfma_f32_16x16x32_bf16 v[180:183], a[40:43], a[72:75], v[180:183]
    v_mfma_f32_16x16x32_bf16 v[180:183], a[44:47], a[76:79], v[180:183]
    ds_read_b64_tr_b16 a[14:15], v49 offset:41984
    v_mfma_f32_16x16x32_bf16 v[212:215], a[40:43], a[80:83], v[212:215]
    s_waitcnt vmcnt(13)
    ds_read_b128 a[96:99], v62 offset:16384
    v_mfma_f32_16x16x32_bf16 v[212:215], a[44:47], a[84:87], v[212:215]
    ds_read_b64_tr_b16 a[16:17], v50 offset:32768
    ds_read_b128 a[100:103], v63 offset:16384
    buffer_load_dwordx4 v61, s[4:7], s63 offen offset:1024 lds
    ds_read_b64_tr_b16 a[18:19], v50 offset:33792
    v_mfma_f32_16x16x32_bf16 v[152:155], a[48:51], a[64:67], v[152:155]
    s_waitcnt vmcnt(12)
    ds_read_b128 a[104:107], v62 offset:18432
    v_mfma_f32_16x16x32_bf16 v[152:155], a[52:55], a[68:71], v[152:155]
    ds_read_b64_tr_b16 a[20:21], v50 offset:40960
    v_mfma_f32_16x16x32_bf16 v[184:187], a[48:51], a[72:75], v[184:187]
    ds_read_b128 a[108:111], v63 offset:18432
    v_mfma_f32_16x16x32_bf16 v[184:187], a[52:55], a[76:79], v[184:187]
    ds_read_b64_tr_b16 a[22:23], v50 offset:41984
    v_mfma_f32_16x16x32_bf16 v[216:219], a[48:51], a[80:83], v[216:219]
    s_waitcnt vmcnt(10)
    ds_read_b128 a[112:115], v62 offset:49152
    v_mfma_f32_16x16x32_bf16 v[216:219], a[52:55], a[84:87], v[216:219]
    ds_read_b64_tr_b16 a[24:25], v51 offset:32768
    ds_read_b128 a[116:119], v63 offset:49152
    ds_read_b64_tr_b16 a[26:27], v51 offset:33792
    v_mfma_f32_16x16x32_bf16 v[156:159], a[56:59], a[64:67], v[156:159]
    v_mfma_f32_16x16x32_bf16 v[156:159], a[60:63], a[68:71], v[156:159]
    ds_read_b64_tr_b16 a[28:29], v51 offset:40960
    v_mfma_f32_16x16x32_bf16 v[188:191], a[56:59], a[72:75], v[188:191]
    v_mfma_f32_16x16x32_bf16 v[188:191], a[60:63], a[76:79], v[188:191]
    ds_read_b64_tr_b16 a[30:31], v51 offset:41984
    v_mfma_f32_16x16x32_bf16 v[220:223], a[56:59], a[80:83], v[220:223]
    v_mfma_f32_16x16x32_bf16 v[220:223], a[60:63], a[84:87], v[220:223]
    s_waitcnt lgkmcnt(6)
    v_mfma_f32_16x16x32_bf16 v[128:131], a[0:3], a[96:99], v[128:131]
    ds_read_b64_tr_b16 a[32:33], v52 offset:32768
    s_add_u32 m0, s53, 0x20000
    v_mfma_f32_16x16x32_bf16 v[128:131], a[4:7], a[100:103], v[128:131]
    ds_read_b64_tr_b16 a[34:35], v52 offset:33792
    s_mov_b32 s65, 0x280000
    v_mfma_f32_16x16x32_bf16 v[160:163], a[0:3], a[104:107], v[160:163]
    ds_read_b64_tr_b16 a[36:37], v52 offset:40960
    buffer_load_dwordx4 v56, s[8:11], s65 offen lds
    v_mfma_f32_16x16x32_bf16 v[160:163], a[4:7], a[108:111], v[160:163]
    s_waitcnt lgkmcnt(4)
    v_mfma_f32_16x16x32_bf16 v[192:195], a[0:3], a[112:115], v[192:195]
    ds_read_b64_tr_b16 a[38:39], v52 offset:41984
    v_mfma_f32_16x16x32_bf16 v[192:195], a[4:7], a[116:119], v[192:195]
    ds_read_b64_tr_b16 a[40:41], v53 offset:32768
    ds_read_b64_tr_b16 a[42:43], v53 offset:33792
    buffer_load_dwordx4 v57, s[8:11], s65 offen offset:1024 lds
    v_mfma_f32_16x16x32_bf16 v[132:135], a[8:11], a[96:99], v[132:135]
    ds_read_b64_tr_b16 a[44:45], v53 offset:40960
    v_mfma_f32_16x16x32_bf16 v[132:135], a[12:15], a[100:103], v[132:135]
    ds_read_b64_tr_b16 a[46:47], v53 offset:41984
    v_mfma_f32_16x16x32_bf16 v[164:167], a[8:11], a[104:107], v[164:167]
    ds_read_b64_tr_b16 a[48:49], v54 offset:32768
    v_mfma_f32_16x16x32_bf16 v[164:167], a[12:15], a[108:111], v[164:167]
    v_mfma_f32_16x16x32_bf16 v[196:199], a[8:11], a[112:115], v[196:199]
    ds_read_b64_tr_b16 a[50:51], v54 offset:33792
    buffer_load_dwordx4 v58, s[8:11], s65 offen offset:2048 lds
    v_mfma_f32_16x16x32_bf16 v[196:199], a[12:15], a[116:119], v[196:199]
    ds_read_b64_tr_b16 a[52:53], v54 offset:40960
    ds_read_b64_tr_b16 a[54:55], v54 offset:41984
    v_mfma_f32_16x16x32_bf16 v[136:139], a[16:19], a[96:99], v[136:139]
    ds_read_b64_tr_b16 a[56:57], v55 offset:32768
    v_mfma_f32_16x16x32_bf16 v[136:139], a[20:23], a[100:103], v[136:139]
    ds_read_b64_tr_b16 a[58:59], v55 offset:33792
    buffer_load_dwordx4 v59, s[8:11], s65 offen offset:3072 lds
    v_mfma_f32_16x16x32_bf16 v[168:171], a[16:19], a[104:107], v[168:171]
    ds_read_b64_tr_b16 a[60:61], v55 offset:40960
    v_mfma_f32_16x16x32_bf16 v[168:171], a[20:23], a[108:111], v[168:171]
    s_add_u32 m0, s53, 0xc000
    s_mov_b32 s63, 0x280
    v_mfma_f32_16x16x32_bf16 v[200:203], a[16:19], a[112:115], v[200:203]
    ds_read_b64_tr_b16 a[62:63], v55 offset:41984
    buffer_load_dwordx4 v60, s[4:7], s63 offen lds
    v_mfma_f32_16x16x32_bf16 v[200:203], a[20:23], a[116:119], v[200:203]
    v_mfma_f32_16x16x32_bf16 v[140:143], a[24:27], a[96:99], v[140:143]
    s_waitcnt lgkmcnt(6)
    v_mfma_f32_16x16x32_bf16 v[140:143], a[28:31], a[100:103], v[140:143]
    v_mfma_f32_16x16x32_bf16 v[172:175], a[24:27], a[104:107], v[172:175]
    buffer_load_dwordx4 v61, s[4:7], s63 offen offset:1024 lds
    v_mfma_f32_16x16x32_bf16 v[172:175], a[28:31], a[108:111], v[172:175]
    v_mfma_f32_16x16x32_bf16 v[204:207], a[24:27], a[112:115], v[204:207]
    s_waitcnt vmcnt(12) lgkmcnt(0)
    s_barrier
    v_mfma_f32_16x16x32_bf16 v[204:207], a[28:31], a[116:119], v[204:207]
    ds_read_b64_tr_b16 a[0:1], v48
    s_add_u32 m0, s53, 0xc800
    s_mov_b32 s63, 0x5280
    ds_read_b64_tr_b16 a[2:3], v48 offset:1024
    buffer_load_dwordx4 v60, s[4:7], s63 offen lds
    v_mfma_f32_16x16x32_bf16 v[144:147], a[32:35], a[96:99], v[144:147]
    v_mfma_f32_16x16x32_bf16 v[144:147], a[36:39], a[100:103], v[144:147]
    ds_read_b64_tr_b16 a[4:5], v48 offset:8192
    v_mfma_f32_16x16x32_bf16 v[176:179], a[32:35], a[104:107], v[176:179]
    v_mfma_f32_16x16x32_bf16 v[176:179], a[36:39], a[108:111], v[176:179]
    ds_read_b64_tr_b16 a[6:7], v48 offset:9216
    v_mfma_f32_16x16x32_bf16 v[208:211], a[32:35], a[112:115], v[208:211]
    buffer_load_dwordx4 v61, s[4:7], s63 offen offset:1024 lds
    v_mfma_f32_16x16x32_bf16 v[208:211], a[36:39], a[116:119], v[208:211]
    ds_read_b64_tr_b16 a[8:9], v49
    ds_read_b64_tr_b16 a[10:11], v49 offset:1024
    s_add_u32 m0, s53, 0x14000
    v_mfma_f32_16x16x32_bf16 v[148:151], a[40:43], a[96:99], v[148:151]
    s_mov_b32 s63, 0xa280
    v_mfma_f32_16x16x32_bf16 v[148:151], a[44:47], a[100:103], v[148:151]
    ds_read_b64_tr_b16 a[12:13], v49 offset:8192
    buffer_load_dwordx4 v60, s[4:7], s63 offen lds
    v_mfma_f32_16x16x32_bf16 v[180:183], a[40:43], a[104:107], v[180:183]
    v_mfma_f32_16x16x32_bf16 v[180:183], a[44:47], a[108:111], v[180:183]
    ds_read_b64_tr_b16 a[14:15], v49 offset:9216
    v_mfma_f32_16x16x32_bf16 v[212:215], a[40:43], a[112:115], v[212:215]
    s_waitcnt vmcnt(13)
    ds_read_b128 a[64:67], v62 offset:32768
    v_mfma_f32_16x16x32_bf16 v[212:215], a[44:47], a[116:119], v[212:215]
    ds_read_b64_tr_b16 a[16:17], v50
    ds_read_b128 a[68:71], v63 offset:32768
    buffer_load_dwordx4 v61, s[4:7], s63 offen offset:1024 lds
    ds_read_b64_tr_b16 a[18:19], v50 offset:1024
    v_mfma_f32_16x16x32_bf16 v[152:155], a[48:51], a[96:99], v[152:155]
    s_waitcnt vmcnt(12)
    ds_read_b128 a[72:75], v62 offset:34816
    v_mfma_f32_16x16x32_bf16 v[152:155], a[52:55], a[100:103], v[152:155]
    ds_read_b64_tr_b16 a[20:21], v50 offset:8192
    v_mfma_f32_16x16x32_bf16 v[184:187], a[48:51], a[104:107], v[184:187]
    ds_read_b128 a[76:79], v63 offset:34816
    v_mfma_f32_16x16x32_bf16 v[184:187], a[52:55], a[108:111], v[184:187]
    ds_read_b64_tr_b16 a[22:23], v50 offset:9216
    v_mfma_f32_16x16x32_bf16 v[216:219], a[48:51], a[112:115], v[216:219]
    s_waitcnt vmcnt(10)
    ds_read_b128 a[80:83], v62
    v_mfma_f32_16x16x32_bf16 v[216:219], a[52:55], a[116:119], v[216:219]
    ds_read_b64_tr_b16 a[24:25], v51
    ds_read_b128 a[84:87], v63
    ds_read_b64_tr_b16 a[26:27], v51 offset:1024
    v_mfma_f32_16x16x32_bf16 v[156:159], a[56:59], a[96:99], v[156:159]
    v_mfma_f32_16x16x32_bf16 v[156:159], a[60:63], a[100:103], v[156:159]
    ds_read_b64_tr_b16 a[28:29], v51 offset:8192
    v_mfma_f32_16x16x32_bf16 v[188:191], a[56:59], a[104:107], v[188:191]
    v_mfma_f32_16x16x32_bf16 v[188:191], a[60:63], a[108:111], v[188:191]
    ds_read_b64_tr_b16 a[30:31], v51 offset:9216
    v_mfma_f32_16x16x32_bf16 v[220:223], a[56:59], a[112:115], v[220:223]
    v_mfma_f32_16x16x32_bf16 v[220:223], a[60:63], a[116:119], v[220:223]
    s_waitcnt lgkmcnt(6)
    v_mfma_f32_16x16x32_bf16 v[128:131], a[0:3], a[64:67], v[128:131]
    ds_read_b64_tr_b16 a[32:33], v52
    s_add_u32 m0, s53, 0x24000
    v_mfma_f32_16x16x32_bf16 v[128:131], a[4:7], a[68:71], v[128:131]
    ds_read_b64_tr_b16 a[34:35], v52 offset:1024
    s_mov_b32 s65, 0x300000
    v_mfma_f32_16x16x32_bf16 v[160:163], a[0:3], a[72:75], v[160:163]
    ds_read_b64_tr_b16 a[36:37], v52 offset:8192
    buffer_load_dwordx4 v56, s[8:11], s65 offen lds
    v_mfma_f32_16x16x32_bf16 v[160:163], a[4:7], a[76:79], v[160:163]
    s_waitcnt lgkmcnt(4)
    v_mfma_f32_16x16x32_bf16 v[192:195], a[0:3], a[80:83], v[192:195]
    ds_read_b64_tr_b16 a[38:39], v52 offset:9216
    v_mfma_f32_16x16x32_bf16 v[192:195], a[4:7], a[84:87], v[192:195]
    ds_read_b64_tr_b16 a[40:41], v53
    ds_read_b64_tr_b16 a[42:43], v53 offset:1024
    buffer_load_dwordx4 v57, s[8:11], s65 offen offset:1024 lds
    v_mfma_f32_16x16x32_bf16 v[132:135], a[8:11], a[64:67], v[132:135]
    ds_read_b64_tr_b16 a[44:45], v53 offset:8192
    v_mfma_f32_16x16x32_bf16 v[132:135], a[12:15], a[68:71], v[132:135]
    ds_read_b64_tr_b16 a[46:47], v53 offset:9216
    v_mfma_f32_16x16x32_bf16 v[164:167], a[8:11], a[72:75], v[164:167]
    ds_read_b64_tr_b16 a[48:49], v54
    v_mfma_f32_16x16x32_bf16 v[164:167], a[12:15], a[76:79], v[164:167]
    v_mfma_f32_16x16x32_bf16 v[196:199], a[8:11], a[80:83], v[196:199]
    ds_read_b64_tr_b16 a[50:51], v54 offset:1024
    buffer_load_dwordx4 v58, s[8:11], s65 offen offset:2048 lds
    v_mfma_f32_16x16x32_bf16 v[196:199], a[12:15], a[84:87], v[196:199]
    ds_read_b64_tr_b16 a[52:53], v54 offset:8192
    ds_read_b64_tr_b16 a[54:55], v54 offset:9216
    v_mfma_f32_16x16x32_bf16 v[136:139], a[16:19], a[64:67], v[136:139]
    ds_read_b64_tr_b16 a[56:57], v55
    v_mfma_f32_16x16x32_bf16 v[136:139], a[20:23], a[68:71], v[136:139]
    ds_read_b64_tr_b16 a[58:59], v55 offset:1024
    buffer_load_dwordx4 v59, s[8:11], s65 offen offset:3072 lds
    v_mfma_f32_16x16x32_bf16 v[168:171], a[16:19], a[72:75], v[168:171]
    ds_read_b64_tr_b16 a[60:61], v55 offset:8192
    v_mfma_f32_16x16x32_bf16 v[168:171], a[20:23], a[76:79], v[168:171]
    s_add_u32 m0, s53, 0x10000
    s_mov_b32 s63, 0x300
    v_mfma_f32_16x16x32_bf16 v[200:203], a[16:19], a[80:83], v[200:203]
    ds_read_b64_tr_b16 a[62:63], v55 offset:9216
    buffer_load_dwordx4 v60, s[4:7], s63 offen lds
    v_mfma_f32_16x16x32_bf16 v[200:203], a[20:23], a[84:87], v[200:203]
    v_mfma_f32_16x16x32_bf16 v[140:143], a[24:27], a[64:67], v[140:143]
    s_waitcnt lgkmcnt(6)
    v_mfma_f32_16x16x32_bf16 v[140:143], a[28:31], a[68:71], v[140:143]
    v_mfma_f32_16x16x32_bf16 v[172:175], a[24:27], a[72:75], v[172:175]
    buffer_load_dwordx4 v61, s[4:7], s63 offen offset:1024 lds
    v_mfma_f32_16x16x32_bf16 v[172:175], a[28:31], a[76:79], v[172:175]
    v_mfma_f32_16x16x32_bf16 v[204:207], a[24:27], a[80:83], v[204:207]
    s_waitcnt vmcnt(12) lgkmcnt(0)
    s_barrier
    v_mfma_f32_16x16x32_bf16 v[204:207], a[28:31], a[84:87], v[204:207]
    ds_read_b64_tr_b16 a[0:1], v48 offset:16384
    s_add_u32 m0, s53, 0x10800
    s_mov_b32 s63, 0x5300
    ds_read_b64_tr_b16 a[2:3], v48 offset:17408
    buffer_load_dwordx4 v60, s[4:7], s63 offen lds
    v_mfma_f32_16x16x32_bf16 v[144:147], a[32:35], a[64:67], v[144:147]
    v_mfma_f32_16x16x32_bf16 v[144:147], a[36:39], a[68:71], v[144:147]
    ds_read_b64_tr_b16 a[4:5], v48 offset:24576
    v_mfma_f32_16x16x32_bf16 v[176:179], a[32:35], a[72:75], v[176:179]
    v_mfma_f32_16x16x32_bf16 v[176:179], a[36:39], a[76:79], v[176:179]
    ds_read_b64_tr_b16 a[6:7], v48 offset:25600
    v_mfma_f32_16x16x32_bf16 v[208:211], a[32:35], a[80:83], v[208:211]
    buffer_load_dwordx4 v61, s[4:7], s63 offen offset:1024 lds
    v_mfma_f32_16x16x32_bf16 v[208:211], a[36:39], a[84:87], v[208:211]
    ds_read_b64_tr_b16 a[8:9], v49 offset:16384
    ds_read_b64_tr_b16 a[10:11], v49 offset:17408
    s_add_u32 m0, s53, 0x8000
    v_mfma_f32_16x16x32_bf16 v[148:151], a[40:43], a[64:67], v[148:151]
    s_mov_b32 s63, 0xa300
    v_mfma_f32_16x16x32_bf16 v[148:151], a[44:47], a[68:71], v[148:151]
    ds_read_b64_tr_b16 a[12:13], v49 offset:24576
    buffer_load_dwordx4 v60, s[4:7], s63 offen lds
    v_mfma_f32_16x16x32_bf16 v[180:183], a[40:43], a[72:75], v[180:183]
    v_mfma_f32_16x16x32_bf16 v[180:183], a[44:47], a[76:79], v[180:183]
    ds_read_b64_tr_b16 a[14:15], v49 offset:25600
    v_mfma_f32_16x16x32_bf16 v[212:215], a[40:43], a[80:83], v[212:215]
    s_waitcnt vmcnt(13)
    ds_read_b128 a[96:99], v62 offset:16384
    v_mfma_f32_16x16x32_bf16 v[212:215], a[44:47], a[84:87], v[212:215]
    ds_read_b64_tr_b16 a[16:17], v50 offset:16384
    ds_read_b128 a[100:103], v63 offset:16384
    buffer_load_dwordx4 v61, s[4:7], s63 offen offset:1024 lds
    ds_read_b64_tr_b16 a[18:19], v50 offset:17408
    v_mfma_f32_16x16x32_bf16 v[152:155], a[48:51], a[64:67], v[152:155]
    s_waitcnt vmcnt(12)
    ds_read_b128 a[104:107], v62 offset:18432
    v_mfma_f32_16x16x32_bf16 v[152:155], a[52:55], a[68:71], v[152:155]
    ds_read_b64_tr_b16 a[20:21], v50 offset:24576
    v_mfma_f32_16x16x32_bf16 v[184:187], a[48:51], a[72:75], v[184:187]
    ds_read_b128 a[108:111], v63 offset:18432
    v_mfma_f32_16x16x32_bf16 v[184:187], a[52:55], a[76:79], v[184:187]
    ds_read_b64_tr_b16 a[22:23], v50 offset:25600
    v_mfma_f32_16x16x32_bf16 v[216:219], a[48:51], a[80:83], v[216:219]
    s_waitcnt vmcnt(10)
    ds_read_b128 a[112:115], v62 offset:49152
    v_mfma_f32_16x16x32_bf16 v[216:219], a[52:55], a[84:87], v[216:219]
    ds_read_b64_tr_b16 a[24:25], v51 offset:16384
    ds_read_b128 a[116:119], v63 offset:49152
    ds_read_b64_tr_b16 a[26:27], v51 offset:17408
    v_mfma_f32_16x16x32_bf16 v[156:159], a[56:59], a[64:67], v[156:159]
    v_mfma_f32_16x16x32_bf16 v[156:159], a[60:63], a[68:71], v[156:159]
    ds_read_b64_tr_b16 a[28:29], v51 offset:24576
    v_mfma_f32_16x16x32_bf16 v[188:191], a[56:59], a[72:75], v[188:191]
    v_mfma_f32_16x16x32_bf16 v[188:191], a[60:63], a[76:79], v[188:191]
    ds_read_b64_tr_b16 a[30:31], v51 offset:25600
    v_mfma_f32_16x16x32_bf16 v[220:223], a[56:59], a[80:83], v[220:223]
    v_mfma_f32_16x16x32_bf16 v[220:223], a[60:63], a[84:87], v[220:223]
    s_waitcnt lgkmcnt(6)
    v_mfma_f32_16x16x32_bf16 v[128:131], a[0:3], a[96:99], v[128:131]
    ds_read_b64_tr_b16 a[32:33], v52 offset:16384
    s_add_u32 m0, s53, 0x1c000
    v_mfma_f32_16x16x32_bf16 v[128:131], a[4:7], a[100:103], v[128:131]
    ds_read_b64_tr_b16 a[34:35], v52 offset:17408
    s_mov_b32 s65, 0x380000
    v_mfma_f32_16x16x32_bf16 v[160:163], a[0:3], a[104:107], v[160:163]
    ds_read_b64_tr_b16 a[36:37], v52 offset:24576
    buffer_load_dwordx4 v56, s[8:11], s65 offen lds
    v_mfma_f32_16x16x32_bf16 v[160:163], a[4:7], a[108:111], v[160:163]
    s_waitcnt lgkmcnt(4)
    v_mfma_f32_16x16x32_bf16 v[192:195], a[0:3], a[112:115], v[192:195]
    ds_read_b64_tr_b16 a[38:39], v52 offset:25600
    v_mfma_f32_16x16x32_bf16 v[192:195], a[4:7], a[116:119], v[192:195]
    ds_read_b64_tr_b16 a[40:41], v53 offset:16384
    ds_read_b64_tr_b16 a[42:43], v53 offset:17408
    buffer_load_dwordx4 v57, s[8:11], s65 offen offset:1024 lds
    v_mfma_f32_16x16x32_bf16 v[132:135], a[8:11], a[96:99], v[132:135]
    ds_read_b64_tr_b16 a[44:45], v53 offset:24576
    v_mfma_f32_16x16x32_bf16 v[132:135], a[12:15], a[100:103], v[132:135]
    ds_read_b64_tr_b16 a[46:47], v53 offset:25600
    v_mfma_f32_16x16x32_bf16 v[164:167], a[8:11], a[104:107], v[164:167]
    ds_read_b64_tr_b16 a[48:49], v54 offset:16384
    v_mfma_f32_16x16x32_bf16 v[164:167], a[12:15], a[108:111], v[164:167]
    v_mfma_f32_16x16x32_bf16 v[196:199], a[8:11], a[112:115], v[196:199]
    ds_read_b64_tr_b16 a[50:51], v54 offset:17408
    buffer_load_dwordx4 v58, s[8:11], s65 offen offset:2048 lds
    v_mfma_f32_16x16x32_bf16 v[196:199], a[12:15], a[116:119], v[196:199]
    ds_read_b64_tr_b16 a[52:53], v54 offset:24576
    ds_read_b64_tr_b16 a[54:55], v54 offset:25600
    v_mfma_f32_16x16x32_bf16 v[136:139], a[16:19], a[96:99], v[136:139]
    ds_read_b64_tr_b16 a[56:57], v55 offset:16384
    v_mfma_f32_16x16x32_bf16 v[136:139], a[20:23], a[100:103], v[136:139]
    ds_read_b64_tr_b16 a[58:59], v55 offset:17408
    buffer_load_dwordx4 v59, s[8:11], s65 offen offset:3072 lds
    v_mfma_f32_16x16x32_bf16 v[168:171], a[16:19], a[104:107], v[168:171]
    ds_read_b64_tr_b16 a[60:61], v55 offset:24576
    v_mfma_f32_16x16x32_bf16 v[168:171], a[20:23], a[108:111], v[168:171]
    s_add_u32 m0, s53, 0xc000
    s_mov_b32 s63, 0x380
    v_mfma_f32_16x16x32_bf16 v[200:203], a[16:19], a[112:115], v[200:203]
    ds_read_b64_tr_b16 a[62:63], v55 offset:25600
    buffer_load_dwordx4 v60, s[4:7], s63 offen lds
    v_mfma_f32_16x16x32_bf16 v[200:203], a[20:23], a[116:119], v[200:203]
    v_mfma_f32_16x16x32_bf16 v[140:143], a[24:27], a[96:99], v[140:143]
    s_waitcnt lgkmcnt(6)
    v_mfma_f32_16x16x32_bf16 v[140:143], a[28:31], a[100:103], v[140:143]
    v_mfma_f32_16x16x32_bf16 v[172:175], a[24:27], a[104:107], v[172:175]
    buffer_load_dwordx4 v61, s[4:7], s63 offen offset:1024 lds
    v_mfma_f32_16x16x32_bf16 v[172:175], a[28:31], a[108:111], v[172:175]
    v_mfma_f32_16x16x32_bf16 v[204:207], a[24:27], a[112:115], v[204:207]
    s_waitcnt vmcnt(12) lgkmcnt(0)
    s_barrier
    v_mfma_f32_16x16x32_bf16 v[204:207], a[28:31], a[116:119], v[204:207]
    ds_read_b64_tr_b16 a[0:1], v48 offset:32768
    s_add_u32 m0, s53, 0xc800
    s_mov_b32 s63, 0x5380
    ds_read_b64_tr_b16 a[2:3], v48 offset:33792
    buffer_load_dwordx4 v60, s[4:7], s63 offen lds
    v_mfma_f32_16x16x32_bf16 v[144:147], a[32:35], a[96:99], v[144:147]
    v_mfma_f32_16x16x32_bf16 v[144:147], a[36:39], a[100:103], v[144:147]
    ds_read_b64_tr_b16 a[4:5], v48 offset:40960
    v_mfma_f32_16x16x32_bf16 v[176:179], a[32:35], a[104:107], v[176:179]
    v_mfma_f32_16x16x32_bf16 v[176:179], a[36:39], a[108:111], v[176:179]
    ds_read_b64_tr_b16 a[6:7], v48 offset:41984
    v_mfma_f32_16x16x32_bf16 v[208:211], a[32:35], a[112:115], v[208:211]
    buffer_load_dwordx4 v61, s[4:7], s63 offen offset:1024 lds
    v_mfma_f32_16x16x32_bf16 v[208:211], a[36:39], a[116:119], v[208:211]
    ds_read_b64_tr_b16 a[8:9], v49 offset:32768
    ds_read_b64_tr_b16 a[10:11], v49 offset:33792
    s_add_u32 m0, s53, 0x14000
    v_mfma_f32_16x16x32_bf16 v[148:151], a[40:43], a[96:99], v[148:151]
    s_mov_b32 s63, 0xa380
    v_mfma_f32_16x16x32_bf16 v[148:151], a[44:47], a[100:103], v[148:151]
    ds_read_b64_tr_b16 a[12:13], v49 offset:40960
    buffer_load_dwordx4 v60, s[4:7], s63 offen lds
    v_mfma_f32_16x16x32_bf16 v[180:183], a[40:43], a[104:107], v[180:183]
    v_mfma_f32_16x16x32_bf16 v[180:183], a[44:47], a[108:111], v[180:183]
    ds_read_b64_tr_b16 a[14:15], v49 offset:41984
    v_mfma_f32_16x16x32_bf16 v[212:215], a[40:43], a[112:115], v[212:215]
    s_waitcnt vmcnt(13)
    ds_read_b128 a[64:67], v62 offset:32768
    v_mfma_f32_16x16x32_bf16 v[212:215], a[44:47], a[116:119], v[212:215]
    ds_read_b64_tr_b16 a[16:17], v50 offset:32768
    ds_read_b128 a[68:71], v63 offset:32768
    buffer_load_dwordx4 v61, s[4:7], s63 offen offset:1024 lds
    ds_read_b64_tr_b16 a[18:19], v50 offset:33792
    v_mfma_f32_16x16x32_bf16 v[152:155], a[48:51], a[96:99], v[152:155]
    s_waitcnt vmcnt(12)
    ds_read_b128 a[72:75], v62 offset:34816
    v_mfma_f32_16x16x32_bf16 v[152:155], a[52:55], a[100:103], v[152:155]
    ds_read_b64_tr_b16 a[20:21], v50 offset:40960
    v_mfma_f32_16x16x32_bf16 v[184:187], a[48:51], a[104:107], v[184:187]
    ds_read_b128 a[76:79], v63 offset:34816
    v_mfma_f32_16x16x32_bf16 v[184:187], a[52:55], a[108:111], v[184:187]
    ds_read_b64_tr_b16 a[22:23], v50 offset:41984
    v_mfma_f32_16x16x32_bf16 v[216:219], a[48:51], a[112:115], v[216:219]
    s_waitcnt vmcnt(10)
    ds_read_b128 a[80:83], v62
    v_mfma_f32_16x16x32_bf16 v[216:219], a[52:55], a[116:119], v[216:219]
    ds_read_b64_tr_b16 a[24:25], v51 offset:32768
    ds_read_b128 a[84:87], v63
    ds_read_b64_tr_b16 a[26:27], v51 offset:33792
    v_mfma_f32_16x16x32_bf16 v[156:159], a[56:59], a[96:99], v[156:159]
    v_mfma_f32_16x16x32_bf16 v[156:159], a[60:63], a[100:103], v[156:159]
    ds_read_b64_tr_b16 a[28:29], v51 offset:40960
    v_mfma_f32_16x16x32_bf16 v[188:191], a[56:59], a[104:107], v[188:191]
    v_mfma_f32_16x16x32_bf16 v[188:191], a[60:63], a[108:111], v[188:191]
    ds_read_b64_tr_b16 a[30:31], v51 offset:41984
    v_mfma_f32_16x16x32_bf16 v[220:223], a[56:59], a[112:115], v[220:223]
    v_mfma_f32_16x16x32_bf16 v[220:223], a[60:63], a[116:119], v[220:223]
    s_waitcnt lgkmcnt(6)
    v_mfma_f32_16x16x32_bf16 v[128:131], a[0:3], a[64:67], v[128:131]
    ds_read_b64_tr_b16 a[32:33], v52 offset:32768
    s_add_u32 m0, s53, 0x20000
    v_mfma_f32_16x16x32_bf16 v[128:131], a[4:7], a[68:71], v[128:131]
    ds_read_b64_tr_b16 a[34:35], v52 offset:33792
    s_mov_b32 s65, 0x400000
    v_mfma_f32_16x16x32_bf16 v[160:163], a[0:3], a[72:75], v[160:163]
    ds_read_b64_tr_b16 a[36:37], v52 offset:40960
    buffer_load_dwordx4 v56, s[8:11], s65 offen lds
    v_mfma_f32_16x16x32_bf16 v[160:163], a[4:7], a[76:79], v[160:163]
    s_waitcnt lgkmcnt(4)
    v_mfma_f32_16x16x32_bf16 v[192:195], a[0:3], a[80:83], v[192:195]
    ds_read_b64_tr_b16 a[38:39], v52 offset:41984
    v_mfma_f32_16x16x32_bf16 v[192:195], a[4:7], a[84:87], v[192:195]
    ds_read_b64_tr_b16 a[40:41], v53 offset:32768
    ds_read_b64_tr_b16 a[42:43], v53 offset:33792
    buffer_load_dwordx4 v57, s[8:11], s65 offen offset:1024 lds
    v_mfma_f32_16x16x32_bf16 v[132:135], a[8:11], a[64:67], v[132:135]
    ds_read_b64_tr_b16 a[44:45], v53 offset:40960
    v_mfma_f32_16x16x32_bf16 v[132:135], a[12:15], a[68:71], v[132:135]
    ds_read_b64_tr_b16 a[46:47], v53 offset:41984
    v_mfma_f32_16x16x32_bf16 v[164:167], a[8:11], a[72:75], v[164:167]
    ds_read_b64_tr_b16 a[48:49], v54 offset:32768
    v_mfma_f32_16x16x32_bf16 v[164:167], a[12:15], a[76:79], v[164:167]
    v_mfma_f32_16x16x32_bf16 v[196:199], a[8:11], a[80:83], v[196:199]
    ds_read_b64_tr_b16 a[50:51], v54 offset:33792
    buffer_load_dwordx4 v58, s[8:11], s65 offen offset:2048 lds
    v_mfma_f32_16x16x32_bf16 v[196:199], a[12:15], a[84:87], v[196:199]
    ds_read_b64_tr_b16 a[52:53], v54 offset:40960
    ds_read_b64_tr_b16 a[54:55], v54 offset:41984
    v_mfma_f32_16x16x32_bf16 v[136:139], a[16:19], a[64:67], v[136:139]
    ds_read_b64_tr_b16 a[56:57], v55 offset:32768
    v_mfma_f32_16x16x32_bf16 v[136:139], a[20:23], a[68:71], v[136:139]
    ds_read_b64_tr_b16 a[58:59], v55 offset:33792
    buffer_load_dwordx4 v59, s[8:11], s65 offen offset:3072 lds
    v_mfma_f32_16x16x32_bf16 v[168:171], a[16:19], a[72:75], v[168:171]
    ds_read_b64_tr_b16 a[60:61], v55 offset:40960
    v_mfma_f32_16x16x32_bf16 v[168:171], a[20:23], a[76:79], v[168:171]
    s_add_u32 m0, s53, 0x10000
    s_mov_b32 s63, 0x400
    v_mfma_f32_16x16x32_bf16 v[200:203], a[16:19], a[80:83], v[200:203]
    ds_read_b64_tr_b16 a[62:63], v55 offset:41984
    buffer_load_dwordx4 v60, s[4:7], s63 offen lds
    v_mfma_f32_16x16x32_bf16 v[200:203], a[20:23], a[84:87], v[200:203]
    v_mfma_f32_16x16x32_bf16 v[140:143], a[24:27], a[64:67], v[140:143]
    s_waitcnt lgkmcnt(6)
    v_mfma_f32_16x16x32_bf16 v[140:143], a[28:31], a[68:71], v[140:143]
    v_mfma_f32_16x16x32_bf16 v[172:175], a[24:27], a[72:75], v[172:175]
    buffer_load_dwordx4 v61, s[4:7], s63 offen offset:1024 lds
    v_mfma_f32_16x16x32_bf16 v[172:175], a[28:31], a[76:79], v[172:175]
    v_mfma_f32_16x16x32_bf16 v[204:207], a[24:27], a[80:83], v[204:207]
    s_waitcnt vmcnt(12) lgkmcnt(0)
    s_barrier
    v_mfma_f32_16x16x32_bf16 v[204:207], a[28:31], a[84:87], v[204:207]
    ds_read_b64_tr_b16 a[0:1], v48
    s_add_u32 m0, s53, 0x10800
    s_mov_b32 s63, 0x5400
    ds_read_b64_tr_b16 a[2:3], v48 offset:1024
    buffer_load_dwordx4 v60, s[4:7], s63 offen lds
    v_mfma_f32_16x16x32_bf16 v[144:147], a[32:35], a[64:67], v[144:147]
    v_mfma_f32_16x16x32_bf16 v[144:147], a[36:39], a[68:71], v[144:147]
    ds_read_b64_tr_b16 a[4:5], v48 offset:8192
    v_mfma_f32_16x16x32_bf16 v[176:179], a[32:35], a[72:75], v[176:179]
    v_mfma_f32_16x16x32_bf16 v[176:179], a[36:39], a[76:79], v[176:179]
    ds_read_b64_tr_b16 a[6:7], v48 offset:9216
    v_mfma_f32_16x16x32_bf16 v[208:211], a[32:35], a[80:83], v[208:211]
    buffer_load_dwordx4 v61, s[4:7], s63 offen offset:1024 lds
    v_mfma_f32_16x16x32_bf16 v[208:211], a[36:39], a[84:87], v[208:211]
    ds_read_b64_tr_b16 a[8:9], v49
    ds_read_b64_tr_b16 a[10:11], v49 offset:1024
    s_add_u32 m0, s53, 0x8000
    v_mfma_f32_16x16x32_bf16 v[148:151], a[40:43], a[64:67], v[148:151]
    s_mov_b32 s63, 0xa400
    v_mfma_f32_16x16x32_bf16 v[148:151], a[44:47], a[68:71], v[148:151]
    ds_read_b64_tr_b16 a[12:13], v49 offset:8192
    buffer_load_dwordx4 v60, s[4:7], s63 offen lds
    v_mfma_f32_16x16x32_bf16 v[180:183], a[40:43], a[72:75], v[180:183]
    v_mfma_f32_16x16x32_bf16 v[180:183], a[44:47], a[76:79], v[180:183]
    ds_read_b64_tr_b16 a[14:15], v49 offset:9216
    v_mfma_f32_16x16x32_bf16 v[212:215], a[40:43], a[80:83], v[212:215]
    s_waitcnt vmcnt(13)
    ds_read_b128 a[96:99], v62 offset:16384
    v_mfma_f32_16x16x32_bf16 v[212:215], a[44:47], a[84:87], v[212:215]
    ds_read_b64_tr_b16 a[16:17], v50
    ds_read_b128 a[100:103], v63 offset:16384
    buffer_load_dwordx4 v61, s[4:7], s63 offen offset:1024 lds
    ds_read_b64_tr_b16 a[18:19], v50 offset:1024
    v_mfma_f32_16x16x32_bf16 v[152:155], a[48:51], a[64:67], v[152:155]
    s_waitcnt vmcnt(12)
    ds_read_b128 a[104:107], v62 offset:18432
    v_mfma_f32_16x16x32_bf16 v[152:155], a[52:55], a[68:71], v[152:155]
    ds_read_b64_tr_b16 a[20:21], v50 offset:8192
    v_mfma_f32_16x16x32_bf16 v[184:187], a[48:51], a[72:75], v[184:187]
    ds_read_b128 a[108:111], v63 offset:18432
    v_mfma_f32_16x16x32_bf16 v[184:187], a[52:55], a[76:79], v[184:187]
    ds_read_b64_tr_b16 a[22:23], v50 offset:9216
    v_mfma_f32_16x16x32_bf16 v[216:219], a[48:51], a[80:83], v[216:219]
    s_waitcnt vmcnt(10)
    ds_read_b128 a[112:115], v62 offset:49152
    v_mfma_f32_16x16x32_bf16 v[216:219], a[52:55], a[84:87], v[216:219]
    ds_read_b64_tr_b16 a[24:25], v51
    ds_read_b128 a[116:119], v63 offset:49152
    ds_read_b64_tr_b16 a[26:27], v51 offset:1024
    v_mfma_f32_16x16x32_bf16 v[156:159], a[56:59], a[64:67], v[156:159]
    v_mfma_f32_16x16x32_bf16 v[156:159], a[60:63], a[68:71], v[156:159]
    ds_read_b64_tr_b16 a[28:29], v51 offset:8192
    v_mfma_f32_16x16x32_bf16 v[188:191], a[56:59], a[72:75], v[188:191]
    v_mfma_f32_16x16x32_bf16 v[188:191], a[60:63], a[76:79], v[188:191]
    ds_read_b64_tr_b16 a[30:31], v51 offset:9216
    v_mfma_f32_16x16x32_bf16 v[220:223], a[56:59], a[80:83], v[220:223]
    v_mfma_f32_16x16x32_bf16 v[220:223], a[60:63], a[84:87], v[220:223]
    s_waitcnt lgkmcnt(6)
    v_mfma_f32_16x16x32_bf16 v[128:131], a[0:3], a[96:99], v[128:131]
    ds_read_b64_tr_b16 a[32:33], v52
    s_add_u32 m0, s53, 0x24000
    v_mfma_f32_16x16x32_bf16 v[128:131], a[4:7], a[100:103], v[128:131]
    ds_read_b64_tr_b16 a[34:35], v52 offset:1024
    s_mov_b32 s65, 0x480000
    v_mfma_f32_16x16x32_bf16 v[160:163], a[0:3], a[104:107], v[160:163]
    ds_read_b64_tr_b16 a[36:37], v52 offset:8192
    buffer_load_dwordx4 v56, s[8:11], s65 offen lds
    v_mfma_f32_16x16x32_bf16 v[160:163], a[4:7], a[108:111], v[160:163]
    s_waitcnt lgkmcnt(4)
    v_mfma_f32_16x16x32_bf16 v[192:195], a[0:3], a[112:115], v[192:195]
    ds_read_b64_tr_b16 a[38:39], v52 offset:9216
    v_mfma_f32_16x16x32_bf16 v[192:195], a[4:7], a[116:119], v[192:195]
    ds_read_b64_tr_b16 a[40:41], v53
    ds_read_b64_tr_b16 a[42:43], v53 offset:1024
    buffer_load_dwordx4 v57, s[8:11], s65 offen offset:1024 lds
    v_mfma_f32_16x16x32_bf16 v[132:135], a[8:11], a[96:99], v[132:135]
    ds_read_b64_tr_b16 a[44:45], v53 offset:8192
    v_mfma_f32_16x16x32_bf16 v[132:135], a[12:15], a[100:103], v[132:135]
    ds_read_b64_tr_b16 a[46:47], v53 offset:9216
    v_mfma_f32_16x16x32_bf16 v[164:167], a[8:11], a[104:107], v[164:167]
    ds_read_b64_tr_b16 a[48:49], v54
    v_mfma_f32_16x16x32_bf16 v[164:167], a[12:15], a[108:111], v[164:167]
    v_mfma_f32_16x16x32_bf16 v[196:199], a[8:11], a[112:115], v[196:199]
    ds_read_b64_tr_b16 a[50:51], v54 offset:1024
    buffer_load_dwordx4 v58, s[8:11], s65 offen offset:2048 lds
    v_mfma_f32_16x16x32_bf16 v[196:199], a[12:15], a[116:119], v[196:199]
    ds_read_b64_tr_b16 a[52:53], v54 offset:8192
    ds_read_b64_tr_b16 a[54:55], v54 offset:9216
    v_mfma_f32_16x16x32_bf16 v[136:139], a[16:19], a[96:99], v[136:139]
    ds_read_b64_tr_b16 a[56:57], v55
    v_mfma_f32_16x16x32_bf16 v[136:139], a[20:23], a[100:103], v[136:139]
    ds_read_b64_tr_b16 a[58:59], v55 offset:1024
    buffer_load_dwordx4 v59, s[8:11], s65 offen offset:3072 lds
    v_mfma_f32_16x16x32_bf16 v[168:171], a[16:19], a[104:107], v[168:171]
    ds_read_b64_tr_b16 a[60:61], v55 offset:8192
    v_mfma_f32_16x16x32_bf16 v[168:171], a[20:23], a[108:111], v[168:171]
    s_add_u32 m0, s53, 0xc000
    s_mov_b32 s63, 0x480
    v_mfma_f32_16x16x32_bf16 v[200:203], a[16:19], a[112:115], v[200:203]
    ds_read_b64_tr_b16 a[62:63], v55 offset:9216
    buffer_load_dwordx4 v60, s[4:7], s63 offen lds
    v_mfma_f32_16x16x32_bf16 v[200:203], a[20:23], a[116:119], v[200:203]
    v_mfma_f32_16x16x32_bf16 v[140:143], a[24:27], a[96:99], v[140:143]
    s_waitcnt lgkmcnt(6)
    v_mfma_f32_16x16x32_bf16 v[140:143], a[28:31], a[100:103], v[140:143]
    v_mfma_f32_16x16x32_bf16 v[172:175], a[24:27], a[104:107], v[172:175]
    buffer_load_dwordx4 v61, s[4:7], s63 offen offset:1024 lds
    v_mfma_f32_16x16x32_bf16 v[172:175], a[28:31], a[108:111], v[172:175]
    v_mfma_f32_16x16x32_bf16 v[204:207], a[24:27], a[112:115], v[204:207]
    s_waitcnt vmcnt(12) lgkmcnt(0)
    s_barrier
    v_mfma_f32_16x16x32_bf16 v[204:207], a[28:31], a[116:119], v[204:207]
    ds_read_b64_tr_b16 a[0:1], v48 offset:16384
    s_add_u32 m0, s53, 0xc800
    s_mov_b32 s63, 0x5480
    ds_read_b64_tr_b16 a[2:3], v48 offset:17408
    buffer_load_dwordx4 v60, s[4:7], s63 offen lds
    v_mfma_f32_16x16x32_bf16 v[144:147], a[32:35], a[96:99], v[144:147]
    v_mfma_f32_16x16x32_bf16 v[144:147], a[36:39], a[100:103], v[144:147]
    ds_read_b64_tr_b16 a[4:5], v48 offset:24576
    v_mfma_f32_16x16x32_bf16 v[176:179], a[32:35], a[104:107], v[176:179]
    v_mfma_f32_16x16x32_bf16 v[176:179], a[36:39], a[108:111], v[176:179]
    ds_read_b64_tr_b16 a[6:7], v48 offset:25600
    v_mfma_f32_16x16x32_bf16 v[208:211], a[32:35], a[112:115], v[208:211]
    buffer_load_dwordx4 v61, s[4:7], s63 offen offset:1024 lds
    v_mfma_f32_16x16x32_bf16 v[208:211], a[36:39], a[116:119], v[208:211]
    ds_read_b64_tr_b16 a[8:9], v49 offset:16384
    ds_read_b64_tr_b16 a[10:11], v49 offset:17408
    s_add_u32 m0, s53, 0x14000
    v_mfma_f32_16x16x32_bf16 v[148:151], a[40:43], a[96:99], v[148:151]
    s_mov_b32 s63, 0xa480
    v_mfma_f32_16x16x32_bf16 v[148:151], a[44:47], a[100:103], v[148:151]
    ds_read_b64_tr_b16 a[12:13], v49 offset:24576
    buffer_load_dwordx4 v60, s[4:7], s63 offen lds
    v_mfma_f32_16x16x32_bf16 v[180:183], a[40:43], a[104:107], v[180:183]
    v_mfma_f32_16x16x32_bf16 v[180:183], a[44:47], a[108:111], v[180:183]
    ds_read_b64_tr_b16 a[14:15], v49 offset:25600
    v_mfma_f32_16x16x32_bf16 v[212:215], a[40:43], a[112:115], v[212:215]
    s_waitcnt vmcnt(13)
    ds_read_b128 a[64:67], v62 offset:32768
    v_mfma_f32_16x16x32_bf16 v[212:215], a[44:47], a[116:119], v[212:215]
    ds_read_b64_tr_b16 a[16:17], v50 offset:16384
    ds_read_b128 a[68:71], v63 offset:32768
    buffer_load_dwordx4 v61, s[4:7], s63 offen offset:1024 lds
    ds_read_b64_tr_b16 a[18:19], v50 offset:17408
    v_mfma_f32_16x16x32_bf16 v[152:155], a[48:51], a[96:99], v[152:155]
    s_waitcnt vmcnt(12)
    ds_read_b128 a[72:75], v62 offset:34816
    v_mfma_f32_16x16x32_bf16 v[152:155], a[52:55], a[100:103], v[152:155]
    ds_read_b64_tr_b16 a[20:21], v50 offset:24576
    v_mfma_f32_16x16x32_bf16 v[184:187], a[48:51], a[104:107], v[184:187]
    ds_read_b128 a[76:79], v63 offset:34816
    v_mfma_f32_16x16x32_bf16 v[184:187], a[52:55], a[108:111], v[184:187]
    ds_read_b64_tr_b16 a[22:23], v50 offset:25600
    v_mfma_f32_16x16x32_bf16 v[216:219], a[48:51], a[112:115], v[216:219]
    s_waitcnt vmcnt(10)
    ds_read_b128 a[80:83], v62
    v_mfma_f32_16x16x32_bf16 v[216:219], a[52:55], a[116:119], v[216:219]
    ds_read_b64_tr_b16 a[24:25], v51 offset:16384
    ds_read_b128 a[84:87], v63
    ds_read_b64_tr_b16 a[26:27], v51 offset:17408
    v_mfma_f32_16x16x32_bf16 v[156:159], a[56:59], a[96:99], v[156:159]
    v_mfma_f32_16x16x32_bf16 v[156:159], a[60:63], a[100:103], v[156:159]
    ds_read_b64_tr_b16 a[28:29], v51 offset:24576
    v_mfma_f32_16x16x32_bf16 v[188:191], a[56:59], a[104:107], v[188:191]
    v_mfma_f32_16x16x32_bf16 v[188:191], a[60:63], a[108:111], v[188:191]
    ds_read_b64_tr_b16 a[30:31], v51 offset:25600
    v_mfma_f32_16x16x32_bf16 v[220:223], a[56:59], a[112:115], v[220:223]
    v_mfma_f32_16x16x32_bf16 v[220:223], a[60:63], a[116:119], v[220:223]
    s_waitcnt lgkmcnt(6)
    v_mfma_f32_16x16x32_bf16 v[128:131], a[0:3], a[64:67], v[128:131]
    ds_read_b64_tr_b16 a[32:33], v52 offset:16384
    v_mfma_f32_16x16x32_bf16 v[128:131], a[4:7], a[68:71], v[128:131]
    ds_read_b64_tr_b16 a[34:35], v52 offset:17408
    v_mfma_f32_16x16x32_bf16 v[160:163], a[0:3], a[72:75], v[160:163]
    ds_read_b64_tr_b16 a[36:37], v52 offset:24576
    v_mfma_f32_16x16x32_bf16 v[160:163], a[4:7], a[76:79], v[160:163]
    s_waitcnt lgkmcnt(4)
    v_mfma_f32_16x16x32_bf16 v[192:195], a[0:3], a[80:83], v[192:195]
    ds_read_b64_tr_b16 a[38:39], v52 offset:25600
    s_add_u32 m0, s53, 0
    s_mov_b32 s64, 0
    buffer_load_dwordx4 v20, s[12:15], s64 offen nt lds
    v_mfma_f32_16x16x32_bf16 v[192:195], a[4:7], a[84:87], v[192:195]
    ds_read_b64_tr_b16 a[40:41], v53 offset:16384
    ds_read_b64_tr_b16 a[42:43], v53 offset:17408
    v_mfma_f32_16x16x32_bf16 v[132:135], a[8:11], a[64:67], v[132:135]
    ds_read_b64_tr_b16 a[44:45], v53 offset:24576
    v_mfma_f32_16x16x32_bf16 v[132:135], a[12:15], a[68:71], v[132:135]
    ds_read_b64_tr_b16 a[46:47], v53 offset:25600
    v_mfma_f32_16x16x32_bf16 v[164:167], a[8:11], a[72:75], v[164:167]
    ds_read_b64_tr_b16 a[48:49], v54 offset:16384
    v_mfma_f32_16x16x32_bf16 v[164:167], a[12:15], a[76:79], v[164:167]
    buffer_load_dwordx4 v21, s[12:15], s64 offen offset:1024 nt lds
    v_mfma_f32_16x16x32_bf16 v[196:199], a[8:11], a[80:83], v[196:199]
    ds_read_b64_tr_b16 a[50:51], v54 offset:17408
    v_mfma_f32_16x16x32_bf16 v[196:199], a[12:15], a[84:87], v[196:199]
    ds_read_b64_tr_b16 a[52:53], v54 offset:24576
    ds_read_b64_tr_b16 a[54:55], v54 offset:25600
    v_mfma_f32_16x16x32_bf16 v[136:139], a[16:19], a[64:67], v[136:139]
    ds_read_b64_tr_b16 a[56:57], v55 offset:16384
    v_mfma_f32_16x16x32_bf16 v[136:139], a[20:23], a[68:71], v[136:139]
    ds_read_b64_tr_b16 a[58:59], v55 offset:17408
    v_mfma_f32_16x16x32_bf16 v[168:171], a[16:19], a[72:75], v[168:171]
    ds_read_b64_tr_b16 a[60:61], v55 offset:24576
    buffer_load_dwordx4 v22, s[12:15], s64 offen offset:2048 nt lds
    v_mfma_f32_16x16x32_bf16 v[168:171], a[20:23], a[76:79], v[168:171]
    v_mfma_f32_16x16x32_bf16 v[200:203], a[16:19], a[80:83], v[200:203]
    ds_read_b64_tr_b16 a[62:63], v55 offset:25600
    v_mfma_f32_16x16x32_bf16 v[200:203], a[20:23], a[84:87], v[200:203]
    v_mfma_f32_16x16x32_bf16 v[140:143], a[24:27], a[64:67], v[140:143]
    s_waitcnt lgkmcnt(6)
    v_mfma_f32_16x16x32_bf16 v[140:143], a[28:31], a[68:71], v[140:143]
    buffer_load_dwordx4 v23, s[12:15], s64 offen offset:3072 nt lds
    v_mfma_f32_16x16x32_bf16 v[172:175], a[24:27], a[72:75], v[172:175]
    v_mfma_f32_16x16x32_bf16 v[172:175], a[28:31], a[76:79], v[172:175]
    v_mfma_f32_16x16x32_bf16 v[204:207], a[24:27], a[80:83], v[204:207]
    s_waitcnt vmcnt(10) lgkmcnt(0)
    s_barrier
    v_mfma_f32_16x16x32_bf16 v[204:207], a[28:31], a[84:87], v[204:207]
    ds_read_b64_tr_b16 a[0:1], v48 offset:32768
    ds_read_b64_tr_b16 a[2:3], v48 offset:33792
    ds_read_b64_tr_b16 a[4:5], v48 offset:40960
    v_mfma_f32_16x16x32_bf16 v[144:147], a[32:35], a[64:67], v[144:147]
    ds_read_b64_tr_b16 a[6:7], v48 offset:41984
    s_add_u32 m0, s53, 0x18000
    s_mov_b32 s64, 0
    buffer_load_dwordx4 v24, s[16:19], s64 offen nt lds
    v_mfma_f32_16x16x32_bf16 v[144:147], a[36:39], a[68:71], v[144:147]
    ds_read_b64_tr_b16 a[8:9], v49 offset:32768
    v_mfma_f32_16x16x32_bf16 v[176:179], a[32:35], a[72:75], v[176:179]
    ds_read_b64_tr_b16 a[10:11], v49 offset:33792
    v_mfma_f32_16x16x32_bf16 v[176:179], a[36:39], a[76:79], v[176:179]
    ds_read_b64_tr_b16 a[12:13], v49 offset:40960
    v_mfma_f32_16x16x32_bf16 v[208:211], a[32:35], a[80:83], v[208:211]
    ds_read_b64_tr_b16 a[14:15], v49 offset:41984
    v_mfma_f32_16x16x32_bf16 v[208:211], a[36:39], a[84:87], v[208:211]
    ds_read_b64_tr_b16 a[16:17], v50 offset:32768
    ds_read_b64_tr_b16 a[18:19], v50 offset:33792
    ds_read_b64_tr_b16 a[20:21], v50 offset:40960
    buffer_load_dwordx4 v25, s[16:19], s64 offen offset:1024 nt lds
    v_mfma_f32_16x16x32_bf16 v[148:151], a[40:43], a[64:67], v[148:151]
    ds_read_b64_tr_b16 a[22:23], v50 offset:41984
    v_mfma_f32_16x16x32_bf16 v[148:151], a[44:47], a[68:71], v[148:151]
    ds_read_b64_tr_b16 a[24:25], v51 offset:32768
    v_mfma_f32_16x16x32_bf16 v[180:183], a[40:43], a[72:75], v[180:183]
    ds_read_b64_tr_b16 a[26:27], v51 offset:33792
    v_mfma_f32_16x16x32_bf16 v[180:183], a[44:47], a[76:79], v[180:183]
    ds_read_b64_tr_b16 a[28:29], v51 offset:40960
    v_mfma_f32_16x16x32_bf16 v[212:215], a[40:43], a[80:83], v[212:215]
    ds_read_b64_tr_b16 a[30:31], v51 offset:41984
    s_waitcnt vmcnt(10)
    ds_read_b128 a[96:99], v62 offset:16384
    v_mfma_f32_16x16x32_bf16 v[212:215], a[44:47], a[84:87], v[212:215]
    ds_read_b64_tr_b16 a[32:33], v52 offset:32768
    ds_read_b64_tr_b16 a[34:35], v52 offset:33792
    ds_read_b128 a[100:103], v63 offset:16384
    buffer_load_dwordx4 v24, s[16:19], s64 offen offset:2048 nt lds
    ds_read_b64_tr_b16 a[36:37], v52 offset:40960
    v_mfma_f32_16x16x32_bf16 v[152:155], a[48:51], a[64:67], v[152:155]
    ds_read_b64_tr_b16 a[38:39], v52 offset:41984
    s_waitcnt vmcnt(9)
    ds_read_b128 a[104:107], v62 offset:18432
    v_mfma_f32_16x16x32_bf16 v[152:155], a[52:55], a[68:71], v[152:155]
    ds_read_b64_tr_b16 a[40:41], v53 offset:32768
    v_mfma_f32_16x16x32_bf16 v[184:187], a[48:51], a[72:75], v[184:187]
    ds_read_b64_tr_b16 a[42:43], v53 offset:33792
    ds_read_b128 a[108:111], v63 offset:18432
    v_mfma_f32_16x16x32_bf16 v[184:187], a[52:55], a[76:79], v[184:187]
    ds_read_b64_tr_b16 a[44:45], v53 offset:40960
    v_mfma_f32_16x16x32_bf16 v[216:219], a[48:51], a[80:83], v[216:219]
    ds_read_b64_tr_b16 a[46:47], v53 offset:41984
    s_waitcnt vmcnt(7)
    ds_read_b128 a[112:115], v62 offset:49152
    v_mfma_f32_16x16x32_bf16 v[216:219], a[52:55], a[84:87], v[216:219]
    buffer_load_dwordx4 v25, s[16:19], s64 offen offset:3072 nt lds
    ds_read_b128 a[116:119], v63 offset:49152
    v_mfma_f32_16x16x32_bf16 v[156:159], a[56:59], a[64:67], v[156:159]
    ds_read_b64_tr_b16 a[48:49], v54 offset:32768
    v_mfma_f32_16x16x32_bf16 v[156:159], a[60:63], a[68:71], v[156:159]
    ds_read_b64_tr_b16 a[50:51], v54 offset:33792
    v_mfma_f32_16x16x32_bf16 v[188:191], a[56:59], a[72:75], v[188:191]
    ds_read_b64_tr_b16 a[52:53], v54 offset:40960
    v_mfma_f32_16x16x32_bf16 v[188:191], a[60:63], a[76:79], v[188:191]
    ds_read_b64_tr_b16 a[54:55], v54 offset:41984
    v_mfma_f32_16x16x32_bf16 v[220:223], a[56:59], a[80:83], v[220:223]
    v_mfma_f32_16x16x32_bf16 v[220:223], a[60:63], a[84:87], v[220:223]
    s_waitcnt lgkmcnt(7)
    v_mfma_f32_16x16x32_bf16 v[128:131], a[0:3], a[96:99], v[128:131]
    ds_read_b64_tr_b16 a[56:57], v55 offset:32768
    v_mfma_f32_16x16x32_bf16 v[128:131], a[4:7], a[100:103], v[128:131]
    ds_read_b64_tr_b16 a[58:59], v55 offset:33792
    v_mfma_f32_16x16x32_bf16 v[132:135], a[8:11], a[96:99], v[132:135]
    ds_read_b64_tr_b16 a[60:61], v55 offset:40960
    v_mfma_f32_16x16x32_bf16 v[132:135], a[12:15], a[100:103], v[132:135]
    ds_read_b64_tr_b16 a[62:63], v55 offset:41984
    v_mfma_f32_16x16x32_bf16 v[136:139], a[16:19], a[96:99], v[136:139]
    s_add_u32 m0, s53, 0x4000
    s_mov_b32 s64, 0x4000
    buffer_load_dwordx4 v20, s[12:15], s64 offen nt lds
    v_mfma_f32_16x16x32_bf16 v[136:139], a[20:23], a[100:103], v[136:139]
    v_mfma_f32_16x16x32_bf16 v[140:143], a[24:27], a[96:99], v[140:143]
    v_mfma_f32_16x16x32_bf16 v[140:143], a[28:31], a[100:103], v[140:143]
    v_mfma_f32_16x16x32_bf16 v[144:147], a[32:35], a[96:99], v[144:147]
    v_mfma_f32_16x16x32_bf16 v[144:147], a[36:39], a[100:103], v[144:147]
    v_mfma_f32_16x16x32_bf16 v[148:151], a[40:43], a[96:99], v[148:151]
    s_waitcnt lgkmcnt(1)
    v_mfma_f32_16x16x32_bf16 v[148:151], a[44:47], a[100:103], v[148:151]
    buffer_load_dwordx4 v21, s[12:15], s64 offen offset:1024 nt lds
    v_mfma_f32_16x16x32_bf16 v[152:155], a[48:51], a[96:99], v[152:155]
    v_mfma_f32_16x16x32_bf16 v[152:155], a[52:55], a[100:103], v[152:155]
    v_mfma_f32_16x16x32_bf16 v[156:159], a[56:59], a[96:99], v[156:159]
    s_waitcnt lgkmcnt(0)
    v_mfma_f32_16x16x32_bf16 v[156:159], a[60:63], a[100:103], v[156:159]
    v_mfma_f32_16x16x32_bf16 v[160:163], a[0:3], a[104:107], v[160:163]
    v_mfma_f32_16x16x32_bf16 v[160:163], a[4:7], a[108:111], v[160:163]
    v_mfma_f32_16x16x32_bf16 v[164:167], a[8:11], a[104:107], v[164:167]
    buffer_load_dwordx4 v22, s[12:15], s64 offen offset:2048 nt lds
    v_mfma_f32_16x16x32_bf16 v[164:167], a[12:15], a[108:111], v[164:167]
    v_mfma_f32_16x16x32_bf16 v[168:171], a[16:19], a[104:107], v[168:171]
    v_mfma_f32_16x16x32_bf16 v[168:171], a[20:23], a[108:111], v[168:171]
    v_mul_f32 v128, s70, v128
    v_mul_f32 v129, s70, v129
    v_mul_f32 v130, s70, v130
    v_mul_f32 v131, s70, v131
    v_cvt_pk_bf16_f32 v80, v128, v129
    v_mfma_f32_16x16x32_bf16 v[172:175], a[24:27], a[104:107], v[172:175]
    v_cvt_pk_bf16_f32 v81, v130, v131
    v_mul_f32 v132, s70, v132
    v_mul_f32 v133, s70, v133
    v_mul_f32 v134, s70, v134
    v_mul_f32 v135, s70, v135
    v_mfma_f32_16x16x32_bf16 v[172:175], a[28:31], a[108:111], v[172:175]
    v_cvt_pk_bf16_f32 v82, v132, v133
    v_cvt_pk_bf16_f32 v83, v134, v135
    v_mul_f32 v136, s70, v136
    v_mul_f32 v137, s70, v137
    v_mul_f32 v138, s70, v138
    v_mfma_f32_16x16x32_bf16 v[176:179], a[32:35], a[104:107], v[176:179]
    v_mul_f32 v139, s70, v139
    v_cvt_pk_bf16_f32 v84, v136, v137
    v_cvt_pk_bf16_f32 v85, v138, v139
    v_mul_f32 v140, s70, v140
    v_mul_f32 v141, s70, v141
    v_mfma_f32_16x16x32_bf16 v[176:179], a[36:39], a[108:111], v[176:179]
    buffer_load_dwordx4 v23, s[12:15], s64 offen offset:3072 nt lds
    v_mul_f32 v142, s70, v142
    v_mul_f32 v143, s70, v143
    v_cvt_pk_bf16_f32 v86, v140, v141
    v_cvt_pk_bf16_f32 v87, v142, v143
    v_permlane32_swap_b32 v80, v82
    v_mfma_f32_16x16x32_bf16 v[180:183], a[40:43], a[104:107], v[180:183]
    v_permlane32_swap_b32 v81, v83
    v_permlane32_swap_b32 v84, v86
    v_permlane32_swap_b32 v85, v87
    v_permlane16_swap_b32 v80, v82
    v_permlane16_swap_b32 v81, v83
    v_mfma_f32_16x16x32_bf16 v[180:183], a[44:47], a[108:111], v[180:183]
    v_permlane16_swap_b32 v84, v86
    v_permlane16_swap_b32 v85, v87
    v_accvgpr_write_b32 a192, v80
    v_accvgpr_write_b32 a193, v81
    v_accvgpr_write_b32 a194, v82
    v_mfma_f32_16x16x32_bf16 v[184:187], a[48:51], a[104:107], v[184:187]
    v_accvgpr_write_b32 a195, v83
    v_accvgpr_write_b32 a196, v84
    v_accvgpr_write_b32 a197, v85
    v_accvgpr_write_b32 a198, v86
    v_accvgpr_write_b32 a199, v87
    v_mfma_f32_16x16x32_bf16 v[184:187], a[52:55], a[108:111], v[184:187]
    v_mul_f32 v144, s70, v144
    v_mul_f32 v145, s70, v145
    v_mul_f32 v146, s70, v146
    v_mul_f32 v147, s70, v147
    v_cvt_pk_bf16_f32 v80, v144, v145
    v_mfma_f32_16x16x32_bf16 v[188:191], a[56:59], a[104:107], v[188:191]
    v_cvt_pk_bf16_f32 v81, v146, v147
    v_mul_f32 v148, s70, v148
    v_mul_f32 v149, s70, v149
    v_mul_f32 v150, s70, v150
    v_mul_f32 v151, s70, v151
    v_mfma_f32_16x16x32_bf16 v[188:191], a[60:63], a[108:111], v[188:191]
    v_cvt_pk_bf16_f32 v82, v148, v149
    v_cvt_pk_bf16_f32 v83, v150, v151
    v_mul_f32 v152, s70, v152
    v_mul_f32 v153, s70, v153
    v_mul_f32 v154, s70, v154
    v_mfma_f32_16x16x32_bf16 v[192:195], a[0:3], a[112:115], v[192:195]
    s_add_u32 m0, s53, 0x10000
    s_mov_b32 s64, 0x4000
    buffer_load_dwordx4 v24, s[16:19], s64 offen nt lds
    v_mul_f32 v155, s70, v155
    v_cvt_pk_bf16_f32 v84, v152, v153
    v_cvt_pk_bf16_f32 v85, v154, v155
    v_mul_f32 v156, s70, v156
    v_mul_f32 v157, s70, v157
    v_mfma_f32_16x16x32_bf16 v[192:195], a[4:7], a[116:119], v[192:195]
    v_mul_f32 v158, s70, v158
    v_mul_f32 v159, s70, v159
    v_cvt_pk_bf16_f32 v86, v156, v157
    v_cvt_pk_bf16_f32 v87, v158, v159
    v_permlane32_swap_b32 v80, v82
    v_mfma_f32_16x16x32_bf16 v[196:199], a[8:11], a[112:115], v[196:199]
    v_permlane32_swap_b32 v81, v83
    v_permlane32_swap_b32 v84, v86
    v_permlane32_swap_b32 v85, v87
    v_permlane16_swap_b32 v80, v82
    v_permlane16_swap_b32 v81, v83
    v_mfma_f32_16x16x32_bf16 v[196:199], a[12:15], a[116:119], v[196:199]
    v_permlane16_swap_b32 v84, v86
    v_permlane16_swap_b32 v85, v87
    v_accvgpr_write_b32 a200, v80
    v_accvgpr_write_b32 a201, v81
    v_accvgpr_write_b32 a202, v82
    v_mfma_f32_16x16x32_bf16 v[200:203], a[16:19], a[112:115], v[200:203]
    v_accvgpr_write_b32 a203, v83
    v_accvgpr_write_b32 a204, v84
    v_accvgpr_write_b32 a205, v85
    v_accvgpr_write_b32 a206, v86
    v_accvgpr_write_b32 a207, v87
    v_mfma_f32_16x16x32_bf16 v[200:203], a[20:23], a[116:119], v[200:203]
    v_mul_f32 v160, s70, v160
    v_mul_f32 v161, s70, v161
    v_mul_f32 v162, s70, v162
    v_mul_f32 v163, s70, v163
    v_cvt_pk_bf16_f32 v80, v160, v161
    v_mfma_f32_16x16x32_bf16 v[204:207], a[24:27], a[112:115], v[204:207]
    v_cvt_pk_bf16_f32 v81, v162, v163
    v_mul_f32 v164, s70, v164
    v_mul_f32 v165, s70, v165
    v_mul_f32 v166, s70, v166
    v_mul_f32 v167, s70, v167
    v_mfma_f32_16x16x32_bf16 v[204:207], a[28:31], a[116:119], v[204:207]
    buffer_load_dwordx4 v25, s[16:19], s64 offen offset:1024 nt lds
    v_cvt_pk_bf16_f32 v82, v164, v165
    v_cvt_pk_bf16_f32 v83, v166, v167
    v_mul_f32 v168, s70, v168
    v_mul_f32 v169, s70, v169
    v_mul_f32 v170, s70, v170
    v_mfma_f32_16x16x32_bf16 v[208:211], a[32:35], a[112:115], v[208:211]
    v_mul_f32 v171, s70, v171
    v_cvt_pk_bf16_f32 v84, v168, v169
    v_cvt_pk_bf16_f32 v85, v170, v171
    v_mul_f32 v172, s70, v172
    v_mul_f32 v173, s70, v173
    v_mfma_f32_16x16x32_bf16 v[208:211], a[36:39], a[116:119], v[208:211]
    v_mul_f32 v174, s70, v174
    v_mul_f32 v175, s70, v175
    v_cvt_pk_bf16_f32 v86, v172, v173
    v_cvt_pk_bf16_f32 v87, v174, v175
    v_permlane32_swap_b32 v80, v82
    v_mfma_f32_16x16x32_bf16 v[212:215], a[40:43], a[112:115], v[212:215]
    v_permlane32_swap_b32 v81, v83
    v_permlane32_swap_b32 v84, v86
    v_permlane32_swap_b32 v85, v87
    v_permlane16_swap_b32 v80, v82
    v_permlane16_swap_b32 v81, v83
    v_mfma_f32_16x16x32_bf16 v[212:215], a[44:47], a[116:119], v[212:215]
    v_permlane16_swap_b32 v84, v86
    v_permlane16_swap_b32 v85, v87
    v_accvgpr_write_b32 a208, v80
    v_accvgpr_write_b32 a209, v81
    v_accvgpr_write_b32 a210, v82
    v_mfma_f32_16x16x32_bf16 v[216:219], a[48:51], a[112:115], v[216:219]
    v_accvgpr_write_b32 a211, v83
    v_accvgpr_write_b32 a212, v84
    v_accvgpr_write_b32 a213, v85
    v_accvgpr_write_b32 a214, v86
    v_accvgpr_write_b32 a215, v87
    v_mfma_f32_16x16x32_bf16 v[216:219], a[52:55], a[116:119], v[216:219]
    v_mul_f32 v176, s70, v176
    v_mul_f32 v177, s70, v177
    v_mul_f32 v178, s70, v178
    v_mul_f32 v179, s70, v179
    v_cvt_pk_bf16_f32 v80, v176, v177
    v_mfma_f32_16x16x32_bf16 v[220:223], a[56:59], a[112:115], v[220:223]
    buffer_load_dwordx4 v24, s[16:19], s64 offen offset:2048 nt lds
    v_cvt_pk_bf16_f32 v81, v178, v179
    v_mul_f32 v180, s70, v180
    v_mul_f32 v181, s70, v181
    v_mul_f32 v182, s70, v182
    v_mul_f32 v183, s70, v183
    v_mfma_f32_16x16x32_bf16 v[220:223], a[60:63], a[116:119], v[220:223]
    v_cvt_pk_bf16_f32 v82, v180, v181
    v_cvt_pk_bf16_f32 v83, v182, v183
    v_mul_f32 v184, s70, v184
    v_mul_f32 v185, s70, v185
    v_mul_f32 v186, s70, v186
    v_mul_f32 v187, s70, v187
    v_cvt_pk_bf16_f32 v84, v184, v185
    v_cvt_pk_bf16_f32 v85, v186, v187
    v_mul_f32 v188, s70, v188
    v_mul_f32 v189, s70, v189
    v_mul_f32 v190, s70, v190
    v_mul_f32 v191, s70, v191
    v_cvt_pk_bf16_f32 v86, v188, v189
    v_cvt_pk_bf16_f32 v87, v190, v191
    v_permlane32_swap_b32 v80, v82
    s_waitcnt vmcnt(11)
    s_barrier
    v_permlane32_swap_b32 v81, v83
    v_permlane32_swap_b32 v84, v86
    v_permlane32_swap_b32 v85, v87
    v_permlane16_swap_b32 v80, v82
    v_permlane16_swap_b32 v81, v83
    ds_read_b128 a[128:131], v8
    v_permlane16_swap_b32 v84, v86
    v_permlane16_swap_b32 v85, v87
    v_accvgpr_write_b32 a216, v80
    v_accvgpr_write_b32 a217, v81
    v_accvgpr_write_b32 a218, v82
    ds_read_b128 a[132:135], v9
    v_accvgpr_write_b32 a219, v83
    v_accvgpr_write_b32 a220, v84
    v_accvgpr_write_b32 a221, v85
    v_accvgpr_write_b32 a222, v86
    v_accvgpr_write_b32 a223, v87
    buffer_load_dwordx4 v25, s[16:19], s64 offen offset:3072 nt lds
    ds_read_b128 a[136:139], v10
    v_mul_f32 v192, s70, v192
    v_mul_f32 v193, s70, v193
    v_mul_f32 v194, s70, v194
    v_mul_f32 v195, s70, v195
    v_cvt_pk_bf16_f32 v80, v192, v193
    v_cvt_pk_bf16_f32 v81, v194, v195
    v_mul_f32 v196, s70, v196
    v_mul_f32 v197, s70, v197
    ds_read_b128 a[140:143], v11
    v_mul_f32 v198, s70, v198
    v_mul_f32 v199, s70, v199
    v_cvt_pk_bf16_f32 v82, v196, v197
    v_cvt_pk_bf16_f32 v83, v198, v199
    v_mul_f32 v200, s70, v200
    v_mul_f32 v201, s70, v201
    v_mul_f32 v202, s70, v202
    v_mul_f32 v203, s70, v203
    ds_read_b128 a[144:147], v8 offset:4096
    v_cvt_pk_bf16_f32 v84, v200, v201
    v_cvt_pk_bf16_f32 v85, v202, v203
    v_mul_f32 v204, s70, v204
    v_mul_f32 v205, s70, v205
    v_mul_f32 v206, s70, v206
    v_mul_f32 v207, s70, v207
    v_cvt_pk_bf16_f32 v86, v204, v205
    v_cvt_pk_bf16_f32 v87, v206, v207
    ds_read_b128 a[148:151], v9 offset:4096
    v_permlane32_swap_b32 v80, v82
    v_permlane32_swap_b32 v81, v83
    v_permlane32_swap_b32 v84, v86
    v_permlane32_swap_b32 v85, v87
    v_permlane16_swap_b32 v80, v82
    v_permlane16_swap_b32 v81, v83
    v_permlane16_swap_b32 v84, v86
    ds_read_b128 a[152:155], v10 offset:4096
    v_permlane16_swap_b32 v85, v87
    v_accvgpr_write_b32 a224, v80
    v_accvgpr_write_b32 a225, v81
    v_accvgpr_write_b32 a226, v82
    v_accvgpr_write_b32 a227, v83
    v_accvgpr_write_b32 a228, v84
    v_accvgpr_write_b32 a229, v85
    ds_read_b128 a[156:159], v11 offset:4096
    v_accvgpr_write_b32 a230, v86
    v_accvgpr_write_b32 a231, v87
    v_mul_f32 v208, s70, v208
    v_mul_f32 v209, s70, v209
    v_mul_f32 v210, s70, v210
    v_mul_f32 v211, s70, v211
    v_cvt_pk_bf16_f32 v80, v208, v209
    v_cvt_pk_bf16_f32 v81, v210, v211
    v_mul_f32 v212, s70, v212
    v_mul_f32 v213, s70, v213
    v_mul_f32 v214, s70, v214
    v_mul_f32 v215, s70, v215
    v_cvt_pk_bf16_f32 v82, v212, v213
    v_cvt_pk_bf16_f32 v83, v214, v215
    v_mul_f32 v216, s70, v216
    v_mul_f32 v217, s70, v217
    v_mul_f32 v218, s70, v218
    v_mul_f32 v219, s70, v219
    v_cvt_pk_bf16_f32 v84, v216, v217
    v_cvt_pk_bf16_f32 v85, v218, v219
    v_mul_f32 v220, s70, v220
    v_mul_f32 v221, s70, v221
    v_mul_f32 v222, s70, v222
    v_mul_f32 v223, s70, v223
    v_cvt_pk_bf16_f32 v86, v220, v221
    v_cvt_pk_bf16_f32 v87, v222, v223
    v_permlane32_swap_b32 v80, v82
    v_permlane32_swap_b32 v81, v83
    v_permlane32_swap_b32 v84, v86
    v_permlane32_swap_b32 v85, v87
    v_permlane16_swap_b32 v80, v82
    v_permlane16_swap_b32 v81, v83
    v_permlane16_swap_b32 v84, v86
    v_permlane16_swap_b32 v85, v87
    v_accvgpr_write_b32 a232, v80
    v_accvgpr_write_b32 a233, v81
    v_accvgpr_write_b32 a234, v82
    v_accvgpr_write_b32 a235, v83
    v_accvgpr_write_b32 a236, v84
    v_accvgpr_write_b32 a237, v85
    v_accvgpr_write_b32 a238, v86
    v_accvgpr_write_b32 a239, v87
    s_waitcnt lgkmcnt(0)
    v_mfma_f32_16x16x32_bf16 v[48:51], a[128:131], a[192:195], 0
    v_mfma_f32_16x16x32_bf16 v[48:51], a[132:135], a[196:199], v[48:51]
    v_mfma_f32_16x16x32_bf16 v[48:51], a[136:139], a[200:203], v[48:51]
    v_mfma_f32_16x16x32_bf16 v[48:51], a[140:143], a[204:207], v[48:51]
    v_mfma_f32_16x16x32_bf16 v[56:59], a[128:131], a[208:211], 0
    v_mfma_f32_16x16x32_bf16 v[56:59], a[132:135], a[212:215], v[56:59]
    v_mfma_f32_16x16x32_bf16 v[56:59], a[136:139], a[216:219], v[56:59]
    v_mfma_f32_16x16x32_bf16 v[56:59], a[140:143], a[220:223], v[56:59]
    s_nop 3
    v_max3_f32 v2, v48, v49, v50
    v_max_f32 v2, v2, v51
    v_mov_b32 v3, v2
    s_nop 1
    v_permlane32_swap_b32 v2, v3
    v_max_f32 v2, v2, v3
    v_mov_b32 v3, v2
    s_nop 1
    v_permlane16_swap_b32 v2, v3
    v_min_f32_e64 v96, -v2, -v3
    v_mov_b32 v97, v96
    v_mov_b32 v98, v96
    v_mov_b32 v99, v96
    v_mfma_f32_16x16x32_bf16 v[64:67], a[128:131], a[224:227], 0
    v_mfma_f32_16x16x32_bf16 v[64:67], a[132:135], a[228:231], v[64:67]
    v_mfma_f32_16x16x32_bf16 v[64:67], a[136:139], a[232:235], v[64:67]
    v_mfma_f32_16x16x32_bf16 v[64:67], a[140:143], a[236:239], v[64:67]
    v_max3_f32 v4, v56, v57, v58
    v_max_f32 v4, v4, v59
    v_mov_b32 v5, v4
    s_nop 1
    v_permlane32_swap_b32 v4, v5
    v_max_f32 v4, v4, v5
    v_mov_b32 v5, v4
    s_nop 1
    v_permlane16_swap_b32 v4, v5
    v_min_f32_e64 v100, -v4, -v5
    v_mov_b32 v101, v100
    v_mov_b32 v102, v100
    v_mov_b32 v103, v100
    v_max3_f32 v2, v64, v65, v66
    v_max_f32 v2, v2, v67
    v_mov_b32 v3, v2
    s_nop 1
    v_permlane32_swap_b32 v2, v3
    v_max_f32 v2, v2, v3
    v_mov_b32 v3, v2
    s_nop 1
    v_permlane16_swap_b32 v2, v3
    v_min_f32_e64 v104, -v2, -v3
    v_mov_b32 v105, v104
    v_mov_b32 v106, v104
    v_mov_b32 v107, v104
    v_mfma_f32_16x16x32_bf16 v[48:51], a[128:131], a[192:195], v[96:99]
    v_mfma_f32_16x16x32_bf16 v[48:51], a[132:135], a[196:199], v[48:51]
    v_mfma_f32_16x16x32_bf16 v[48:51], a[136:139], a[200:203], v[48:51]
    v_mfma_f32_16x16x32_bf16 v[48:51], a[140:143], a[204:207], v[48:51]
    v_mfma_f32_16x16x32_bf16 v[52:55], a[144:147], a[192:195], v[96:99]
    v_mfma_f32_16x16x32_bf16 v[52:55], a[148:151], a[196:199], v[52:55]
    v_mfma_f32_16x16x32_bf16 v[52:55], a[152:155], a[200:203], v[52:55]
    v_mfma_f32_16x16x32_bf16 v[52:55], a[156:159], a[204:207], v[52:55]
    s_add_u32 m0, s53, 0x8000
    s_mov_b32 s64, 0x8000
    buffer_load_dwordx4 v20, s[12:15], s64 offen nt lds
    s_nop 0
    v_exp_f32 v48, v48
    s_waitcnt vmcnt(9)
    s_barrier
    ds_read_b64_tr_b16 a[160:161], v12 offset:32768
    v_exp_f32 v49, v49
    ds_read_b64_tr_b16 a[162:163], v12 offset:36864
    v_cvt_pk_bf16_f32 v80, v48, v49
    ds_read_b64_tr_b16 a[164:165], v13 offset:32768
    v_exp_f32 v50, v50
    v_mfma_f32_16x16x32_bf16 v[56:59], a[128:131], a[208:211], v[100:103]
    ds_read_b64_tr_b16 a[166:167], v13 offset:36864
    v_mfma_f32_16x16x32_bf16 v[56:59], a[132:135], a[212:215], v[56:59]
    ds_read_b64_tr_b16 a[168:169], v14 offset:32768
    v_exp_f32 v51, v51
    v_mfma_f32_16x16x32_bf16 v[56:59], a[136:139], a[216:219], v[56:59]
    ds_read_b64_tr_b16 a[170:171], v14 offset:36864
    v_cvt_pk_bf16_f32 v81, v50, v51
    v_mfma_f32_16x16x32_bf16 v[56:59], a[140:143], a[220:223], v[56:59]
    ds_read_b64_tr_b16 a[172:173], v15 offset:32768
    v_exp_f32 v52, v52
    v_mfma_f32_16x16x32_bf16 v[60:63], a[144:147], a[208:211], v[100:103]
    ds_read_b64_tr_b16 a[174:175], v15 offset:36864
    v_mfma_f32_16x16x32_bf16 v[60:63], a[148:151], a[212:215], v[60:63]
    s_add_u32 m0, s53, 0x8000
    s_mov_b32 s64, 0x8000
    buffer_load_dwordx4 v21, s[12:15], s64 offen offset:1024 nt lds
    ds_read_b64_tr_b16 a[176:177], v16 offset:32768
    v_exp_f32 v53, v53
    v_mfma_f32_16x16x32_bf16 v[60:63], a[152:155], a[216:219], v[60:63]
    ds_read_b64_tr_b16 a[178:179], v16 offset:36864
    v_cvt_pk_bf16_f32 v82, v52, v53
    v_mfma_f32_16x16x32_bf16 v[60:63], a[156:159], a[220:223], v[60:63]
    ds_read_b64_tr_b16 a[180:181], v17 offset:32768
    v_exp_f32 v54, v54
    ds_read_b64_tr_b16 a[182:183], v17 offset:36864
    ds_read_b64_tr_b16 a[184:185], v18 offset:32768
    v_exp_f32 v55, v55
    ds_read_b64_tr_b16 a[186:187], v18 offset:36864
    v_cvt_pk_bf16_f32 v83, v54, v55
    ds_read_b64_tr_b16 a[188:189], v19 offset:32768
    ds_read_b64_tr_b16 a[190:191], v19 offset:36864
    v_exp_f32 v56, v56
    v_exp_f32 v57, v57
    s_nop 0
    v_cvt_pk_bf16_f32 v84, v56, v57
    v_exp_f32 v58, v58
    v_mfma_f32_16x16x32_bf16 v[64:67], a[128:131], a[224:227], v[104:107]
    v_mfma_f32_16x16x32_bf16 v[64:67], a[132:135], a[228:231], v[64:67]
    s_add_u32 m0, s53, 0x8000
    s_mov_b32 s64, 0x8000
    buffer_load_dwordx4 v22, s[12:15], s64 offen offset:2048 nt lds
    v_exp_f32 v59, v59
    v_mfma_f32_16x16x32_bf16 v[64:67], a[136:139], a[232:235], v[64:67]
    v_cvt_pk_bf16_f32 v85, v58, v59
    v_mfma_f32_16x16x32_bf16 v[64:67], a[140:143], a[236:239], v[64:67]
    v_exp_f32 v60, v60
    v_mfma_f32_16x16x32_bf16 v[68:71], a[144:147], a[224:227], v[104:107]
    v_mfma_f32_16x16x32_bf16 v[68:71], a[148:151], a[228:231], v[68:71]
    v_exp_f32 v61, v61
    v_mfma_f32_16x16x32_bf16 v[68:71], a[152:155], a[232:235], v[68:71]
    v_cvt_pk_bf16_f32 v86, v60, v61
    v_mfma_f32_16x16x32_bf16 v[68:71], a[156:159], a[236:239], v[68:71]
    v_exp_f32 v62, v62
    s_waitcnt lgkmcnt(0)
    v_mfma_f32_16x16x32_bf16 v[128:131], a[160:163], v[80:83], 0
    v_mfma_f32_16x16x32_bf16 v[132:135], a[164:167], v[80:83], 0
    v_exp_f32 v63, v63
    v_mfma_f32_16x16x32_bf16 v[136:139], a[168:171], v[80:83], 0
    v_cvt_pk_bf16_f32 v87, v62, v63
    v_mfma_f32_16x16x32_bf16 v[140:143], a[172:175], v[80:83], 0
    v_mfma_f32_16x16x32_bf16 v[144:147], a[176:179], v[80:83], 0
    v_exp_f32 v64, v64
    v_mfma_f32_16x16x32_bf16 v[148:151], a[180:183], v[80:83], 0
    ds_read_b128 a[0:3], v8 offset:8192
    v_mfma_f32_16x16x32_bf16 v[152:155], a[184:187], v[80:83], 0
    s_add_u32 m0, s53, 0x8000
    s_mov_b32 s64, 0x8000
    buffer_load_dwordx4 v23, s[12:15], s64 offen offset:3072 nt lds
    v_exp_f32 v65, v65
    v_mfma_f32_16x16x32_bf16 v[156:159], a[188:191], v[80:83], 0
    ds_read_b128 a[4:7], v9 offset:8192
    v_cvt_pk_bf16_f32 v88, v64, v65
    v_mfma_f32_16x16x32_bf16 v[112:115], v[28:31], v[80:83], 0
    v_exp_f32 v66, v66
    ds_read_b128 a[8:11], v10 offset:8192
    v_exp_f32 v67, v67
    ds_read_b128 a[12:15], v11 offset:8192
    v_cvt_pk_bf16_f32 v89, v66, v67
    v_exp_f32 v68, v68
    ds_read_b128 a[16:19], v8 offset:12288
    v_exp_f32 v69, v69
    ds_read_b128 a[20:23], v9 offset:12288
    v_cvt_pk_bf16_f32 v90, v68, v69
    v_exp_f32 v70, v70
    v_mfma_f32_16x16x32_bf16 v[160:163], a[160:163], v[84:87], 0
    v_mfma_f32_16x16x32_bf16 v[164:167], a[164:167], v[84:87], 0
    v_exp_f32 v71, v71
    v_mfma_f32_16x16x32_bf16 v[168:171], a[168:171], v[84:87], 0
    s_add_u32 m0, s53, 0x14000
    s_mov_b32 s64, 0x8000
    buffer_load_dwordx4 v24, s[16:19], s64 offen nt lds
    ds_read_b128 a[24:27], v10 offset:12288
    v_cvt_pk_bf16_f32 v91, v70, v71
    v_mfma_f32_16x16x32_bf16 v[172:175], a[172:175], v[84:87], 0
    v_mfma_f32_16x16x32_bf16 v[176:179], a[176:179], v[84:87], 0
    v_mfma_f32_16x16x32_bf16 v[180:183], a[180:183], v[84:87], 0
    ds_read_b128 a[28:31], v11 offset:12288
    v_mfma_f32_16x16x32_bf16 v[184:187], a[184:187], v[84:87], 0
    v_mfma_f32_16x16x32_bf16 v[188:191], a[188:191], v[84:87], 0
    v_mfma_f32_16x16x32_bf16 v[116:119], v[28:31], v[84:87], 0
    s_waitcnt lgkmcnt(2)
    v_mfma_f32_16x16x32_bf16 v[48:51], a[0:3], a[192:195], v[96:99]
    ds_read_b64_tr_b16 a[32:33], v12 offset:40960
    v_mfma_f32_16x16x32_bf16 v[48:51], a[4:7], a[196:199], v[48:51]
    v_mfma_f32_16x16x32_bf16 v[48:51], a[8:11], a[200:203], v[48:51]
    ds_read_b64_tr_b16 a[34:35], v12 offset:45056
    v_mfma_f32_16x16x32_bf16 v[48:51], a[12:15], a[204:207], v[48:51]
    v_mfma_f32_16x16x32_bf16 v[52:55], a[16:19], a[192:195], v[96:99]
    ds_read_b64_tr_b16 a[36:37], v13 offset:40960
    v_mfma_f32_16x16x32_bf16 v[52:55], a[20:23], a[196:199], v[52:55]
    s_waitcnt lgkmcnt(3)
    v_mfma_f32_16x16x32_bf16 v[52:55], a[24:27], a[200:203], v[52:55]
    s_add_u32 m0, s53, 0x14000
    s_mov_b32 s64, 0x8000
    buffer_load_dwordx4 v25, s[16:19], s64 offen offset:1024 nt lds
    ds_read_b64_tr_b16 a[38:39], v13 offset:45056
    v_mfma_f32_16x16x32_bf16 v[52:55], a[28:31], a[204:207], v[52:55]
    v_mfma_f32_16x16x32_bf16 v[192:195], a[160:163], v[88:91], 0
    v_mfma_f32_16x16x32_bf16 v[196:199], a[164:167], v[88:91], 0
    v_mfma_f32_16x16x32_bf16 v[200:203], a[168:171], v[88:91], 0
    ds_read_b64_tr_b16 a[40:41], v14 offset:40960
    v_mfma_f32_16x16x32_bf16 v[204:207], a[172:175], v[88:91], 0
    ds_read_b64_tr_b16 a[42:43], v14 offset:45056
    v_mfma_f32_16x16x32_bf16 v[208:211], a[176:179], v[88:91], 0
    v_exp_f32 v48, v48
    v_mfma_f32_16x16x32_bf16 v[212:215], a[180:183], v[88:91], 0
    ds_read_b64_tr_b16 a[44:45], v15 offset:40960
    v_mfma_f32_16x16x32_bf16 v[216:219], a[184:187], v[88:91], 0
    v_exp_f32 v49, v49
    v_mfma_f32_16x16x32_bf16 v[220:223], a[188:191], v[88:91], 0
    ds_read_b64_tr_b16 a[46:47], v15 offset:45056
    v_cvt_pk_bf16_f32 v80, v48, v49
    v_mfma_f32_16x16x32_bf16 v[120:123], v[28:31], v[88:91], 0
    v_exp_f32 v50, v50
    v_mfma_f32_16x16x32_bf16 v[56:59], a[0:3], a[208:211], v[100:103]
    ds_read_b64_tr_b16 a[48:49], v16 offset:40960
    v_mfma_f32_16x16x32_bf16 v[56:59], a[4:7], a[212:215], v[56:59]
    v_exp_f32 v51, v51
    v_mfma_f32_16x16x32_bf16 v[56:59], a[8:11], a[216:219], v[56:59]
    s_add_u32 m0, s53, 0x14000
    s_mov_b32 s64, 0x8000
    buffer_load_dwordx4 v24, s[16:19], s64 offen offset:2048 nt lds
    ds_read_b64_tr_b16 a[50:51], v16 offset:45056
    v_cvt_pk_bf16_f32 v81, v50, v51
    v_mfma_f32_16x16x32_bf16 v[56:59], a[12:15], a[220:223], v[56:59]
    v_exp_f32 v52, v52
    v_mfma_f32_16x16x32_bf16 v[60:63], a[16:19], a[208:211], v[100:103]
    ds_read_b64_tr_b16 a[52:53], v17 offset:40960
    v_mfma_f32_16x16x32_bf16 v[60:63], a[20:23], a[212:215], v[60:63]
    v_exp_f32 v53, v53
    v_mfma_f32_16x16x32_bf16 v[60:63], a[24:27], a[216:219], v[60:63]
    ds_read_b64_tr_b16 a[54:55], v17 offset:45056
    v_cvt_pk_bf16_f32 v82, v52, v53
    v_mfma_f32_16x16x32_bf16 v[60:63], a[28:31], a[220:223], v[60:63]
    v_exp_f32 v54, v54
    v_exp_f32 v55, v55
    ds_read_b64_tr_b16 a[56:57], v18 offset:40960
    v_cvt_pk_bf16_f32 v83, v54, v55
    ds_read_b64_tr_b16 a[58:59], v18 offset:45056
    v_exp_f32 v56, v56
    ds_read_b64_tr_b16 a[60:61], v19 offset:40960
    v_exp_f32 v57, v57
    s_add_u32 m0, s53, 0x14000
    s_mov_b32 s64, 0x8000
    buffer_load_dwordx4 v25, s[16:19], s64 offen offset:3072 nt lds
    ds_read_b64_tr_b16 a[62:63], v19 offset:45056
    v_cvt_pk_bf16_f32 v84, v56, v57
    v_exp_f32 v58, v58
    v_mfma_f32_16x16x32_bf16 v[64:67], a[0:3], a[224:227], v[104:107]
    v_mfma_f32_16x16x32_bf16 v[64:67], a[4:7], a[228:231], v[64:67]
    v_exp_f32 v59, v59
    v_mfma_f32_16x16x32_bf16 v[64:67], a[8:11], a[232:235], v[64:67]
    v_cvt_pk_bf16_f32 v85, v58, v59
    v_mfma_f32_16x16x32_bf16 v[64:67], a[12:15], a[236:239], v[64:67]
    s_mov_b32 s64, 0x8000
    v_exp_f32 v60, v60
    v_mfma_f32_16x16x32_bf16 v[68:71], a[16:19], a[224:227], v[104:107]
    v_mfma_f32_16x16x32_bf16 v[68:71], a[20:23], a[228:231], v[68:71]
    v_exp_f32 v61, v61
    v_mfma_f32_16x16x32_bf16 v[68:71], a[24:27], a[232:235], v[68:71]
    s_add_u32 m0, s53, 0xc000
    v_cvt_pk_bf16_f32 v86, v60, v61
    v_mfma_f32_16x16x32_bf16 v[68:71], a[28:31], a[236:239], v[68:71]
    s_add_u32 s64, s64, 0x4000
    v_exp_f32 v62, v62
    s_waitcnt lgkmcnt(0)
    v_mfma_f32_16x16x32_bf16 v[128:131], a[32:35], v[80:83], v[128:131]
    buffer_load_dwordx4 v20, s[12:15], s64 offen nt lds
    v_mfma_f32_16x16x32_bf16 v[132:135], a[36:39], v[80:83], v[132:135]
    v_exp_f32 v63, v63
    v_mfma_f32_16x16x32_bf16 v[136:139], a[40:43], v[80:83], v[136:139]
    v_cvt_pk_bf16_f32 v87, v62, v63
    v_mfma_f32_16x16x32_bf16 v[140:143], a[44:47], v[80:83], v[140:143]
    s_waitcnt vmcnt(9) lgkmcnt(0)
    s_barrier
    v_mfma_f32_16x16x32_bf16 v[144:147], a[48:51], v[80:83], v[144:147]
    v_exp_f32 v64, v64
    v_mfma_f32_16x16x32_bf16 v[148:151], a[52:55], v[80:83], v[148:151]
    ds_read_b128 a[128:131], v8 offset:16384
    v_mfma_f32_16x16x32_bf16 v[152:155], a[56:59], v[80:83], v[152:155]
    v_exp_f32 v65, v65
    v_mfma_f32_16x16x32_bf16 v[156:159], a[60:63], v[80:83], v[156:159]
    ds_read_b128 a[132:135], v9 offset:16384
    v_cvt_pk_bf16_f32 v88, v64, v65
    v_mfma_f32_16x16x32_bf16 v[112:115], v[28:31], v[80:83], v[112:115]
    v_exp_f32 v66, v66
    ds_read_b128 a[136:139], v10 offset:16384
    v_exp_f32 v67, v67
    ds_read_b128 a[140:143], v11 offset:16384
    v_cvt_pk_bf16_f32 v89, v66, v67
    v_exp_f32 v68, v68
    ds_read_b128 a[144:147], v8 offset:20480
    v_exp_f32 v69, v69
    ds_read_b128 a[148:151], v9 offset:20480
    v_cvt_pk_bf16_f32 v90, v68, v69
    v_exp_f32 v70, v70
    v_mfma_f32_16x16x32_bf16 v[160:163], a[32:35], v[84:87], v[160:163]
    buffer_load_dwordx4 v21, s[12:15], s64 offen offset:1024 nt lds
    v_mfma_f32_16x16x32_bf16 v[164:167], a[36:39], v[84:87], v[164:167]
    v_exp_f32 v71, v71
    v_mfma_f32_16x16x32_bf16 v[168:171], a[40:43], v[84:87], v[168:171]
    ds_read_b128 a[152:155], v10 offset:20480
    v_cvt_pk_bf16_f32 v91, v70, v71
    v_mfma_f32_16x16x32_bf16 v[172:175], a[44:47], v[84:87], v[172:175]
    v_mfma_f32_16x16x32_bf16 v[176:179], a[48:51], v[84:87], v[176:179]
    v_mfma_f32_16x16x32_bf16 v[180:183], a[52:55], v[84:87], v[180:183]
    ds_read_b128 a[156:159], v11 offset:20480
    v_mfma_f32_16x16x32_bf16 v[184:187], a[56:59], v[84:87], v[184:187]
    v_mfma_f32_16x16x32_bf16 v[188:191], a[60:63], v[84:87], v[188:191]
    v_mfma_f32_16x16x32_bf16 v[116:119], v[28:31], v[84:87], v[116:119]
    s_mov_b32 s66, 3
L_attn_w3:
    s_waitcnt lgkmcnt(2)
    v_mfma_f32_16x16x32_bf16 v[48:51], a[128:131], a[192:195], v[96:99]
    ds_read_b64_tr_b16 a[160:161], v12
    v_mfma_f32_16x16x32_bf16 v[48:51], a[132:135], a[196:199], v[48:51]
    v_mfma_f32_16x16x32_bf16 v[48:51], a[136:139], a[200:203], v[48:51]
    ds_read_b64_tr_b16 a[162:163], v12 offset:4096
    v_mfma_f32_16x16x32_bf16 v[48:51], a[140:143], a[204:207], v[48:51]
    v_mfma_f32_16x16x32_bf16 v[52:55], a[144:147], a[192:195], v[96:99]
    ds_read_b64_tr_b16 a[164:165], v13
    v_mfma_f32_16x16x32_bf16 v[52:55], a[148:151], a[196:199], v[52:55]
    s_waitcnt lgkmcnt(3)
    v_mfma_f32_16x16x32_bf16 v[52:55], a[152:155], a[200:203], v[52:55]
    ds_read_b64_tr_b16 a[166:167], v13 offset:4096
    v_mfma_f32_16x16x32_bf16 v[52:55], a[156:159], a[204:207], v[52:55]
    v_mfma_f32_16x16x32_bf16 v[192:195], a[32:35], v[88:91], v[192:195]
    buffer_load_dwordx4 v22, s[12:15], s64 offen offset:2048 nt lds
    v_mfma_f32_16x16x32_bf16 v[196:199], a[36:39], v[88:91], v[196:199]
    v_mfma_f32_16x16x32_bf16 v[200:203], a[40:43], v[88:91], v[200:203]
    ds_read_b64_tr_b16 a[168:169], v14
    v_mfma_f32_16x16x32_bf16 v[204:207], a[44:47], v[88:91], v[204:207]
    ds_read_b64_tr_b16 a[170:171], v14 offset:4096
    v_mfma_f32_16x16x32_bf16 v[208:211], a[48:51], v[88:91], v[208:211]
    v_exp_f32 v48, v48
    v_mfma_f32_16x16x32_bf16 v[212:215], a[52:55], v[88:91], v[212:215]
    ds_read_b64_tr_b16 a[172:173], v15
    v_mfma_f32_16x16x32_bf16 v[216:219], a[56:59], v[88:91], v[216:219]
    v_exp_f32 v49, v49
    v_mfma_f32_16x16x32_bf16 v[220:223], a[60:63], v[88:91], v[220:223]
    ds_read_b64_tr_b16 a[174:175], v15 offset:4096
    v_cvt_pk_bf16_f32 v80, v48, v49
    v_mfma_f32_16x16x32_bf16 v[120:123], v[28:31], v[88:91], v[120:123]
    v_exp_f32 v50, v50
    v_mfma_f32_16x16x32_bf16 v[56:59], a[128:131], a[208:211], v[100:103]
    ds_read_b64_tr_b16 a[176:177], v16
    v_mfma_f32_16x16x32_bf16 v[56:59], a[132:135], a[212:215], v[56:59]
    v_exp_f32 v51, v51
    v_mfma_f32_16x16x32_bf16 v[56:59], a[136:139], a[216:219], v[56:59]
    ds_read_b64_tr_b16 a[178:179], v16 offset:4096
    v_cvt_pk_bf16_f32 v81, v50, v51
    v_mfma_f32_16x16x32_bf16 v[56:59], a[140:143], a[220:223], v[56:59]
    v_exp_f32 v52, v52
    v_mfma_f32_16x16x32_bf16 v[60:63], a[144:147], a[208:211], v[100:103]
    ds_read_b64_tr_b16 a[180:181], v17
    v_mfma_f32_16x16x32_bf16 v[60:63], a[148:151], a[212:215], v[60:63]
    v_exp_f32 v53, v53
    v_mfma_f32_16x16x32_bf16 v[60:63], a[152:155], a[216:219], v[60:63]
    ds_read_b64_tr_b16 a[182:183], v17 offset:4096
    v_cvt_pk_bf16_f32 v82, v52, v53
    v_mfma_f32_16x16x32_bf16 v[60:63], a[156:159], a[220:223], v[60:63]
    v_exp_f32 v54, v54
    buffer_load_dwordx4 v23, s[12:15], s64 offen offset:3072 nt lds
    v_exp_f32 v55, v55
    ds_read_b64_tr_b16 a[184:185], v18
    v_cvt_pk_bf16_f32 v83, v54, v55
    ds_read_b64_tr_b16 a[186:187], v18 offset:4096
    v_exp_f32 v56, v56
    ds_read_b64_tr_b16 a[188:189], v19
    v_exp_f32 v57, v57
    ds_read_b64_tr_b16 a[190:191], v19 offset:4096
    v_cvt_pk_bf16_f32 v84, v56, v57
    v_exp_f32 v58, v58
    v_mfma_f32_16x16x32_bf16 v[64:67], a[128:131], a[224:227], v[104:107]
    v_mfma_f32_16x16x32_bf16 v[64:67], a[132:135], a[228:231], v[64:67]
    v_exp_f32 v59, v59
    v_mfma_f32_16x16x32_bf16 v[64:67], a[136:139], a[232:235], v[64:67]
    v_cvt_pk_bf16_f32 v85, v58, v59
    v_mfma_f32_16x16x32_bf16 v[64:67], a[140:143], a[236:239], v[64:67]
    v_exp_f32 v60, v60
    v_mfma_f32_16x16x32_bf16 v[68:71], a[144:147], a[224:227], v[104:107]
    v_mfma_f32_16x16x32_bf16 v[68:71], a[148:151], a[228:231], v[68:71]
    v_exp_f32 v61, v61
    v_mfma_f32_16x16x32_bf16 v[68:71], a[152:155], a[232:235], v[68:71]
    s_add_u32 m0, s53, 0x1c000
    v_cvt_pk_bf16_f32 v86, v60, v61
    v_mfma_f32_16x16x32_bf16 v[68:71], a[156:159], a[236:239], v[68:71]
    v_exp_f32 v62, v62
    s_waitcnt lgkmcnt(0)
    v_mfma_f32_16x16x32_bf16 v[128:131], a[160:163], v[80:83], v[128:131]
    buffer_load_dwordx4 v24, s[16:19], s64 offen nt lds
    v_mfma_f32_16x16x32_bf16 v[132:135], a[164:167], v[80:83], v[132:135]
    v_exp_f32 v63, v63
    v_mfma_f32_16x16x32_bf16 v[136:139], a[168:171], v[80:83], v[136:139]
    v_cvt_pk_bf16_f32 v87, v62, v63
    v_mfma_f32_16x16x32_bf16 v[140:143], a[172:175], v[80:83], v[140:143]
    v_mfma_f32_16x16x32_bf16 v[144:147], a[176:179], v[80:83], v[144:147]
    v_exp_f32 v64, v64
    v_mfma_f32_16x16x32_bf16 v[148:151], a[180:183], v[80:83], v[148:151]
    ds_read_b128 a[0:3], v8 offset:24576
    v_mfma_f32_16x16x32_bf16 v[152:155], a[184:187], v[80:83], v[152:155]
    v_exp_f32 v65, v65
    v_mfma_f32_16x16x32_bf16 v[156:159], a[188:191], v[80:83], v[156:159]
    ds_read_b128 a[4:7], v9 offset:24576
    v_cvt_pk_bf16_f32 v88, v64, v65
    v_mfma_f32_16x16x32_bf16 v[112:115], v[28:31], v[80:83], v[112:115]
    v_exp_f32 v66, v66
    ds_read_b128 a[8:11], v10 offset:24576
    v_exp_f32 v67, v67
    ds_read_b128 a[12:15], v11 offset:24576
    v_cvt_pk_bf16_f32 v89, v66, v67
    v_exp_f32 v68, v68
    ds_read_b128 a[16:19], v8 offset:28672
    v_exp_f32 v69, v69
    ds_read_b128 a[20:23], v9 offset:28672
    v_cvt_pk_bf16_f32 v90, v68, v69
    v_exp_f32 v70, v70
    v_mfma_f32_16x16x32_bf16 v[160:163], a[160:163], v[84:87], v[160:163]
    buffer_load_dwordx4 v25, s[16:19], s64 offen offset:1024 nt lds
    v_mfma_f32_16x16x32_bf16 v[164:167], a[164:167], v[84:87], v[164:167]
    v_exp_f32 v71, v71
    v_mfma_f32_16x16x32_bf16 v[168:171], a[168:171], v[84:87], v[168:171]
    ds_read_b128 a[24:27], v10 offset:28672
    v_cvt_pk_bf16_f32 v91, v70, v71
    v_mfma_f32_16x16x32_bf16 v[172:175], a[172:175], v[84:87], v[172:175]
    v_mfma_f32_16x16x32_bf16 v[176:179], a[176:179], v[84:87], v[176:179]
    v_mfma_f32_16x16x32_bf16 v[180:183], a[180:183], v[84:87], v[180:183]
    ds_read_b128 a[28:31], v11 offset:28672
    v_mfma_f32_16x16x32_bf16 v[184:187], a[184:187], v[84:87], v[184:187]
    v_mfma_f32_16x16x32_bf16 v[188:191], a[188:191], v[84:87], v[188:191]
    v_mfma_f32_16x16x32_bf16 v[116:119], v[28:31], v[84:87], v[116:119]
    s_waitcnt lgkmcnt(2)
    v_mfma_f32_16x16x32_bf16 v[48:51], a[0:3], a[192:195], v[96:99]
    ds_read_b64_tr_b16 a[32:33], v12 offset:8192
    v_mfma_f32_16x16x32_bf16 v[48:51], a[4:7], a[196:199], v[48:51]
    v_mfma_f32_16x16x32_bf16 v[48:51], a[8:11], a[200:203], v[48:51]
    ds_read_b64_tr_b16 a[34:35], v12 offset:12288
    v_mfma_f32_16x16x32_bf16 v[48:51], a[12:15], a[204:207], v[48:51]
    v_mfma_f32_16x16x32_bf16 v[52:55], a[16:19], a[192:195], v[96:99]
    ds_read_b64_tr_b16 a[36:37], v13 offset:8192
    v_mfma_f32_16x16x32_bf16 v[52:55], a[20:23], a[196:199], v[52:55]
    s_waitcnt lgkmcnt(3)
    v_mfma_f32_16x16x32_bf16 v[52:55], a[24:27], a[200:203], v[52:55]
    ds_read_b64_tr_b16 a[38:39], v13 offset:12288
    v_mfma_f32_16x16x32_bf16 v[52:55], a[28:31], a[204:207], v[52:55]
    v_mfma_f32_16x16x32_bf16 v[192:195], a[160:163], v[88:91], v[192:195]
    buffer_load_dwordx4 v24, s[16:19], s64 offen offset:2048 nt lds
    v_mfma_f32_16x16x32_bf16 v[196:199], a[164:167], v[88:91], v[196:199]
    v_mfma_f32_16x16x32_bf16 v[200:203], a[168:171], v[88:91], v[200:203]
    ds_read_b64_tr_b16 a[40:41], v14 offset:8192
    v_mfma_f32_16x16x32_bf16 v[204:207], a[172:175], v[88:91], v[204:207]
    ds_read_b64_tr_b16 a[42:43], v14 offset:12288
    v_mfma_f32_16x16x32_bf16 v[208:211], a[176:179], v[88:91], v[208:211]
    v_exp_f32 v48, v48
    v_mfma_f32_16x16x32_bf16 v[212:215], a[180:183], v[88:91], v[212:215]
    ds_read_b64_tr_b16 a[44:45], v15 offset:8192
    v_mfma_f32_16x16x32_bf16 v[216:219], a[184:187], v[88:91], v[216:219]
    v_exp_f32 v49, v49
    v_mfma_f32_16x16x32_bf16 v[220:223], a[188:191], v[88:91], v[220:223]
    ds_read_b64_tr_b16 a[46:47], v15 offset:12288
    v_cvt_pk_bf16_f32 v80, v48, v49
    v_mfma_f32_16x16x32_bf16 v[120:123], v[28:31], v[88:91], v[120:123]
    v_exp_f32 v50, v50
    v_mfma_f32_16x16x32_bf16 v[56:59], a[0:3], a[208:211], v[100:103]
    ds_read_b64_tr_b16 a[48:49], v16 offset:8192
    v_mfma_f32_16x16x32_bf16 v[56:59], a[4:7], a[212:215], v[56:59]
    v_exp_f32 v51, v51
    v_mfma_f32_16x16x32_bf16 v[56:59], a[8:11], a[216:219], v[56:59]
    ds_read_b64_tr_b16 a[50:51], v16 offset:12288
    v_cvt_pk_bf16_f32 v81, v50, v51
    v_mfma_f32_16x16x32_bf16 v[56:59], a[12:15], a[220:223], v[56:59]
    v_exp_f32 v52, v52
    v_mfma_f32_16x16x32_bf16 v[60:63], a[16:19], a[208:211], v[100:103]
    ds_read_b64_tr_b16 a[52:53], v17 offset:8192
    v_mfma_f32_16x16x32_bf16 v[60:63], a[20:23], a[212:215], v[60:63]
    v_exp_f32 v53, v53
    v_mfma_f32_16x16x32_bf16 v[60:63], a[24:27], a[216:219], v[60:63]
    ds_read_b64_tr_b16 a[54:55], v17 offset:12288
    v_cvt_pk_bf16_f32 v82, v52, v53
    v_mfma_f32_16x16x32_bf16 v[60:63], a[28:31], a[220:223], v[60:63]
    v_exp_f32 v54, v54
    buffer_load_dwordx4 v25, s[16:19], s64 offen offset:3072 nt lds
    v_exp_f32 v55, v55
    ds_read_b64_tr_b16 a[56:57], v18 offset:8192
    v_cvt_pk_bf16_f32 v83, v54, v55
    ds_read_b64_tr_b16 a[58:59], v18 offset:12288
    v_exp_f32 v56, v56
    ds_read_b64_tr_b16 a[60:61], v19 offset:8192
    v_exp_f32 v57, v57
    ds_read_b64_tr_b16 a[62:63], v19 offset:12288
    v_cvt_pk_bf16_f32 v84, v56, v57
    v_exp_f32 v58, v58
    v_mfma_f32_16x16x32_bf16 v[64:67], a[0:3], a[224:227], v[104:107]
    v_mfma_f32_16x16x32_bf16 v[64:67], a[4:7], a[228:231], v[64:67]
    v_exp_f32 v59, v59
    v_mfma_f32_16x16x32_bf16 v[64:67], a[8:11], a[232:235], v[64:67]
    v_cvt_pk_bf16_f32 v85, v58, v59
    v_mfma_f32_16x16x32_bf16 v[64:67], a[12:15], a[236:239], v[64:67]
    v_exp_f32 v60, v60
    v_mfma_f32_16x16x32_bf16 v[68:71], a[16:19], a[224:227], v[104:107]
    v_mfma_f32_16x16x32_bf16 v[68:71], a[20:23], a[228:231], v[68:71]
    v_exp_f32 v61, v61
    v_mfma_f32_16x16x32_bf16 v[68:71], a[24:27], a[232:235], v[68:71]
    s_add_u32 m0, s53, 0
    v_cvt_pk_bf16_f32 v86, v60, v61
    v_mfma_f32_16x16x32_bf16 v[68:71], a[28:31], a[236:239], v[68:71]
    s_add_u32 s64, s64, 0x4000
    v_exp_f32 v62, v62
    s_waitcnt lgkmcnt(0)
    v_mfma_f32_16x16x32_bf16 v[128:131], a[32:35], v[80:83], v[128:131]
    buffer_load_dwordx4 v20, s[12:15], s64 offen nt lds
    v_mfma_f32_16x16x32_bf16 v[132:135], a[36:39], v[80:83], v[132:135]
    v_exp_f32 v63, v63
    v_mfma_f32_16x16x32_bf16 v[136:139], a[40:43], v[80:83], v[136:139]
    v_cvt_pk_bf16_f32 v87, v62, v63
    v_mfma_f32_16x16x32_bf16 v[140:143], a[44:47], v[80:83], v[140:143]
    s_waitcnt vmcnt(9) lgkmcnt(0)
    s_barrier
    v_mfma_f32_16x16x32_bf16 v[144:147], a[48:51], v[80:83], v[144:147]
    v_exp_f32 v64, v64
    v_mfma_f32_16x16x32_bf16 v[148:151], a[52:55], v[80:83], v[148:151]
    ds_read_b128 a[128:131], v8 offset:32768
    v_mfma_f32_16x16x32_bf16 v[152:155], a[56:59], v[80:83], v[152:155]
    v_exp_f32 v65, v65
    v_mfma_f32_16x16x32_bf16 v[156:159], a[60:63], v[80:83], v[156:159]
    ds_read_b128 a[132:135], v9 offset:32768
    v_cvt_pk_bf16_f32 v88, v64, v65
    v_mfma_f32_16x16x32_bf16 v[112:115], v[28:31], v[80:83], v[112:115]
    v_exp_f32 v66, v66
    ds_read_b128 a[136:139], v10 offset:32768
    v_exp_f32 v67, v67
    ds_read_b128 a[140:143], v11 offset:32768
    v_cvt_pk_bf16_f32 v89, v66, v67
    v_exp_f32 v68, v68
    ds_read_b128 a[144:147], v8 offset:36864
    v_exp_f32 v69, v69
    ds_read_b128 a[148:151], v9 offset:36864
    v_cvt_pk_bf16_f32 v90, v68, v69
    v_exp_f32 v70, v70
    v_mfma_f32_16x16x32_bf16 v[160:163], a[32:35], v[84:87], v[160:163]
    buffer_load_dwordx4 v21, s[12:15], s64 offen offset:1024 nt lds
    v_mfma_f32_16x16x32_bf16 v[164:167], a[36:39], v[84:87], v[164:167]
    v_exp_f32 v71, v71
    v_mfma_f32_16x16x32_bf16 v[168:171], a[40:43], v[84:87], v[168:171]
    ds_read_b128 a[152:155], v10 offset:36864
    v_cvt_pk_bf16_f32 v91, v70, v71
    v_mfma_f32_16x16x32_bf16 v[172:175], a[44:47], v[84:87], v[172:175]
    v_mfma_f32_16x16x32_bf16 v[176:179], a[48:51], v[84:87], v[176:179]
    v_mfma_f32_16x16x32_bf16 v[180:183], a[52:55], v[84:87], v[180:183]
    ds_read_b128 a[156:159], v11 offset:36864
    v_mfma_f32_16x16x32_bf16 v[184:187], a[56:59], v[84:87], v[184:187]
    v_mfma_f32_16x16x32_bf16 v[188:191], a[60:63], v[84:87], v[188:191]
    v_mfma_f32_16x16x32_bf16 v[116:119], v[28:31], v[84:87], v[116:119]
    s_waitcnt lgkmcnt(2)
    v_mfma_f32_16x16x32_bf16 v[48:51], a[128:131], a[192:195], v[96:99]
    ds_read_b64_tr_b16 a[160:161], v12 offset:16384
    v_mfma_f32_16x16x32_bf16 v[48:51], a[132:135], a[196:199], v[48:51]
    v_mfma_f32_16x16x32_bf16 v[48:51], a[136:139], a[200:203], v[48:51]
    ds_read_b64_tr_b16 a[162:163], v12 offset:20480
    v_mfma_f32_16x16x32_bf16 v[48:51], a[140:143], a[204:207], v[48:51]
    v_mfma_f32_16x16x32_bf16 v[52:55], a[144:147], a[192:195], v[96:99]
    ds_read_b64_tr_b16 a[164:165], v13 offset:16384
    v_mfma_f32_16x16x32_bf16 v[52:55], a[148:151], a[196:199], v[52:55]
    s_waitcnt lgkmcnt(3)
    v_mfma_f32_16x16x32_bf16 v[52:55], a[152:155], a[200:203], v[52:55]
    ds_read_b64_tr_b16 a[166:167], v13 offset:20480
    v_mfma_f32_16x16x32_bf16 v[52:55], a[156:159], a[204:207], v[52:55]
    v_mfma_f32_16x16x32_bf16 v[192:195], a[32:35], v[88:91], v[192:195]
    buffer_load_dwordx4 v22, s[12:15], s64 offen offset:2048 nt lds
    v_mfma_f32_16x16x32_bf16 v[196:199], a[36:39], v[88:91], v[196:199]
    v_mfma_f32_16x16x32_bf16 v[200:203], a[40:43], v[88:91], v[200:203]
    ds_read_b64_tr_b16 a[168:169], v14 offset:16384
    v_mfma_f32_16x16x32_bf16 v[204:207], a[44:47], v[88:91], v[204:207]
    ds_read_b64_tr_b16 a[170:171], v14 offset:20480
    v_mfma_f32_16x16x32_bf16 v[208:211], a[48:51], v[88:91], v[208:211]
    v_exp_f32 v48, v48
    v_mfma_f32_16x16x32_bf16 v[212:215], a[52:55], v[88:91], v[212:215]
    ds_read_b64_tr_b16 a[172:173], v15 offset:16384
    v_mfma_f32_16x16x32_bf16 v[216:219], a[56:59], v[88:91], v[216:219]
    v_exp_f32 v49, v49
    v_mfma_f32_16x16x32_bf16 v[220:223], a[60:63], v[88:91], v[220:223]
    ds_read_b64_tr_b16 a[174:175], v15 offset:20480
    v_cvt_pk_bf16_f32 v80, v48, v49
    v_mfma_f32_16x16x32_bf16 v[120:123], v[28:31], v[88:91], v[120:123]
    v_exp_f32 v50, v50
    v_mfma_f32_16x16x32_bf16 v[56:59], a[128:131], a[208:211], v[100:103]
    ds_read_b64_tr_b16 a[176:177], v16 offset:16384
    v_mfma_f32_16x16x32_bf16 v[56:59], a[132:135], a[212:215], v[56:59]
    v_exp_f32 v51, v51
    v_mfma_f32_16x16x32_bf16 v[56:59], a[136:139], a[216:219], v[56:59]
    ds_read_b64_tr_b16 a[178:179], v16 offset:20480
    v_cvt_pk_bf16_f32 v81, v50, v51
    v_mfma_f32_16x16x32_bf16 v[56:59], a[140:143], a[220:223], v[56:59]
    v_exp_f32 v52, v52
    v_mfma_f32_16x16x32_bf16 v[60:63], a[144:147], a[208:211], v[100:103]
    ds_read_b64_tr_b16 a[180:181], v17 offset:16384
    v_mfma_f32_16x16x32_bf16 v[60:63], a[148:151], a[212:215], v[60:63]
    v_exp_f32 v53, v53
    v_mfma_f32_16x16x32_bf16 v[60:63], a[152:155], a[216:219], v[60:63]
    ds_read_b64_tr_b16 a[182:183], v17 offset:20480
    v_cvt_pk_bf16_f32 v82, v52, v53
    v_mfma_f32_16x16x32_bf16 v[60:63], a[156:159], a[220:223], v[60:63]
    v_exp_f32 v54, v54
    buffer_load_dwordx4 v23, s[12:15], s64 offen offset:3072 nt lds
    v_exp_f32 v55, v55
    ds_read_b64_tr_b16 a[184:185], v18 offset:16384
    v_cvt_pk_bf16_f32 v83, v54, v55
    ds_read_b64_tr_b16 a[186:187], v18 offset:20480
    v_exp_f32 v56, v56
    ds_read_b64_tr_b16 a[188:189], v19 offset:16384
    v_exp_f32 v57, v57
    ds_read_b64_tr_b16 a[190:191], v19 offset:20480
    v_cvt_pk_bf16_f32 v84, v56, v57
    v_exp_f32 v58, v58
    v_mfma_f32_16x16x32_bf16 v[64:67], a[128:131], a[224:227], v[104:107]
    v_mfma_f32_16x16x32_bf16 v[64:67], a[132:135], a[228:231], v[64:67]
    v_exp_f32 v59, v59
    v_mfma_f32_16x16x32_bf16 v[64:67], a[136:139], a[232:235], v[64:67]
    v_cvt_pk_bf16_f32 v85, v58, v59
    v_mfma_f32_16x16x32_bf16 v[64:67], a[140:143], a[236:239], v[64:67]
    v_exp_f32 v60, v60
    v_mfma_f32_16x16x32_bf16 v[68:71], a[144:147], a[224:227], v[104:107]
    v_mfma_f32_16x16x32_bf16 v[68:71], a[148:151], a[228:231], v[68:71]
    v_exp_f32 v61, v61
    v_mfma_f32_16x16x32_bf16 v[68:71], a[152:155], a[232:235], v[68:71]
    s_add_u32 m0, s53, 0x18000
    v_cvt_pk_bf16_f32 v86, v60, v61
    v_mfma_f32_16x16x32_bf16 v[68:71], a[156:159], a[236:239], v[68:71]
    v_exp_f32 v62, v62
    s_waitcnt lgkmcnt(0)
    v_mfma_f32_16x16x32_bf16 v[128:131], a[160:163], v[80:83], v[128:131]
    buffer_load_dwordx4 v24, s[16:19], s64 offen nt lds
    v_mfma_f32_16x16x32_bf16 v[132:135], a[164:167], v[80:83], v[132:135]
    v_exp_f32 v63, v63
    v_mfma_f32_16x16x32_bf16 v[136:139], a[168:171], v[80:83], v[136:139]
    v_cvt_pk_bf16_f32 v87, v62, v63
    v_mfma_f32_16x16x32_bf16 v[140:143], a[172:175], v[80:83], v[140:143]
    v_mfma_f32_16x16x32_bf16 v[144:147], a[176:179], v[80:83], v[144:147]
    v_exp_f32 v64, v64
    v_mfma_f32_16x16x32_bf16 v[148:151], a[180:183], v[80:83], v[148:151]
    ds_read_b128 a[0:3], v8 offset:40960
    v_mfma_f32_16x16x32_bf16 v[152:155], a[184:187], v[80:83], v[152:155]
    v_exp_f32 v65, v65
    v_mfma_f32_16x16x32_bf16 v[156:159], a[188:191], v[80:83], v[156:159]
    ds_read_b128 a[4:7], v9 offset:40960
    v_cvt_pk_bf16_f32 v88, v64, v65
    v_mfma_f32_16x16x32_bf16 v[112:115], v[28:31], v[80:83], v[112:115]
    v_exp_f32 v66, v66
    ds_read_b128 a[8:11], v10 offset:40960
    v_exp_f32 v67, v67
    ds_read_b128 a[12:15], v11 offset:40960
    v_cvt_pk_bf16_f32 v89, v66, v67
    v_exp_f32 v68, v68
    ds_read_b128 a[16:19], v8 offset:45056
    v_exp_f32 v69, v69
    ds_read_b128 a[20:23], v9 offset:45056
    v_cvt_pk_bf16_f32 v90, v68, v69
    v_exp_f32 v70, v70
    v_mfma_f32_16x16x32_bf16 v[160:163], a[160:163], v[84:87], v[160:163]
    buffer_load_dwordx4 v25, s[16:19], s64 offen offset:1024 nt lds
    v_mfma_f32_16x16x32_bf16 v[164:167], a[164:167], v[84:87], v[164:167]
    v_exp_f32 v71, v71
    v_mfma_f32_16x16x32_bf16 v[168:171], a[168:171], v[84:87], v[168:171]
    ds_read_b128 a[24:27], v10 offset:45056
    v_cvt_pk_bf16_f32 v91, v70, v71
    v_mfma_f32_16x16x32_bf16 v[172:175], a[172:175], v[84:87], v[172:175]
    v_mfma_f32_16x16x32_bf16 v[176:179], a[176:179], v[84:87], v[176:179]
    v_mfma_f32_16x16x32_bf16 v[180:183], a[180:183], v[84:87], v[180:183]
    ds_read_b128 a[28:31], v11 offset:45056
    v_mfma_f32_16x16x32_bf16 v[184:187], a[184:187], v[84:87], v[184:187]
    v_mfma_f32_16x16x32_bf16 v[188:191], a[188:191], v[84:87], v[188:191]
    v_mfma_f32_16x16x32_bf16 v[116:119], v[28:31], v[84:87], v[116:119]
    s_waitcnt lgkmcnt(2)
    v_mfma_f32_16x16x32_bf16 v[48:51], a[0:3], a[192:195], v[96:99]
    ds_read_b64_tr_b16 a[32:33], v12 offset:24576
    v_mfma_f32_16x16x32_bf16 v[48:51], a[4:7], a[196:199], v[48:51]
    v_mfma_f32_16x16x32_bf16 v[48:51], a[8:11], a[200:203], v[48:51]
    ds_read_b64_tr_b16 a[34:35], v12 offset:28672
    v_mfma_f32_16x16x32_bf16 v[48:51], a[12:15], a[204:207], v[48:51]
    v_mfma_f32_16x16x32_bf16 v[52:55], a[16:19], a[192:195], v[96:99]
    ds_read_b64_tr_b16 a[36:37], v13 offset:24576
    v_mfma_f32_16x16x32_bf16 v[52:55], a[20:23], a[196:199], v[52:55]
    s_waitcnt lgkmcnt(3)
    v_mfma_f32_16x16x32_bf16 v[52:55], a[24:27], a[200:203], v[52:55]
    ds_read_b64_tr_b16 a[38:39], v13 offset:28672
    v_mfma_f32_16x16x32_bf16 v[52:55], a[28:31], a[204:207], v[52:55]
    v_mfma_f32_16x16x32_bf16 v[192:195], a[160:163], v[88:91], v[192:195]
    buffer_load_dwordx4 v24, s[16:19], s64 offen offset:2048 nt lds
    v_mfma_f32_16x16x32_bf16 v[196:199], a[164:167], v[88:91], v[196:199]
    v_mfma_f32_16x16x32_bf16 v[200:203], a[168:171], v[88:91], v[200:203]
    ds_read_b64_tr_b16 a[40:41], v14 offset:24576
    v_mfma_f32_16x16x32_bf16 v[204:207], a[172:175], v[88:91], v[204:207]
    ds_read_b64_tr_b16 a[42:43], v14 offset:28672
    v_mfma_f32_16x16x32_bf16 v[208:211], a[176:179], v[88:91], v[208:211]
    v_exp_f32 v48, v48
    v_mfma_f32_16x16x32_bf16 v[212:215], a[180:183], v[88:91], v[212:215]
    ds_read_b64_tr_b16 a[44:45], v15 offset:24576
    v_mfma_f32_16x16x32_bf16 v[216:219], a[184:187], v[88:91], v[216:219]
    v_exp_f32 v49, v49
    v_mfma_f32_16x16x32_bf16 v[220:223], a[188:191], v[88:91], v[220:223]
    ds_read_b64_tr_b16 a[46:47], v15 offset:28672
    v_cvt_pk_bf16_f32 v80, v48, v49
    v_mfma_f32_16x16x32_bf16 v[120:123], v[28:31], v[88:91], v[120:123]
    v_exp_f32 v50, v50
    v_mfma_f32_16x16x32_bf16 v[56:59], a[0:3], a[208:211], v[100:103]
    ds_read_b64_tr_b16 a[48:49], v16 offset:24576
    v_mfma_f32_16x16x32_bf16 v[56:59], a[4:7], a[212:215], v[56:59]
    v_exp_f32 v51, v51
    v_mfma_f32_16x16x32_bf16 v[56:59], a[8:11], a[216:219], v[56:59]
    ds_read_b64_tr_b16 a[50:51], v16 offset:28672
    v_cvt_pk_bf16_f32 v81, v50, v51
    v_mfma_f32_16x16x32_bf16 v[56:59], a[12:15], a[220:223], v[56:59]
    v_exp_f32 v52, v52
    v_mfma_f32_16x16x32_bf16 v[60:63], a[16:19], a[208:211], v[100:103]
    ds_read_b64_tr_b16 a[52:53], v17 offset:24576
    v_mfma_f32_16x16x32_bf16 v[60:63], a[20:23], a[212:215], v[60:63]
    v_exp_f32 v53, v53
    v_mfma_f32_16x16x32_bf16 v[60:63], a[24:27], a[216:219], v[60:63]
    ds_read_b64_tr_b16 a[54:55], v17 offset:28672
    v_cvt_pk_bf16_f32 v82, v52, v53
    v_mfma_f32_16x16x32_bf16 v[60:63], a[28:31], a[220:223], v[60:63]
    v_exp_f32 v54, v54
    buffer_load_dwordx4 v25, s[16:19], s64 offen offset:3072 nt lds
    v_exp_f32 v55, v55
    ds_read_b64_tr_b16 a[56:57], v18 offset:24576
    v_cvt_pk_bf16_f32 v83, v54, v55
    ds_read_b64_tr_b16 a[58:59], v18 offset:28672
    v_exp_f32 v56, v56
    ds_read_b64_tr_b16 a[60:61], v19 offset:24576
    v_exp_f32 v57, v57
    ds_read_b64_tr_b16 a[62:63], v19 offset:28672
    v_cvt_pk_bf16_f32 v84, v56, v57
    v_exp_f32 v58, v58
    v_mfma_f32_16x16x32_bf16 v[64:67], a[0:3], a[224:227], v[104:107]
    v_mfma_f32_16x16x32_bf16 v[64:67], a[4:7], a[228:231], v[64:67]
    v_exp_f32 v59, v59
    v_mfma_f32_16x16x32_bf16 v[64:67], a[8:11], a[232:235], v[64:67]
    v_cvt_pk_bf16_f32 v85, v58, v59
    v_mfma_f32_16x16x32_bf16 v[64:67], a[12:15], a[236:239], v[64:67]
    v_exp_f32 v60, v60
    v_mfma_f32_16x16x32_bf16 v[68:71], a[16:19], a[224:227], v[104:107]
    v_mfma_f32_16x16x32_bf16 v[68:71], a[20:23], a[228:231], v[68:71]
    v_exp_f32 v61, v61
    v_mfma_f32_16x16x32_bf16 v[68:71], a[24:27], a[232:235], v[68:71]
    s_add_u32 m0, s53, 0x4000
    v_cvt_pk_bf16_f32 v86, v60, v61
    v_mfma_f32_16x16x32_bf16 v[68:71], a[28:31], a[236:239], v[68:71]
    s_add_u32 s64, s64, 0x4000
    v_exp_f32 v62, v62
    s_waitcnt lgkmcnt(0)
    v_mfma_f32_16x16x32_bf16 v[128:131], a[32:35], v[80:83], v[128:131]
    buffer_load_dwordx4 v20, s[12:15], s64 offen nt lds
    v_mfma_f32_16x16x32_bf16 v[132:135], a[36:39], v[80:83], v[132:135]
    v_exp_f32 v63, v63
    v_mfma_f32_16x16x32_bf16 v[136:139], a[40:43], v[80:83], v[136:139]
    v_cvt_pk_bf16_f32 v87, v62, v63
    v_mfma_f32_16x16x32_bf16 v[140:143], a[44:47], v[80:83], v[140:143]
    s_waitcnt vmcnt(9) lgkmcnt(0)
    s_barrier
    v_mfma_f32_16x16x32_bf16 v[144:147], a[48:51], v[80:83], v[144:147]
    v_exp_f32 v64, v64
    v_mfma_f32_16x16x32_bf16 v[148:151], a[52:55], v[80:83], v[148:151]
    ds_read_b128 a[128:131], v8 offset:49152
    v_mfma_f32_16x16x32_bf16 v[152:155], a[56:59], v[80:83], v[152:155]
    v_exp_f32 v65, v65
    v_mfma_f32_16x16x32_bf16 v[156:159], a[60:63], v[80:83], v[156:159]
    ds_read_b128 a[132:135], v9 offset:49152
    v_cvt_pk_bf16_f32 v88, v64, v65
    v_mfma_f32_16x16x32_bf16 v[112:115], v[28:31], v[80:83], v[112:115]
    v_exp_f32 v66, v66
    ds_read_b128 a[136:139], v10 offset:49152
    v_exp_f32 v67, v67
    ds_read_b128 a[140:143], v11 offset:49152
    v_cvt_pk_bf16_f32 v89, v66, v67
    v_exp_f32 v68, v68
    ds_read_b128 a[144:147], v8 offset:53248
    v_exp_f32 v69, v69
    ds_read_b128 a[148:151], v9 offset:53248
    v_cvt_pk_bf16_f32 v90, v68, v69
    v_exp_f32 v70, v70
    v_mfma_f32_16x16x32_bf16 v[160:163], a[32:35], v[84:87], v[160:163]
    buffer_load_dwordx4 v21, s[12:15], s64 offen offset:1024 nt lds
    v_mfma_f32_16x16x32_bf16 v[164:167], a[36:39], v[84:87], v[164:167]
    v_exp_f32 v71, v71
    v_mfma_f32_16x16x32_bf16 v[168:171], a[40:43], v[84:87], v[168:171]
    ds_read_b128 a[152:155], v10 offset:53248
    v_cvt_pk_bf16_f32 v91, v70, v71
    v_mfma_f32_16x16x32_bf16 v[172:175], a[44:47], v[84:87], v[172:175]
    v_mfma_f32_16x16x32_bf16 v[176:179], a[48:51], v[84:87], v[176:179]
    v_mfma_f32_16x16x32_bf16 v[180:183], a[52:55], v[84:87], v[180:183]
    ds_read_b128 a[156:159], v11 offset:53248
    v_mfma_f32_16x16x32_bf16 v[184:187], a[56:59], v[84:87], v[184:187]
    v_mfma_f32_16x16x32_bf16 v[188:191], a[60:63], v[84:87], v[188:191]
    v_mfma_f32_16x16x32_bf16 v[116:119], v[28:31], v[84:87], v[116:119]
    s_waitcnt lgkmcnt(2)
    v_mfma_f32_16x16x32_bf16 v[48:51], a[128:131], a[192:195], v[96:99]
    ds_read_b64_tr_b16 a[160:161], v12 offset:49152
    v_mfma_f32_16x16x32_bf16 v[48:51], a[132:135], a[196:199], v[48:51]
    v_mfma_f32_16x16x32_bf16 v[48:51], a[136:139], a[200:203], v[48:51]
    ds_read_b64_tr_b16 a[162:163], v12 offset:53248
    v_mfma_f32_16x16x32_bf16 v[48:51], a[140:143], a[204:207], v[48:51]
    v_mfma_f32_16x16x32_bf16 v[52:55], a[144:147], a[192:195], v[96:99]
    ds_read_b64_tr_b16 a[164:165], v13 offset:49152
    v_mfma_f32_16x16x32_bf16 v[52:55], a[148:151], a[196:199], v[52:55]
    s_waitcnt lgkmcnt(3)
    v_mfma_f32_16x16x32_bf16 v[52:55], a[152:155], a[200:203], v[52:55]
    ds_read_b64_tr_b16 a[166:167], v13 offset:53248
    v_mfma_f32_16x16x32_bf16 v[52:55], a[156:159], a[204:207], v[52:55]
    v_mfma_f32_16x16x32_bf16 v[192:195], a[32:35], v[88:91], v[192:195]
    buffer_load_dwordx4 v22, s[12:15], s64 offen offset:2048 nt lds
    v_mfma_f32_16x16x32_bf16 v[196:199], a[36:39], v[88:91], v[196:199]
    v_mfma_f32_16x16x32_bf16 v[200:203], a[40:43], v[88:91], v[200:203]
    ds_read_b64_tr_b16 a[168:169], v14 offset:49152
    v_mfma_f32_16x16x32_bf16 v[204:207], a[44:47], v[88:91], v[204:207]
    ds_read_b64_tr_b16 a[170:171], v14 offset:53248
    v_mfma_f32_16x16x32_bf16 v[208:211], a[48:51], v[88:91], v[208:211]
    v_exp_f32 v48, v48
    v_mfma_f32_16x16x32_bf16 v[212:215], a[52:55], v[88:91], v[212:215]
    ds_read_b64_tr_b16 a[172:173], v15 offset:49152
    v_mfma_f32_16x16x32_bf16 v[216:219], a[56:59], v[88:91], v[216:219]
    v_exp_f32 v49, v49
    v_mfma_f32_16x16x32_bf16 v[220:223], a[60:63], v[88:91], v[220:223]
    ds_read_b64_tr_b16 a[174:175], v15 offset:53248
    v_cvt_pk_bf16_f32 v80, v48, v49
    v_mfma_f32_16x16x32_bf16 v[120:123], v[28:31], v[88:91], v[120:123]
    v_exp_f32 v50, v50
    v_mfma_f32_16x16x32_bf16 v[56:59], a[128:131], a[208:211], v[100:103]
    ds_read_b64_tr_b16 a[176:177], v16 offset:49152
    v_mfma_f32_16x16x32_bf16 v[56:59], a[132:135], a[212:215], v[56:59]
    v_exp_f32 v51, v51
    v_mfma_f32_16x16x32_bf16 v[56:59], a[136:139], a[216:219], v[56:59]
    ds_read_b64_tr_b16 a[178:179], v16 offset:53248
    v_cvt_pk_bf16_f32 v81, v50, v51
    v_mfma_f32_16x16x32_bf16 v[56:59], a[140:143], a[220:223], v[56:59]
    v_exp_f32 v52, v52
    v_mfma_f32_16x16x32_bf16 v[60:63], a[144:147], a[208:211], v[100:103]
    ds_read_b64_tr_b16 a[180:181], v17 offset:49152
    v_mfma_f32_16x16x32_bf16 v[60:63], a[148:151], a[212:215], v[60:63]
    v_exp_f32 v53, v53
    v_mfma_f32_16x16x32_bf16 v[60:63], a[152:155], a[216:219], v[60:63]
    ds_read_b64_tr_b16 a[182:183], v17 offset:53248
    v_cvt_pk_bf16_f32 v82, v52, v53
    v_mfma_f32_16x16x32_bf16 v[60:63], a[156:159], a[220:223], v[60:63]
    v_exp_f32 v54, v54
    buffer_load_dwordx4 v23, s[12:15], s64 offen offset:3072 nt lds
    v_exp_f32 v55, v55
    ds_read_b64_tr_b16 a[184:185], v18 offset:49152
    v_cvt_pk_bf16_f32 v83, v54, v55
    ds_read_b64_tr_b16 a[186:187], v18 offset:53248
    v_exp_f32 v56, v56
    ds_read_b64_tr_b16 a[188:189], v19 offset:49152
    v_exp_f32 v57, v57
    ds_read_b64_tr_b16 a[190:191], v19 offset:53248
    v_cvt_pk_bf16_f32 v84, v56, v57
    v_exp_f32 v58, v58
    v_mfma_f32_16x16x32_bf16 v[64:67], a[128:131], a[224:227], v[104:107]
    v_mfma_f32_16x16x32_bf16 v[64:67], a[132:135], a[228:231], v[64:67]
    v_exp_f32 v59, v59
    v_mfma_f32_16x16x32_bf16 v[64:67], a[136:139], a[232:235], v[64:67]
    v_cvt_pk_bf16_f32 v85, v58, v59
    v_mfma_f32_16x16x32_bf16 v[64:67], a[140:143], a[236:239], v[64:67]
    v_exp_f32 v60, v60
    v_mfma_f32_16x16x32_bf16 v[68:71], a[144:147], a[224:227], v[104:107]
    v_mfma_f32_16x16x32_bf16 v[68:71], a[148:151], a[228:231], v[68:71]
    v_exp_f32 v61, v61
    v_mfma_f32_16x16x32_bf16 v[68:71], a[152:155], a[232:235], v[68:71]
    s_add_u32 m0, s53, 0x10000
    v_cvt_pk_bf16_f32 v86, v60, v61
    v_mfma_f32_16x16x32_bf16 v[68:71], a[156:159], a[236:239], v[68:71]
    v_exp_f32 v62, v62
    s_waitcnt lgkmcnt(0)
    v_mfma_f32_16x16x32_bf16 v[128:131], a[160:163], v[80:83], v[128:131]
    buffer_load_dwordx4 v24, s[16:19], s64 offen nt lds
    v_mfma_f32_16x16x32_bf16 v[132:135], a[164:167], v[80:83], v[132:135]
    v_exp_f32 v63, v63
    v_mfma_f32_16x16x32_bf16 v[136:139], a[168:171], v[80:83], v[136:139]
    v_cvt_pk_bf16_f32 v87, v62, v63
    v_mfma_f32_16x16x32_bf16 v[140:143], a[172:175], v[80:83], v[140:143]
    v_mfma_f32_16x16x32_bf16 v[144:147], a[176:179], v[80:83], v[144:147]
    v_exp_f32 v64, v64
    v_mfma_f32_16x16x32_bf16 v[148:151], a[180:183], v[80:83], v[148:151]
    ds_read_b128 a[0:3], v8 offset:57344
    v_mfma_f32_16x16x32_bf16 v[152:155], a[184:187], v[80:83], v[152:155]
    v_exp_f32 v65, v65
    v_mfma_f32_16x16x32_bf16 v[156:159], a[188:191], v[80:83], v[156:159]
    ds_read_b128 a[4:7], v9 offset:57344
    v_cvt_pk_bf16_f32 v88, v64, v65
    v_mfma_f32_16x16x32_bf16 v[112:115], v[28:31], v[80:83], v[112:115]
    v_exp_f32 v66, v66
    ds_read_b128 a[8:11], v10 offset:57344
    v_exp_f32 v67, v67
    ds_read_b128 a[12:15], v11 offset:57344
    v_cvt_pk_bf16_f32 v89, v66, v67
    v_exp_f32 v68, v68
    ds_read_b128 a[16:19], v8 offset:61440
    v_exp_f32 v69, v69
    ds_read_b128 a[20:23], v9 offset:61440
    v_cvt_pk_bf16_f32 v90, v68, v69
    v_exp_f32 v70, v70
    v_mfma_f32_16x16x32_bf16 v[160:163], a[160:163], v[84:87], v[160:163]
    buffer_load_dwordx4 v25, s[16:19], s64 offen offset:1024 nt lds
    v_mfma_f32_16x16x32_bf16 v[164:167], a[164:167], v[84:87], v[164:167]
    v_exp_f32 v71, v71
    v_mfma_f32_16x16x32_bf16 v[168:171], a[168:171], v[84:87], v[168:171]
    ds_read_b128 a[24:27], v10 offset:61440
    v_cvt_pk_bf16_f32 v91, v70, v71
    v_mfma_f32_16x16x32_bf16 v[172:175], a[172:175], v[84:87], v[172:175]
    v_mfma_f32_16x16x32_bf16 v[176:179], a[176:179], v[84:87], v[176:179]
    v_mfma_f32_16x16x32_bf16 v[180:183], a[180:183], v[84:87], v[180:183]
    ds_read_b128 a[28:31], v11 offset:61440
    v_mfma_f32_16x16x32_bf16 v[184:187], a[184:187], v[84:87], v[184:187]
    v_mfma_f32_16x16x32_bf16 v[188:191], a[188:191], v[84:87], v[188:191]
    v_mfma_f32_16x16x32_bf16 v[116:119], v[28:31], v[84:87], v[116:119]
    s_waitcnt lgkmcnt(2)
    v_mfma_f32_16x16x32_bf16 v[48:51], a[0:3], a[192:195], v[96:99]
    ds_read_b64_tr_b16 a[32:33], v12 offset:57344
    v_mfma_f32_16x16x32_bf16 v[48:51], a[4:7], a[196:199], v[48:51]
    v_mfma_f32_16x16x32_bf16 v[48:51], a[8:11], a[200:203], v[48:51]
    ds_read_b64_tr_b16 a[34:35], v12 offset:61440
    v_mfma_f32_16x16x32_bf16 v[48:51], a[12:15], a[204:207], v[48:51]
    v_mfma_f32_16x16x32_bf16 v[52:55], a[16:19], a[192:195], v[96:99]
    ds_read_b64_tr_b16 a[36:37], v13 offset:57344
    v_mfma_f32_16x16x32_bf16 v[52:55], a[20:23], a[196:199], v[52:55]
    s_waitcnt lgkmcnt(3)
    v_mfma_f32_16x16x32_bf16 v[52:55], a[24:27], a[200:203], v[52:55]
    ds_read_b64_tr_b16 a[38:39], v13 offset:61440
    v_mfma_f32_16x16x32_bf16 v[52:55], a[28:31], a[204:207], v[52:55]
    v_mfma_f32_16x16x32_bf16 v[192:195], a[160:163], v[88:91], v[192:195]
    buffer_load_dwordx4 v24, s[16:19], s64 offen offset:2048 nt lds
    v_mfma_f32_16x16x32_bf16 v[196:199], a[164:167], v[88:91], v[196:199]
    v_mfma_f32_16x16x32_bf16 v[200:203], a[168:171], v[88:91], v[200:203]
    ds_read_b64_tr_b16 a[40:41], v14 offset:57344
    v_mfma_f32_16x16x32_bf16 v[204:207], a[172:175], v[88:91], v[204:207]
    ds_read_b64_tr_b16 a[42:43], v14 offset:61440
    v_mfma_f32_16x16x32_bf16 v[208:211], a[176:179], v[88:91], v[208:211]
    v_exp_f32 v48, v48
    v_mfma_f32_16x16x32_bf16 v[212:215], a[180:183], v[88:91], v[212:215]
    ds_read_b64_tr_b16 a[44:45], v15 offset:57344
    v_mfma_f32_16x16x32_bf16 v[216:219], a[184:187], v[88:91], v[216:219]
    v_exp_f32 v49, v49
    v_mfma_f32_16x16x32_bf16 v[220:223], a[188:191], v[88:91], v[220:223]
    ds_read_b64_tr_b16 a[46:47], v15 offset:61440
    v_cvt_pk_bf16_f32 v80, v48, v49
    v_mfma_f32_16x16x32_bf16 v[120:123], v[28:31], v[88:91], v[120:123]
    v_exp_f32 v50, v50
    v_mfma_f32_16x16x32_bf16 v[56:59], a[0:3], a[208:211], v[100:103]
    ds_read_b64_tr_b16 a[48:49], v16 offset:57344
    v_mfma_f32_16x16x32_bf16 v[56:59], a[4:7], a[212:215], v[56:59]
    v_exp_f32 v51, v51
    v_mfma_f32_16x16x32_bf16 v[56:59], a[8:11], a[216:219], v[56:59]
    ds_read_b64_tr_b16 a[50:51], v16 offset:61440
    v_cvt_pk_bf16_f32 v81, v50, v51
    v_mfma_f32_16x16x32_bf16 v[56:59], a[12:15], a[220:223], v[56:59]
    v_exp_f32 v52, v52
    v_mfma_f32_16x16x32_bf16 v[60:63], a[16:19], a[208:211], v[100:103]
    ds_read_b64_tr_b16 a[52:53], v17 offset:57344
    v_mfma_f32_16x16x32_bf16 v[60:63], a[20:23], a[212:215], v[60:63]
    v_exp_f32 v53, v53
    v_mfma_f32_16x16x32_bf16 v[60:63], a[24:27], a[216:219], v[60:63]
    ds_read_b64_tr_b16 a[54:55], v17 offset:61440
    v_cvt_pk_bf16_f32 v82, v52, v53
    v_mfma_f32_16x16x32_bf16 v[60:63], a[28:31], a[220:223], v[60:63]
    v_exp_f32 v54, v54
    buffer_load_dwordx4 v25, s[16:19], s64 offen offset:3072 nt lds
    v_exp_f32 v55, v55
    ds_read_b64_tr_b16 a[56:57], v18 offset:57344
    v_cvt_pk_bf16_f32 v83, v54, v55
    ds_read_b64_tr_b16 a[58:59], v18 offset:61440
    v_exp_f32 v56, v56
    ds_read_b64_tr_b16 a[60:61], v19 offset:57344
    v_exp_f32 v57, v57
    ds_read_b64_tr_b16 a[62:63], v19 offset:61440
    v_cvt_pk_bf16_f32 v84, v56, v57
    v_exp_f32 v58, v58
    v_mfma_f32_16x16x32_bf16 v[64:67], a[0:3], a[224:227], v[104:107]
    v_mfma_f32_16x16x32_bf16 v[64:67], a[4:7], a[228:231], v[64:67]
    v_exp_f32 v59, v59
    v_mfma_f32_16x16x32_bf16 v[64:67], a[8:11], a[232:235], v[64:67]
    v_cvt_pk_bf16_f32 v85, v58, v59
    v_mfma_f32_16x16x32_bf16 v[64:67], a[12:15], a[236:239], v[64:67]
    v_exp_f32 v60, v60
    v_mfma_f32_16x16x32_bf16 v[68:71], a[16:19], a[224:227], v[104:107]
    v_mfma_f32_16x16x32_bf16 v[68:71], a[20:23], a[228:231], v[68:71]
    v_exp_f32 v61, v61
    v_mfma_f32_16x16x32_bf16 v[68:71], a[24:27], a[232:235], v[68:71]
    s_add_u32 m0, s53, 0x8000
    v_cvt_pk_bf16_f32 v86, v60, v61
    v_mfma_f32_16x16x32_bf16 v[68:71], a[28:31], a[236:239], v[68:71]
    s_add_u32 s64, s64, 0x4000
    v_exp_f32 v62, v62
    s_waitcnt lgkmcnt(0)
    v_mfma_f32_16x16x32_bf16 v[128:131], a[32:35], v[80:83], v[128:131]
    buffer_load_dwordx4 v20, s[12:15], s64 offen nt lds
    v_mfma_f32_16x16x32_bf16 v[132:135], a[36:39], v[80:83], v[132:135]
    v_exp_f32 v63, v63
    v_mfma_f32_16x16x32_bf16 v[136:139], a[40:43], v[80:83], v[136:139]
    v_cvt_pk_bf16_f32 v87, v62, v63
    v_mfma_f32_16x16x32_bf16 v[140:143], a[44:47], v[80:83], v[140:143]
    s_waitcnt vmcnt(9) lgkmcnt(0)
    s_barrier
    v_mfma_f32_16x16x32_bf16 v[144:147], a[48:51], v[80:83], v[144:147]
    v_exp_f32 v64, v64
    v_mfma_f32_16x16x32_bf16 v[148:151], a[52:55], v[80:83], v[148:151]
    ds_read_b128 a[128:131], v8
    v_mfma_f32_16x16x32_bf16 v[152:155], a[56:59], v[80:83], v[152:155]
    v_exp_f32 v65, v65
    v_mfma_f32_16x16x32_bf16 v[156:159], a[60:63], v[80:83], v[156:159]
    ds_read_b128 a[132:135], v9
    v_cvt_pk_bf16_f32 v88, v64, v65
    v_mfma_f32_16x16x32_bf16 v[112:115], v[28:31], v[80:83], v[112:115]
    v_exp_f32 v66, v66
    ds_read_b128 a[136:139], v10
    v_exp_f32 v67, v67
    ds_read_b128 a[140:143], v11
    v_cvt_pk_bf16_f32 v89, v66, v67
    v_exp_f32 v68, v68
    ds_read_b128 a[144:147], v8 offset:4096
    v_exp_f32 v69, v69
    ds_read_b128 a[148:151], v9 offset:4096
    v_cvt_pk_bf16_f32 v90, v68, v69
    v_exp_f32 v70, v70
    v_mfma_f32_16x16x32_bf16 v[160:163], a[32:35], v[84:87], v[160:163]
    buffer_load_dwordx4 v21, s[12:15], s64 offen offset:1024 nt lds
    v_mfma_f32_16x16x32_bf16 v[164:167], a[36:39], v[84:87], v[164:167]
    v_exp_f32 v71, v71
    v_mfma_f32_16x16x32_bf16 v[168:171], a[40:43], v[84:87], v[168:171]
    ds_read_b128 a[152:155], v10 offset:4096
    v_cvt_pk_bf16_f32 v91, v70, v71
    v_mfma_f32_16x16x32_bf16 v[172:175], a[44:47], v[84:87], v[172:175]
    v_mfma_f32_16x16x32_bf16 v[176:179], a[48:51], v[84:87], v[176:179]
    v_mfma_f32_16x16x32_bf16 v[180:183], a[52:55], v[84:87], v[180:183]
    ds_read_b128 a[156:159], v11 offset:4096
    v_mfma_f32_16x16x32_bf16 v[184:187], a[56:59], v[84:87], v[184:187]
    v_mfma_f32_16x16x32_bf16 v[188:191], a[60:63], v[84:87], v[188:191]
    v_mfma_f32_16x16x32_bf16 v[116:119], v[28:31], v[84:87], v[116:119]
    s_waitcnt lgkmcnt(2)
    v_mfma_f32_16x16x32_bf16 v[48:51], a[128:131], a[192:195], v[96:99]
    ds_read_b64_tr_b16 a[160:161], v12 offset:32768
    v_mfma_f32_16x16x32_bf16 v[48:51], a[132:135], a[196:199], v[48:51]
    v_mfma_f32_16x16x32_bf16 v[48:51], a[136:139], a[200:203], v[48:51]
    ds_read_b64_tr_b16 a[162:163], v12 offset:36864
    v_mfma_f32_16x16x32_bf16 v[48:51], a[140:143], a[204:207], v[48:51]
    v_mfma_f32_16x16x32_bf16 v[52:55], a[144:147], a[192:195], v[96:99]
    ds_read_b64_tr_b16 a[164:165], v13 offset:32768
    v_mfma_f32_16x16x32_bf16 v[52:55], a[148:151], a[196:199], v[52:55]
    s_waitcnt lgkmcnt(3)
    v_mfma_f32_16x16x32_bf16 v[52:55], a[152:155], a[200:203], v[52:55]
    ds_read_b64_tr_b16 a[166:167], v13 offset:36864
    v_mfma_f32_16x16x32_bf16 v[52:55], a[156:159], a[204:207], v[52:55]
    v_mfma_f32_16x16x32_bf16 v[192:195], a[32:35], v[88:91], v[192:195]
    buffer_load_dwordx4 v22, s[12:15], s64 offen offset:2048 nt lds
    v_mfma_f32_16x16x32_bf16 v[196:199], a[36:39], v[88:91], v[196:199]
    v_mfma_f32_16x16x32_bf16 v[200:203], a[40:43], v[88:91], v[200:203]
    ds_read_b64_tr_b16 a[168:169], v14 offset:32768
    v_mfma_f32_16x16x32_bf16 v[204:207], a[44:47], v[88:91], v[204:207]
    ds_read_b64_tr_b16 a[170:171], v14 offset:36864
    v_mfma_f32_16x16x32_bf16 v[208:211], a[48:51], v[88:91], v[208:211]
    v_exp_f32 v48, v48
    v_mfma_f32_16x16x32_bf16 v[212:215], a[52:55], v[88:91], v[212:215]
    ds_read_b64_tr_b16 a[172:173], v15 offset:32768
    v_mfma_f32_16x16x32_bf16 v[216:219], a[56:59], v[88:91], v[216:219]
    v_exp_f32 v49, v49
    v_mfma_f32_16x16x32_bf16 v[220:223], a[60:63], v[88:91], v[220:223]
    ds_read_b64_tr_b16 a[174:175], v15 offset:36864
    v_cvt_pk_bf16_f32 v80, v48, v49
    v_mfma_f32_16x16x32_bf16 v[120:123], v[28:31], v[88:91], v[120:123]
    v_exp_f32 v50, v50
    v_mfma_f32_16x16x32_bf16 v[56:59], a[128:131], a[208:211], v[100:103]
    ds_read_b64_tr_b16 a[176:177], v16 offset:32768
    v_mfma_f32_16x16x32_bf16 v[56:59], a[132:135], a[212:215], v[56:59]
    v_exp_f32 v51, v51
    v_mfma_f32_16x16x32_bf16 v[56:59], a[136:139], a[216:219], v[56:59]
    ds_read_b64_tr_b16 a[178:179], v16 offset:36864
    v_cvt_pk_bf16_f32 v81, v50, v51
    v_mfma_f32_16x16x32_bf16 v[56:59], a[140:143], a[220:223], v[56:59]
    v_exp_f32 v52, v52
    v_mfma_f32_16x16x32_bf16 v[60:63], a[144:147], a[208:211], v[100:103]
    ds_read_b64_tr_b16 a[180:181], v17 offset:32768
    v_mfma_f32_16x16x32_bf16 v[60:63], a[148:151], a[212:215], v[60:63]
    v_exp_f32 v53, v53
    v_mfma_f32_16x16x32_bf16 v[60:63], a[152:155], a[216:219], v[60:63]
    ds_read_b64_tr_b16 a[182:183], v17 offset:36864
    v_cvt_pk_bf16_f32 v82, v52, v53
    v_mfma_f32_16x16x32_bf16 v[60:63], a[156:159], a[220:223], v[60:63]
    v_exp_f32 v54, v54
    buffer_load_dwordx4 v23, s[12:15], s64 offen offset:3072 nt lds
    v_exp_f32 v55, v55
    ds_read_b64_tr_b16 a[184:185], v18 offset:32768
    v_cvt_pk_bf16_f32 v83, v54, v55
    ds_read_b64_tr_b16 a[186:187], v18 offset:36864
    v_exp_f32 v56, v56
    ds_read_b64_tr_b16 a[188:189], v19 offset:32768
    v_exp_f32 v57, v57
    ds_read_b64_tr_b16 a[190:191], v19 offset:36864
    v_cvt_pk_bf16_f32 v84, v56, v57
    v_exp_f32 v58, v58
    v_mfma_f32_16x16x32_bf16 v[64:67], a[128:131], a[224:227], v[104:107]
    v_mfma_f32_16x16x32_bf16 v[64:67], a[132:135], a[228:231], v[64:67]
    v_exp_f32 v59, v59
    v_mfma_f32_16x16x32_bf16 v[64:67], a[136:139], a[232:235], v[64:67]
    v_cvt_pk_bf16_f32 v85, v58, v59
    v_mfma_f32_16x16x32_bf16 v[64:67], a[140:143], a[236:239], v[64:67]
    v_exp_f32 v60, v60
    v_mfma_f32_16x16x32_bf16 v[68:71], a[144:147], a[224:227], v[104:107]
    v_mfma_f32_16x16x32_bf16 v[68:71], a[148:151], a[228:231], v[68:71]
    v_exp_f32 v61, v61
    v_mfma_f32_16x16x32_bf16 v[68:71], a[152:155], a[232:235], v[68:71]
    s_add_u32 m0, s53, 0x14000
    v_cvt_pk_bf16_f32 v86, v60, v61
    v_mfma_f32_16x16x32_bf16 v[68:71], a[156:159], a[236:239], v[68:71]
    v_exp_f32 v62, v62
    s_waitcnt lgkmcnt(0)
    v_mfma_f32_16x16x32_bf16 v[128:131], a[160:163], v[80:83], v[128:131]
    buffer_load_dwordx4 v24, s[16:19], s64 offen nt lds
    v_mfma_f32_16x16x32_bf16 v[132:135], a[164:167], v[80:83], v[132:135]
    v_exp_f32 v63, v63
    v_mfma_f32_16x16x32_bf16 v[136:139], a[168:171], v[80:83], v[136:139]
    v_cvt_pk_bf16_f32 v87, v62, v63
    v_mfma_f32_16x16x32_bf16 v[140:143], a[172:175], v[80:83], v[140:143]
    v_mfma_f32_16x16x32_bf16 v[144:147], a[176:179], v[80:83], v[144:147]
    v_exp_f32 v64, v64
    v_mfma_f32_16x16x32_bf16 v[148:151], a[180:183], v[80:83], v[148:151]
    ds_read_b128 a[0:3], v8 offset:8192
    v_mfma_f32_16x16x32_bf16 v[152:155], a[184:187], v[80:83], v[152:155]
    v_exp_f32 v65, v65
    v_mfma_f32_16x16x32_bf16 v[156:159], a[188:191], v[80:83], v[156:159]
    ds_read_b128 a[4:7], v9 offset:8192
    v_cvt_pk_bf16_f32 v88, v64, v65
    v_mfma_f32_16x16x32_bf16 v[112:115], v[28:31], v[80:83], v[112:115]
    v_exp_f32 v66, v66
    ds_read_b128 a[8:11], v10 offset:8192
    v_exp_f32 v67, v67
    ds_read_b128 a[12:15], v11 offset:8192
    v_cvt_pk_bf16_f32 v89, v66, v67
    v_exp_f32 v68, v68
    ds_read_b128 a[16:19], v8 offset:12288
    v_exp_f32 v69, v69
    ds_read_b128 a[20:23], v9 offset:12288
    v_cvt_pk_bf16_f32 v90, v68, v69
    v_exp_f32 v70, v70
    v_mfma_f32_16x16x32_bf16 v[160:163], a[160:163], v[84:87], v[160:163]
    buffer_load_dwordx4 v25, s[16:19], s64 offen offset:1024 nt lds
    v_mfma_f32_16x16x32_bf16 v[164:167], a[164:167], v[84:87], v[164:167]
    v_exp_f32 v71, v71
    v_mfma_f32_16x16x32_bf16 v[168:171], a[168:171], v[84:87], v[168:171]
    ds_read_b128 a[24:27], v10 offset:12288
    v_cvt_pk_bf16_f32 v91, v70, v71
    v_mfma_f32_16x16x32_bf16 v[172:175], a[172:175], v[84:87], v[172:175]
    v_mfma_f32_16x16x32_bf16 v[176:179], a[176:179], v[84:87], v[176:179]
    v_mfma_f32_16x16x32_bf16 v[180:183], a[180:183], v[84:87], v[180:183]
    ds_read_b128 a[28:31], v11 offset:12288
    v_mfma_f32_16x16x32_bf16 v[184:187], a[184:187], v[84:87], v[184:187]
    v_mfma_f32_16x16x32_bf16 v[188:191], a[188:191], v[84:87], v[188:191]
    v_mfma_f32_16x16x32_bf16 v[116:119], v[28:31], v[84:87], v[116:119]
    s_waitcnt lgkmcnt(2)
    v_mfma_f32_16x16x32_bf16 v[48:51], a[0:3], a[192:195], v[96:99]
    ds_read_b64_tr_b16 a[32:33], v12 offset:40960
    v_mfma_f32_16x16x32_bf16 v[48:51], a[4:7], a[196:199], v[48:51]
    v_mfma_f32_16x16x32_bf16 v[48:51], a[8:11], a[200:203], v[48:51]
    ds_read_b64_tr_b16 a[34:35], v12 offset:45056
    v_mfma_f32_16x16x32_bf16 v[48:51], a[12:15], a[204:207], v[48:51]
    v_mfma_f32_16x16x32_bf16 v[52:55], a[16:19], a[192:195], v[96:99]
    ds_read_b64_tr_b16 a[36:37], v13 offset:40960
    v_mfma_f32_16x16x32_bf16 v[52:55], a[20:23], a[196:199], v[52:55]
    s_waitcnt lgkmcnt(3)
    v_mfma_f32_16x16x32_bf16 v[52:55], a[24:27], a[200:203], v[52:55]
    ds_read_b64_tr_b16 a[38:39], v13 offset:45056
    v_mfma_f32_16x16x32_bf16 v[52:55], a[28:31], a[204:207], v[52:55]
    v_mfma_f32_16x16x32_bf16 v[192:195], a[160:163], v[88:91], v[192:195]
    buffer_load_dwordx4 v24, s[16:19], s64 offen offset:2048 nt lds
    v_mfma_f32_16x16x32_bf16 v[196:199], a[164:167], v[88:91], v[196:199]
    v_mfma_f32_16x16x32_bf16 v[200:203], a[168:171], v[88:91], v[200:203]
    ds_read_b64_tr_b16 a[40:41], v14 offset:40960
    v_mfma_f32_16x16x32_bf16 v[204:207], a[172:175], v[88:91], v[204:207]
    ds_read_b64_tr_b16 a[42:43], v14 offset:45056
    v_mfma_f32_16x16x32_bf16 v[208:211], a[176:179], v[88:91], v[208:211]
    v_exp_f32 v48, v48
    v_mfma_f32_16x16x32_bf16 v[212:215], a[180:183], v[88:91], v[212:215]
    ds_read_b64_tr_b16 a[44:45], v15 offset:40960
    v_mfma_f32_16x16x32_bf16 v[216:219], a[184:187], v[88:91], v[216:219]
    v_exp_f32 v49, v49
    v_mfma_f32_16x16x32_bf16 v[220:223], a[188:191], v[88:91], v[220:223]
    ds_read_b64_tr_b16 a[46:47], v15 offset:45056
    v_cvt_pk_bf16_f32 v80, v48, v49
    v_mfma_f32_16x16x32_bf16 v[120:123], v[28:31], v[88:91], v[120:123]
    v_exp_f32 v50, v50
    v_mfma_f32_16x16x32_bf16 v[56:59], a[0:3], a[208:211], v[100:103]
    ds_read_b64_tr_b16 a[48:49], v16 offset:40960
    v_mfma_f32_16x16x32_bf16 v[56:59], a[4:7], a[212:215], v[56:59]
    v_exp_f32 v51, v51
    v_mfma_f32_16x16x32_bf16 v[56:59], a[8:11], a[216:219], v[56:59]
    ds_read_b64_tr_b16 a[50:51], v16 offset:45056
    v_cvt_pk_bf16_f32 v81, v50, v51
    v_mfma_f32_16x16x32_bf16 v[56:59], a[12:15], a[220:223], v[56:59]
    v_exp_f32 v52, v52
    v_mfma_f32_16x16x32_bf16 v[60:63], a[16:19], a[208:211], v[100:103]
    ds_read_b64_tr_b16 a[52:53], v17 offset:40960
    v_mfma_f32_16x16x32_bf16 v[60:63], a[20:23], a[212:215], v[60:63]
    v_exp_f32 v53, v53
    v_mfma_f32_16x16x32_bf16 v[60:63], a[24:27], a[216:219], v[60:63]
    ds_read_b64_tr_b16 a[54:55], v17 offset:45056
    v_cvt_pk_bf16_f32 v82, v52, v53
    v_mfma_f32_16x16x32_bf16 v[60:63], a[28:31], a[220:223], v[60:63]
    v_exp_f32 v54, v54
    buffer_load_dwordx4 v25, s[16:19], s64 offen offset:3072 nt lds
    v_exp_f32 v55, v55
    ds_read_b64_tr_b16 a[56:57], v18 offset:40960
    v_cvt_pk_bf16_f32 v83, v54, v55
    ds_read_b64_tr_b16 a[58:59], v18 offset:45056
    v_exp_f32 v56, v56
    ds_read_b64_tr_b16 a[60:61], v19 offset:40960
    v_exp_f32 v57, v57
    ds_read_b64_tr_b16 a[62:63], v19 offset:45056
    v_cvt_pk_bf16_f32 v84, v56, v57
    v_exp_f32 v58, v58
    v_mfma_f32_16x16x32_bf16 v[64:67], a[0:3], a[224:227], v[104:107]
    v_mfma_f32_16x16x32_bf16 v[64:67], a[4:7], a[228:231], v[64:67]
    v_exp_f32 v59, v59
    v_mfma_f32_16x16x32_bf16 v[64:67], a[8:11], a[232:235], v[64:67]
    v_cvt_pk_bf16_f32 v85, v58, v59
    v_mfma_f32_16x16x32_bf16 v[64:67], a[12:15], a[236:239], v[64:67]
    v_exp_f32 v60, v60
    v_mfma_f32_16x16x32_bf16 v[68:71], a[16:19], a[224:227], v[104:107]
    v_mfma_f32_16x16x32_bf16 v[68:71], a[20:23], a[228:231], v[68:71]
    v_exp_f32 v61, v61
    v_mfma_f32_16x16x32_bf16 v[68:71], a[24:27], a[232:235], v[68:71]
    s_add_u32 m0, s53, 0xc000
    v_cvt_pk_bf16_f32 v86, v60, v61
    v_mfma_f32_16x16x32_bf16 v[68:71], a[28:31], a[236:239], v[68:71]
    s_add_u32 s64, s64, 0x4000
    v_exp_f32 v62, v62
    s_waitcnt lgkmcnt(0)
    v_mfma_f32_16x16x32_bf16 v[128:131], a[32:35], v[80:83], v[128:131]
    buffer_load_dwordx4 v20, s[12:15], s64 offen nt lds
    v_mfma_f32_16x16x32_bf16 v[132:135], a[36:39], v[80:83], v[132:135]
    v_exp_f32 v63, v63
    v_mfma_f32_16x16x32_bf16 v[136:139], a[40:43], v[80:83], v[136:139]
    v_cvt_pk_bf16_f32 v87, v62, v63
    v_mfma_f32_16x16x32_bf16 v[140:143], a[44:47], v[80:83], v[140:143]
    s_waitcnt vmcnt(9) lgkmcnt(0)
    s_barrier
    v_mfma_f32_16x16x32_bf16 v[144:147], a[48:51], v[80:83], v[144:147]
    v_exp_f32 v64, v64
    v_mfma_f32_16x16x32_bf16 v[148:151], a[52:55], v[80:83], v[148:151]
    ds_read_b128 a[128:131], v8 offset:16384
    v_mfma_f32_16x16x32_bf16 v[152:155], a[56:59], v[80:83], v[152:155]
    v_exp_f32 v65, v65
    v_mfma_f32_16x16x32_bf16 v[156:159], a[60:63], v[80:83], v[156:159]
    ds_read_b128 a[132:135], v9 offset:16384
    v_cvt_pk_bf16_f32 v88, v64, v65
    v_mfma_f32_16x16x32_bf16 v[112:115], v[28:31], v[80:83], v[112:115]
    v_exp_f32 v66, v66
    ds_read_b128 a[136:139], v10 offset:16384
    v_exp_f32 v67, v67
    ds_read_b128 a[140:143], v11 offset:16384
    v_cvt_pk_bf16_f32 v89, v66, v67
    v_exp_f32 v68, v68
    ds_read_b128 a[144:147], v8 offset:20480
    v_exp_f32 v69, v69
    ds_read_b128 a[148:151], v9 offset:20480
    v_cvt_pk_bf16_f32 v90, v68, v69
    v_exp_f32 v70, v70
    v_mfma_f32_16x16x32_bf16 v[160:163], a[32:35], v[84:87], v[160:163]
    buffer_load_dwordx4 v21, s[12:15], s64 offen offset:1024 nt lds
    v_mfma_f32_16x16x32_bf16 v[164:167], a[36:39], v[84:87], v[164:167]
    v_exp_f32 v71, v71
    v_mfma_f32_16x16x32_bf16 v[168:171], a[40:43], v[84:87], v[168:171]
    ds_read_b128 a[152:155], v10 offset:20480
    v_cvt_pk_bf16_f32 v91, v70, v71
    v_mfma_f32_16x16x32_bf16 v[172:175], a[44:47], v[84:87], v[172:175]
    v_mfma_f32_16x16x32_bf16 v[176:179], a[48:51], v[84:87], v[176:179]
    v_mfma_f32_16x16x32_bf16 v[180:183], a[52:55], v[84:87], v[180:183]
    ds_read_b128 a[156:159], v11 offset:20480
    v_mfma_f32_16x16x32_bf16 v[184:187], a[56:59], v[84:87], v[184:187]
    v_mfma_f32_16x16x32_bf16 v[188:191], a[60:63], v[84:87], v[188:191]
    v_mfma_f32_16x16x32_bf16 v[116:119], v[28:31], v[84:87], v[116:119]
    s_sub_u32 s66, s66, 1
    s_cmp_lg_u32 s66, 0
    s_cbranch_scc1 L_attn_w3
L_tail_w3:
    s_waitcnt lgkmcnt(2)
    v_mfma_f32_16x16x32_bf16 v[48:51], a[128:131], a[192:195], v[96:99]
    ds_read_b64_tr_b16 a[160:161], v12
    v_mfma_f32_16x16x32_bf16 v[48:51], a[132:135], a[196:199], v[48:51]
    v_mfma_f32_16x16x32_bf16 v[48:51], a[136:139], a[200:203], v[48:51]
    ds_read_b64_tr_b16 a[162:163], v12 offset:4096
    v_mfma_f32_16x16x32_bf16 v[48:51], a[140:143], a[204:207], v[48:51]
    v_mfma_f32_16x16x32_bf16 v[52:55], a[144:147], a[192:195], v[96:99]
    ds_read_b64_tr_b16 a[164:165], v13
    v_mfma_f32_16x16x32_bf16 v[52:55], a[148:151], a[196:199], v[52:55]
    s_waitcnt lgkmcnt(3)
    v_mfma_f32_16x16x32_bf16 v[52:55], a[152:155], a[200:203], v[52:55]
    ds_read_b64_tr_b16 a[166:167], v13 offset:4096
    v_mfma_f32_16x16x32_bf16 v[52:55], a[156:159], a[204:207], v[52:55]
    v_mfma_f32_16x16x32_bf16 v[192:195], a[32:35], v[88:91], v[192:195]
    buffer_load_dwordx4 v22, s[12:15], s64 offen offset:2048 nt lds
    v_mfma_f32_16x16x32_bf16 v[196:199], a[36:39], v[88:91], v[196:199]
    v_mfma_f32_16x16x32_bf16 v[200:203], a[40:43], v[88:91], v[200:203]
    ds_read_b64_tr_b16 a[168:169], v14
    v_mfma_f32_16x16x32_bf16 v[204:207], a[44:47], v[88:91], v[204:207]
    ds_read_b64_tr_b16 a[170:171], v14 offset:4096
    v_mfma_f32_16x16x32_bf16 v[208:211], a[48:51], v[88:91], v[208:211]
    v_exp_f32 v48, v48
    v_mfma_f32_16x16x32_bf16 v[212:215], a[52:55], v[88:91], v[212:215]
    ds_read_b64_tr_b16 a[172:173], v15
    v_mfma_f32_16x16x32_bf16 v[216:219], a[56:59], v[88:91], v[216:219]
    v_exp_f32 v49, v49
    v_mfma_f32_16x16x32_bf16 v[220:223], a[60:63], v[88:91], v[220:223]
    ds_read_b64_tr_b16 a[174:175], v15 offset:4096
    v_cvt_pk_bf16_f32 v80, v48, v49
    v_mfma_f32_16x16x32_bf16 v[120:123], v[28:31], v[88:91], v[120:123]
    v_exp_f32 v50, v50
    v_mfma_f32_16x16x32_bf16 v[56:59], a[128:131], a[208:211], v[100:103]
    ds_read_b64_tr_b16 a[176:177], v16
    v_mfma_f32_16x16x32_bf16 v[56:59], a[132:135], a[212:215], v[56:59]
    v_exp_f32 v51, v51
    v_mfma_f32_16x16x32_bf16 v[56:59], a[136:139], a[216:219], v[56:59]
    ds_read_b64_tr_b16 a[178:179], v16 offset:4096
    v_cvt_pk_bf16_f32 v81, v50, v51
    v_mfma_f32_16x16x32_bf16 v[56:59], a[140:143], a[220:223], v[56:59]
    v_exp_f32 v52, v52
    v_mfma_f32_16x16x32_bf16 v[60:63], a[144:147], a[208:211], v[100:103]
    ds_read_b64_tr_b16 a[180:181], v17
    v_mfma_f32_16x16x32_bf16 v[60:63], a[148:151], a[212:215], v[60:63]
    v_exp_f32 v53, v53
    v_mfma_f32_16x16x32_bf16 v[60:63], a[152:155], a[216:219], v[60:63]
    ds_read_b64_tr_b16 a[182:183], v17 offset:4096
    v_cvt_pk_bf16_f32 v82, v52, v53
    v_mfma_f32_16x16x32_bf16 v[60:63], a[156:159], a[220:223], v[60:63]
    v_exp_f32 v54, v54
    buffer_load_dwordx4 v23, s[12:15], s64 offen offset:3072 nt lds
    v_exp_f32 v55, v55
    ds_read_b64_tr_b16 a[184:185], v18
    v_cvt_pk_bf16_f32 v83, v54, v55
    ds_read_b64_tr_b16 a[186:187], v18 offset:4096
    v_exp_f32 v56, v56
    ds_read_b64_tr_b16 a[188:189], v19
    s_add_u32 m0, s53, 0x1c000
    s_nop 0
    buffer_load_dwordx4 v24, s[16:19], s64 offen nt lds
    v_exp_f32 v57, v57
    ds_read_b64_tr_b16 a[190:191], v19 offset:4096
    v_cvt_pk_bf16_f32 v84, v56, v57
    v_exp_f32 v58, v58
    v_mfma_f32_16x16x32_bf16 v[64:67], a[128:131], a[224:227], v[104:107]
    v_mfma_f32_16x16x32_bf16 v[64:67], a[132:135], a[228:231], v[64:67]
    v_exp_f32 v59, v59
    v_mfma_f32_16x16x32_bf16 v[64:67], a[136:139], a[232:235], v[64:67]
    v_cvt_pk_bf16_f32 v85, v58, v59
    v_mfma_f32_16x16x32_bf16 v[64:67], a[140:143], a[236:239], v[64:67]
    v_exp_f32 v60, v60
    v_mfma_f32_16x16x32_bf16 v[68:71], a[144:147], a[224:227], v[104:107]
    s_add_u32 m0, s53, 0x1c000
    s_nop 0
    buffer_load_dwordx4 v25, s[16:19], s64 offen offset:1024 nt lds
    v_mfma_f32_16x16x32_bf16 v[68:71], a[148:151], a[228:231], v[68:71]
    v_exp_f32 v61, v61
    v_mfma_f32_16x16x32_bf16 v[68:71], a[152:155], a[232:235], v[68:71]
    v_cvt_pk_bf16_f32 v86, v60, v61
    v_mfma_f32_16x16x32_bf16 v[68:71], a[156:159], a[236:239], v[68:71]
    v_exp_f32 v62, v62
    s_waitcnt lgkmcnt(0)
    v_mfma_f32_16x16x32_bf16 v[128:131], a[160:163], v[80:83], v[128:131]
    v_mfma_f32_16x16x32_bf16 v[132:135], a[164:167], v[80:83], v[132:135]
    v_exp_f32 v63, v63
    v_mfma_f32_16x16x32_bf16 v[136:139], a[168:171], v[80:83], v[136:139]
    v_cvt_pk_bf16_f32 v87, v62, v63
    v_mfma_f32_16x16x32_bf16 v[140:143], a[172:175], v[80:83], v[140:143]
    v_mfma_f32_16x16x32_bf16 v[144:147], a[176:179], v[80:83], v[144:147]
    s_add_u32 m0, s53, 0x1c000
    s_nop 0
    buffer_load_dwordx4 v24, s[16:19], s64 offen offset:2048 nt lds
    v_exp_f32 v64, v64
    v_mfma_f32_16x16x32_bf16 v[148:151], a[180:183], v[80:83], v[148:151]
    ds_read_b128 a[0:3], v8 offset:24576
    v_mfma_f32_16x16x32_bf16 v[152:155], a[184:187], v[80:83], v[152:155]
    v_exp_f32 v65, v65
    v_mfma_f32_16x16x32_bf16 v[156:159], a[188:191], v[80:83], v[156:159]
    ds_read_b128 a[4:7], v9 offset:24576
    v_cvt_pk_bf16_f32 v88, v64, v65
    v_mfma_f32_16x16x32_bf16 v[112:115], v[28:31], v[80:83], v[112:115]
    v_exp_f32 v66, v66
    ds_read_b128 a[8:11], v10 offset:24576
    v_exp_f32 v67, v67
    ds_read_b128 a[12:15], v11 offset:24576
    v_cvt_pk_bf16_f32 v89, v66, v67
    s_add_u32 m0, s53, 0x1c000
    s_nop 0
    buffer_load_dwordx4 v25, s[16:19], s64 offen offset:3072 nt lds
    v_exp_f32 v68, v68
    ds_read_b128 a[16:19], v8 offset:28672
    v_exp_f32 v69, v69
    ds_read_b128 a[20:23], v9 offset:28672
    v_cvt_pk_bf16_f32 v90, v68, v69
    v_exp_f32 v70, v70
    v_mfma_f32_16x16x32_bf16 v[160:163], a[160:163], v[84:87], v[160:163]
    v_mfma_f32_16x16x32_bf16 v[164:167], a[164:167], v[84:87], v[164:167]
    v_exp_f32 v71, v71
    v_mfma_f32_16x16x32_bf16 v[168:171], a[168:171], v[84:87], v[168:171]
    ds_read_b128 a[24:27], v10 offset:28672
    v_cvt_pk_bf16_f32 v91, v70, v71
    v_mfma_f32_16x16x32_bf16 v[172:175], a[172:175], v[84:87], v[172:175]
    v_mfma_f32_16x16x32_bf16 v[176:179], a[176:179], v[84:87], v[176:179]
    v_mfma_f32_16x16x32_bf16 v[180:183], a[180:183], v[84:87], v[180:183]
    ds_read_b128 a[28:31], v11 offset:28672
    v_mfma_f32_16x16x32_bf16 v[184:187], a[184:187], v[84:87], v[184:187]
    v_mfma_f32_16x16x32_bf16 v[188:191], a[188:191], v[84:87], v[188:191]
    v_mfma_f32_16x16x32_bf16 v[116:119], v[28:31], v[84:87], v[116:119]
    s_waitcnt lgkmcnt(2)
    v_mfma_f32_16x16x32_bf16 v[48:51], a[0:3], a[192:195], v[96:99]
    ds_read_b64_tr_b16 a[32:33], v12 offset:8192
    v_mfma_f32_16x16x32_bf16 v[48:51], a[4:7], a[196:199], v[48:51]
    v_mfma_f32_16x16x32_bf16 v[48:51], a[8:11], a[200:203], v[48:51]
    ds_read_b64_tr_b16 a[34:35], v12 offset:12288
    v_mfma_f32_16x16x32_bf16 v[48:51], a[12:15], a[204:207], v[48:51]
    v_mfma_f32_16x16x32_bf16 v[52:55], a[16:19], a[192:195], v[96:99]
    ds_read_b64_tr_b16 a[36:37], v13 offset:8192
    s_lshl_b32 s67, s52, 9
    v_mul_u32_u24 v2, 0x500, v0
    v_mfma_f32_16x16x32_bf16 v[52:55], a[20:23], a[196:199], v[52:55]
    s_waitcnt lgkmcnt(3)
    v_mfma_f32_16x16x32_bf16 v[52:55], a[24:27], a[200:203], v[52:55]
    ds_read_b64_tr_b16 a[38:39], v13 offset:12288
    s_mul_i32 s68, s75, 38
    v_cmp_gt_u32 vcc, 38, v0
    v_mfma_f32_16x16x32_bf16 v[52:55], a[28:31], a[204:207], v[52:55]
    s_add_u32 s68, s68, s67
    s_add_u32 s68, s68, 0
    v_mfma_f32_16x16x32_bf16 v[192:195], a[160:163], v[88:91], v[192:195]
    s_mul_i32 s68, s68, 0x500
    v_cndmask_b32 v3, -1, v2, vcc
    v_mfma_f32_16x16x32_bf16 v[196:199], a[164:167], v[88:91], v[196:199]
    v_mfma_f32_16x16x32_bf16 v[200:203], a[168:171], v[88:91], v[200:203]
    ds_read_b64_tr_b16 a[40:41], v14 offset:8192
    buffer_load_dword v42, v3, s[24:27], s68 offen
    v_mfma_f32_16x16x32_bf16 v[204:207], a[172:175], v[88:91], v[204:207]
    ds_read_b64_tr_b16 a[42:43], v14 offset:12288
    v_mfma_f32_16x16x32_bf16 v[208:211], a[176:179], v[88:91], v[208:211]
    s_mul_i32 s68, s75, 48
    v_exp_f32 v48, v48
    v_cmp_gt_u32 vcc, 48, v0
    v_mfma_f32_16x16x32_bf16 v[212:215], a[180:183], v[88:91], v[212:215]
    ds_read_b64_tr_b16 a[44:45], v15 offset:8192
    s_add_u32 s68, s68, s67
    s_add_u32 s68, s68, 0xe0
    v_mfma_f32_16x16x32_bf16 v[216:219], a[184:187], v[88:91], v[216:219]
    s_mul_i32 s68, s68, 0x500
    v_exp_f32 v49, v49
    v_cndmask_b32 v3, -1, v2, vcc
    v_mfma_f32_16x16x32_bf16 v[220:223], a[188:191], v[88:91], v[220:223]
    ds_read_b64_tr_b16 a[46:47], v15 offset:12288
    v_cvt_pk_bf16_f32 v80, v48, v49
    v_mfma_f32_16x16x32_bf16 v[120:123], v[28:31], v[88:91], v[120:123]
    buffer_load_dword v43, v3, s[24:27], s68 offen
    v_exp_f32 v50, v50
    v_mfma_f32_16x16x32_bf16 v[56:59], a[0:3], a[208:211], v[100:103]
    ds_read_b64_tr_b16 a[48:49], v16 offset:8192
    v_mfma_f32_16x16x32_bf16 v[56:59], a[4:7], a[212:215], v[56:59]
    v_exp_f32 v51, v51
    v_mfma_f32_16x16x32_bf16 v[56:59], a[8:11], a[216:219], v[56:59]
    ds_read_b64_tr_b16 a[50:51], v16 offset:12288
    v_cvt_pk_bf16_f32 v81, v50, v51
    v_mfma_f32_16x16x32_bf16 v[56:59], a[12:15], a[220:223], v[56:59]
    v_exp_f32 v52, v52
    v_mfma_f32_16x16x32_bf16 v[60:63], a[16:19], a[208:211], v[100:103]
    ds_read_b64_tr_b16 a[52:53], v17 offset:8192
    v_mfma_f32_16x16x32_bf16 v[60:63], a[20:23], a[212:215], v[60:63]
    v_exp_f32 v53, v53
    v_mfma_f32_16x16x32_bf16 v[60:63], a[24:27], a[216:219], v[60:63]
    ds_read_b64_tr_b16 a[54:55], v17 offset:12288
    v_cvt_pk_bf16_f32 v82, v52, v53
    v_mfma_f32_16x16x32_bf16 v[60:63], a[28:31], a[220:223], v[60:63]
    v_exp_f32 v54, v54
    v_exp_f32 v55, v55
    ds_read_b64_tr_b16 a[56:57], v18 offset:8192
    v_cvt_pk_bf16_f32 v83, v54, v55
    ds_read_b64_tr_b16 a[58:59], v18 offset:12288
    v_exp_f32 v56, v56
    ds_read_b64_tr_b16 a[60:61], v19 offset:8192
    v_exp_f32 v57, v57
    ds_read_b64_tr_b16 a[62:63], v19 offset:12288
    v_cvt_pk_bf16_f32 v84, v56, v57
    v_exp_f32 v58, v58
    v_mfma_f32_16x16x32_bf16 v[64:67], a[0:3], a[224:227], v[104:107]
    v_mfma_f32_16x16x32_bf16 v[64:67], a[4:7], a[228:231], v[64:67]
    v_exp_f32 v59, v59
    v_mfma_f32_16x16x32_bf16 v[64:67], a[8:11], a[232:235], v[64:67]
    v_cvt_pk_bf16_f32 v85, v58, v59
    v_mfma_f32_16x16x32_bf16 v[64:67], a[12:15], a[236:239], v[64:67]
    v_exp_f32 v60, v60
    v_mfma_f32_16x16x32_bf16 v[68:71], a[16:19], a[224:227], v[104:107]
    v_mfma_f32_16x16x32_bf16 v[68:71], a[20:23], a[228:231], v[68:71]
    v_exp_f32 v61, v61
    v_mfma_f32_16x16x32_bf16 v[68:71], a[24:27], a[232:235], v[68:71]
    v_cvt_pk_bf16_f32 v86, v60, v61
    v_mfma_f32_16x16x32_bf16 v[68:71], a[28:31], a[236:239], v[68:71]
    v_exp_f32 v62, v62
    s_waitcnt lgkmcnt(0)
    v_mfma_f32_16x16x32_bf16 v[128:131], a[32:35], v[80:83], v[128:131]
    v_mfma_f32_16x16x32_bf16 v[132:135], a[36:39], v[80:83], v[132:135]
    v_exp_f32 v63, v63
    v_mfma_f32_16x16x32_bf16 v[136:139], a[40:43], v[80:83], v[136:139]
    v_cvt_pk_bf16_f32 v87, v62, v63
    v_mfma_f32_16x16x32_bf16 v[140:143], a[44:47], v[80:83], v[140:143]
    s_waitcnt vmcnt(10) lgkmcnt(0)
    s_barrier
    v_mfma_f32_16x16x32_bf16 v[144:147], a[48:51], v[80:83], v[144:147]
    v_exp_f32 v64, v64
    v_mfma_f32_16x16x32_bf16 v[148:151], a[52:55], v[80:83], v[148:151]
    ds_read_b128 a[128:131], v8 offset:32768
    v_mfma_f32_16x16x32_bf16 v[152:155], a[56:59], v[80:83], v[152:155]
    v_exp_f32 v65, v65
    v_mfma_f32_16x16x32_bf16 v[156:159], a[60:63], v[80:83], v[156:159]
    ds_read_b128 a[132:135], v9 offset:32768
    v_cvt_pk_bf16_f32 v88, v64, v65
    v_mfma_f32_16x16x32_bf16 v[112:115], v[28:31], v[80:83], v[112:115]
    v_exp_f32 v66, v66
    ds_read_b128 a[136:139], v10 offset:32768
    v_exp_f32 v67, v67
    ds_read_b128 a[140:143], v11 offset:32768
    v_cvt_pk_bf16_f32 v89, v66, v67
    v_exp_f32 v68, v68
    ds_read_b128 a[144:147], v8 offset:36864
    v_exp_f32 v69, v69
    ds_read_b128 a[148:151], v9 offset:36864
    v_cvt_pk_bf16_f32 v90, v68, v69
    v_exp_f32 v70, v70
    v_mfma_f32_16x16x32_bf16 v[160:163], a[32:35], v[84:87], v[160:163]
    v_mfma_f32_16x16x32_bf16 v[164:167], a[36:39], v[84:87], v[164:167]
    v_exp_f32 v71, v71
    v_mfma_f32_16x16x32_bf16 v[168:171], a[40:43], v[84:87], v[168:171]
    ds_read_b128 a[152:155], v10 offset:36864
    v_cvt_pk_bf16_f32 v91, v70, v71
    v_mfma_f32_16x16x32_bf16 v[172:175], a[44:47], v[84:87], v[172:175]
    v_mfma_f32_16x16x32_bf16 v[176:179], a[48:51], v[84:87], v[176:179]
    v_mfma_f32_16x16x32_bf16 v[180:183], a[52:55], v[84:87], v[180:183]
    ds_read_b128 a[156:159], v11 offset:36864
    v_mfma_f32_16x16x32_bf16 v[184:187], a[56:59], v[84:87], v[184:187]
    v_mfma_f32_16x16x32_bf16 v[188:191], a[60:63], v[84:87], v[188:191]
    v_mfma_f32_16x16x32_bf16 v[116:119], v[28:31], v[84:87], v[116:119]
    s_waitcnt lgkmcnt(2)
    v_mfma_f32_16x16x32_bf16 v[48:51], a[128:131], a[192:195], v[96:99]
    ds_read_b64_tr_b16 a[160:161], v12 offset:16384
    v_mfma_f32_16x16x32_bf16 v[48:51], a[132:135], a[196:199], v[48:51]
    v_mfma_f32_16x16x32_bf16 v[48:51], a[136:139], a[200:203], v[48:51]
    ds_read_b64_tr_b16 a[162:163], v12 offset:20480
    v_mfma_f32_16x16x32_bf16 v[48:51], a[140:143], a[204:207], v[48:51]
    v_mfma_f32_16x16x32_bf16 v[52:55], a[144:147], a[192:195], v[96:99]
    ds_read_b64_tr_b16 a[164:165], v13 offset:16384
    v_mfma_f32_16x16x32_bf16 v[52:55], a[148:151], a[196:199], v[52:55]
    s_waitcnt lgkmcnt(3)
    v_mfma_f32_16x16x32_bf16 v[52:55], a[152:155], a[200:203], v[52:55]
    ds_read_b64_tr_b16 a[166:167], v13 offset:20480
    v_mfma_f32_16x16x32_bf16 v[52:55], a[156:159], a[204:207], v[52:55]
    v_mfma_f32_16x16x32_bf16 v[192:195], a[32:35], v[88:91], v[192:195]
    v_mfma_f32_16x16x32_bf16 v[196:199], a[36:39], v[88:91], v[196:199]
    v_mfma_f32_16x16x32_bf16 v[200:203], a[40:43], v[88:91], v[200:203]
    ds_read_b64_tr_b16 a[168:169], v14 offset:16384
    v_mfma_f32_16x16x32_bf16 v[204:207], a[44:47], v[88:91], v[204:207]
    ds_read_b64_tr_b16 a[170:171], v14 offset:20480
    v_mfma_f32_16x16x32_bf16 v[208:211], a[48:51], v[88:91], v[208:211]
    v_exp_f32 v48, v48
    v_mfma_f32_16x16x32_bf16 v[212:215], a[52:55], v[88:91], v[212:215]
    ds_read_b64_tr_b16 a[172:173], v15 offset:16384
    v_mfma_f32_16x16x32_bf16 v[216:219], a[56:59], v[88:91], v[216:219]
    v_exp_f32 v49, v49
    v_mfma_f32_16x16x32_bf16 v[220:223], a[60:63], v[88:91], v[220:223]
    ds_read_b64_tr_b16 a[174:175], v15 offset:20480
    v_cvt_pk_bf16_f32 v80, v48, v49
    v_mfma_f32_16x16x32_bf16 v[120:123], v[28:31], v[88:91], v[120:123]
    v_exp_f32 v50, v50
    v_mfma_f32_16x16x32_bf16 v[56:59], a[128:131], a[208:211], v[100:103]
    ds_read_b64_tr_b16 a[176:177], v16 offset:16384
    v_mfma_f32_16x16x32_bf16 v[56:59], a[132:135], a[212:215], v[56:59]
    v_exp_f32 v51, v51
    v_mfma_f32_16x16x32_bf16 v[56:59], a[136:139], a[216:219], v[56:59]
    ds_read_b64_tr_b16 a[178:179], v16 offset:20480
    v_cvt_pk_bf16_f32 v81, v50, v51
    v_mfma_f32_16x16x32_bf16 v[56:59], a[140:143], a[220:223], v[56:59]
    v_exp_f32 v52, v52
    v_mov_b32 v45, 0
    v_mfma_f32_16x16x32_bf16 v[60:63], a[144:147], a[208:211], v[100:103]
    ds_read_b64_tr_b16 a[180:181], v17 offset:16384
    buffer_load_dword v44, v45, s[32:35], 0 offen sc1
    v_mfma_f32_16x16x32_bf16 v[60:63], a[148:151], a[212:215], v[60:63]
    v_exp_f32 v53, v53
    v_mfma_f32_16x16x32_bf16 v[60:63], a[152:155], a[216:219], v[60:63]
    ds_read_b64_tr_b16 a[182:183], v17 offset:20480
    v_cvt_pk_bf16_f32 v82, v52, v53
    v_mfma_f32_16x16x32_bf16 v[60:63], a[156:159], a[220:223], v[60:63]
    v_exp_f32 v54, v54
    v_exp_f32 v55, v55
    ds_read_b64_tr_b16 a[184:185], v18 offset:16384
    v_cvt_pk_bf16_f32 v83, v54, v55
    ds_read_b64_tr_b16 a[186:187], v18 offset:20480
    v_exp_f32 v56, v56
    ds_read_b64_tr_b16 a[188:189], v19 offset:16384
    v_exp_f32 v57, v57
    ds_read_b64_tr_b16 a[190:191], v19 offset:20480
    v_cvt_pk_bf16_f32 v84, v56, v57
    v_exp_f32 v58, v58
    v_mfma_f32_16x16x32_bf16 v[64:67], a[128:131], a[224:227], v[104:107]
    v_mfma_f32_16x16x32_bf16 v[64:67], a[132:135], a[228:231], v[64:67]
    v_exp_f32 v59, v59
    v_mfma_f32_16x16x32_bf16 v[64:67], a[136:139], a[232:235], v[64:67]
    v_cvt_pk_bf16_f32 v85, v58, v59
    v_mfma_f32_16x16x32_bf16 v[64:67], a[140:143], a[236:239], v[64:67]
    v_exp_f32 v60, v60
    v_mfma_f32_16x16x32_bf16 v[68:71], a[144:147], a[224:227], v[104:107]
    v_mfma_f32_16x16x32_bf16 v[68:71], a[148:151], a[228:231], v[68:71]
    v_exp_f32 v61, v61
    v_mfma_f32_16x16x32_bf16 v[68:71], a[152:155], a[232:235], v[68:71]
    v_cvt_pk_bf16_f32 v86, v60, v61
    v_mfma_f32_16x16x32_bf16 v[68:71], a[156:159], a[236:239], v[68:71]
    v_exp_f32 v62, v62
    s_waitcnt lgkmcnt(0)
    v_mfma_f32_16x16x32_bf16 v[128:131], a[160:163], v[80:83], v[128:131]
    v_mfma_f32_16x16x32_bf16 v[132:135], a[164:167], v[80:83], v[132:135]
    v_exp_f32 v63, v63
    v_mfma_f32_16x16x32_bf16 v[136:139], a[168:171], v[80:83], v[136:139]
    v_cvt_pk_bf16_f32 v87, v62, v63
    v_mfma_f32_16x16x32_bf16 v[140:143], a[172:175], v[80:83], v[140:143]
    v_mfma_f32_16x16x32_bf16 v[144:147], a[176:179], v[80:83], v[144:147]
    v_exp_f32 v64, v64
    v_mfma_f32_16x16x32_bf16 v[148:151], a[180:183], v[80:83], v[148:151]
    ds_read_b128 a[0:3], v8 offset:40960
    v_mfma_f32_16x16x32_bf16 v[152:155], a[184:187], v[80:83], v[152:155]
    v_exp_f32 v65, v65
    v_mfma_f32_16x16x32_bf16 v[156:159], a[188:191], v[80:83], v[156:159]
    ds_read_b128 a[4:7], v9 offset:40960
    v_cvt_pk_bf16_f32 v88, v64, v65
    v_mfma_f32_16x16x32_bf16 v[112:115], v[28:31], v[80:83], v[112:115]
    v_exp_f32 v66, v66
    ds_read_b128 a[8:11], v10 offset:40960
    v_exp_f32 v67, v67
    ds_read_b128 a[12:15], v11 offset:40960
    v_cvt_pk_bf16_f32 v89, v66, v67
    v_exp_f32 v68, v68
    ds_read_b128 a[16:19], v8 offset:45056
    v_exp_f32 v69, v69
    ds_read_b128 a[20:23], v9 offset:45056
    v_cvt_pk_bf16_f32 v90, v68, v69
    v_exp_f32 v70, v70
    v_mfma_f32_16x16x32_bf16 v[160:163], a[160:163], v[84:87], v[160:163]
    v_mfma_f32_16x16x32_bf16 v[164:167], a[164:167], v[84:87], v[164:167]
    v_exp_f32 v71, v71
    v_mfma_f32_16x16x32_bf16 v[168:171], a[168:171], v[84:87], v[168:171]
    ds_read_b128 a[24:27], v10 offset:45056
    v_cvt_pk_bf16_f32 v91, v70, v71
    v_mfma_f32_16x16x32_bf16 v[172:175], a[172:175], v[84:87], v[172:175]
    v_mfma_f32_16x16x32_bf16 v[176:179], a[176:179], v[84:87], v[176:179]
    v_mfma_f32_16x16x32_bf16 v[180:183], a[180:183], v[84:87], v[180:183]
    ds_read_b128 a[28:31], v11 offset:45056
    v_mfma_f32_16x16x32_bf16 v[184:187], a[184:187], v[84:87], v[184:187]
    v_mfma_f32_16x16x32_bf16 v[188:191], a[188:191], v[84:87], v[188:191]
    v_mfma_f32_16x16x32_bf16 v[116:119], v[28:31], v[84:87], v[116:119]
    s_waitcnt lgkmcnt(2)
    v_mfma_f32_16x16x32_bf16 v[48:51], a[0:3], a[192:195], v[96:99]
    ds_read_b64_tr_b16 a[32:33], v12 offset:24576
    v_mfma_f32_16x16x32_bf16 v[48:51], a[4:7], a[196:199], v[48:51]
    v_mfma_f32_16x16x32_bf16 v[48:51], a[8:11], a[200:203], v[48:51]
    ds_read_b64_tr_b16 a[34:35], v12 offset:28672
    v_mfma_f32_16x16x32_bf16 v[48:51], a[12:15], a[204:207], v[48:51]
    v_mfma_f32_16x16x32_bf16 v[52:55], a[16:19], a[192:195], v[96:99]
    ds_read_b64_tr_b16 a[36:37], v13 offset:24576
    v_mfma_f32_16x16x32_bf16 v[52:55], a[20:23], a[196:199], v[52:55]
    s_waitcnt lgkmcnt(3)
    v_mfma_f32_16x16x32_bf16 v[52:55], a[24:27], a[200:203], v[52:55]
    ds_read_b64_tr_b16 a[38:39], v13 offset:28672
    v_mfma_f32_16x16x32_bf16 v[52:55], a[28:31], a[204:207], v[52:55]
    v_mfma_f32_16x16x32_bf16 v[192:195], a[160:163], v[88:91], v[192:195]
    v_mfma_f32_16x16x32_bf16 v[196:199], a[164:167], v[88:91], v[196:199]
    v_mfma_f32_16x16x32_bf16 v[200:203], a[168:171], v[88:91], v[200:203]
    ds_read_b64_tr_b16 a[40:41], v14 offset:24576
    v_mfma_f32_16x16x32_bf16 v[204:207], a[172:175], v[88:91], v[204:207]
    ds_read_b64_tr_b16 a[42:43], v14 offset:28672
    v_mfma_f32_16x16x32_bf16 v[208:211], a[176:179], v[88:91], v[208:211]
    v_exp_f32 v48, v48
    v_mfma_f32_16x16x32_bf16 v[212:215], a[180:183], v[88:91], v[212:215]
    ds_read_b64_tr_b16 a[44:45], v15 offset:24576
    v_mfma_f32_16x16x32_bf16 v[216:219], a[184:187], v[88:91], v[216:219]
    v_exp_f32 v49, v49
    v_mfma_f32_16x16x32_bf16 v[220:223], a[188:191], v[88:91], v[220:223]
    ds_read_b64_tr_b16 a[46:47], v15 offset:28672
    v_cvt_pk_bf16_f32 v80, v48, v49
    v_mfma_f32_16x16x32_bf16 v[120:123], v[28:31], v[88:91], v[120:123]
    v_exp_f32 v50, v50
    v_mfma_f32_16x16x32_bf16 v[56:59], a[0:3], a[208:211], v[100:103]
    ds_read_b64_tr_b16 a[48:49], v16 offset:24576
    v_mfma_f32_16x16x32_bf16 v[56:59], a[4:7], a[212:215], v[56:59]
    v_exp_f32 v51, v51
    v_mfma_f32_16x16x32_bf16 v[56:59], a[8:11], a[216:219], v[56:59]
    ds_read_b64_tr_b16 a[50:51], v16 offset:28672
    v_cvt_pk_bf16_f32 v81, v50, v51
    v_mfma_f32_16x16x32_bf16 v[56:59], a[12:15], a[220:223], v[56:59]
    v_exp_f32 v52, v52
    v_mfma_f32_16x16x32_bf16 v[60:63], a[16:19], a[208:211], v[100:103]
    ds_read_b64_tr_b16 a[52:53], v17 offset:24576
    v_mfma_f32_16x16x32_bf16 v[60:63], a[20:23], a[212:215], v[60:63]
    v_exp_f32 v53, v53
    v_mfma_f32_16x16x32_bf16 v[60:63], a[24:27], a[216:219], v[60:63]
    ds_read_b64_tr_b16 a[54:55], v17 offset:28672
    v_cvt_pk_bf16_f32 v82, v52, v53
    v_mfma_f32_16x16x32_bf16 v[60:63], a[28:31], a[220:223], v[60:63]
    v_exp_f32 v54, v54
    v_exp_f32 v55, v55
    ds_read_b64_tr_b16 a[56:57], v18 offset:24576
    v_cvt_pk_bf16_f32 v83, v54, v55
    ds_read_b64_tr_b16 a[58:59], v18 offset:28672
    v_exp_f32 v56, v56
    ds_read_b64_tr_b16 a[60:61], v19 offset:24576
    s_add_u32 m0, s53, 0x20000
    s_mov_b32 s65, 0
    buffer_load_dwordx4 v32, s[24:27], s65 offen lds
    v_exp_f32 v57, v57
    ds_read_b64_tr_b16 a[62:63], v19 offset:28672
    v_cvt_pk_bf16_f32 v84, v56, v57
    v_exp_f32 v58, v58
    v_mfma_f32_16x16x32_bf16 v[64:67], a[0:3], a[224:227], v[104:107]
    v_mfma_f32_16x16x32_bf16 v[64:67], a[4:7], a[228:231], v[64:67]
    v_exp_f32 v59, v59
    v_mfma_f32_16x16x32_bf16 v[64:67], a[8:11], a[232:235], v[64:67]
    v_cvt_pk_bf16_f32 v85, v58, v59
    v_mfma_f32_16x16x32_bf16 v[64:67], a[12:15], a[236:239], v[64:67]
    v_exp_f32 v60, v60
    v_mfma_f32_16x16x32_bf16 v[68:71], a[16:19], a[224:227], v[104:107]
    buffer_load_dwordx4 v33, s[24:27], s65 offen offset:1024 lds
    v_mfma_f32_16x16x32_bf16 v[68:71], a[20:23], a[228:231], v[68:71]
    v_exp_f32 v61, v61
    v_mfma_f32_16x16x32_bf16 v[68:71], a[24:27], a[232:235], v[68:71]
    v_cvt_pk_bf16_f32 v86, v60, v61
    v_mfma_f32_16x16x32_bf16 v[68:71], a[28:31], a[236:239], v[68:71]
    v_exp_f32 v62, v62
    s_waitcnt lgkmcnt(0)
    v_mfma_f32_16x16x32_bf16 v[128:131], a[32:35], v[80:83], v[128:131]
    buffer_load_dwordx4 v34, s[24:27], s65 offen offset:2048 lds
    v_mfma_f32_16x16x32_bf16 v[132:135], a[36:39], v[80:83], v[132:135]
    v_exp_f32 v63, v63
    v_mfma_f32_16x16x32_bf16 v[136:139], a[40:43], v[80:83], v[136:139]
    v_cvt_pk_bf16_f32 v87, v62, v63
    v_mfma_f32_16x16x32_bf16 v[140:143], a[44:47], v[80:83], v[140:143]
    s_waitcnt vmcnt(6) lgkmcnt(0)
    s_barrier
    v_mfma_f32_16x16x32_bf16 v[144:147], a[48:51], v[80:83], v[144:147]
    v_exp_f32 v64, v64
    v_mfma_f32_16x16x32_bf16 v[148:151], a[52:55], v[80:83], v[148:151]
    ds_read_b128 a[128:131], v8 offset:49152
    v_mfma_f32_16x16x32_bf16 v[152:155], a[56:59], v[80:83], v[152:155]
    v_exp_f32 v65, v65
    v_mfma_f32_16x16x32_bf16 v[156:159], a[60:63], v[80:83], v[156:159]
    ds_read_b128 a[132:135], v9 offset:49152
    v_cvt_pk_bf16_f32 v88, v64, v65
    v_mfma_f32_16x16x32_bf16 v[112:115], v[28:31], v[80:83], v[112:115]
    v_exp_f32 v66, v66
    ds_read_b128 a[136:139], v10 offset:49152
    buffer_load_dwordx4 v35, s[24:27], s65 offen offset:3072 lds
    v_exp_f32 v67, v67
    ds_read_b128 a[140:143], v11 offset:49152
    v_cvt_pk_bf16_f32 v89, v66, v67
    v_exp_f32 v68, v68
    ds_read_b128 a[144:147], v8 offset:53248
    s_add_u32 m0, s53, 0x24000
    s_mov_b32 s65, 0xa000
    buffer_load_dwordx4 v32, s[24:27], s65 offen lds
    v_exp_f32 v69, v69
    ds_read_b128 a[148:151], v9 offset:53248
    v_cvt_pk_bf16_f32 v90, v68, v69
    v_exp_f32 v70, v70
    v_mfma_f32_16x16x32_bf16 v[160:163], a[32:35], v[84:87], v[160:163]
    v_mfma_f32_16x16x32_bf16 v[164:167], a[36:39], v[84:87], v[164:167]
    v_exp_f32 v71, v71
    v_mfma_f32_16x16x32_bf16 v[168:171], a[40:43], v[84:87], v[168:171]
    ds_read_b128 a[152:155], v10 offset:53248
    v_cvt_pk_bf16_f32 v91, v70, v71
    v_mfma_f32_16x16x32_bf16 v[172:175], a[44:47], v[84:87], v[172:175]
    buffer_load_dwordx4 v33, s[24:27], s65 offen offset:1024 lds
    v_mfma_f32_16x16x32_bf16 v[176:179], a[48:51], v[84:87], v[176:179]
    v_mfma_f32_16x16x32_bf16 v[180:183], a[52:55], v[84:87], v[180:183]
    ds_read_b128 a[156:159], v11 offset:53248
    v_mfma_f32_16x16x32_bf16 v[184:187], a[56:59], v[84:87], v[184:187]
    v_mfma_f32_16x16x32_bf16 v[188:191], a[60:63], v[84:87], v[188:191]
    buffer_load_dwordx4 v34, s[24:27], s65 offen offset:2048 lds
    v_mfma_f32_16x16x32_bf16 v[116:119], v[28:31], v[84:87], v[116:119]
    s_waitcnt lgkmcnt(2)
    v_mfma_f32_16x16x32_bf16 v[48:51], a[128:131], a[192:195], v[96:99]
    ds_read_b64_tr_b16 a[160:161], v12 offset:49152
    v_mfma_f32_16x16x32_bf16 v[48:51], a[132:135], a[196:199], v[48:51]
    v_mfma_f32_16x16x32_bf16 v[48:51], a[136:139], a[200:203], v[48:51]
    ds_read_b64_tr_b16 a[162:163], v12 offset:53248
    v_mfma_f32_16x16x32_bf16 v[48:51], a[140:143], a[204:207], v[48:51]
    v_mfma_f32_16x16x32_bf16 v[52:55], a[144:147], a[192:195], v[96:99]
    ds_read_b64_tr_b16 a[164:165], v13 offset:49152
    v_mfma_f32_16x16x32_bf16 v[52:55], a[148:151], a[196:199], v[52:55]
    buffer_load_dwordx4 v35, s[24:27], s65 offen offset:3072 lds
    s_waitcnt lgkmcnt(3)
    v_mfma_f32_16x16x32_bf16 v[52:55], a[152:155], a[200:203], v[52:55]
    ds_read_b64_tr_b16 a[166:167], v13 offset:53248
    v_mfma_f32_16x16x32_bf16 v[52:55], a[156:159], a[204:207], v[52:55]
    v_mfma_f32_16x16x32_bf16 v[192:195], a[32:35], v[88:91], v[192:195]
    v_mfma_f32_16x16x32_bf16 v[196:199], a[36:39], v[88:91], v[196:199]
    v_mfma_f32_16x16x32_bf16 v[200:203], a[40:43], v[88:91], v[200:203]
    ds_read_b64_tr_b16 a[168:169], v14 offset:49152
    s_add_u32 m0, s53, 0
    s_mov_b32 s65, 0x14000
    buffer_load_dwordx4 v32, s[24:27], s65 offen lds
    v_mfma_f32_16x16x32_bf16 v[204:207], a[44:47], v[88:91], v[204:207]
    ds_read_b64_tr_b16 a[170:171], v14 offset:53248
    v_mfma_f32_16x16x32_bf16 v[208:211], a[48:51], v[88:91], v[208:211]
    v_exp_f32 v48, v48
    v_mfma_f32_16x16x32_bf16 v[212:215], a[52:55], v[88:91], v[212:215]
    ds_read_b64_tr_b16 a[172:173], v15 offset:49152
    v_mfma_f32_16x16x32_bf16 v[216:219], a[56:59], v[88:91], v[216:219]
    v_exp_f32 v49, v49
    v_mfma_f32_16x16x32_bf16 v[220:223], a[60:63], v[88:91], v[220:223]
    ds_read_b64_tr_b16 a[174:175], v15 offset:53248
    v_cvt_pk_bf16_f32 v80, v48, v49
    v_mfma_f32_16x16x32_bf16 v[120:123], v[28:31], v[88:91], v[120:123]
    v_exp_f32 v50, v50
    v_mfma_f32_16x16x32_bf16 v[56:59], a[128:131], a[208:211], v[100:103]
    ds_read_b64_tr_b16 a[176:177], v16 offset:49152
    buffer_load_dwordx4 v33, s[24:27], s65 offen offset:1024 lds
    v_mfma_f32_16x16x32_bf16 v[56:59], a[132:135], a[212:215], v[56:59]
    v_exp_f32 v51, v51
    v_mfma_f32_16x16x32_bf16 v[56:59], a[136:139], a[216:219], v[56:59]
    ds_read_b64_tr_b16 a[178:179], v16 offset:53248
    v_cvt_pk_bf16_f32 v81, v50, v51
    v_mfma_f32_16x16x32_bf16 v[56:59], a[140:143], a[220:223], v[56:59]
    v_exp_f32 v52, v52
    v_mfma_f32_16x16x32_bf16 v[60:63], a[144:147], a[208:211], v[100:103]
    ds_read_b64_tr_b16 a[180:181], v17 offset:49152
    v_mfma_f32_16x16x32_bf16 v[60:63], a[148:151], a[212:215], v[60:63]
    v_exp_f32 v53, v53
    v_mfma_f32_16x16x32_bf16 v[60:63], a[152:155], a[216:219], v[60:63]
    ds_read_b64_tr_b16 a[182:183], v17 offset:53248
    v_cvt_pk_bf16_f32 v82, v52, v53
    v_mfma_f32_16x16x32_bf16 v[60:63], a[156:159], a[220:223], v[60:63]
    v_exp_f32 v54, v54
    buffer_load_dwordx4 v34, s[24:27], s65 offen offset:2048 lds
    v_exp_f32 v55, v55
    ds_read_b64_tr_b16 a[184:185], v18 offset:49152
    v_cvt_pk_bf16_f32 v83, v54, v55
    ds_read_b64_tr_b16 a[186:187], v18 offset:53248
    buffer_load_dwordx4 v35, s[24:27], s65 offen offset:3072 lds
    v_exp_f32 v56, v56
    ds_read_b64_tr_b16 a[188:189], v19 offset:49152
    v_exp_f32 v57, v57
    ds_read_b64_tr_b16 a[190:191], v19 offset:53248
    v_cvt_pk_bf16_f32 v84, v56, v57
    v_exp_f32 v58, v58
    v_mfma_f32_16x16x32_bf16 v[64:67], a[128:131], a[224:227], v[104:107]
    s_add_u32 m0, s53, 0x18000
    s_mov_b32 s65, 0x1e000
    buffer_load_dwordx4 v32, s[24:27], s65 offen lds
    v_mfma_f32_16x16x32_bf16 v[64:67], a[132:135], a[228:231], v[64:67]
    v_exp_f32 v59, v59
    v_mfma_f32_16x16x32_bf16 v[64:67], a[136:139], a[232:235], v[64:67]
    v_cvt_pk_bf16_f32 v85, v58, v59
    v_mfma_f32_16x16x32_bf16 v[64:67], a[140:143], a[236:239], v[64:67]
    v_exp_f32 v60, v60
    v_mfma_f32_16x16x32_bf16 v[68:71], a[144:147], a[224:227], v[104:107]
    v_mfma_f32_16x16x32_bf16 v[68:71], a[148:151], a[228:231], v[68:71]
    v_exp_f32 v61, v61
    v_mfma_f32_16x16x32_bf16 v[68:71], a[152:155], a[232:235], v[68:71]
    v_cvt_pk_bf16_f32 v86, v60, v61
    v_mfma_f32_16x16x32_bf16 v[68:71], a[156:159], a[236:239], v[68:71]
    v_exp_f32 v62, v62
    s_waitcnt lgkmcnt(0)
    v_mfma_f32_16x16x32_bf16 v[128:131], a[160:163], v[80:83], v[128:131]
    buffer_load_dwordx4 v33, s[24:27], s65 offen offset:1024 lds
    v_mfma_f32_16x16x32_bf16 v[132:135], a[164:167], v[80:83], v[132:135]
    v_exp_f32 v63, v63
    v_mfma_f32_16x16x32_bf16 v[136:139], a[168:171], v[80:83], v[136:139]
    v_cvt_pk_bf16_f32 v87, v62, v63
    v_mfma_f32_16x16x32_bf16 v[140:143], a[172:175], v[80:83], v[140:143]
    v_mfma_f32_16x16x32_bf16 v[144:147], a[176:179], v[80:83], v[144:147]
    v_exp_f32 v64, v64
    v_mfma_f32_16x16x32_bf16 v[148:151], a[180:183], v[80:83], v[148:151]
    ds_read_b128 a[0:3], v8 offset:57344
    buffer_load_dwordx4 v34, s[24:27], s65 offen offset:2048 lds
    v_mfma_f32_16x16x32_bf16 v[152:155], a[184:187], v[80:83], v[152:155]
    v_exp_f32 v65, v65
    v_mfma_f32_16x16x32_bf16 v[156:159], a[188:191], v[80:83], v[156:159]
    ds_read_b128 a[4:7], v9 offset:57344
    v_cvt_pk_bf16_f32 v88, v64, v65
    v_mfma_f32_16x16x32_bf16 v[112:115], v[28:31], v[80:83], v[112:115]
    v_exp_f32 v66, v66
    ds_read_b128 a[8:11], v10 offset:57344
    v_exp_f32 v67, v67
    ds_read_b128 a[12:15], v11 offset:57344
    v_cvt_pk_bf16_f32 v89, v66, v67
    v_exp_f32 v68, v68
    ds_read_b128 a[16:19], v8 offset:61440
    buffer_load_dwordx4 v35, s[24:27], s65 offen offset:3072 lds
    v_exp_f32 v69, v69
    ds_read_b128 a[20:23], v9 offset:61440
    v_cvt_pk_bf16_f32 v90, v68, v69
    v_exp_f32 v70, v70
    v_mfma_f32_16x16x32_bf16 v[160:163], a[160:163], v[84:87], v[160:163]
    s_add_u32 m0, s53, 0x4000
    s_mov_b32 s65, 0x28000
    buffer_load_dwordx4 v32, s[24:27], s65 offen lds
    v_mfma_f32_16x16x32_bf16 v[164:167], a[164:167], v[84:87], v[164:167]
    v_exp_f32 v71, v71
    v_mfma_f32_16x16x32_bf16 v[168:171], a[168:171], v[84:87], v[168:171]
    ds_read_b128 a[24:27], v10 offset:61440
    v_cvt_pk_bf16_f32 v91, v70, v71
    v_mfma_f32_16x16x32_bf16 v[172:175], a[172:175], v[84:87], v[172:175]
    v_mfma_f32_16x16x32_bf16 v[176:179], a[176:179], v[84:87], v[176:179]
    v_mfma_f32_16x16x32_bf16 v[180:183], a[180:183], v[84:87], v[180:183]
    ds_read_b128 a[28:31], v11 offset:61440
    v_mfma_f32_16x16x32_bf16 v[184:187], a[184:187], v[84:87], v[184:187]
    buffer_load_dwordx4 v33, s[24:27], s65 offen offset:1024 lds
    v_mfma_f32_16x16x32_bf16 v[188:191], a[188:191], v[84:87], v[188:191]
    v_mfma_f32_16x16x32_bf16 v[116:119], v[28:31], v[84:87], v[116:119]
    s_waitcnt lgkmcnt(2)
    v_mfma_f32_16x16x32_bf16 v[48:51], a[0:3], a[192:195], v[96:99]
    ds_read_b64_tr_b16 a[32:33], v12 offset:57344
    v_mfma_f32_16x16x32_bf16 v[48:51], a[4:7], a[196:199], v[48:51]
    v_mfma_f32_16x16x32_bf16 v[48:51], a[8:11], a[200:203], v[48:51]
    ds_read_b64_tr_b16 a[34:35], v12 offset:61440
    v_mfma_f32_16x16x32_bf16 v[48:51], a[12:15], a[204:207], v[48:51]
    buffer_load_dwordx4 v34, s[24:27], s65 offen offset:2048 lds
    v_mfma_f32_16x16x32_bf16 v[52:55], a[16:19], a[192:195], v[96:99]
    ds_read_b64_tr_b16 a[36:37], v13 offset:57344
    v_mfma_f32_16x16x32_bf16 v[52:55], a[20:23], a[196:199], v[52:55]
    s_waitcnt lgkmcnt(3)
    v_mfma_f32_16x16x32_bf16 v[52:55], a[24:27], a[200:203], v[52:55]
    ds_read_b64_tr_b16 a[38:39], v13 offset:61440
    v_mfma_f32_16x16x32_bf16 v[52:55], a[28:31], a[204:207], v[52:55]
    v_mfma_f32_16x16x32_bf16 v[192:195], a[160:163], v[88:91], v[192:195]
    buffer_load_dwordx4 v35, s[24:27], s65 offen offset:3072 lds
    v_mfma_f32_16x16x32_bf16 v[196:199], a[164:167], v[88:91], v[196:199]
    v_mfma_f32_16x16x32_bf16 v[200:203], a[168:171], v[88:91], v[200:203]
    ds_read_b64_tr_b16 a[40:41], v14 offset:57344
    v_mfma_f32_16x16x32_bf16 v[204:207], a[172:175], v[88:91], v[204:207]
    ds_read_b64_tr_b16 a[42:43], v14 offset:61440
    v_mfma_f32_16x16x32_bf16 v[208:211], a[176:179], v[88:91], v[208:211]
    v_exp_f32 v48, v48
    v_mfma_f32_16x16x32_bf16 v[212:215], a[180:183], v[88:91], v[212:215]
    ds_read_b64_tr_b16 a[44:45], v15 offset:57344
    v_mfma_f32_16x16x32_bf16 v[216:219], a[184:187], v[88:91], v[216:219]
    v_exp_f32 v49, v49
    v_mfma_f32_16x16x32_bf16 v[220:223], a[188:191], v[88:91], v[220:223]
    ds_read_b64_tr_b16 a[46:47], v15 offset:61440
    v_cvt_pk_bf16_f32 v80, v48, v49
    v_mfma_f32_16x16x32_bf16 v[120:123], v[28:31], v[88:91], v[120:123]
    v_exp_f32 v50, v50
    v_mfma_f32_16x16x32_bf16 v[56:59], a[0:3], a[208:211], v[100:103]
    ds_read_b64_tr_b16 a[48:49], v16 offset:57344
    s_add_u32 m0, s53, 0x10000
    s_mov_b32 s65, 0x32000
    buffer_load_dwordx4 v32, s[24:27], s65 offen lds
    v_mfma_f32_16x16x32_bf16 v[56:59], a[4:7], a[212:215], v[56:59]
    v_exp_f32 v51, v51
    v_mfma_f32_16x16x32_bf16 v[56:59], a[8:11], a[216:219], v[56:59]
    ds_read_b64_tr_b16 a[50:51], v16 offset:61440
    v_cvt_pk_bf16_f32 v81, v50, v51
    v_mfma_f32_16x16x32_bf16 v[56:59], a[12:15], a[220:223], v[56:59]
    v_exp_f32 v52, v52
    v_mfma_f32_16x16x32_bf16 v[60:63], a[16:19], a[208:211], v[100:103]
    ds_read_b64_tr_b16 a[52:53], v17 offset:57344
    buffer_load_dwordx4 v33, s[24:27], s65 offen offset:1024 lds
    v_mfma_f32_16x16x32_bf16 v[60:63], a[20:23], a[212:215], v[60:63]
    v_exp_f32 v53, v53
    v_mfma_f32_16x16x32_bf16 v[60:63], a[24:27], a[216:219], v[60:63]
    ds_read_b64_tr_b16 a[54:55], v17 offset:61440
    v_cvt_pk_bf16_f32 v82, v52, v53
    v_mfma_f32_16x16x32_bf16 v[60:63], a[28:31], a[220:223], v[60:63]
    v_exp_f32 v54, v54
    v_exp_f32 v55, v55
    ds_read_b64_tr_b16 a[56:57], v18 offset:57344
    v_cvt_pk_bf16_f32 v83, v54, v55
    ds_read_b64_tr_b16 a[58:59], v18 offset:61440
    buffer_load_dwordx4 v34, s[24:27], s65 offen offset:2048 lds
    v_exp_f32 v56, v56
    ds_read_b64_tr_b16 a[60:61], v19 offset:57344
    v_exp_f32 v57, v57
    ds_read_b64_tr_b16 a[62:63], v19 offset:61440
    v_cvt_pk_bf16_f32 v84, v56, v57
    v_exp_f32 v58, v58
    v_mfma_f32_16x16x32_bf16 v[64:67], a[0:3], a[224:227], v[104:107]
    buffer_load_dwordx4 v35, s[24:27], s65 offen offset:3072 lds
    v_mfma_f32_16x16x32_bf16 v[64:67], a[4:7], a[228:231], v[64:67]
    v_exp_f32 v59, v59
    v_mfma_f32_16x16x32_bf16 v[64:67], a[8:11], a[232:235], v[64:67]
    v_cvt_pk_bf16_f32 v85, v58, v59
    v_mfma_f32_16x16x32_bf16 v[64:67], a[12:15], a[236:239], v[64:67]
    v_exp_f32 v60, v60
    v_mfma_f32_16x16x32_bf16 v[68:71], a[16:19], a[224:227], v[104:107]
    s_add_u32 m0, s53, 0x8000
    s_mov_b32 s65, 0x3c000
    buffer_load_dwordx4 v32, s[24:27], s65 offen lds
    v_mfma_f32_16x16x32_bf16 v[68:71], a[20:23], a[228:231], v[68:71]
    v_exp_f32 v61, v61
    v_mfma_f32_16x16x32_bf16 v[68:71], a[24:27], a[232:235], v[68:71]
    v_cvt_pk_bf16_f32 v86, v60, v61
    v_mfma_f32_16x16x32_bf16 v[68:71], a[28:31], a[236:239], v[68:71]
    v_exp_f32 v62, v62
    s_waitcnt lgkmcnt(0)
    v_mfma_f32_16x16x32_bf16 v[128:131], a[32:35], v[80:83], v[128:131]
    v_mfma_f32_16x16x32_bf16 v[132:135], a[36:39], v[80:83], v[132:135]
    v_exp_f32 v63, v63
    v_mfma_f32_16x16x32_bf16 v[136:139], a[40:43], v[80:83], v[136:139]
    v_cvt_pk_bf16_f32 v87, v62, v63
    v_mfma_f32_16x16x32_bf16 v[140:143], a[44:47], v[80:83], v[140:143]
    buffer_load_dwordx4 v33, s[24:27], s65 offen offset:1024 lds
    v_mfma_f32_16x16x32_bf16 v[144:147], a[48:51], v[80:83], v[144:147]
    v_exp_f32 v64, v64
    v_mfma_f32_16x16x32_bf16 v[148:151], a[52:55], v[80:83], v[148:151]
    v_mfma_f32_16x16x32_bf16 v[152:155], a[56:59], v[80:83], v[152:155]
    v_exp_f32 v65, v65
    v_mfma_f32_16x16x32_bf16 v[156:159], a[60:63], v[80:83], v[156:159]
    v_cvt_pk_bf16_f32 v88, v64, v65
    v_mfma_f32_16x16x32_bf16 v[112:115], v[28:31], v[80:83], v[112:115]
    v_exp_f32 v66, v66
    buffer_load_dwordx4 v34, s[24:27], s65 offen offset:2048 lds
    v_exp_f32 v67, v67
    s_nop 0
    v_cvt_pk_bf16_f32 v89, v66, v67
    v_exp_f32 v68, v68
    v_exp_f32 v69, v69
    s_nop 0
    v_cvt_pk_bf16_f32 v90, v68, v69
    v_rcp_f32 v40, v112
    s_nop 0
    v_mul_f32 v128, v40, v128
    v_mul_f32 v129, v40, v129
    v_mul_f32 v130, v40, v130
    v_exp_f32 v70, v70
    v_mfma_f32_16x16x32_bf16 v[160:163], a[32:35], v[84:87], v[160:163]
    buffer_load_dwordx4 v35, s[24:27], s65 offen offset:3072 lds
    v_mul_f32 v131, v40, v131
    v_cvt_pk_bf16_f32 v128, v128, v129
    v_cvt_pk_bf16_f32 v129, v130, v131
    v_mul_f32 v132, v40, v132
    v_mfma_f32_16x16x32_bf16 v[164:167], a[36:39], v[84:87], v[164:167]
    v_exp_f32 v71, v71
    v_mfma_f32_16x16x32_bf16 v[168:171], a[40:43], v[84:87], v[168:171]
    v_cvt_pk_bf16_f32 v91, v70, v71
    v_mul_f32 v133, v40, v133
    v_mul_f32 v134, v40, v134
    v_mul_f32 v135, v40, v135
    v_mfma_f32_16x16x32_bf16 v[172:175], a[44:47], v[84:87], v[172:175]
    v_cvt_pk_bf16_f32 v130, v132, v133
    v_cvt_pk_bf16_f32 v131, v134, v135
    v_mfma_f32_16x16x32_bf16 v[176:179], a[48:51], v[84:87], v[176:179]
    buffer_store_dwordx4 v[128:131], v47, s[20:23], s56 offen sc1
    v_mul_f32 v136, v40, v136
    v_mfma_f32_16x16x32_bf16 v[180:183], a[52:55], v[84:87], v[180:183]
    v_mul_f32 v137, v40, v137
    v_mul_f32 v138, v40, v138
    v_mfma_f32_16x16x32_bf16 v[184:187], a[56:59], v[84:87], v[184:187]
    v_mul_f32 v139, v40, v139
    v_cvt_pk_bf16_f32 v136, v136, v137
    v_mfma_f32_16x16x32_bf16 v[188:191], a[60:63], v[84:87], v[188:191]
    v_cvt_pk_bf16_f32 v137, v138, v139
    v_mul_f32 v140, v40, v140
    v_mfma_f32_16x16x32_bf16 v[116:119], v[28:31], v[84:87], v[116:119]
    v_mul_f32 v141, v40, v141
    v_mul_f32 v142, v40, v142
    v_mfma_f32_16x16x32_bf16 v[192:195], a[32:35], v[88:91], v[192:195]
    v_mul_f32 v143, v40, v143
    v_cvt_pk_bf16_f32 v138, v140, v141
    v_mfma_f32_16x16x32_bf16 v[196:199], a[36:39], v[88:91], v[196:199]
    v_cvt_pk_bf16_f32 v139, v142, v143
    buffer_store_dwordx4 v[136:139], v47, s[20:23], s56 offen offset:1024 sc1
    v_mfma_f32_16x16x32_bf16 v[200:203], a[40:43], v[88:91], v[200:203]
    v_mul_f32 v144, v40, v144
    v_mul_f32 v145, v40, v145
    v_mfma_f32_16x16x32_bf16 v[204:207], a[44:47], v[88:91], v[204:207]
    v_mul_f32 v146, v40, v146
    v_mul_f32 v147, v40, v147
    v_mfma_f32_16x16x32_bf16 v[208:211], a[48:51], v[88:91], v[208:211]
    v_cvt_pk_bf16_f32 v144, v144, v145
    v_cvt_pk_bf16_f32 v145, v146, v147
    v_mfma_f32_16x16x32_bf16 v[212:215], a[52:55], v[88:91], v[212:215]
    v_mul_f32 v148, v40, v148
    v_mul_f32 v149, v40, v149
    v_mfma_f32_16x16x32_bf16 v[216:219], a[56:59], v[88:91], v[216:219]
    v_mul_f32 v150, v40, v150
    v_mul_f32 v151, v40, v151
    v_mfma_f32_16x16x32_bf16 v[220:223], a[60:63], v[88:91], v[220:223]
    v_cvt_pk_bf16_f32 v146, v148, v149
    v_cvt_pk_bf16_f32 v147, v150, v151
    v_mfma_f32_16x16x32_bf16 v[120:123], v[28:31], v[88:91], v[120:123]
    buffer_store_dwordx4 v[144:147], v47, s[20:23], s56 offen offset:2048 sc1
    v_mul_f32 v152, v40, v152
    v_mul_f32 v153, v40, v153
    v_mul_f32 v154, v40, v154
    v_mul_f32 v155, v40, v155
    v_cvt_pk_bf16_f32 v152, v152, v153
    v_cvt_pk_bf16_f32 v153, v154, v155
    v_mul_f32 v156, v40, v156
    v_mul_f32 v157, v40, v157
    v_mul_f32 v158, v40, v158
    v_mul_f32 v159, v40, v159
    v_cvt_pk_bf16_f32 v154, v156, v157
    v_cvt_pk_bf16_f32 v155, v158, v159
    buffer_store_dwordx4 v[152:155], v47, s[20:23], s56 offen offset:3072 sc1
    v_mov_b32 v124, 0
    s_waitcnt lgkmcnt(0)
    s_nop 7
    s_branch L_norm
L_slow:
    s_waitcnt vmcnt(0) lgkmcnt(0)
    s_nop 7
    s_mov_b32 s71, 1
    s_mov_b32 s64, 0
    v_mov_b32 v36, 0xff800000
    v_mov_b32 v112, 0
    v_mov_b32 v113, 0
    v_mov_b32 v114, 0
    v_mov_b32 v115, 0
    v_mov_b32 v128, 0
    v_mov_b32 v129, 0
    v_mov_b32 v130, 0
    v_mov_b32 v131, 0
    v_mov_b32 v132, 0
    v_mov_b32 v133, 0
    v_mov_b32 v134, 0
    v_mov_b32 v135, 0
    v_mov_b32 v136, 0
    v_mov_b32 v137, 0
    v_mov_b32 v138, 0
    v_mov_b32 v139, 0
    v_mov_b32 v140, 0
    v_mov_b32 v141, 0
    v_mov_b32 v142, 0
    v_mov_b32 v143, 0
    v_mov_b32 v144, 0
    v_mov_b32 v145, 0
    v_mov_b32 v146, 0
    v_mov_b32 v147, 0
    v_mov_b32 v148, 0
    v_mov_b32 v149, 0
    v_mov_b32 v150, 0
    v_mov_b32 v151, 0
    v_mov_b32 v152, 0
    v_mov_b32 v153, 0
    v_mov_b32 v154, 0
    v_mov_b32 v155, 0
    v_mov_b32 v156, 0
    v_mov_b32 v157, 0
    v_mov_b32 v158, 0
    v_mov_b32 v159, 0
    v_mov_b32 v37, 0xff800000
    v_mov_b32 v116, 0
    v_mov_b32 v117, 0
    v_mov_b32 v118, 0
    v_mov_b32 v119, 0
    v_mov_b32 v160, 0
    v_mov_b32 v161, 0
    v_mov_b32 v162, 0
    v_mov_b32 v163, 0
    v_mov_b32 v164, 0
    v_mov_b32 v165, 0
    v_mov_b32 v166, 0
    v_mov_b32 v167, 0
    v_mov_b32 v168, 0
    v_mov_b32 v169, 0
    v_mov_b32 v170, 0
    v_mov_b32 v171, 0
    v_mov_b32 v172, 0
    v_mov_b32 v173, 0
    v_mov_b32 v174, 0
    v_mov_b32 v175, 0
    v_mov_b32 v176, 0
    v_mov_b32 v177, 0
    v_mov_b32 v178, 0
    v_mov_b32 v179, 0
    v_mov_b32 v180, 0
    v_mov_b32 v181, 0
    v_mov_b32 v182, 0
    v_mov_b32 v183, 0
    v_mov_b32 v184, 0
    v_mov_b32 v185, 0
    v_mov_b32 v186, 0
    v_mov_b32 v187, 0
    v_mov_b32 v188, 0
    v_mov_b32 v189, 0
    v_mov_b32 v190, 0
    v_mov_b32 v191, 0
    v_mov_b32 v38, 0xff800000
    v_mov_b32 v120, 0
    v_mov_b32 v121, 0
    v_mov_b32 v122, 0
    v_mov_b32 v123, 0
    v_mov_b32 v192, 0
    v_mov_b32 v193, 0
    v_mov_b32 v194, 0
    v_mov_b32 v195, 0
    v_mov_b32 v196, 0
    v_mov_b32 v197, 0
    v_mov_b32 v198, 0
    v_mov_b32 v199, 0
    v_mov_b32 v200, 0
    v_mov_b32 v201, 0
    v_mov_b32 v202, 0
    v_mov_b32 v203, 0
    v_mov_b32 v204, 0
    v_mov_b32 v205, 0
    v_mov_b32 v206, 0
    v_mov_b32 v207, 0
    v_mov_b32 v208, 0
    v_mov_b32 v209, 0
    v_mov_b32 v210, 0
    v_mov_b32 v211, 0
    v_mov_b32 v212, 0
    v_mov_b32 v213, 0
    v_mov_b32 v214, 0
    v_mov_b32 v215, 0
    v_mov_b32 v216, 0
    v_mov_b32 v217, 0
    v_mov_b32 v218, 0
    v_mov_b32 v219, 0
    v_mov_b32 v220, 0
    v_mov_b32 v221, 0
    v_mov_b32 v222, 0
    v_mov_b32 v223, 0
    v_mov_b32 v39, 0xff800000
    v_mov_b32 v124, 0
    v_mov_b32 v125, 0
    v_mov_b32 v126, 0
    v_mov_b32 v127, 0
    v_mov_b32 v224, 0
    v_mov_b32 v225, 0
    v_mov_b32 v226, 0
    v_mov_b32 v227, 0
    v_mov_b32 v228, 0
    v_mov_b32 v229, 0
    v_mov_b32 v230, 0
    v_mov_b32 v231, 0
    v_mov_b32 v232, 0
    v_mov_b32 v233, 0
    v_mov_b32 v234, 0
    v_mov_b32 v235, 0
    v_mov_b32 v236, 0
    v_mov_b32 v237, 0
    v_mov_b32 v238, 0
    v_mov_b32 v239, 0
    v_mov_b32 v240, 0
    v_mov_b32 v241, 0
    v_mov_b32 v242, 0
    v_mov_b32 v243, 0
    v_mov_b32 v244, 0
    v_mov_b32 v245, 0
    v_mov_b32 v246, 0
    v_mov_b32 v247, 0
    v_mov_b32 v248, 0
    v_mov_b32 v249, 0
    v_mov_b32 v250, 0
    v_mov_b32 v251, 0
    v_mov_b32 v252, 0
    v_mov_b32 v253, 0
    v_mov_b32 v254, 0
    v_mov_b32 v255, 0
L_slow_loop:
    s_waitcnt lgkmcnt(0)
    s_barrier
    s_add_u32 m0, s53, 0xc000
    s_nop 0
    buffer_load_dwordx4 v20, s[12:15], s64 offen nt lds
    s_add_u32 m0, s53, 0x1c000
    s_nop 0
    buffer_load_dwordx4 v24, s[16:19], s64 offen nt lds
    s_add_u32 m0, s53, 0xc000
    s_nop 0
    buffer_load_dwordx4 v21, s[12:15], s64 offen offset:1024 nt lds
    s_add_u32 m0, s53, 0x1c000
    s_nop 0
    buffer_load_dwordx4 v25, s[16:19], s64 offen offset:1024 nt lds
    s_add_u32 m0, s53, 0xc000
    s_nop 0
    buffer_load_dwordx4 v22, s[12:15], s64 offen offset:2048 nt lds
    s_add_u32 m0, s53, 0x1c000
    s_nop 0
    buffer_load_dwordx4 v24, s[16:19], s64 offen offset:2048 nt lds
    s_add_u32 m0, s53, 0xc000
    s_nop 0
    buffer_load_dwordx4 v23, s[12:15], s64 offen offset:3072 nt lds
    s_add_u32 m0, s53, 0x1c000
    s_nop 0
    buffer_load_dwordx4 v25, s[16:19], s64 offen offset:3072 nt lds
    s_waitcnt vmcnt(0)
    s_barrier
    ds_read_b128 a[128:131], v8 offset:49152
    ds_read_b128 a[132:135], v9 offset:49152
    ds_read_b128 a[136:139], v10 offset:49152
    ds_read_b128 a[140:143], v11 offset:49152
    ds_read_b128 a[144:147], v8 offset:53248
    ds_read_b128 a[148:151], v9 offset:53248
    ds_read_b128 a[152:155], v10 offset:53248
    ds_read_b128 a[156:159], v11 offset:53248
    ds_read_b64_tr_b16 a[160:161], v12 offset:49152
    ds_read_b64_tr_b16 a[162:163], v12 offset:53248
    ds_read_b64_tr_b16 a[164:165], v13 offset:49152
    ds_read_b64_tr_b16 a[166:167], v13 offset:53248
    ds_read_b64_tr_b16 a[168:169], v14 offset:49152
    ds_read_b64_tr_b16 a[170:171], v14 offset:53248
    ds_read_b64_tr_b16 a[172:173], v15 offset:49152
    ds_read_b64_tr_b16 a[174:175], v15 offset:53248
    ds_read_b64_tr_b16 a[176:177], v16 offset:49152
    ds_read_b64_tr_b16 a[178:179], v16 offset:53248
    ds_read_b64_tr_b16 a[180:181], v17 offset:49152
    ds_read_b64_tr_b16 a[182:183], v17 offset:53248
    ds_read_b64_tr_b16 a[184:185], v18 offset:49152
    ds_read_b64_tr_b16 a[186:187], v18 offset:53248
    ds_read_b64_tr_b16 a[188:189], v19 offset:49152
    ds_read_b64_tr_b16 a[190:191], v19 offset:53248
    s_waitcnt lgkmcnt(15)
    v_mfma_f32_16x16x32_bf16 v[48:51], a[128:131], a[192:195], 0
    v_mfma_f32_16x16x32_bf16 v[48:51], a[132:135], a[196:199], v[48:51]
    v_mfma_f32_16x16x32_bf16 v[48:51], a[136:139], a[200:203], v[48:51]
    v_mfma_f32_16x16x32_bf16 v[48:51], a[140:143], a[204:207], v[48:51]
    v_mfma_f32_16x16x32_bf16 v[52:55], a[144:147], a[192:195], 0
    v_mfma_f32_16x16x32_bf16 v[52:55], a[148:151], a[196:199], v[52:55]
    v_mfma_f32_16x16x32_bf16 v[52:55], a[152:155], a[200:203], v[52:55]
    v_mfma_f32_16x16x32_bf16 v[52:55], a[156:159], a[204:207], v[52:55]
    v_mfma_f32_16x16x32_bf16 v[56:59], a[128:131], a[208:211], 0
    v_mfma_f32_16x16x32_bf16 v[56:59], a[132:135], a[212:215], v[56:59]
    v_mfma_f32_16x16x32_bf16 v[56:59], a[136:139], a[216:219], v[56:59]
    v_mfma_f32_16x16x32_bf16 v[56:59], a[140:143], a[220:223], v[56:59]
    v_mfma_f32_16x16x32_bf16 v[60:63], a[144:147], a[208:211], 0
    v_mfma_f32_16x16x32_bf16 v[60:63], a[148:151], a[212:215], v[60:63]
    v_mfma_f32_16x16x32_bf16 v[60:63], a[152:155], a[216:219], v[60:63]
    v_mfma_f32_16x16x32_bf16 v[60:63], a[156:159], a[220:223], v[60:63]
    v_mfma_f32_16x16x32_bf16 v[64:67], a[128:131], a[224:227], 0
    v_mfma_f32_16x16x32_bf16 v[64:67], a[132:135], a[228:231], v[64:67]
    v_mfma_f32_16x16x32_bf16 v[64:67], a[136:139], a[232:235], v[64:67]
    v_mfma_f32_16x16x32_bf16 v[64:67], a[140:143], a[236:239], v[64:67]
    v_mfma_f32_16x16x32_bf16 v[68:71], a[144:147], a[224:227], 0
    v_mfma_f32_16x16x32_bf16 v[68:71], a[148:151], a[228:231], v[68:71]
    v_mfma_f32_16x16x32_bf16 v[68:71], a[152:155], a[232:235], v[68:71]
    v_mfma_f32_16x16x32_bf16 v[68:71], a[156:159], a[236:239], v[68:71]
    v_mfma_f32_16x16x32_bf16 v[72:75], a[128:131], a[240:243], 0
    v_mfma_f32_16x16x32_bf16 v[72:75], a[132:135], a[244:247], v[72:75]
    v_mfma_f32_16x16x32_bf16 v[72:75], a[136:139], a[248:251], v[72:75]
    v_mfma_f32_16x16x32_bf16 v[72:75], a[140:143], a[252:255], v[72:75]
    v_mfma_f32_16x16x32_bf16 v[76:79], a[144:147], a[240:243], 0
    v_mfma_f32_16x16x32_bf16 v[76:79], a[148:151], a[244:247], v[76:79]
    v_mfma_f32_16x16x32_bf16 v[76:79], a[152:155], a[248:251], v[76:79]
    v_mfma_f32_16x16x32_bf16 v[76:79], a[156:159], a[252:255], v[76:79]
    v_max3_f32 v2, v48, v49, v50
    v_max3_f32 v3, v51, v52, v53
    v_max3_f32 v2, v2, v54, v55
    v_max_f32 v2, v2, v3
    v_mov_b32 v3, v2
    s_nop 1
    v_permlane32_swap_b32 v2, v3
    v_max_f32 v2, v2, v3
    v_mov_b32 v3, v2
    s_nop 1
    v_permlane16_swap_b32 v2, v3
    v_max_f32 v2, v2, v3
    v_max_f32 v2, v2, v36
    v_sub_f32 v3, v36, v2
    v_exp_f32 v3, v3
    v_mov_b32 v36, v2
    v_mul_f32 v112, v112, v3
    v_mul_f32 v128, v128, v3
    v_mul_f32 v129, v129, v3
    v_mul_f32 v130, v130, v3
    v_mul_f32 v131, v131, v3
    v_mul_f32 v132, v132, v3
    v_mul_f32 v133, v133, v3
    v_mul_f32 v134, v134, v3
    v_mul_f32 v135, v135, v3
    v_mul_f32 v136, v136, v3
    v_mul_f32 v137, v137, v3
    v_mul_f32 v138, v138, v3
    v_mul_f32 v139, v139, v3
    v_mul_f32 v140, v140, v3
    v_mul_f32 v141, v141, v3
    v_mul_f32 v142, v142, v3
    v_mul_f32 v143, v143, v3
    v_mul_f32 v144, v144, v3
    v_mul_f32 v145, v145, v3
    v_mul_f32 v146, v146, v3
    v_mul_f32 v147, v147, v3
    v_mul_f32 v148, v148, v3
    v_mul_f32 v149, v149, v3
    v_mul_f32 v150, v150, v3
    v_mul_f32 v151, v151, v3
    v_mul_f32 v152, v152, v3
    v_mul_f32 v153, v153, v3
    v_mul_f32 v154, v154, v3
    v_mul_f32 v155, v155, v3
    v_mul_f32 v156, v156, v3
    v_mul_f32 v157, v157, v3
    v_mul_f32 v158, v158, v3
    v_mul_f32 v159, v159, v3
    v_sub_f32 v48, v48, v2
    v_sub_f32 v49, v49, v2
    v_sub_f32 v50, v50, v2
    v_sub_f32 v51, v51, v2
    v_sub_f32 v52, v52, v2
    v_sub_f32 v53, v53, v2
    v_sub_f32 v54, v54, v2
    v_sub_f32 v55, v55, v2
    v_exp_f32 v48, v48
    v_exp_f32 v49, v49
    v_exp_f32 v50, v50
    v_exp_f32 v51, v51
    v_exp_f32 v52, v52
    v_exp_f32 v53, v53
    v_exp_f32 v54, v54
    v_exp_f32 v55, v55
    v_cvt_pk_bf16_f32 v80, v48, v49
    v_cvt_pk_bf16_f32 v81, v50, v51
    v_cvt_pk_bf16_f32 v82, v52, v53
    v_cvt_pk_bf16_f32 v83, v54, v55
    s_waitcnt lgkmcnt(0)
    s_nop 0
    v_mfma_f32_16x16x32_bf16 v[128:131], a[160:163], v[80:83], v[128:131]
    v_mfma_f32_16x16x32_bf16 v[132:135], a[164:167], v[80:83], v[132:135]
    v_mfma_f32_16x16x32_bf16 v[136:139], a[168:171], v[80:83], v[136:139]
    v_mfma_f32_16x16x32_bf16 v[140:143], a[172:175], v[80:83], v[140:143]
    v_mfma_f32_16x16x32_bf16 v[144:147], a[176:179], v[80:83], v[144:147]
    v_mfma_f32_16x16x32_bf16 v[148:151], a[180:183], v[80:83], v[148:151]
    v_mfma_f32_16x16x32_bf16 v[152:155], a[184:187], v[80:83], v[152:155]
    v_mfma_f32_16x16x32_bf16 v[156:159], a[188:191], v[80:83], v[156:159]
    v_mfma_f32_16x16x32_bf16 v[112:115], v[28:31], v[80:83], v[112:115]
    v_max3_f32 v2, v56, v57, v58
    v_max3_f32 v3, v59, v60, v61
    v_max3_f32 v2, v2, v62, v63
    v_max_f32 v2, v2, v3
    v_mov_b32 v3, v2
    s_nop 1
    v_permlane32_swap_b32 v2, v3
    v_max_f32 v2, v2, v3
    v_mov_b32 v3, v2
    s_nop 1
    v_permlane16_swap_b32 v2, v3
    v_max_f32 v2, v2, v3
    v_max_f32 v2, v2, v37
    v_sub_f32 v3, v37, v2
    v_exp_f32 v3, v3
    v_mov_b32 v37, v2
    v_mul_f32 v116, v116, v3
    v_mul_f32 v160, v160, v3
    v_mul_f32 v161, v161, v3
    v_mul_f32 v162, v162, v3
    v_mul_f32 v163, v163, v3
    v_mul_f32 v164, v164, v3
    v_mul_f32 v165, v165, v3
    v_mul_f32 v166, v166, v3
    v_mul_f32 v167, v167, v3
    v_mul_f32 v168, v168, v3
    v_mul_f32 v169, v169, v3
    v_mul_f32 v170, v170, v3
    v_mul_f32 v171, v171, v3
    v_mul_f32 v172, v172, v3
    v_mul_f32 v173, v173, v3
    v_mul_f32 v174, v174, v3
    v_mul_f32 v175, v175, v3
    v_mul_f32 v176, v176, v3
    v_mul_f32 v177, v177, v3
    v_mul_f32 v178, v178, v3
    v_mul_f32 v179, v179, v3
    v_mul_f32 v180, v180, v3
    v_mul_f32 v181, v181, v3
    v_mul_f32 v182, v182, v3
    v_mul_f32 v183, v183, v3
    v_mul_f32 v184, v184, v3
    v_mul_f32 v185, v185, v3
    v_mul_f32 v186, v186, v3
    v_mul_f32 v187, v187, v3
    v_mul_f32 v188, v188, v3
    v_mul_f32 v189, v189, v3
    v_mul_f32 v190, v190, v3
    v_mul_f32 v191, v191, v3
    v_sub_f32 v56, v56, v2
    v_sub_f32 v57, v57, v2
    v_sub_f32 v58, v58, v2
    v_sub_f32 v59, v59, v2
    v_sub_f32 v60, v60, v2
    v_sub_f32 v61, v61, v2
    v_sub_f32 v62, v62, v2
    v_sub_f32 v63, v63, v2
    v_exp_f32 v56, v56
    v_exp_f32 v57, v57
    v_exp_f32 v58, v58
    v_exp_f32 v59, v59
    v_exp_f32 v60, v60
    v_exp_f32 v61, v61
    v_exp_f32 v62, v62
    v_exp_f32 v63, v63
    v_cvt_pk_bf16_f32 v84, v56, v57
    v_cvt_pk_bf16_f32 v85, v58, v59
    v_cvt_pk_bf16_f32 v86, v60, v61
    v_cvt_pk_bf16_f32 v87, v62, v63
    s_nop 1
    v_mfma_f32_16x16x32_bf16 v[160:163], a[160:163], v[84:87], v[160:163]
    v_mfma_f32_16x16x32_bf16 v[164:167], a[164:167], v[84:87], v[164:167]
    v_mfma_f32_16x16x32_bf16 v[168:171], a[168:171], v[84:87], v[168:171]
    v_mfma_f32_16x16x32_bf16 v[172:175], a[172:175], v[84:87], v[172:175]
    v_mfma_f32_16x16x32_bf16 v[176:179], a[176:179], v[84:87], v[176:179]
    v_mfma_f32_16x16x32_bf16 v[180:183], a[180:183], v[84:87], v[180:183]
    v_mfma_f32_16x16x32_bf16 v[184:187], a[184:187], v[84:87], v[184:187]
    v_mfma_f32_16x16x32_bf16 v[188:191], a[188:191], v[84:87], v[188:191]
    v_mfma_f32_16x16x32_bf16 v[116:119], v[28:31], v[84:87], v[116:119]
    v_max3_f32 v2, v64, v65, v66
    v_max3_f32 v3, v67, v68, v69
    v_max3_f32 v2, v2, v70, v71
    v_max_f32 v2, v2, v3
    v_mov_b32 v3, v2
    s_nop 1
    v_permlane32_swap_b32 v2, v3
    v_max_f32 v2, v2, v3
    v_mov_b32 v3, v2
    s_nop 1
    v_permlane16_swap_b32 v2, v3
    v_max_f32 v2, v2, v3
    v_max_f32 v2, v2, v38
    v_sub_f32 v3, v38, v2
    v_exp_f32 v3, v3
    v_mov_b32 v38, v2
    v_mul_f32 v120, v120, v3
    v_mul_f32 v192, v192, v3
    v_mul_f32 v193, v193, v3
    v_mul_f32 v194, v194, v3
    v_mul_f32 v195, v195, v3
    v_mul_f32 v196, v196, v3
    v_mul_f32 v197, v197, v3
    v_mul_f32 v198, v198, v3
    v_mul_f32 v199, v199, v3
    v_mul_f32 v200, v200, v3
    v_mul_f32 v201, v201, v3
    v_mul_f32 v202, v202, v3
    v_mul_f32 v203, v203, v3
    v_mul_f32 v204, v204, v3
    v_mul_f32 v205, v205, v3
    v_mul_f32 v206, v206, v3
    v_mul_f32 v207, v207, v3
    v_mul_f32 v208, v208, v3
    v_mul_f32 v209, v209, v3
    v_mul_f32 v210, v210, v3
    v_mul_f32 v211, v211, v3
    v_mul_f32 v212, v212, v3
    v_mul_f32 v213, v213, v3
    v_mul_f32 v214, v214, v3
    v_mul_f32 v215, v215, v3
    v_mul_f32 v216, v216, v3
    v_mul_f32 v217, v217, v3
    v_mul_f32 v218, v218, v3
    v_mul_f32 v219, v219, v3
    v_mul_f32 v220, v220, v3
    v_mul_f32 v221, v221, v3
    v_mul_f32 v222, v222, v3
    v_mul_f32 v223, v223, v3
    v_sub_f32 v64, v64, v2
    v_sub_f32 v65, v65, v2
    v_sub_f32 v66, v66, v2
    v_sub_f32 v67, v67, v2
    v_sub_f32 v68, v68, v2
    v_sub_f32 v69, v69, v2
    v_sub_f32 v70, v70, v2
    v_sub_f32 v71, v71, v2
    v_exp_f32 v64, v64
    v_exp_f32 v65, v65
    v_exp_f32 v66, v66
    v_exp_f32 v67, v67
    v_exp_f32 v68, v68
    v_exp_f32 v69, v69
    v_exp_f32 v70, v70
    v_exp_f32 v71, v71
    v_cvt_pk_bf16_f32 v88, v64, v65
    v_cvt_pk_bf16_f32 v89, v66, v67
    v_cvt_pk_bf16_f32 v90, v68, v69
    v_cvt_pk_bf16_f32 v91, v70, v71
    s_nop 1
    v_mfma_f32_16x16x32_bf16 v[192:195], a[160:163], v[88:91], v[192:195]
    v_mfma_f32_16x16x32_bf16 v[196:199], a[164:167], v[88:91], v[196:199]
    v_mfma_f32_16x16x32_bf16 v[200:203], a[168:171], v[88:91], v[200:203]
    v_mfma_f32_16x16x32_bf16 v[204:207], a[172:175], v[88:91], v[204:207]
    v_mfma_f32_16x16x32_bf16 v[208:211], a[176:179], v[88:91], v[208:211]
    v_mfma_f32_16x16x32_bf16 v[212:215], a[180:183], v[88:91], v[212:215]
    v_mfma_f32_16x16x32_bf16 v[216:219], a[184:187], v[88:91], v[216:219]
    v_mfma_f32_16x16x32_bf16 v[220:223], a[188:191], v[88:91], v[220:223]
    v_mfma_f32_16x16x32_bf16 v[120:123], v[28:31], v[88:91], v[120:123]
    v_max3_f32 v2, v72, v73, v74
    v_max3_f32 v3, v75, v76, v77
    v_max3_f32 v2, v2, v78, v79
    v_max_f32 v2, v2, v3
    v_mov_b32 v3, v2
    s_nop 1
    v_permlane32_swap_b32 v2, v3
    v_max_f32 v2, v2, v3
    v_mov_b32 v3, v2
    s_nop 1
    v_permlane16_swap_b32 v2, v3
    v_max_f32 v2, v2, v3
    v_max_f32 v2, v2, v39
    v_sub_f32 v3, v39, v2
    v_exp_f32 v3, v3
    v_mov_b32 v39, v2
    v_mul_f32 v124, v124, v3
    v_mul_f32 v224, v224, v3
    v_mul_f32 v225, v225, v3
    v_mul_f32 v226, v226, v3
    v_mul_f32 v227, v227, v3
    v_mul_f32 v228, v228, v3
    v_mul_f32 v229, v229, v3
    v_mul_f32 v230, v230, v3
    v_mul_f32 v231, v231, v3
    v_mul_f32 v232, v232, v3
    v_mul_f32 v233, v233, v3
    v_mul_f32 v234, v234, v3
    v_mul_f32 v235, v235, v3
    v_mul_f32 v236, v236, v3
    v_mul_f32 v237, v237, v3
    v_mul_f32 v238, v238, v3
    v_mul_f32 v239, v239, v3
    v_mul_f32 v240, v240, v3
    v_mul_f32 v241, v241, v3
    v_mul_f32 v242, v242, v3
    v_mul_f32 v243, v243, v3
    v_mul_f32 v244, v244, v3
    v_mul_f32 v245, v245, v3
    v_mul_f32 v246, v246, v3
    v_mul_f32 v247, v247, v3
    v_mul_f32 v248, v248, v3
    v_mul_f32 v249, v249, v3
    v_mul_f32 v250, v250, v3
    v_mul_f32 v251, v251, v3
    v_mul_f32 v252, v252, v3
    v_mul_f32 v253, v253, v3
    v_mul_f32 v254, v254, v3
    v_mul_f32 v255, v255, v3
    v_sub_f32 v72, v72, v2
    v_sub_f32 v73, v73, v2
    v_sub_f32 v74, v74, v2
    v_sub_f32 v75, v75, v2
    v_sub_f32 v76, v76, v2
    v_sub_f32 v77, v77, v2
    v_sub_f32 v78, v78, v2
    v_sub_f32 v79, v79, v2
    v_exp_f32 v72, v72
    v_exp_f32 v73, v73
    v_exp_f32 v74, v74
    v_exp_f32 v75, v75
    v_exp_f32 v76, v76
    v_exp_f32 v77, v77
    v_exp_f32 v78, v78
    v_exp_f32 v79, v79
    v_cvt_pk_bf16_f32 v92, v72, v73
    v_cvt_pk_bf16_f32 v93, v74, v75
    v_cvt_pk_bf16_f32 v94, v76, v77
    v_cvt_pk_bf16_f32 v95, v78, v79
    s_nop 1
    v_mfma_f32_16x16x32_bf16 v[224:227], a[160:163], v[92:95], v[224:227]
    v_mfma_f32_16x16x32_bf16 v[228:231], a[164:167], v[92:95], v[228:231]
    v_mfma_f32_16x16x32_bf16 v[232:235], a[168:171], v[92:95], v[232:235]
    v_mfma_f32_16x16x32_bf16 v[236:239], a[172:175], v[92:95], v[236:239]
    v_mfma_f32_16x16x32_bf16 v[240:243], a[176:179], v[92:95], v[240:243]
    v_mfma_f32_16x16x32_bf16 v[244:247], a[180:183], v[92:95], v[244:247]
    v_mfma_f32_16x16x32_bf16 v[248:251], a[184:187], v[92:95], v[248:251]
    v_mfma_f32_16x16x32_bf16 v[252:255], a[188:191], v[92:95], v[252:255]
    v_mfma_f32_16x16x32_bf16 v[124:127], v[28:31], v[92:95], v[124:127]
    ds_read_b128 a[128:131], v8 offset:57344
    ds_read_b128 a[132:135], v9 offset:57344
    ds_read_b128 a[136:139], v10 offset:57344
    ds_read_b128 a[140:143], v11 offset:57344
    ds_read_b128 a[144:147], v8 offset:61440
    ds_read_b128 a[148:151], v9 offset:61440
    ds_read_b128 a[152:155], v10 offset:61440
    ds_read_b128 a[156:159], v11 offset:61440
    ds_read_b64_tr_b16 a[160:161], v12 offset:57344
    ds_read_b64_tr_b16 a[162:163], v12 offset:61440
    ds_read_b64_tr_b16 a[164:165], v13 offset:57344
    ds_read_b64_tr_b16 a[166:167], v13 offset:61440
    ds_read_b64_tr_b16 a[168:169], v14 offset:57344
    ds_read_b64_tr_b16 a[170:171], v14 offset:61440
    ds_read_b64_tr_b16 a[172:173], v15 offset:57344
    ds_read_b64_tr_b16 a[174:175], v15 offset:61440
    ds_read_b64_tr_b16 a[176:177], v16 offset:57344
    ds_read_b64_tr_b16 a[178:179], v16 offset:61440
    ds_read_b64_tr_b16 a[180:181], v17 offset:57344
    ds_read_b64_tr_b16 a[182:183], v17 offset:61440
    ds_read_b64_tr_b16 a[184:185], v18 offset:57344
    ds_read_b64_tr_b16 a[186:187], v18 offset:61440
    ds_read_b64_tr_b16 a[188:189], v19 offset:57344
    ds_read_b64_tr_b16 a[190:191], v19 offset:61440
    s_waitcnt lgkmcnt(15)
    v_mfma_f32_16x16x32_bf16 v[48:51], a[128:131], a[192:195], 0
    v_mfma_f32_16x16x32_bf16 v[48:51], a[132:135], a[196:199], v[48:51]
    v_mfma_f32_16x16x32_bf16 v[48:51], a[136:139], a[200:203], v[48:51]
    v_mfma_f32_16x16x32_bf16 v[48:51], a[140:143], a[204:207], v[48:51]
    v_mfma_f32_16x16x32_bf16 v[52:55], a[144:147], a[192:195], 0
    v_mfma_f32_16x16x32_bf16 v[52:55], a[148:151], a[196:199], v[52:55]
    v_mfma_f32_16x16x32_bf16 v[52:55], a[152:155], a[200:203], v[52:55]
    v_mfma_f32_16x16x32_bf16 v[52:55], a[156:159], a[204:207], v[52:55]
    v_mfma_f32_16x16x32_bf16 v[56:59], a[128:131], a[208:211], 0
    v_mfma_f32_16x16x32_bf16 v[56:59], a[132:135], a[212:215], v[56:59]
    v_mfma_f32_16x16x32_bf16 v[56:59], a[136:139], a[216:219], v[56:59]
    v_mfma_f32_16x16x32_bf16 v[56:59], a[140:143], a[220:223], v[56:59]
    v_mfma_f32_16x16x32_bf16 v[60:63], a[144:147], a[208:211], 0
    v_mfma_f32_16x16x32_bf16 v[60:63], a[148:151], a[212:215], v[60:63]
    v_mfma_f32_16x16x32_bf16 v[60:63], a[152:155], a[216:219], v[60:63]
    v_mfma_f32_16x16x32_bf16 v[60:63], a[156:159], a[220:223], v[60:63]
    v_mfma_f32_16x16x32_bf16 v[64:67], a[128:131], a[224:227], 0
    v_mfma_f32_16x16x32_bf16 v[64:67], a[132:135], a[228:231], v[64:67]
    v_mfma_f32_16x16x32_bf16 v[64:67], a[136:139], a[232:235], v[64:67]
    v_mfma_f32_16x16x32_bf16 v[64:67], a[140:143], a[236:239], v[64:67]
    v_mfma_f32_16x16x32_bf16 v[68:71], a[144:147], a[224:227], 0
    v_mfma_f32_16x16x32_bf16 v[68:71], a[148:151], a[228:231], v[68:71]
    v_mfma_f32_16x16x32_bf16 v[68:71], a[152:155], a[232:235], v[68:71]
    v_mfma_f32_16x16x32_bf16 v[68:71], a[156:159], a[236:239], v[68:71]
    v_mfma_f32_16x16x32_bf16 v[72:75], a[128:131], a[240:243], 0
    v_mfma_f32_16x16x32_bf16 v[72:75], a[132:135], a[244:247], v[72:75]
    v_mfma_f32_16x16x32_bf16 v[72:75], a[136:139], a[248:251], v[72:75]
    v_mfma_f32_16x16x32_bf16 v[72:75], a[140:143], a[252:255], v[72:75]
    v_mfma_f32_16x16x32_bf16 v[76:79], a[144:147], a[240:243], 0
    v_mfma_f32_16x16x32_bf16 v[76:79], a[148:151], a[244:247], v[76:79]
    v_mfma_f32_16x16x32_bf16 v[76:79], a[152:155], a[248:251], v[76:79]
    v_mfma_f32_16x16x32_bf16 v[76:79], a[156:159], a[252:255], v[76:79]
    v_max3_f32 v2, v48, v49, v50
    v_max3_f32 v3, v51, v52, v53
    v_max3_f32 v2, v2, v54, v55
    v_max_f32 v2, v2, v3
    v_mov_b32 v3, v2
    s_nop 1
    v_permlane32_swap_b32 v2, v3
    v_max_f32 v2, v2, v3
    v_mov_b32 v3, v2
    s_nop 1
    v_permlane16_swap_b32 v2, v3
    v_max_f32 v2, v2, v3
    v_max_f32 v2, v2, v36
    v_sub_f32 v3, v36, v2
    v_exp_f32 v3, v3
    v_mov_b32 v36, v2
    v_mul_f32 v112, v112, v3
    v_mul_f32 v128, v128, v3
    v_mul_f32 v129, v129, v3
    v_mul_f32 v130, v130, v3
    v_mul_f32 v131, v131, v3
    v_mul_f32 v132, v132, v3
    v_mul_f32 v133, v133, v3
    v_mul_f32 v134, v134, v3
    v_mul_f32 v135, v135, v3
    v_mul_f32 v136, v136, v3
    v_mul_f32 v137, v137, v3
    v_mul_f32 v138, v138, v3
    v_mul_f32 v139, v139, v3
    v_mul_f32 v140, v140, v3
    v_mul_f32 v141, v141, v3
    v_mul_f32 v142, v142, v3
    v_mul_f32 v143, v143, v3
    v_mul_f32 v144, v144, v3
    v_mul_f32 v145, v145, v3
    v_mul_f32 v146, v146, v3
    v_mul_f32 v147, v147, v3
    v_mul_f32 v148, v148, v3
    v_mul_f32 v149, v149, v3
    v_mul_f32 v150, v150, v3
    v_mul_f32 v151, v151, v3
    v_mul_f32 v152, v152, v3
    v_mul_f32 v153, v153, v3
    v_mul_f32 v154, v154, v3
    v_mul_f32 v155, v155, v3
    v_mul_f32 v156, v156, v3
    v_mul_f32 v157, v157, v3
    v_mul_f32 v158, v158, v3
    v_mul_f32 v159, v159, v3
    v_sub_f32 v48, v48, v2
    v_sub_f32 v49, v49, v2
    v_sub_f32 v50, v50, v2
    v_sub_f32 v51, v51, v2
    v_sub_f32 v52, v52, v2
    v_sub_f32 v53, v53, v2
    v_sub_f32 v54, v54, v2
    v_sub_f32 v55, v55, v2
    v_exp_f32 v48, v48
    v_exp_f32 v49, v49
    v_exp_f32 v50, v50
    v_exp_f32 v51, v51
    v_exp_f32 v52, v52
    v_exp_f32 v53, v53
    v_exp_f32 v54, v54
    v_exp_f32 v55, v55
    v_cvt_pk_bf16_f32 v80, v48, v49
    v_cvt_pk_bf16_f32 v81, v50, v51
    v_cvt_pk_bf16_f32 v82, v52, v53
    v_cvt_pk_bf16_f32 v83, v54, v55
    s_waitcnt lgkmcnt(0)
    s_nop 0
    v_mfma_f32_16x16x32_bf16 v[128:131], a[160:163], v[80:83], v[128:131]
    v_mfma_f32_16x16x32_bf16 v[132:135], a[164:167], v[80:83], v[132:135]
    v_mfma_f32_16x16x32_bf16 v[136:139], a[168:171], v[80:83], v[136:139]
    v_mfma_f32_16x16x32_bf16 v[140:143], a[172:175], v[80:83], v[140:143]
    v_mfma_f32_16x16x32_bf16 v[144:147], a[176:179], v[80:83], v[144:147]
    v_mfma_f32_16x16x32_bf16 v[148:151], a[180:183], v[80:83], v[148:151]
    v_mfma_f32_16x16x32_bf16 v[152:155], a[184:187], v[80:83], v[152:155]
    v_mfma_f32_16x16x32_bf16 v[156:159], a[188:191], v[80:83], v[156:159]
    v_mfma_f32_16x16x32_bf16 v[112:115], v[28:31], v[80:83], v[112:115]
    v_max3_f32 v2, v56, v57, v58
    v_max3_f32 v3, v59, v60, v61
    v_max3_f32 v2, v2, v62, v63
    v_max_f32 v2, v2, v3
    v_mov_b32 v3, v2
    s_nop 1
    v_permlane32_swap_b32 v2, v3
    v_max_f32 v2, v2, v3
    v_mov_b32 v3, v2
    s_nop 1
    v_permlane16_swap_b32 v2, v3
    v_max_f32 v2, v2, v3
    v_max_f32 v2, v2, v37
    v_sub_f32 v3, v37, v2
    v_exp_f32 v3, v3
    v_mov_b32 v37, v2
    v_mul_f32 v116, v116, v3
    v_mul_f32 v160, v160, v3
    v_mul_f32 v161, v161, v3
    v_mul_f32 v162, v162, v3
    v_mul_f32 v163, v163, v3
    v_mul_f32 v164, v164, v3
    v_mul_f32 v165, v165, v3
    v_mul_f32 v166, v166, v3
    v_mul_f32 v167, v167, v3
    v_mul_f32 v168, v168, v3
    v_mul_f32 v169, v169, v3
    v_mul_f32 v170, v170, v3
    v_mul_f32 v171, v171, v3
    v_mul_f32 v172, v172, v3
    v_mul_f32 v173, v173, v3
    v_mul_f32 v174, v174, v3
    v_mul_f32 v175, v175, v3
    v_mul_f32 v176, v176, v3
    v_mul_f32 v177, v177, v3
    v_mul_f32 v178, v178, v3
    v_mul_f32 v179, v179, v3
    v_mul_f32 v180, v180, v3
    v_mul_f32 v181, v181, v3
    v_mul_f32 v182, v182, v3
    v_mul_f32 v183, v183, v3
    v_mul_f32 v184, v184, v3
    v_mul_f32 v185, v185, v3
    v_mul_f32 v186, v186, v3
    v_mul_f32 v187, v187, v3
    v_mul_f32 v188, v188, v3
    v_mul_f32 v189, v189, v3
    v_mul_f32 v190, v190, v3
    v_mul_f32 v191, v191, v3
    v_sub_f32 v56, v56, v2
    v_sub_f32 v57, v57, v2
    v_sub_f32 v58, v58, v2
    v_sub_f32 v59, v59, v2
    v_sub_f32 v60, v60, v2
    v_sub_f32 v61, v61, v2
    v_sub_f32 v62, v62, v2
    v_sub_f32 v63, v63, v2
    v_exp_f32 v56, v56
    v_exp_f32 v57, v57
    v_exp_f32 v58, v58
    v_exp_f32 v59, v59
    v_exp_f32 v60, v60
    v_exp_f32 v61, v61
    v_exp_f32 v62, v62
    v_exp_f32 v63, v63
    v_cvt_pk_bf16_f32 v84, v56, v57
    v_cvt_pk_bf16_f32 v85, v58, v59
    v_cvt_pk_bf16_f32 v86, v60, v61
    v_cvt_pk_bf16_f32 v87, v62, v63
    s_nop 1
    v_mfma_f32_16x16x32_bf16 v[160:163], a[160:163], v[84:87], v[160:163]
    v_mfma_f32_16x16x32_bf16 v[164:167], a[164:167], v[84:87], v[164:167]
    v_mfma_f32_16x16x32_bf16 v[168:171], a[168:171], v[84:87], v[168:171]
    v_mfma_f32_16x16x32_bf16 v[172:175], a[172:175], v[84:87], v[172:175]
    v_mfma_f32_16x16x32_bf16 v[176:179], a[176:179], v[84:87], v[176:179]
    v_mfma_f32_16x16x32_bf16 v[180:183], a[180:183], v[84:87], v[180:183]
    v_mfma_f32_16x16x32_bf16 v[184:187], a[184:187], v[84:87], v[184:187]
    v_mfma_f32_16x16x32_bf16 v[188:191], a[188:191], v[84:87], v[188:191]
    v_mfma_f32_16x16x32_bf16 v[116:119], v[28:31], v[84:87], v[116:119]
    v_max3_f32 v2, v64, v65, v66
    v_max3_f32 v3, v67, v68, v69
    v_max3_f32 v2, v2, v70, v71
    v_max_f32 v2, v2, v3
    v_mov_b32 v3, v2
    s_nop 1
    v_permlane32_swap_b32 v2, v3
    v_max_f32 v2, v2, v3
    v_mov_b32 v3, v2
    s_nop 1
    v_permlane16_swap_b32 v2, v3
    v_max_f32 v2, v2, v3
    v_max_f32 v2, v2, v38
    v_sub_f32 v3, v38, v2
    v_exp_f32 v3, v3
    v_mov_b32 v38, v2
    v_mul_f32 v120, v120, v3
    v_mul_f32 v192, v192, v3
    v_mul_f32 v193, v193, v3
    v_mul_f32 v194, v194, v3
    v_mul_f32 v195, v195, v3
    v_mul_f32 v196, v196, v3
    v_mul_f32 v197, v197, v3
    v_mul_f32 v198, v198, v3
    v_mul_f32 v199, v199, v3
    v_mul_f32 v200, v200, v3
    v_mul_f32 v201, v201, v3
    v_mul_f32 v202, v202, v3
    v_mul_f32 v203, v203, v3
    v_mul_f32 v204, v204, v3
    v_mul_f32 v205, v205, v3
    v_mul_f32 v206, v206, v3
    v_mul_f32 v207, v207, v3
    v_mul_f32 v208, v208, v3
    v_mul_f32 v209, v209, v3
    v_mul_f32 v210, v210, v3
    v_mul_f32 v211, v211, v3
    v_mul_f32 v212, v212, v3
    v_mul_f32 v213, v213, v3
    v_mul_f32 v214, v214, v3
    v_mul_f32 v215, v215, v3
    v_mul_f32 v216, v216, v3
    v_mul_f32 v217, v217, v3
    v_mul_f32 v218, v218, v3
    v_mul_f32 v219, v219, v3
    v_mul_f32 v220, v220, v3
    v_mul_f32 v221, v221, v3
    v_mul_f32 v222, v222, v3
    v_mul_f32 v223, v223, v3
    v_sub_f32 v64, v64, v2
    v_sub_f32 v65, v65, v2
    v_sub_f32 v66, v66, v2
    v_sub_f32 v67, v67, v2
    v_sub_f32 v68, v68, v2
    v_sub_f32 v69, v69, v2
    v_sub_f32 v70, v70, v2
    v_sub_f32 v71, v71, v2
    v_exp_f32 v64, v64
    v_exp_f32 v65, v65
    v_exp_f32 v66, v66
    v_exp_f32 v67, v67
    v_exp_f32 v68, v68
    v_exp_f32 v69, v69
    v_exp_f32 v70, v70
    v_exp_f32 v71, v71
    v_cvt_pk_bf16_f32 v88, v64, v65
    v_cvt_pk_bf16_f32 v89, v66, v67
    v_cvt_pk_bf16_f32 v90, v68, v69
    v_cvt_pk_bf16_f32 v91, v70, v71
    s_nop 1
    v_mfma_f32_16x16x32_bf16 v[192:195], a[160:163], v[88:91], v[192:195]
    v_mfma_f32_16x16x32_bf16 v[196:199], a[164:167], v[88:91], v[196:199]
    v_mfma_f32_16x16x32_bf16 v[200:203], a[168:171], v[88:91], v[200:203]
    v_mfma_f32_16x16x32_bf16 v[204:207], a[172:175], v[88:91], v[204:207]
    v_mfma_f32_16x16x32_bf16 v[208:211], a[176:179], v[88:91], v[208:211]
    v_mfma_f32_16x16x32_bf16 v[212:215], a[180:183], v[88:91], v[212:215]
    v_mfma_f32_16x16x32_bf16 v[216:219], a[184:187], v[88:91], v[216:219]
    v_mfma_f32_16x16x32_bf16 v[220:223], a[188:191], v[88:91], v[220:223]
    v_mfma_f32_16x16x32_bf16 v[120:123], v[28:31], v[88:91], v[120:123]
    v_max3_f32 v2, v72, v73, v74
    v_max3_f32 v3, v75, v76, v77
    v_max3_f32 v2, v2, v78, v79
    v_max_f32 v2, v2, v3
    v_mov_b32 v3, v2
    s_nop 1
    v_permlane32_swap_b32 v2, v3
    v_max_f32 v2, v2, v3
    v_mov_b32 v3, v2
    s_nop 1
    v_permlane16_swap_b32 v2, v3
    v_max_f32 v2, v2, v3
    v_max_f32 v2, v2, v39
    v_sub_f32 v3, v39, v2
    v_exp_f32 v3, v3
    v_mov_b32 v39, v2
    v_mul_f32 v124, v124, v3
    v_mul_f32 v224, v224, v3
    v_mul_f32 v225, v225, v3
    v_mul_f32 v226, v226, v3
    v_mul_f32 v227, v227, v3
    v_mul_f32 v228, v228, v3
    v_mul_f32 v229, v229, v3
    v_mul_f32 v230, v230, v3
    v_mul_f32 v231, v231, v3
    v_mul_f32 v232, v232, v3
    v_mul_f32 v233, v233, v3
    v_mul_f32 v234, v234, v3
    v_mul_f32 v235, v235, v3
    v_mul_f32 v236, v236, v3
    v_mul_f32 v237, v237, v3
    v_mul_f32 v238, v238, v3
    v_mul_f32 v239, v239, v3
    v_mul_f32 v240, v240, v3
    v_mul_f32 v241, v241, v3
    v_mul_f32 v242, v242, v3
    v_mul_f32 v243, v243, v3
    v_mul_f32 v244, v244, v3
    v_mul_f32 v245, v245, v3
    v_mul_f32 v246, v246, v3
    v_mul_f32 v247, v247, v3
    v_mul_f32 v248, v248, v3
    v_mul_f32 v249, v249, v3
    v_mul_f32 v250, v250, v3
    v_mul_f32 v251, v251, v3
    v_mul_f32 v252, v252, v3
    v_mul_f32 v253, v253, v3
    v_mul_f32 v254, v254, v3
    v_mul_f32 v255, v255, v3
    v_sub_f32 v72, v72, v2
    v_sub_f32 v73, v73, v2
    v_sub_f32 v74, v74, v2
    v_sub_f32 v75, v75, v2
    v_sub_f32 v76, v76, v2
    v_sub_f32 v77, v77, v2
    v_sub_f32 v78, v78, v2
    v_sub_f32 v79, v79, v2
    v_exp_f32 v72, v72
    v_exp_f32 v73, v73
    v_exp_f32 v74, v74
    v_exp_f32 v75, v75
    v_exp_f32 v76, v76
    v_exp_f32 v77, v77
    v_exp_f32 v78, v78
    v_exp_f32 v79, v79
    v_cvt_pk_bf16_f32 v92, v72, v73
    v_cvt_pk_bf16_f32 v93, v74, v75
    v_cvt_pk_bf16_f32 v94, v76, v77
    v_cvt_pk_bf16_f32 v95, v78, v79
    s_nop 1
    v_mfma_f32_16x16x32_bf16 v[224:227], a[160:163], v[92:95], v[224:227]
    v_mfma_f32_16x16x32_bf16 v[228:231], a[164:167], v[92:95], v[228:231]
    v_mfma_f32_16x16x32_bf16 v[232:235], a[168:171], v[92:95], v[232:235]
    v_mfma_f32_16x16x32_bf16 v[236:239], a[172:175], v[92:95], v[236:239]
    v_mfma_f32_16x16x32_bf16 v[240:243], a[176:179], v[92:95], v[240:243]
    v_mfma_f32_16x16x32_bf16 v[244:247], a[180:183], v[92:95], v[244:247]
    v_mfma_f32_16x16x32_bf16 v[248:251], a[184:187], v[92:95], v[248:251]
    v_mfma_f32_16x16x32_bf16 v[252:255], a[188:191], v[92:95], v[252:255]
    v_mfma_f32_16x16x32_bf16 v[124:127], v[28:31], v[92:95], v[124:127]
    s_add_u32 s64, s64, 0x4000
    s_cmp_lt_u32 s64, 0x40000
    s_cbranch_scc1 L_slow_loop
    v_rcp_f32 v40, v112
    s_nop 0
    v_pk_mul_f32 v[128:129], v[128:129], v[40:41] op_sel:[0,0] op_sel_hi:[1,0]
    v_pk_mul_f32 v[130:131], v[130:131], v[40:41] op_sel:[0,0] op_sel_hi:[1,0]
    v_cvt_pk_bf16_f32 v128, v128, v129
    v_cvt_pk_bf16_f32 v129, v130, v131
    v_pk_mul_f32 v[132:133], v[132:133], v[40:41] op_sel:[0,0] op_sel_hi:[1,0]
    v_pk_mul_f32 v[134:135], v[134:135], v[40:41] op_sel:[0,0] op_sel_hi:[1,0]
    v_cvt_pk_bf16_f32 v130, v132, v133
    v_cvt_pk_bf16_f32 v131, v134, v135
    buffer_store_dwordx4 v[128:131], v47, s[20:23], s56 offen sc1
    v_pk_mul_f32 v[136:137], v[136:137], v[40:41] op_sel:[0,0] op_sel_hi:[1,0]
    v_pk_mul_f32 v[138:139], v[138:139], v[40:41] op_sel:[0,0] op_sel_hi:[1,0]
    v_cvt_pk_bf16_f32 v136, v136, v137
    v_cvt_pk_bf16_f32 v137, v138, v139
    v_pk_mul_f32 v[140:141], v[140:141], v[40:41] op_sel:[0,0] op_sel_hi:[1,0]
    v_pk_mul_f32 v[142:143], v[142:143], v[40:41] op_sel:[0,0] op_sel_hi:[1,0]
    v_cvt_pk_bf16_f32 v138, v140, v141
    v_cvt_pk_bf16_f32 v139, v142, v143
    buffer_store_dwordx4 v[136:139], v47, s[20:23], s56 offen offset:1024 sc1
    v_pk_mul_f32 v[144:145], v[144:145], v[40:41] op_sel:[0,0] op_sel_hi:[1,0]
    v_pk_mul_f32 v[146:147], v[146:147], v[40:41] op_sel:[0,0] op_sel_hi:[1,0]
    v_cvt_pk_bf16_f32 v144, v144, v145
    v_cvt_pk_bf16_f32 v145, v146, v147
    v_pk_mul_f32 v[148:149], v[148:149], v[40:41] op_sel:[0,0] op_sel_hi:[1,0]
    v_pk_mul_f32 v[150:151], v[150:151], v[40:41] op_sel:[0,0] op_sel_hi:[1,0]
    v_cvt_pk_bf16_f32 v146, v148, v149
    v_cvt_pk_bf16_f32 v147, v150, v151
    buffer_store_dwordx4 v[144:147], v47, s[20:23], s56 offen offset:2048 sc1
    v_pk_mul_f32 v[152:153], v[152:153], v[40:41] op_sel:[0,0] op_sel_hi:[1,0]
    v_pk_mul_f32 v[154:155], v[154:155], v[40:41] op_sel:[0,0] op_sel_hi:[1,0]
    v_cvt_pk_bf16_f32 v152, v152, v153
    v_cvt_pk_bf16_f32 v153, v154, v155
    v_pk_mul_f32 v[156:157], v[156:157], v[40:41] op_sel:[0,0] op_sel_hi:[1,0]
    v_pk_mul_f32 v[158:159], v[158:159], v[40:41] op_sel:[0,0] op_sel_hi:[1,0]
    v_cvt_pk_bf16_f32 v154, v156, v157
    v_cvt_pk_bf16_f32 v155, v158, v159
    buffer_store_dwordx4 v[152:155], v47, s[20:23], s56 offen offset:3072 sc1
    s_add_u32 m0, s53, 0x20000
    s_mov_b32 s65, 0
    buffer_load_dwordx4 v32, s[24:27], s65 offen lds
    buffer_load_dwordx4 v33, s[24:27], s65 offen offset:1024 lds
    buffer_load_dwordx4 v34, s[24:27], s65 offen offset:2048 lds
    buffer_load_dwordx4 v35, s[24:27], s65 offen offset:3072 lds
    s_add_u32 m0, s53, 0x24000
    s_mov_b32 s65, 0xa000
    buffer_load_dwordx4 v32, s[24:27], s65 offen lds
    buffer_load_dwordx4 v33, s[24:27], s65 offen offset:1024 lds
    buffer_load_dwordx4 v34, s[24:27], s65 offen offset:2048 lds
    buffer_load_dwordx4 v35, s[24:27], s65 offen offset:3072 lds
    s_add_u32 m0, s53, 0
    s_mov_b32 s65, 0x14000
    buffer_load_dwordx4 v32, s[24:27], s65 offen lds
    buffer_load_dwordx4 v33, s[24:27], s65 offen offset:1024 lds
    buffer_load_dwordx4 v34, s[24:27], s65 offen offset:2048 lds
    buffer_load_dwordx4 v35, s[24:27], s65 offen offset:3072 lds
    s_add_u32 m0, s53, 0x18000
    s_mov_b32 s65, 0x1e000
    buffer_load_dwordx4 v32, s[24:27], s65 offen lds
    buffer_load_dwordx4 v33, s[24:27], s65 offen offset:1024 lds
    buffer_load_dwordx4 v34, s[24:27], s65 offen offset:2048 lds
    buffer_load_dwordx4 v35, s[24:27], s65 offen offset:3072 lds
    s_add_u32 m0, s53, 0x4000
    s_mov_b32 s65, 0x28000
    buffer_load_dwordx4 v32, s[24:27], s65 offen lds
    buffer_load_dwordx4 v33, s[24:27], s65 offen offset:1024 lds
    buffer_load_dwordx4 v34, s[24:27], s65 offen offset:2048 lds
    buffer_load_dwordx4 v35, s[24:27], s65 offen offset:3072 lds
    s_add_u32 m0, s53, 0x10000
    s_mov_b32 s65, 0x32000
    buffer_load_dwordx4 v32, s[24:27], s65 offen lds
    buffer_load_dwordx4 v33, s[24:27], s65 offen offset:1024 lds
    buffer_load_dwordx4 v34, s[24:27], s65 offen offset:2048 lds
    buffer_load_dwordx4 v35, s[24:27], s65 offen offset:3072 lds
    s_add_u32 m0, s53, 0x8000
    s_mov_b32 s65, 0x3c000
    buffer_load_dwordx4 v32, s[24:27], s65 offen lds
    buffer_load_dwordx4 v33, s[24:27], s65 offen offset:1024 lds
    buffer_load_dwordx4 v34, s[24:27], s65 offen offset:2048 lds
    buffer_load_dwordx4 v35, s[24:27], s65 offen offset:3072 lds
    s_waitcnt vmcnt(0) lgkmcnt(0)
    s_barrier
    s_nop 15
    s_branch L_norm
L_codeend:
.section .rodata,"a"
.p2align 6
.amdhsa_kernel standalone__mha_block_cached__near_ridge_kernel
  .amdhsa_next_free_vgpr 512
  .amdhsa_next_free_sgpr 102
  .amdhsa_accum_offset 256
  .amdhsa_group_segment_fixed_size 0
  .amdhsa_kernarg_size 64
  .amdhsa_user_sgpr_count 2
  .amdhsa_user_sgpr_kernarg_segment_ptr 1
  .amdhsa_system_sgpr_workgroup_id_x 1
.end_amdhsa_kernel
```
